```python
import torch

def _softmax(x, axis=-1):
    return torch.softmax(x, dim=axis)
def _gelu(x):
    return torch.nn.functional.gelu(x, approximate="tanh")
def _silu(x):
    return torch.nn.functional.silu(x)
def _sigmoid(x):
    return torch.sigmoid(x)
def _layernorm(x, axis=-1, eps=1e-5):
    m = x.mean(dim=axis, keepdim=True)
    v = x.var(dim=axis, keepdim=True, unbiased=False)
    return (x - m) / torch.sqrt(v + eps)
def _scatter_add(tgt, idx, src, axis=0):
    return tgt.clone().index_add_(axis, idx, src)
def _segment_sum(src, seg, n):
    out = torch.zeros((n,) + src.shape[1:], dtype=src.dtype)
    return out.index_add_(0, seg, src)
def _pad(x, pw):
    flat = tuple(v for pair in reversed(pw) for v in pair)
    return torch.nn.functional.pad(x, flat)

kernel_name = 'recurrent_scan__compressed_kv_cla__mixer_s_mlp__prompt'

def setup_inputs():

    _w = (lambda a: (lambda t: t.to(torch.bfloat16) if t.is_floating_point() else t)(torch.as_tensor(a)))
    def _A_setup():
        B, H, Sq, Sk, D, M = 1, 32, 2048, 2048, 128, 640
        Dc = 4 * D
        return {
            "x": _w((lambda *s: torch.randn(*s, dtype=torch.bfloat16) * 0.05)(B, Sq, M)),
            "c_kv": _w((lambda *s: torch.randn(*s, dtype=torch.bfloat16) * 0.2)(B, Sk, Dc)),
            "w_q": _w((lambda *s: torch.randn(*s, dtype=torch.bfloat16) * 3.2)(M, H, D) * (M ** -0.5)),
            "w_uk": _w((lambda *s: torch.randn(*s, dtype=torch.bfloat16) * 3.2)(Dc, H, D) * (Dc ** -0.5)),
            "w_uv": _w((lambda *s: torch.randn(*s, dtype=torch.bfloat16) * 0.2)(Dc, H, D) * (Dc ** -0.5)),
            "w_o": _w((lambda *s: torch.randn(*s, dtype=torch.bfloat16) * 0.2)(H, D, M) * ((H * D) ** -0.5)),
        }
    _A_in = _A_setup()

    def _B_setup():
        B, S, D, F = 1, 2048, 640, 1728
        return {
            "x":  _w((lambda *s: torch.randn(*s, dtype=torch.bfloat16) * 0.05)(B, S, D)),
            "w1": _w((lambda *s: torch.randn(*s, dtype=torch.bfloat16) * 3.2)(D, D) * (D ** -0.5)),
            "w2": _w((lambda *s: torch.randn(*s, dtype=torch.bfloat16) * 3.2)(D, D) * (D ** -0.5)),
            "w3": _w((lambda *s: torch.randn(*s, dtype=torch.bfloat16) * 3.2)(D, F) * (D ** -0.5)),
            "w4": _w((lambda *s: torch.randn(*s, dtype=torch.bfloat16) * 1.6)(F, D) * (F ** -0.5)),
        }
    _B_in = _B_setup()

    return {
        "A_x": _A_in["x"],
        "A_c_kv": _A_in["c_kv"],
        "A_w_q": _A_in["w_q"],
        "A_w_uk": _A_in["w_uk"],
        "A_w_uv": _A_in["w_uv"],
        "A_w_o": _A_in["w_o"],
        "B_x": _B_in["x"],
        "B_w1": _B_in["w1"],
        "B_w2": _B_in["w2"],
        "B_w3": _B_in["w3"],
        "B_w4": _B_in["w4"],
    }

def reference(A_x, A_c_kv, A_w_q, A_w_uk, A_w_uv, A_w_o, B_x, B_w1, B_w2, B_w3, B_w4):
    def _A_ref(x, c_kv, w_q, w_uk, w_uv, w_o):
        B, Sq, M = x.shape[0], x.shape[1], x.shape[2]
        Sk = c_kv.shape[1]
        H, D = w_q.shape[1], w_q.shape[2]
        q = torch.einsum("bqm,mhd->bhqd", x, w_q)
        k = torch.einsum("bkc,chd->bhkd", c_kv, w_uk)
        v = torch.einsum("bkc,chd->bhkd", c_kv, w_uv)
        scores = torch.einsum("bhqd,bhkd->bhqk", q, k) * (D ** -0.5)
        off = Sk - Sq
        qi = torch.arange(Sq)[:, None]
        kj = torch.arange(Sk)[None, :]
        cmask = kj <= (qi + off)
        scores = torch.where(cmask[None, None], scores, -1e9)
        p = _softmax(scores, axis=-1)
        ctx = torch.einsum("bhqk,bhkd->bhqd", p, v)
        return torch.einsum("bhqd,hdm->bqm", ctx, w_o)

    def _B_ref(x, w1, w2, w3, w4):
        B, S, D = x.shape
        h = _gelu(_layernorm(x, axis=-1) @ w1)
        c = D // 4
        g0 = _pad(h[:, :, 0*c:1*c], ((0, 0), (1, 0), (0, 0)))[:, :S, :]
        g1 = _pad(h[:, :, 1*c:2*c], ((0, 0), (0, 1), (0, 0)))[:, 1:, :]
        g2 = _pad(h[:, :, 2*c:3*c], ((0, 0), (2, 0), (0, 0)))[:, :S, :]
        g3 = _pad(h[:, :, 3*c:   ], ((0, 0), (0, 2), (0, 0)))[:, 2:, :]
        hs = torch.concatenate([g0, g1, g2, g3], axis=-1) @ w2
        x1 = x + hs
        h2 = _gelu(_layernorm(x1, axis=-1) @ w3) @ w4
        return x1 + h2

    x = A_x
    xn = _layernorm(x, axis=-1)
    s = _A_ref(xn, A_c_kv, A_w_q, A_w_uk, A_w_uv, A_w_o)
    g = _silu(_B_ref(xn, B_w1, B_w2, B_w3, B_w4))
    return x + s * g
```

```asm
; @launch kernel=l1_kernel grid=(256,1,1) block=(512,1,1) lds=163840
; @launch kernel=l2_kernel grid=(256,1,1) block=(512,1,1) lds=163840
; @launch kernel=l3_kernel grid=(256,1,1) block=(512,1,1) lds=163840
.amdgcn_target "amdgcn-amd-amdhsa--gfx950"
.text
.globl l1_kernel
.p2align 8
.type l1_kernel,@function
l1_kernel:
s_load_dwordx2 s[20:21], s[0:1], 0
s_load_dwordx2 s[4:5], s[0:1], 8
s_load_dwordx2 s[8:9], s[0:1], 104
s_load_dwordx2 s[12:13], s[0:1], 24
s_load_dwordx2 s[16:17], s[0:1], 32
s_load_dwordx2 s[36:37], s[0:1], 96
s_load_dwordx2 s[40:41], s[0:1], 56
s_load_dwordx2 s[44:45], s[0:1], 40
s_load_dwordx2 s[48:49], s[0:1], 80
s_load_dwordx2 s[52:53], s[0:1], 72
s_mov_b32 s22, 0x280000
s_mov_b32 s23, 0x00020000
s_mov_b32 s6, 0x200000
s_mov_b32 s7, 0x00020000
s_mov_b32 s10, 0x10000000
s_mov_b32 s11, 0x00020000
s_mov_b32 s14, 0x400000
s_mov_b32 s15, 0x00020000
s_mov_b32 s18, 0x400000
s_mov_b32 s19, 0x00020000
s_mov_b32 s38, 0x100
s_mov_b32 s39, 0x00020000
s_mov_b32 s42, 0xc8000
s_mov_b32 s43, 0x00020000
s_mov_b32 s46, 0x500000
s_mov_b32 s47, 0x00020000
s_mov_b32 s50, 0x21c000
s_mov_b32 s51, 0x00020000
s_mov_b32 s54, 0x21c000
s_mov_b32 s55, 0x00020000
s_load_dwordx2 s[96:97], s[0:1], 16
s_load_dwordx2 s[98:99], s[0:1], 64
v_lshrrev_b32 v6, 6, v0
v_and_b32 v7, 63, v0
v_readfirstlane_b32 s24, v6
s_cmp_ge_u32 s2, 256
s_cbranch_scc1 Ll1_end
v_and_b32 v56, 7, v7
v_bfe_u32 v57, v7, 3, 2
v_lshrrev_b32 v58, 5, v7
v_mul_u32_u24 v59, 1280, v56
v_lshl_add_u32 v59, v57, 5, v59
v_lshl_add_u32 v59, v58, 4, v59
s_mul_i32 s27, s2, 10240
s_lshl_b32 s28, s24, 8
s_add_u32 s27, s27, s28
s_cmp_lt_u32 s24, 5
s_cselect_b64 s[56:57], -1, 0
s_and_b32 s25, s2, 7
s_lshl_b32 s25, s25, 2
s_bfe_u32 s28, s2, 0x20003
s_add_u32 s25, s25, s28
s_lshr_b32 s26, s2, 5
v_lshrrev_b32 v6, 3, v7
v_and_b32 v5, 7, v7
v_lshrrev_b32 v4, 1, v6
v_xor_b32 v5, v5, v4
v_lshlrev_b32 v6, 10, v6
v_lshl_add_u32 v96, v5, 4, v6
v_xor_b32 v97, 64, v96
v_lshrrev_b32 v108, 3, v7
v_lshlrev_b32 v108, 7, v108
v_lshl_add_u32 v108, v56, 10, v108
s_lshl_b32 s28, s28, 13
v_add_u32 v108, s28, v108
v_lshrrev_b32 v109, 2, v7
v_lshlrev_b32 v109, 20, v109
v_bfe_u32 v110, v7, 1, 1
v_lshl_add_u32 v109, v110, 13, v109
v_and_b32 v110, 1, v7
v_lshl_add_u32 v109, v110, 7, v109
s_lshl_b32 s60, s26, 3
s_add_u32 s60, s60, s24
s_lshl_b32 s60, s60, 14
s_lshl_b32 s28, s25, 8
s_add_u32 s60, s60, s28
s_lshl_b32 s28, s26, 18
s_lshl_b32 s29, s24, 15
s_add_u32 s28, s28, s29
s_lshl_b32 s29, s24, 12
s_waitcnt lgkmcnt(0)
s_mov_b64 exec, s[56:57]
buffer_load_dwordx4 v[32:35], v59, s[20:23], s27 offen
buffer_load_dwordx4 v[36:39], v59, s[20:23], s27 offen offset:128
s_mov_b32 exec_lo, 0xffff
s_mov_b32 exec_hi, 0x0
buffer_load_dword v110, v108, s[4:7], s28 offen
s_mov_b64 exec, -1
s_mov_b32 exec_lo, 0xf
s_mov_b32 exec_hi, 0x0
buffer_load_dword v110, v109, s[12:15], s60 offen
s_mov_b64 exec, -1
s_barrier
s_add_u32 m0, s29, 98304
s_add_u32 s33, s28, 0
buffer_load_dwordx4 v96, s[4:7], s33 offen lds
s_add_u32 m0, s29, 99328
s_add_u32 s33, s28, 8192
buffer_load_dwordx4 v97, s[4:7], s33 offen lds
s_add_u32 m0, s29, 100352
s_add_u32 s33, s28, 16384
buffer_load_dwordx4 v96, s[4:7], s33 offen lds
s_add_u32 m0, s29, 101376
s_add_u32 s33, s28, 24576
buffer_load_dwordx4 v97, s[4:7], s33 offen lds
v_bfe_u32 v4, v7, 2, 2
v_and_b32 v5, 3, v7
v_lshlrev_b32 v6, 13, v4
v_lshl_add_u32 v6, v5, 4, v6
v_lshrrev_b32 v3, 4, v7
v_lshl_add_u32 v1, v3, 6, v6
v_bfe_u32 v3, v7, 4, 1
v_lshl_add_u32 v2, v3, 6, v6
v_lshrrev_b32 v6, 5, v7
v_lshl_add_u32 v2, v6, 20, v2
s_lshl_b32 s30, s24, 17
s_lshl_b32 s27, s25, 8
s_add_u32 s30, s30, s27
s_add_u32 m0, s29, 65536
s_add_u32 s33, s30, 0
buffer_load_dwordx4 v1, s[12:15], s33 offen lds
s_add_u32 m0, s29, 66560
s_add_u32 s33, s30, 32768
buffer_load_dwordx4 v1, s[12:15], s33 offen lds
s_add_u32 m0, s29, 67584
s_add_u32 s33, s30, 65536
buffer_load_dwordx4 v1, s[12:15], s33 offen lds
s_add_u32 m0, s29, 68608
s_add_u32 s33, s30, 98304
buffer_load_dwordx4 v1, s[12:15], s33 offen lds
s_barrier
s_add_u32 m0, s29, 0
s_add_u32 s33, s28, 128
buffer_load_dwordx4 v96, s[4:7], s33 offen lds
s_add_u32 m0, s29, 1024
s_add_u32 s33, s28, 8320
buffer_load_dwordx4 v97, s[4:7], s33 offen lds
s_add_u32 m0, s29, 2048
s_add_u32 s33, s28, 16512
buffer_load_dwordx4 v96, s[4:7], s33 offen lds
s_add_u32 m0, s29, 3072
s_add_u32 s33, s28, 24704
buffer_load_dwordx4 v97, s[4:7], s33 offen lds
v_lshlrev_b32 v3, 5, v3
v_lshl_add_u32 v3, v6, 11, v3
v_lshl_add_u32 v3, v4, 6, v3
v_lshl_add_u32 v3, v5, 3, v3
v_and_b32 v4, 31, v7
v_bfe_u32 v5, v7, 1, 3
v_xor_b32 v5, v5, v6
v_lshlrev_b32 v5, 4, v5
v_lshl_add_u32 v5, v4, 7, v5
v_add_u32 v5, s29, v5
v_xor_b32 v98, 0, v5
v_add_u32 v102, 0x18000, v98
v_xor_b32 v99, 32, v5
v_add_u32 v103, 0x18000, v99
v_xor_b32 v100, 64, v5
v_add_u32 v104, 0x18000, v100
v_xor_b32 v101, 96, v5
v_add_u32 v105, 0x18000, v101
v_add_u32 v4, 0x10000, v3
v_add_u32 v5, 0x20000, v3
v_lshlrev_b32 v0, 4, v7
s_lshl_b32 s34, s25, 20
s_lshl_b32 s27, s26, 17
s_add_u32 s34, s34, s27
s_lshr_b32 s27, s24, 1
s_lshl_b32 s27, s27, 15
s_add_u32 s34, s34, s27
s_and_b32 s27, s24, 1
s_lshl_b32 s35, s27, 11
s_add_u32 s35, s35, s34
s_add_u32 s35, s35, 16384
s_lshl_b32 s27, s27, 13
s_add_u32 s34, s34, s27
v_lshrrev_b32 v60, 3, v7
v_lshlrev_b32 v60, 12, v60
v_lshl_add_u32 v60, v56, 6, v60
s_lshl_b32 s27, s24, 3
s_add_u32 s27, s27, 0x20000
v_add_u32 v60, s27, v60
s_add_u32 s27, s29, 0x20000
v_lshlrev_b32 v61, 6, v56
v_add_u32 v61, s27, v61
v_lshlrev_b32 v62, 10, v57
v_lshl_add_u32 v62, v58, 9, v62
v_lshl_add_u32 v62, v56, 4, v62
s_and_b32 s27, s2, 3
s_lshl_b32 s27, s27, 7
v_add_u32 v62, s27, v62
s_lshr_b32 s27, s2, 2
s_mul_i32 s27, s27, 40960
s_lshl_b32 s31, s24, 13
s_add_u32 s27, s27, s31
s_mov_b32 s58, 0x3f803f80
v_mov_b32 v63, 0xffff0000
s_waitcnt vmcnt(14)
s_mov_b32 exec_lo, 0xffff0000
s_mov_b32 exec_hi, 0x0
buffer_load_dword v110, v108, s[4:7], s28 offen
s_mov_b64 exec, -1
s_mov_b32 exec_lo, 0xf0
s_mov_b32 exec_hi, 0x0
buffer_load_dword v110, v109, s[12:15], s60 offen
s_mov_b64 exec, -1
s_mov_b64 exec, s[56:57]
v_dot2_f32_bf16 v64, v32, s58, 0
v_dot2_f32_bf16 v65, v32, v32, 0
v_dot2_f32_bf16 v64, v33, s58, v64
v_dot2_f32_bf16 v65, v33, v33, v65
v_dot2_f32_bf16 v64, v34, s58, v64
v_dot2_f32_bf16 v65, v34, v34, v65
v_dot2_f32_bf16 v64, v35, s58, v64
v_dot2_f32_bf16 v65, v35, v35, v65
v_dot2_f32_bf16 v64, v36, s58, v64
v_dot2_f32_bf16 v65, v36, v36, v65
v_dot2_f32_bf16 v64, v37, s58, v64
v_dot2_f32_bf16 v65, v37, v37, v65
v_dot2_f32_bf16 v64, v38, s58, v64
v_dot2_f32_bf16 v65, v38, v38, v65
v_dot2_f32_bf16 v64, v39, s58, v64
v_dot2_f32_bf16 v65, v39, v39, v65
v_lshlrev_b32 v40, 16, v32
v_and_b32 v41, v63, v32
v_lshlrev_b32 v42, 16, v33
v_and_b32 v43, v63, v33
v_lshlrev_b32 v44, 16, v34
v_and_b32 v45, v63, v34
v_lshlrev_b32 v46, 16, v35
v_and_b32 v47, v63, v35
v_add_f32_dpp v64, v64, v64 row_ror:8 row_mask:0xf bank_mask:0xf
v_add_f32_dpp v65, v65, v65 row_ror:8 row_mask:0xf bank_mask:0xf
v_mov_b32 v66, v64
v_mov_b32 v67, v65
s_nop 0
v_permlane16_swap_b32 v66, v64
v_permlane16_swap_b32 v67, v65
v_add_f32 v64, v64, v66
v_add_f32 v65, v65, v67
v_mov_b32 v66, v64
v_mov_b32 v67, v65
s_nop 0
v_permlane32_swap_b32 v66, v64
v_permlane32_swap_b32 v67, v65
v_add_f32 v64, v64, v66
v_add_f32 v65, v65, v67
ds_write_b64 v60, v[64:65] offset:0
v_lshlrev_b32 v48, 16, v36
v_and_b32 v49, v63, v36
v_lshlrev_b32 v50, 16, v37
v_and_b32 v51, v63, v37
v_lshlrev_b32 v52, 16, v38
v_and_b32 v53, v63, v38
v_lshlrev_b32 v54, 16, v39
v_and_b32 v55, v63, v39
s_waitcnt lgkmcnt(0)
s_barrier
ds_read_b128 v[68:71], v61 offset:0
ds_read_b128 v[72:75], v61 offset:16
ds_read_b64 v[76:77], v61 offset:32
s_waitcnt lgkmcnt(0)
v_add_f32 v68, v68, v70
v_add_f32 v72, v72, v74
v_add_f32 v69, v69, v71
v_add_f32 v73, v73, v75
v_add_f32 v68, v68, v72
v_add_f32 v68, v68, v76
v_add_f32 v69, v69, v73
v_add_f32 v69, v69, v77
v_mul_f32 v68, 0x3acccccd, v68
v_mul_f32 v69, 0x3acccccd, v69
v_fma_f32 v69, -v68, v68, v69
v_max_f32 v69, 0, v69
v_add_f32 v70, 0x3727c5ac, v69
v_rcp_f32 v71, v70
v_rsq_f32 v70, v70
v_lshlrev_b32 v72, 2, v56
v_fmaak_f32 v71, v71, v69, 0x3727c5ac
v_mov_b32 v69, v70
v_rsq_f32 v71, v71
v_mul_f32 v68, v68, v69
v_fma_f32 v40, v40, v69, -v68
v_fma_f32 v41, v41, v69, -v68
v_fma_f32 v42, v42, v69, -v68
v_fma_f32 v43, v43, v69, -v68
v_fma_f32 v44, v44, v69, -v68
v_fma_f32 v45, v45, v69, -v68
v_fma_f32 v46, v46, v69, -v68
v_fma_f32 v47, v47, v69, -v68
v_fma_f32 v48, v48, v69, -v68
v_fma_f32 v49, v49, v69, -v68
v_fma_f32 v50, v50, v69, -v68
v_fma_f32 v51, v51, v69, -v68
v_fma_f32 v52, v52, v69, -v68
v_fma_f32 v53, v53, v69, -v68
v_fma_f32 v54, v54, v69, -v68
v_fma_f32 v55, v55, v69, -v68
v_cvt_pk_bf16_f32 v80, v40, v41
v_cvt_pk_bf16_f32 v81, v42, v43
v_cvt_pk_bf16_f32 v82, v44, v45
v_cvt_pk_bf16_f32 v83, v46, v47
v_cvt_pk_bf16_f32 v84, v48, v49
v_cvt_pk_bf16_f32 v85, v50, v51
v_cvt_pk_bf16_f32 v86, v52, v53
v_cvt_pk_bf16_f32 v87, v54, v55
v_permlane32_swap_b32 v80, v82
v_permlane32_swap_b32 v81, v83
v_permlane32_swap_b32 v84, v86
v_permlane32_swap_b32 v85, v87
s_add_u32 s31, s27, 34603008
buffer_store_dwordx4 v[80:83], v62, s[8:11], s31 offen sc1
s_add_u32 s31, s27, 34607104
buffer_store_dwordx4 v[84:87], v62, s[8:11], s31 offen sc1
s_cmp_eq_u32 s24, 0
s_cselect_b32 exec_lo, 0xff, 0
s_mov_b32 exec_hi, 0
s_lshl_b32 s31, s2, 5
s_add_u32 s31, s31, 37748736
buffer_store_dword v71, v72, s[8:11], s31 offen sc1
s_mov_b64 exec, -1
s_waitcnt vmcnt(13)
ds_read_b128 a[0:3], v102 offset:0
ds_read_b128 a[4:7], v103 offset:0
ds_read_b128 a[8:11], v104 offset:0
ds_read_b128 a[12:15], v105 offset:0
s_waitcnt vmcnt(5)
ds_read_b128 a[16:19], v98 offset:0
ds_read_b128 a[20:23], v99 offset:0
ds_read_b128 a[24:27], v100 offset:0
ds_read_b128 a[28:31], v101 offset:0
s_barrier
ds_read_b64_tr_b16 v[8:9], v4 offset:0
ds_read_b64_tr_b16 v[10:11], v4 offset:1024
ds_read_b64_tr_b16 v[12:13], v4 offset:256
ds_read_b64_tr_b16 v[14:15], v4 offset:1280
ds_read_b64_tr_b16 v[16:17], v4 offset:512
ds_read_b64_tr_b16 v[18:19], v4 offset:1536
ds_read_b64_tr_b16 v[20:21], v4 offset:768
ds_read_b64_tr_b16 v[22:23], v4 offset:1792
ds_read_b64_tr_b16 v[24:25], v4 offset:4096
ds_read_b64_tr_b16 v[26:27], v4 offset:5120
s_mov_b32 exec_lo, 0x0
s_mov_b32 exec_hi, 0xffff
buffer_load_dword v110, v108, s[4:7], s28 offen
s_mov_b64 exec, -1
s_mov_b32 exec_lo, 0xf00
s_mov_b32 exec_hi, 0x0
buffer_load_dword v110, v109, s[12:15], s60 offen
s_mov_b64 exec, -1
s_add_u32 m0, s29, 32768
s_add_u32 s33, s28, 256
buffer_load_dwordx4 v96, s[4:7], s33 offen lds
ds_read_b64_tr_b16 v[28:29], v4 offset:4352
ds_read_b64_tr_b16 v[30:31], v4 offset:5376
s_waitcnt lgkmcnt(10)
v_mfma_f32_32x32x16_bf16 v[32:47], v[8:11], a[0:3], 0
s_add_u32 m0, s29, 33792
s_add_u32 s33, s28, 8448
buffer_load_dwordx4 v97, s[4:7], s33 offen lds
ds_read_b64_tr_b16 v[8:9], v4 offset:4608
ds_read_b64_tr_b16 v[10:11], v4 offset:5632
s_waitcnt lgkmcnt(10)
v_mfma_f32_32x32x16_bf16 v[48:63], v[12:15], a[0:3], 0
s_add_u32 m0, s29, 34816
s_add_u32 s33, s28, 16640
buffer_load_dwordx4 v96, s[4:7], s33 offen lds
ds_read_b64_tr_b16 v[12:13], v4 offset:4864
ds_read_b64_tr_b16 v[14:15], v4 offset:5888
s_waitcnt lgkmcnt(10)
v_mfma_f32_32x32x16_bf16 v[64:79], v[16:19], a[0:3], 0
s_add_u32 m0, s29, 35840
s_add_u32 s33, s28, 24832
buffer_load_dwordx4 v97, s[4:7], s33 offen lds
ds_read_b64_tr_b16 v[16:17], v4 offset:8192
ds_read_b64_tr_b16 v[18:19], v4 offset:9216
s_waitcnt lgkmcnt(10)
v_mfma_f32_32x32x16_bf16 v[80:95], v[20:23], a[0:3], 0
s_add_u32 m0, s29, 98304
s_add_u32 s33, s30, 1048576
buffer_load_dwordx4 v1, s[12:15], s33 offen lds
ds_read_b64_tr_b16 v[20:21], v4 offset:8448
ds_read_b64_tr_b16 v[22:23], v4 offset:9472
s_waitcnt lgkmcnt(10)
v_mfma_f32_32x32x16_bf16 v[32:47], v[24:27], a[4:7], v[32:47]
s_add_u32 m0, s29, 99328
s_add_u32 s33, s30, 1081344
buffer_load_dwordx4 v1, s[12:15], s33 offen lds
ds_read_b64_tr_b16 v[24:25], v4 offset:8704
ds_read_b64_tr_b16 v[26:27], v4 offset:9728
s_waitcnt lgkmcnt(10)
v_mfma_f32_32x32x16_bf16 v[48:63], v[28:31], a[4:7], v[48:63]
s_add_u32 m0, s29, 100352
s_add_u32 s33, s30, 1114112
buffer_load_dwordx4 v1, s[12:15], s33 offen lds
ds_read_b64_tr_b16 v[28:29], v4 offset:8960
ds_read_b64_tr_b16 v[30:31], v4 offset:9984
s_waitcnt lgkmcnt(10)
v_mfma_f32_32x32x16_bf16 v[64:79], v[8:11], a[4:7], v[64:79]
s_add_u32 m0, s29, 101376
s_add_u32 s33, s30, 1146880
buffer_load_dwordx4 v1, s[12:15], s33 offen lds
ds_read_b64_tr_b16 v[8:9], v4 offset:12288
ds_read_b64_tr_b16 v[10:11], v4 offset:13312
s_waitcnt lgkmcnt(10)
v_mfma_f32_32x32x16_bf16 v[80:95], v[12:15], a[4:7], v[80:95]
s_add_u32 m0, s29, 131072
s_add_u32 s33, s28, 384
buffer_load_dwordx4 v96, s[4:7], s33 offen lds
ds_read_b64_tr_b16 v[12:13], v4 offset:12544
ds_read_b64_tr_b16 v[14:15], v4 offset:13568
s_waitcnt lgkmcnt(10)
v_mfma_f32_32x32x16_bf16 v[32:47], v[16:19], a[8:11], v[32:47]
s_add_u32 m0, s29, 132096
s_add_u32 s33, s28, 8576
buffer_load_dwordx4 v97, s[4:7], s33 offen lds
ds_read_b64_tr_b16 v[16:17], v4 offset:12800
ds_read_b64_tr_b16 v[18:19], v4 offset:13824
s_waitcnt lgkmcnt(10)
v_mfma_f32_32x32x16_bf16 v[48:63], v[20:23], a[8:11], v[48:63]
s_add_u32 m0, s29, 133120
s_add_u32 s33, s28, 16768
buffer_load_dwordx4 v96, s[4:7], s33 offen lds
ds_read_b64_tr_b16 v[20:21], v4 offset:13056
ds_read_b64_tr_b16 v[22:23], v4 offset:14080
s_waitcnt lgkmcnt(10)
v_mfma_f32_32x32x16_bf16 v[64:79], v[24:27], a[8:11], v[64:79]
s_add_u32 m0, s29, 134144
s_add_u32 s33, s28, 24960
buffer_load_dwordx4 v97, s[4:7], s33 offen lds
ds_read_b64_tr_b16 v[24:25], v4 offset:16384
ds_read_b64_tr_b16 v[26:27], v4 offset:17408
s_waitcnt lgkmcnt(10)
v_mfma_f32_32x32x16_bf16 v[80:95], v[28:31], a[8:11], v[80:95]
s_add_u32 m0, s29, 0
s_add_u32 s33, s28, 512
buffer_load_dwordx4 v96, s[4:7], s33 offen lds
ds_read_b64_tr_b16 v[28:29], v4 offset:16640
ds_read_b64_tr_b16 v[30:31], v4 offset:17664
s_waitcnt lgkmcnt(10)
v_mfma_f32_32x32x16_bf16 v[32:47], v[8:11], a[12:15], v[32:47]
s_add_u32 m0, s29, 1024
s_add_u32 s33, s28, 8704
buffer_load_dwordx4 v97, s[4:7], s33 offen lds
ds_read_b64_tr_b16 v[8:9], v4 offset:16896
ds_read_b64_tr_b16 v[10:11], v4 offset:17920
s_waitcnt lgkmcnt(10)
v_mfma_f32_32x32x16_bf16 v[48:63], v[12:15], a[12:15], v[48:63]
s_add_u32 m0, s29, 2048
s_add_u32 s33, s28, 16896
buffer_load_dwordx4 v96, s[4:7], s33 offen lds
ds_read_b64_tr_b16 v[12:13], v4 offset:17152
ds_read_b64_tr_b16 v[14:15], v4 offset:18176
s_waitcnt lgkmcnt(10)
v_mfma_f32_32x32x16_bf16 v[64:79], v[16:19], a[12:15], v[64:79]
s_add_u32 m0, s29, 3072
s_add_u32 s33, s28, 25088
buffer_load_dwordx4 v97, s[4:7], s33 offen lds
ds_read_b64_tr_b16 v[16:17], v4 offset:20480
ds_read_b64_tr_b16 v[18:19], v4 offset:21504
s_waitcnt lgkmcnt(10)
v_mfma_f32_32x32x16_bf16 v[80:95], v[20:23], a[12:15], v[80:95]
s_mov_b32 exec_lo, 0x0
s_mov_b32 exec_hi, 0xffff0000
buffer_load_dword v110, v108, s[4:7], s28 offen
s_mov_b64 exec, -1
s_mov_b32 exec_lo, 0xf000
s_mov_b32 exec_hi, 0x0
buffer_load_dword v110, v109, s[12:15], s60 offen
s_mov_b64 exec, -1
ds_read_b64_tr_b16 v[20:21], v4 offset:20736
ds_read_b64_tr_b16 v[22:23], v4 offset:21760
s_waitcnt lgkmcnt(10)
v_mfma_f32_32x32x16_bf16 v[32:47], v[24:27], a[16:19], v[32:47]
ds_read_b64_tr_b16 v[24:25], v4 offset:20992
ds_read_b64_tr_b16 v[26:27], v4 offset:22016
s_waitcnt lgkmcnt(10)
v_mfma_f32_32x32x16_bf16 v[48:63], v[28:31], a[16:19], v[48:63]
ds_read_b64_tr_b16 v[28:29], v4 offset:21248
ds_read_b64_tr_b16 v[30:31], v4 offset:22272
s_waitcnt lgkmcnt(10)
v_mfma_f32_32x32x16_bf16 v[64:79], v[8:11], a[16:19], v[64:79]
ds_read_b64_tr_b16 v[8:9], v4 offset:24576
ds_read_b64_tr_b16 v[10:11], v4 offset:25600
s_waitcnt lgkmcnt(10)
v_mfma_f32_32x32x16_bf16 v[80:95], v[12:15], a[16:19], v[80:95]
ds_read_b64_tr_b16 v[12:13], v4 offset:24832
ds_read_b64_tr_b16 v[14:15], v4 offset:25856
s_waitcnt lgkmcnt(10)
v_mfma_f32_32x32x16_bf16 v[32:47], v[16:19], a[20:23], v[32:47]
ds_read_b64_tr_b16 v[16:17], v4 offset:25088
ds_read_b64_tr_b16 v[18:19], v4 offset:26112
s_waitcnt lgkmcnt(10)
v_mfma_f32_32x32x16_bf16 v[48:63], v[20:23], a[20:23], v[48:63]
s_waitcnt vmcnt(14)
ds_read_b128 a[32:35], v98 offset:32768
ds_read_b128 a[36:39], v99 offset:32768
ds_read_b64_tr_b16 v[20:21], v4 offset:25344
ds_read_b64_tr_b16 v[22:23], v4 offset:26368
s_waitcnt lgkmcnt(12)
v_mfma_f32_32x32x16_bf16 v[64:79], v[24:27], a[20:23], v[64:79]
ds_read_b128 a[40:43], v100 offset:32768
ds_read_b128 a[44:47], v101 offset:32768
ds_read_b64_tr_b16 v[24:25], v4 offset:28672
ds_read_b64_tr_b16 v[26:27], v4 offset:29696
s_waitcnt lgkmcnt(14)
v_mfma_f32_32x32x16_bf16 v[80:95], v[28:31], a[20:23], v[80:95]
ds_read_b64_tr_b16 v[28:29], v4 offset:28928
ds_read_b64_tr_b16 v[30:31], v4 offset:29952
s_waitcnt lgkmcnt(14)
v_mfma_f32_32x32x16_bf16 v[32:47], v[8:11], a[24:27], v[32:47]
ds_read_b64_tr_b16 v[8:9], v4 offset:29184
ds_read_b64_tr_b16 v[10:11], v4 offset:30208
s_waitcnt lgkmcnt(14)
v_mfma_f32_32x32x16_bf16 v[48:63], v[12:15], a[24:27], v[48:63]
s_waitcnt lgkmcnt(6)
s_add_u32 m0, s29, 32768
s_add_u32 s33, s28, 640
buffer_load_dwordx4 v96, s[4:7], s33 offen lds
ds_read_b64_tr_b16 v[12:13], v4 offset:29440
ds_read_b64_tr_b16 v[14:15], v4 offset:30464
v_mfma_f32_32x32x16_bf16 v[64:79], v[16:19], a[24:27], v[64:79]
s_add_u32 m0, s29, 33792
s_add_u32 s33, s28, 8832
buffer_load_dwordx4 v97, s[4:7], s33 offen lds
s_waitcnt vmcnt(12)
s_barrier
s_cmp_lg_u32 s24, 0
s_cbranch_scc1 Ll1_nf
s_lshr_b32 s31, s2, 4
s_lshl_b32 s31, s31, 2
v_mov_b32 v106, 1
v_mov_b32 v107, 0
s_mov_b64 exec, 1
buffer_atomic_add v106, v107, s[36:39], s31 offen sc1
s_mov_b64 exec, -1
Ll1_nf:
ds_read_b64_tr_b16 v[16:17], v4 offset:32768
ds_read_b64_tr_b16 v[18:19], v4 offset:33792
v_mfma_f32_32x32x16_bf16 v[80:95], v[20:23], a[24:27], v[80:95]
s_waitcnt vmcnt(8)
ds_read_b128 a[48:51], v102 offset:32768
ds_read_b128 a[52:55], v103 offset:32768
s_add_u32 m0, s29, 34816
s_add_u32 s33, s28, 17024
buffer_load_dwordx4 v96, s[4:7], s33 offen lds
ds_read_b64_tr_b16 v[20:21], v4 offset:33024
ds_read_b64_tr_b16 v[22:23], v4 offset:34048
s_waitcnt lgkmcnt(12)
v_mfma_f32_32x32x16_bf16 v[32:47], v[24:27], a[28:31], v[32:47]
ds_read_b128 a[56:59], v104 offset:32768
ds_read_b128 a[60:63], v105 offset:32768
s_add_u32 m0, s29, 35840
s_add_u32 s33, s28, 25216
buffer_load_dwordx4 v97, s[4:7], s33 offen lds
ds_read_b64_tr_b16 v[24:25], v4 offset:33280
ds_read_b64_tr_b16 v[26:27], v4 offset:34304
s_waitcnt lgkmcnt(14)
v_mfma_f32_32x32x16_bf16 v[48:63], v[28:31], a[28:31], v[48:63]
ds_read_b64_tr_b16 v[28:29], v4 offset:33536
ds_read_b64_tr_b16 v[30:31], v4 offset:34560
s_waitcnt lgkmcnt(14)
v_mfma_f32_32x32x16_bf16 v[64:79], v[8:11], a[28:31], v[64:79]
ds_read_b64_tr_b16 v[8:9], v4 offset:36864
ds_read_b64_tr_b16 v[10:11], v4 offset:37888
s_waitcnt lgkmcnt(14)
v_mfma_f32_32x32x16_bf16 v[80:95], v[12:15], a[28:31], v[80:95]
s_waitcnt lgkmcnt(6)
s_add_u32 m0, s29, 131072
s_add_u32 s33, s30, 2097152
buffer_load_dwordx4 v1, s[12:15], s33 offen lds
ds_read_b64_tr_b16 v[12:13], v4 offset:37120
ds_read_b64_tr_b16 v[14:15], v4 offset:38144
v_mfma_f32_32x32x16_bf16 v[32:47], v[16:19], a[32:35], v[32:47]
s_add_u32 m0, s29, 132096
s_add_u32 s33, s30, 2129920
buffer_load_dwordx4 v1, s[12:15], s33 offen lds
ds_read_b64_tr_b16 v[16:17], v4 offset:37376
ds_read_b64_tr_b16 v[18:19], v4 offset:38400
v_mfma_f32_32x32x16_bf16 v[48:63], v[20:23], a[32:35], v[48:63]
s_add_u32 m0, s29, 133120
s_add_u32 s33, s30, 2162688
buffer_load_dwordx4 v1, s[12:15], s33 offen lds
ds_read_b64_tr_b16 v[20:21], v4 offset:37632
ds_read_b64_tr_b16 v[22:23], v4 offset:38656
s_waitcnt lgkmcnt(10)
v_mfma_f32_32x32x16_bf16 v[64:79], v[24:27], a[32:35], v[64:79]
s_add_u32 m0, s29, 134144
s_add_u32 s33, s30, 2195456
buffer_load_dwordx4 v1, s[12:15], s33 offen lds
ds_read_b64_tr_b16 v[24:25], v4 offset:40960
ds_read_b64_tr_b16 v[26:27], v4 offset:41984
s_waitcnt lgkmcnt(10)
v_mfma_f32_32x32x16_bf16 v[80:95], v[28:31], a[32:35], v[80:95]
s_add_u32 m0, s29, 65536
s_add_u32 s33, s28, 768
buffer_load_dwordx4 v96, s[4:7], s33 offen lds
ds_read_b64_tr_b16 v[28:29], v4 offset:41216
ds_read_b64_tr_b16 v[30:31], v4 offset:42240
s_waitcnt lgkmcnt(10)
v_mfma_f32_32x32x16_bf16 v[32:47], v[8:11], a[36:39], v[32:47]
s_add_u32 m0, s29, 66560
s_add_u32 s33, s28, 8960
buffer_load_dwordx4 v97, s[4:7], s33 offen lds
ds_read_b64_tr_b16 v[8:9], v4 offset:41472
ds_read_b64_tr_b16 v[10:11], v4 offset:42496
s_waitcnt lgkmcnt(10)
v_mfma_f32_32x32x16_bf16 v[48:63], v[12:15], a[36:39], v[48:63]
s_add_u32 m0, s29, 67584
s_add_u32 s33, s28, 17152
buffer_load_dwordx4 v96, s[4:7], s33 offen lds
ds_read_b64_tr_b16 v[12:13], v4 offset:41728
ds_read_b64_tr_b16 v[14:15], v4 offset:42752
s_waitcnt lgkmcnt(10)
v_mfma_f32_32x32x16_bf16 v[64:79], v[16:19], a[36:39], v[64:79]
s_add_u32 m0, s29, 68608
s_add_u32 s33, s28, 25344
buffer_load_dwordx4 v97, s[4:7], s33 offen lds
ds_read_b64_tr_b16 v[16:17], v4 offset:45056
ds_read_b64_tr_b16 v[18:19], v4 offset:46080
s_waitcnt lgkmcnt(10)
v_mfma_f32_32x32x16_bf16 v[80:95], v[20:23], a[36:39], v[80:95]
s_waitcnt vmcnt(14)
ds_read_b128 a[64:67], v98 offset:0
ds_read_b128 a[68:71], v99 offset:0
ds_read_b64_tr_b16 v[20:21], v4 offset:45312
ds_read_b64_tr_b16 v[22:23], v4 offset:46336
s_waitcnt lgkmcnt(12)
v_mfma_f32_32x32x16_bf16 v[32:47], v[24:27], a[40:43], v[32:47]
ds_read_b128 a[72:75], v100 offset:0
ds_read_b128 a[76:79], v101 offset:0
ds_read_b64_tr_b16 v[24:25], v4 offset:45568
ds_read_b64_tr_b16 v[26:27], v4 offset:46592
s_waitcnt lgkmcnt(14)
v_mfma_f32_32x32x16_bf16 v[48:63], v[28:31], a[40:43], v[48:63]
s_mov_b32 exec_lo, 0xffff
s_mov_b32 exec_hi, 0x0
buffer_load_dword v110, v109, s[16:19], s60 offen
s_mov_b64 exec, -1
ds_read_b64_tr_b16 v[28:29], v4 offset:45824
ds_read_b64_tr_b16 v[30:31], v4 offset:46848
s_waitcnt lgkmcnt(14)
v_mfma_f32_32x32x16_bf16 v[64:79], v[8:11], a[40:43], v[64:79]
ds_read_b64_tr_b16 v[8:9], v4 offset:49152
ds_read_b64_tr_b16 v[10:11], v4 offset:50176
s_waitcnt lgkmcnt(14)
v_mfma_f32_32x32x16_bf16 v[80:95], v[12:15], a[40:43], v[80:95]
s_waitcnt lgkmcnt(6)
s_add_u32 m0, s29, 0
s_add_u32 s33, s30, 3145728
buffer_load_dwordx4 v1, s[12:15], s33 offen lds
ds_read_b64_tr_b16 v[12:13], v4 offset:49408
ds_read_b64_tr_b16 v[14:15], v4 offset:50432
v_mfma_f32_32x32x16_bf16 v[32:47], v[16:19], a[44:47], v[32:47]
s_add_u32 m0, s29, 1024
s_add_u32 s33, s30, 3178496
buffer_load_dwordx4 v1, s[12:15], s33 offen lds
ds_read_b64_tr_b16 v[16:17], v4 offset:49664
ds_read_b64_tr_b16 v[18:19], v4 offset:50688
v_mfma_f32_32x32x16_bf16 v[48:63], v[20:23], a[44:47], v[48:63]
s_add_u32 m0, s29, 2048
s_add_u32 s33, s30, 3211264
buffer_load_dwordx4 v1, s[12:15], s33 offen lds
ds_read_b64_tr_b16 v[20:21], v4 offset:49920
ds_read_b64_tr_b16 v[22:23], v4 offset:50944
s_waitcnt lgkmcnt(10)
v_mfma_f32_32x32x16_bf16 v[64:79], v[24:27], a[44:47], v[64:79]
s_add_u32 m0, s29, 3072
s_add_u32 s33, s30, 3244032
buffer_load_dwordx4 v1, s[12:15], s33 offen lds
ds_read_b64_tr_b16 v[24:25], v4 offset:53248
ds_read_b64_tr_b16 v[26:27], v4 offset:54272
s_waitcnt lgkmcnt(10)
v_mfma_f32_32x32x16_bf16 v[80:95], v[28:31], a[44:47], v[80:95]
ds_read_b64_tr_b16 v[28:29], v4 offset:53504
ds_read_b64_tr_b16 v[30:31], v4 offset:54528
s_waitcnt lgkmcnt(10)
v_mfma_f32_32x32x16_bf16 v[32:47], v[8:11], a[48:51], v[32:47]
ds_read_b64_tr_b16 v[8:9], v4 offset:53760
ds_read_b64_tr_b16 v[10:11], v4 offset:54784
s_waitcnt lgkmcnt(10)
v_mfma_f32_32x32x16_bf16 v[48:63], v[12:15], a[48:51], v[48:63]
ds_read_b64_tr_b16 v[12:13], v4 offset:54016
ds_read_b64_tr_b16 v[14:15], v4 offset:55040
s_waitcnt lgkmcnt(10)
v_mfma_f32_32x32x16_bf16 v[64:79], v[16:19], a[48:51], v[64:79]
ds_read_b64_tr_b16 v[16:17], v4 offset:57344
ds_read_b64_tr_b16 v[18:19], v4 offset:58368
s_waitcnt lgkmcnt(10)
v_mfma_f32_32x32x16_bf16 v[80:95], v[20:23], a[48:51], v[80:95]
s_waitcnt vmcnt(13)
ds_read_b128 a[80:83], v98 offset:32768
ds_read_b128 a[84:87], v99 offset:32768
ds_read_b64_tr_b16 v[20:21], v4 offset:57600
ds_read_b64_tr_b16 v[22:23], v4 offset:58624
s_waitcnt lgkmcnt(12)
v_mfma_f32_32x32x16_bf16 v[32:47], v[24:27], a[52:55], v[32:47]
ds_read_b128 a[88:91], v100 offset:32768
ds_read_b128 a[92:95], v101 offset:32768
ds_read_b64_tr_b16 v[24:25], v4 offset:57856
ds_read_b64_tr_b16 v[26:27], v4 offset:58880
s_waitcnt lgkmcnt(14)
v_mfma_f32_32x32x16_bf16 v[48:63], v[28:31], a[52:55], v[48:63]
ds_read_b64_tr_b16 v[28:29], v4 offset:58112
ds_read_b64_tr_b16 v[30:31], v4 offset:59136
s_waitcnt lgkmcnt(14)
v_mfma_f32_32x32x16_bf16 v[64:79], v[8:11], a[52:55], v[64:79]
ds_read_b64_tr_b16 v[8:9], v4 offset:61440
ds_read_b64_tr_b16 v[10:11], v4 offset:62464
s_waitcnt lgkmcnt(14)
v_mfma_f32_32x32x16_bf16 v[80:95], v[12:15], a[52:55], v[80:95]
s_waitcnt lgkmcnt(6)
s_add_u32 m0, s29, 32768
s_add_u32 s33, s28, 896
buffer_load_dwordx4 v96, s[4:7], s33 offen lds
ds_read_b64_tr_b16 v[12:13], v4 offset:61696
ds_read_b64_tr_b16 v[14:15], v4 offset:62720
v_mfma_f32_32x32x16_bf16 v[32:47], v[16:19], a[56:59], v[32:47]
s_add_u32 m0, s29, 33792
s_add_u32 s33, s28, 9088
buffer_load_dwordx4 v97, s[4:7], s33 offen lds
ds_read_b64_tr_b16 v[16:17], v4 offset:61952
ds_read_b64_tr_b16 v[18:19], v4 offset:62976
v_mfma_f32_32x32x16_bf16 v[48:63], v[20:23], a[56:59], v[48:63]
s_add_u32 m0, s29, 34816
s_add_u32 s33, s28, 17280
buffer_load_dwordx4 v96, s[4:7], s33 offen lds
ds_read_b64_tr_b16 v[20:21], v4 offset:62208
ds_read_b64_tr_b16 v[22:23], v4 offset:63232
s_waitcnt lgkmcnt(10)
v_mfma_f32_32x32x16_bf16 v[64:79], v[24:27], a[56:59], v[64:79]
s_add_u32 m0, s29, 35840
s_add_u32 s33, s28, 25472
buffer_load_dwordx4 v97, s[4:7], s33 offen lds
s_waitcnt vmcnt(13)
s_barrier
ds_read_b64_tr_b16 v[24:25], v5 offset:0
ds_read_b64_tr_b16 v[26:27], v5 offset:1024
s_waitcnt lgkmcnt(10)
v_mfma_f32_32x32x16_bf16 v[80:95], v[28:31], a[56:59], v[80:95]
s_mov_b64 s[20:21], s[96:97]
s_mov_b32 s22, 5242880
s_lshl_b32 s31, s2, 3
s_add_u32 s31, s31, s24
s_mul_i32 s33, s31, 2560
v_lshlrev_b32 v108, 3, v0
s_mov_b32 exec_lo, 0xfffff
s_mov_b32 exec_hi, 0x0
buffer_load_dword v110, v108, s[20:23], s33 offen
s_mov_b64 exec, -1
s_lshl_b32 s33, s31, 9
s_mov_b64 s[20:21], s[98:99]
s_mov_b32 s22, 819200
s_mov_b32 exec_lo, 0xf
s_mov_b32 exec_hi, 0x0
buffer_load_dword v110, v108, s[20:23], s33 offen
s_mov_b64 exec, -1
ds_read_b64_tr_b16 v[28:29], v5 offset:256
ds_read_b64_tr_b16 v[30:31], v5 offset:1280
s_waitcnt lgkmcnt(10)
v_mfma_f32_32x32x16_bf16 v[32:47], v[8:11], a[60:63], v[32:47]
ds_read_b64_tr_b16 v[8:9], v5 offset:512
ds_read_b64_tr_b16 v[10:11], v5 offset:1536
s_waitcnt lgkmcnt(10)
v_mfma_f32_32x32x16_bf16 v[48:63], v[12:15], a[60:63], v[48:63]
s_waitcnt vmcnt(11)
v_add_u32 v111, 0x10000, v98
ds_read_b128 a[96:99], v111 offset:0
v_add_u32 v112, 0x10000, v99
ds_read_b128 a[100:103], v112 offset:0
ds_read_b64_tr_b16 v[12:13], v5 offset:768
ds_read_b64_tr_b16 v[14:15], v5 offset:1792
s_waitcnt lgkmcnt(12)
v_mfma_f32_32x32x16_bf16 v[64:79], v[16:19], a[60:63], v[64:79]
v_add_u32 v113, 0x10000, v100
ds_read_b128 a[104:107], v113 offset:0
v_add_u32 v114, 0x10000, v101
ds_read_b128 a[108:111], v114 offset:0
ds_read_b64_tr_b16 v[16:17], v5 offset:4096
ds_read_b64_tr_b16 v[18:19], v5 offset:5120
s_waitcnt lgkmcnt(14)
v_mfma_f32_32x32x16_bf16 v[80:95], v[20:23], a[60:63], v[80:95]
ds_read_b64_tr_b16 v[20:21], v5 offset:4352
ds_read_b64_tr_b16 v[22:23], v5 offset:5376
s_waitcnt lgkmcnt(14)
v_mfma_f32_32x32x16_bf16 v[32:47], v[24:27], a[64:67], v[32:47]
ds_read_b64_tr_b16 v[24:25], v5 offset:4608
ds_read_b64_tr_b16 v[26:27], v5 offset:5632
s_waitcnt lgkmcnt(14)
v_mfma_f32_32x32x16_bf16 v[48:63], v[28:31], a[64:67], v[48:63]
s_waitcnt lgkmcnt(6)
s_add_u32 m0, s29, 65536
s_add_u32 s33, s30, 2097152
buffer_load_dwordx4 v2, s[16:19], s33 offen lds
ds_read_b64_tr_b16 v[28:29], v5 offset:4864
ds_read_b64_tr_b16 v[30:31], v5 offset:5888
v_mfma_f32_32x32x16_bf16 v[64:79], v[8:11], a[64:67], v[64:79]
s_add_u32 m0, s29, 66560
s_add_u32 s33, s30, 2129920
buffer_load_dwordx4 v2, s[16:19], s33 offen lds
ds_read_b64_tr_b16 v[8:9], v5 offset:8192
ds_read_b64_tr_b16 v[10:11], v5 offset:9216
v_mfma_f32_32x32x16_bf16 v[80:95], v[12:15], a[64:67], v[80:95]
s_add_u32 m0, s29, 67584
s_add_u32 s33, s30, 2162688
buffer_load_dwordx4 v2, s[16:19], s33 offen lds
ds_read_b64_tr_b16 v[12:13], v5 offset:8448
ds_read_b64_tr_b16 v[14:15], v5 offset:9472
s_waitcnt lgkmcnt(10)
v_mfma_f32_32x32x16_bf16 v[32:47], v[16:19], a[68:71], v[32:47]
s_add_u32 m0, s29, 68608
s_add_u32 s33, s30, 2195456
buffer_load_dwordx4 v2, s[16:19], s33 offen lds
ds_read_b64_tr_b16 v[16:17], v5 offset:8704
ds_read_b64_tr_b16 v[18:19], v5 offset:9728
s_waitcnt lgkmcnt(10)
v_mfma_f32_32x32x16_bf16 v[48:63], v[20:23], a[68:71], v[48:63]
s_add_u32 m0, s29, 98304
s_add_u32 s33, s30, 128
buffer_load_dwordx4 v2, s[16:19], s33 offen lds
ds_read_b64_tr_b16 v[20:21], v5 offset:8960
ds_read_b64_tr_b16 v[22:23], v5 offset:9984
s_waitcnt lgkmcnt(10)
v_mfma_f32_32x32x16_bf16 v[64:79], v[24:27], a[68:71], v[64:79]
s_add_u32 m0, s29, 99328
s_add_u32 s33, s30, 32896
buffer_load_dwordx4 v2, s[16:19], s33 offen lds
ds_read_b64_tr_b16 v[24:25], v5 offset:12288
ds_read_b64_tr_b16 v[26:27], v5 offset:13312
s_waitcnt lgkmcnt(10)
v_mfma_f32_32x32x16_bf16 v[80:95], v[28:31], a[68:71], v[80:95]
s_add_u32 m0, s29, 100352
s_add_u32 s33, s30, 65664
buffer_load_dwordx4 v2, s[16:19], s33 offen lds
ds_read_b64_tr_b16 v[28:29], v5 offset:12544
ds_read_b64_tr_b16 v[30:31], v5 offset:13568
s_waitcnt lgkmcnt(10)
v_mfma_f32_32x32x16_bf16 v[32:47], v[8:11], a[72:75], v[32:47]
s_add_u32 m0, s29, 101376
s_add_u32 s33, s30, 98432
buffer_load_dwordx4 v2, s[16:19], s33 offen lds
ds_read_b64_tr_b16 v[8:9], v5 offset:12800
ds_read_b64_tr_b16 v[10:11], v5 offset:13824
s_waitcnt lgkmcnt(10)
v_mfma_f32_32x32x16_bf16 v[48:63], v[12:15], a[72:75], v[48:63]
ds_read_b64_tr_b16 v[12:13], v5 offset:13056
ds_read_b64_tr_b16 v[14:15], v5 offset:14080
s_waitcnt lgkmcnt(10)
v_mfma_f32_32x32x16_bf16 v[64:79], v[16:19], a[72:75], v[64:79]
ds_read_b64_tr_b16 v[16:17], v5 offset:16384
ds_read_b64_tr_b16 v[18:19], v5 offset:17408
s_waitcnt lgkmcnt(10)
v_mfma_f32_32x32x16_bf16 v[80:95], v[20:23], a[72:75], v[80:95]
s_lshr_b32 s31, s2, 3
s_lshl_b32 s31, s31, 3
s_add_u32 s31, s31, s24
s_mul_i32 s33, s31, 3200
s_mov_b32 exec_lo, 0x1ffffff
s_mov_b32 exec_hi, 0x0
buffer_load_dword v110, v108, s[40:43], s33 offen
s_mov_b64 exec, -1
ds_read_b64_tr_b16 v[20:21], v5 offset:16640
ds_read_b64_tr_b16 v[22:23], v5 offset:17664
s_waitcnt lgkmcnt(10)
v_mfma_f32_32x32x16_bf16 v[32:47], v[24:27], a[76:79], v[32:47]
ds_read_b64_tr_b16 v[24:25], v5 offset:16896
ds_read_b64_tr_b16 v[26:27], v5 offset:17920
s_waitcnt lgkmcnt(10)
v_mfma_f32_32x32x16_bf16 v[48:63], v[28:31], a[76:79], v[48:63]
ds_read_b64_tr_b16 v[28:29], v5 offset:17152
ds_read_b64_tr_b16 v[30:31], v5 offset:18176
s_waitcnt lgkmcnt(10)
v_mfma_f32_32x32x16_bf16 v[64:79], v[8:11], a[76:79], v[64:79]
ds_read_b64_tr_b16 v[8:9], v5 offset:20480
ds_read_b64_tr_b16 v[10:11], v5 offset:21504
s_waitcnt lgkmcnt(10)
v_mfma_f32_32x32x16_bf16 v[80:95], v[12:15], a[76:79], v[80:95]
ds_read_b64_tr_b16 v[12:13], v5 offset:20736
ds_read_b64_tr_b16 v[14:15], v5 offset:21760
s_waitcnt lgkmcnt(10)
v_mfma_f32_32x32x16_bf16 v[32:47], v[16:19], a[80:83], v[32:47]
ds_read_b64_tr_b16 v[16:17], v5 offset:20992
ds_read_b64_tr_b16 v[18:19], v5 offset:22016
s_waitcnt lgkmcnt(10)
v_mfma_f32_32x32x16_bf16 v[48:63], v[20:23], a[80:83], v[48:63]
ds_read_b64_tr_b16 v[20:21], v5 offset:21248
ds_read_b64_tr_b16 v[22:23], v5 offset:22272
s_waitcnt lgkmcnt(10)
v_mfma_f32_32x32x16_bf16 v[64:79], v[24:27], a[80:83], v[64:79]
ds_read_b64_tr_b16 v[24:25], v5 offset:24576
ds_read_b64_tr_b16 v[26:27], v5 offset:25600
s_waitcnt lgkmcnt(10)
v_mfma_f32_32x32x16_bf16 v[80:95], v[28:31], a[80:83], v[80:95]
s_waitcnt vmcnt(11)
ds_read_b128 a[112:115], v98 offset:32768
ds_read_b128 a[116:119], v99 offset:32768
ds_read_b64_tr_b16 v[28:29], v5 offset:24832
ds_read_b64_tr_b16 v[30:31], v5 offset:25856
s_waitcnt lgkmcnt(12)
v_mfma_f32_32x32x16_bf16 v[32:47], v[8:11], a[84:87], v[32:47]
ds_read_b128 a[120:123], v100 offset:32768
ds_read_b128 a[124:127], v101 offset:32768
ds_read_b64_tr_b16 v[8:9], v5 offset:25088
ds_read_b64_tr_b16 v[10:11], v5 offset:26112
s_waitcnt lgkmcnt(14)
v_mfma_f32_32x32x16_bf16 v[48:63], v[12:15], a[84:87], v[48:63]
ds_read_b64_tr_b16 v[12:13], v5 offset:25344
ds_read_b64_tr_b16 v[14:15], v5 offset:26368
s_waitcnt lgkmcnt(14)
v_mfma_f32_32x32x16_bf16 v[64:79], v[16:19], a[84:87], v[64:79]
ds_read_b64_tr_b16 v[16:17], v5 offset:28672
ds_read_b64_tr_b16 v[18:19], v5 offset:29696
s_waitcnt lgkmcnt(14)
v_mfma_f32_32x32x16_bf16 v[80:95], v[20:23], a[84:87], v[80:95]
s_waitcnt lgkmcnt(6)
s_add_u32 m0, s29, 32768
s_add_u32 s33, s30, 0
buffer_load_dwordx4 v2, s[16:19], s33 offen lds
ds_read_b64_tr_b16 v[20:21], v5 offset:28928
ds_read_b64_tr_b16 v[22:23], v5 offset:29952
v_mfma_f32_32x32x16_bf16 v[32:47], v[24:27], a[88:91], v[32:47]
s_add_u32 m0, s29, 33792
s_add_u32 s33, s30, 32768
buffer_load_dwordx4 v2, s[16:19], s33 offen lds
ds_read_b64_tr_b16 v[24:25], v5 offset:29184
ds_read_b64_tr_b16 v[26:27], v5 offset:30208
v_mfma_f32_32x32x16_bf16 v[48:63], v[28:31], a[88:91], v[48:63]
s_add_u32 m0, s29, 34816
s_add_u32 s33, s30, 65536
buffer_load_dwordx4 v2, s[16:19], s33 offen lds
ds_read_b64_tr_b16 v[28:29], v5 offset:29440
ds_read_b64_tr_b16 v[30:31], v5 offset:30464
s_waitcnt lgkmcnt(10)
v_mfma_f32_32x32x16_bf16 v[64:79], v[8:11], a[88:91], v[64:79]
s_add_u32 m0, s29, 35840
s_add_u32 s33, s30, 98304
buffer_load_dwordx4 v2, s[16:19], s33 offen lds
s_barrier
ds_read_b64_tr_b16 v[8:9], v3 offset:0
ds_read_b64_tr_b16 v[10:11], v3 offset:1024
s_waitcnt lgkmcnt(10)
v_mfma_f32_32x32x16_bf16 v[80:95], v[12:15], a[88:91], v[80:95]
ds_read_b64_tr_b16 v[12:13], v3 offset:256
ds_read_b64_tr_b16 v[14:15], v3 offset:1280
s_waitcnt lgkmcnt(10)
v_mfma_f32_32x32x16_bf16 v[32:47], v[16:19], a[92:95], v[32:47]
ds_read_b64_tr_b16 v[16:17], v3 offset:512
ds_read_b64_tr_b16 v[18:19], v3 offset:1536
s_waitcnt lgkmcnt(10)
v_mfma_f32_32x32x16_bf16 v[48:63], v[20:23], a[92:95], v[48:63]
ds_read_b64_tr_b16 v[20:21], v3 offset:768
ds_read_b64_tr_b16 v[22:23], v3 offset:1792
s_waitcnt lgkmcnt(10)
v_mfma_f32_32x32x16_bf16 v[64:79], v[24:27], a[92:95], v[64:79]
ds_read_b64_tr_b16 v[24:25], v3 offset:4096
ds_read_b64_tr_b16 v[26:27], v3 offset:5120
s_waitcnt lgkmcnt(10)
v_mfma_f32_32x32x16_bf16 v[80:95], v[28:31], a[92:95], v[80:95]
ds_read_b64_tr_b16 v[28:29], v3 offset:4352
ds_read_b64_tr_b16 v[30:31], v3 offset:5376
s_waitcnt lgkmcnt(10)
v_mfma_f32_32x32x16_bf16 v[32:47], v[8:11], a[96:99], v[32:47]
ds_read_b64_tr_b16 v[8:9], v3 offset:4608
ds_read_b64_tr_b16 v[10:11], v3 offset:5632
s_waitcnt lgkmcnt(10)
v_mfma_f32_32x32x16_bf16 v[48:63], v[12:15], a[96:99], v[48:63]
ds_read_b64_tr_b16 v[12:13], v3 offset:4864
ds_read_b64_tr_b16 v[14:15], v3 offset:5888
s_waitcnt lgkmcnt(10)
v_mfma_f32_32x32x16_bf16 v[64:79], v[16:19], a[96:99], v[64:79]
ds_read_b64_tr_b16 v[16:17], v3 offset:8192
ds_read_b64_tr_b16 v[18:19], v3 offset:9216
s_waitcnt lgkmcnt(10)
v_mfma_f32_32x32x16_bf16 v[80:95], v[20:23], a[96:99], v[80:95]
s_add_u32 m0, s29, 131072
s_add_u32 s33, s30, 2097280
buffer_load_dwordx4 v2, s[16:19], s33 offen lds
ds_read_b64_tr_b16 v[20:21], v3 offset:8448
ds_read_b64_tr_b16 v[22:23], v3 offset:9472
s_waitcnt lgkmcnt(10)
v_mfma_f32_32x32x16_bf16 v[32:47], v[24:27], a[100:103], v[32:47]
s_add_u32 m0, s29, 132096
s_add_u32 s33, s30, 2130048
buffer_load_dwordx4 v2, s[16:19], s33 offen lds
ds_read_b64_tr_b16 v[24:25], v3 offset:8704
ds_read_b64_tr_b16 v[26:27], v3 offset:9728
s_waitcnt lgkmcnt(10)
v_mfma_f32_32x32x16_bf16 v[48:63], v[28:31], a[100:103], v[48:63]
s_add_u32 m0, s29, 133120
s_add_u32 s33, s30, 2162816
buffer_load_dwordx4 v2, s[16:19], s33 offen lds
ds_read_b64_tr_b16 v[28:29], v3 offset:8960
ds_read_b64_tr_b16 v[30:31], v3 offset:9984
s_waitcnt lgkmcnt(10)
v_mfma_f32_32x32x16_bf16 v[64:79], v[8:11], a[100:103], v[64:79]
s_add_u32 m0, s29, 134144
s_add_u32 s33, s30, 2195584
buffer_load_dwordx4 v2, s[16:19], s33 offen lds
ds_read_b64_tr_b16 v[8:9], v3 offset:12288
ds_read_b64_tr_b16 v[10:11], v3 offset:13312
s_waitcnt lgkmcnt(10)
v_mfma_f32_32x32x16_bf16 v[80:95], v[12:15], a[100:103], v[80:95]
ds_read_b64_tr_b16 v[12:13], v3 offset:12544
ds_read_b64_tr_b16 v[14:15], v3 offset:13568
s_waitcnt lgkmcnt(10)
v_mfma_f32_32x32x16_bf16 v[32:47], v[16:19], a[104:107], v[32:47]
ds_read_b64_tr_b16 v[16:17], v3 offset:12800
ds_read_b64_tr_b16 v[18:19], v3 offset:13824
s_waitcnt lgkmcnt(10)
v_mfma_f32_32x32x16_bf16 v[48:63], v[20:23], a[104:107], v[48:63]
ds_read_b64_tr_b16 v[20:21], v3 offset:13056
ds_read_b64_tr_b16 v[22:23], v3 offset:14080
s_waitcnt lgkmcnt(10)
v_mfma_f32_32x32x16_bf16 v[64:79], v[24:27], a[104:107], v[64:79]
ds_read_b64_tr_b16 v[24:25], v3 offset:16384
ds_read_b64_tr_b16 v[26:27], v3 offset:17408
s_waitcnt lgkmcnt(10)
v_mfma_f32_32x32x16_bf16 v[80:95], v[28:31], a[104:107], v[80:95]
ds_read_b64_tr_b16 v[28:29], v3 offset:16640
ds_read_b64_tr_b16 v[30:31], v3 offset:17664
s_waitcnt lgkmcnt(10)
v_mfma_f32_32x32x16_bf16 v[32:47], v[8:11], a[108:111], v[32:47]
ds_read_b64_tr_b16 v[8:9], v3 offset:16896
ds_read_b64_tr_b16 v[10:11], v3 offset:17920
s_waitcnt lgkmcnt(10)
v_mfma_f32_32x32x16_bf16 v[48:63], v[12:15], a[108:111], v[48:63]
ds_read_b64_tr_b16 v[12:13], v3 offset:17152
ds_read_b64_tr_b16 v[14:15], v3 offset:18176
s_waitcnt lgkmcnt(10)
v_mfma_f32_32x32x16_bf16 v[64:79], v[16:19], a[108:111], v[64:79]
ds_read_b64_tr_b16 v[16:17], v3 offset:20480
ds_read_b64_tr_b16 v[18:19], v3 offset:21504
s_waitcnt lgkmcnt(10)
v_mfma_f32_32x32x16_bf16 v[80:95], v[20:23], a[108:111], v[80:95]
s_mov_b32 s96, 0x3e0293ee
ds_read_b64_tr_b16 v[20:21], v3 offset:20736
ds_read_b64_tr_b16 v[22:23], v3 offset:21760
s_waitcnt lgkmcnt(10)
v_mfma_f32_32x32x16_bf16 v[32:47], v[24:27], a[112:115], v[32:47]
ds_read_b64_tr_b16 v[24:25], v3 offset:20992
ds_read_b64_tr_b16 v[26:27], v3 offset:22016
s_waitcnt lgkmcnt(10)
v_mfma_f32_32x32x16_bf16 v[48:63], v[28:31], a[112:115], v[48:63]
ds_read_b64_tr_b16 v[28:29], v3 offset:21248
ds_read_b64_tr_b16 v[30:31], v3 offset:22272
s_waitcnt lgkmcnt(10)
v_mfma_f32_32x32x16_bf16 v[64:79], v[8:11], a[112:115], v[64:79]
ds_read_b64_tr_b16 v[8:9], v3 offset:24576
ds_read_b64_tr_b16 v[10:11], v3 offset:25600
s_waitcnt lgkmcnt(10)
v_mfma_f32_32x32x16_bf16 v[80:95], v[12:15], a[112:115], v[80:95]
s_cmp_ge_u32 s2, 160
s_cbranch_scc1 Ll1_pk
s_and_b32 s25, s2, 7
s_lshr_b32 s26, s2, 3
s_lshl_b32 s25, s25, 1
ds_read_b64_tr_b16 v[12:13], v3 offset:24832
ds_read_b64_tr_b16 v[14:15], v3 offset:25856
s_waitcnt lgkmcnt(10)
v_mfma_f32_32x32x16_bf16 v[32:47], v[16:19], a[116:119], v[32:47]
s_sub_u32 s27, s26, 10
s_add_u32 s28, s25, 1
s_cmp_ge_u32 s26, 10
s_cselect_b32 s25, s28, s25
s_cselect_b32 s26, s27, s26
ds_read_b64_tr_b16 v[16:17], v3 offset:25088
ds_read_b64_tr_b16 v[18:19], v3 offset:26112
s_waitcnt lgkmcnt(10)
v_mfma_f32_32x32x16_bf16 v[48:63], v[20:23], a[116:119], v[48:63]
s_lshl_b32 s59, s25, 2
v_mov_b32 v6, 0
v_bfe_u32 v1, v0, 6, 2
ds_read_b64_tr_b16 v[20:21], v3 offset:25344
ds_read_b64_tr_b16 v[22:23], v3 offset:26368
s_waitcnt lgkmcnt(10)
v_mfma_f32_32x32x16_bf16 v[64:79], v[24:27], a[116:119], v[64:79]
v_mul_u32_u24 v1, 1280, v1
v_and_b32 v7, 0x30, v0
v_add_u32 v1, v1, v7
ds_read_b64_tr_b16 v[24:25], v3 offset:28672
ds_read_b64_tr_b16 v[26:27], v3 offset:29696
s_waitcnt lgkmcnt(10)
v_mfma_f32_32x32x16_bf16 v[80:95], v[28:31], a[116:119], v[80:95]
v_bfe_u32 v7, v0, 8, 1
v_lshl_add_u32 v1, v7, 6, v1
v_lshrrev_b32 v7, 9, v0
ds_read_b64_tr_b16 v[28:29], v3 offset:28928
ds_read_b64_tr_b16 v[30:31], v3 offset:29952
s_waitcnt lgkmcnt(10)
v_mfma_f32_32x32x16_bf16 v[32:47], v[8:11], a[120:123], v[32:47]
v_mul_u32_u24 v7, 163840, v7
v_add_u32 v1, v1, v7
s_mul_i32 s30, s24, 20480
ds_read_b64_tr_b16 v[8:9], v3 offset:29184
ds_read_b64_tr_b16 v[10:11], v3 offset:30208
s_waitcnt lgkmcnt(10)
v_mfma_f32_32x32x16_bf16 v[48:63], v[12:15], a[120:123], v[48:63]
s_lshl_b32 s27, s26, 7
s_add_u32 s30, s30, s27
s_and_b32 s27, s24, 3
buffer_load_dword v7, v6, s[36:39], s59 offen sc1
ds_read_b64_tr_b16 v[12:13], v3 offset:29440
ds_read_b64_tr_b16 v[14:15], v3 offset:30464
s_waitcnt lgkmcnt(10)
v_mfma_f32_32x32x16_bf16 v[64:79], v[16:19], a[120:123], v[64:79]
s_add_u32 s27, s27, s59
s_mul_i32 s60, s27, 40960
s_add_u32 s60, s60, 34603008
s_waitcnt vmcnt(5)
s_barrier
ds_read_b64_tr_b16 v[16:17], v3 offset:32768
ds_read_b64_tr_b16 v[18:19], v3 offset:33792
s_waitcnt lgkmcnt(10)
v_mfma_f32_32x32x16_bf16 v[80:95], v[20:23], a[120:123], v[80:95]
s_lshl_b32 s61, s27, 5
s_lshl_b32 s56, s27, 7
s_add_u32 s56, s56, 37748736
ds_read_b64_tr_b16 v[20:21], v3 offset:33024
ds_read_b64_tr_b16 v[22:23], v3 offset:34048
s_waitcnt lgkmcnt(10)
v_mfma_f32_32x32x16_bf16 v[32:47], v[24:27], a[124:127], v[32:47]
s_lshr_b32 s28, s24, 2
s_lshl_b32 s27, s26, 1
s_add_u32 s27, s27, s28
ds_read_b64_tr_b16 v[24:25], v3 offset:36864
ds_read_b64_tr_b16 v[26:27], v3 offset:37888
s_waitcnt lgkmcnt(10)
v_mfma_f32_32x32x16_bf16 v[48:63], v[28:31], a[124:127], v[48:63]
s_mov_b32 s31, 1
s_cmp_ge_u32 s27, 5
s_cselect_b32 s31, -1, s31
s_cmp_ge_u32 s27, 10
s_cselect_b32 s31, 2, s31
ds_read_b64_tr_b16 v[28:29], v3 offset:37120
ds_read_b64_tr_b16 v[30:31], v3 offset:38144
s_waitcnt lgkmcnt(10)
v_mfma_f32_32x32x16_bf16 v[64:79], v[8:11], a[124:127], v[64:79]
s_cmp_ge_u32 s27, 15
s_cselect_b32 s31, -2, s31
s_add_u32 s61, s61, s31
s_lshl_b32 s32, s27, 11
ds_read_b64_tr_b16 v[8:9], v3 offset:40960
ds_read_b64_tr_b16 v[10:11], v3 offset:41984
s_waitcnt lgkmcnt(10)
v_mfma_f32_32x32x16_bf16 v[80:95], v[12:15], a[124:127], v[80:95]
s_add_u32 s57, s32, s60
s_add_u32 s32, s32, 40894464
s_lshl_b32 s28, s28, 8
ds_read_b64_tr_b16 v[12:13], v3 offset:41216
ds_read_b64_tr_b16 v[14:15], v3 offset:42240
s_waitcnt lgkmcnt(10)
v_mfma_f32_32x32x16_bf16 v[96:111], a[0:3], v[16:19], 0
ds_read_b64_tr_b16 v[16:17], v3 offset:45056
ds_read_b64_tr_b16 v[18:19], v3 offset:46080
s_waitcnt lgkmcnt(10)
v_mfma_f32_32x32x16_bf16 v[112:127], a[0:3], v[20:23], 0
ds_read_b64_tr_b16 v[20:21], v3 offset:45312
ds_read_b64_tr_b16 v[22:23], v3 offset:46336
s_waitcnt lgkmcnt(10)
v_mfma_f32_32x32x16_bf16 v[96:111], a[4:7], v[24:27], v[96:111]
v_mul_f32 v32, s96, v32
v_mul_f32 v33, s96, v33
v_cvt_pk_bf16_f32 v32, v32, v33
v_mul_f32 v34, s96, v34
v_mul_f32 v35, s96, v35
v_cvt_pk_bf16_f32 v33, v34, v35
ds_read_b64_tr_b16 v[24:25], v3 offset:49152
ds_read_b64_tr_b16 v[26:27], v3 offset:50176
s_waitcnt lgkmcnt(10)
v_mfma_f32_32x32x16_bf16 v[112:127], a[4:7], v[28:31], v[112:127]
v_mul_f32 v36, s96, v36
v_mul_f32 v37, s96, v37
v_cvt_pk_bf16_f32 v34, v36, v37
v_mul_f32 v38, s96, v38
v_mul_f32 v39, s96, v39
v_cvt_pk_bf16_f32 v35, v38, v39
ds_read_b64_tr_b16 v[28:29], v3 offset:49408
ds_read_b64_tr_b16 v[30:31], v3 offset:50432
s_waitcnt lgkmcnt(10)
v_mfma_f32_32x32x16_bf16 v[96:111], a[8:11], v[8:11], v[96:111]
v_mul_f32 v40, s96, v40
v_mul_f32 v41, s96, v41
v_cvt_pk_bf16_f32 v36, v40, v41
v_mul_f32 v42, s96, v42
v_mul_f32 v43, s96, v43
v_cvt_pk_bf16_f32 v37, v42, v43
s_add_u32 m0, s29, 0
s_add_u32 s33, s30, 0
buffer_load_dwordx4 v1, s[40:43], s33 offen lds
ds_read_b64_tr_b16 v[8:9], v3 offset:53248
ds_read_b64_tr_b16 v[10:11], v3 offset:54272
s_waitcnt lgkmcnt(10)
v_mfma_f32_32x32x16_bf16 v[112:127], a[8:11], v[12:15], v[112:127]
v_mul_f32 v44, s96, v44
v_mul_f32 v45, s96, v45
v_cvt_pk_bf16_f32 v38, v44, v45
v_mul_f32 v46, s96, v46
v_mul_f32 v47, s96, v47
v_cvt_pk_bf16_f32 v39, v46, v47
s_waitcnt vmcnt(1)
v_readfirstlane_b32 s63, v7
s_cmp_ge_u32 s63, 16
s_cbranch_scc1 Ll1_w_ok
s_mov_b32 s62, 8000
Ll1_w_sp:
s_sleep 16
buffer_load_dword v7, v6, s[36:39], s59 offen sc1
s_waitcnt vmcnt(0)
v_readfirstlane_b32 s63, v7
s_cmp_ge_u32 s63, 16
s_cbranch_scc1 Ll1_w_ok
s_sub_u32 s62, s62, 1
s_cmp_lg_u32 s62, 0
s_cbranch_scc1 Ll1_w_sp
Ll1_w_ok:
v_lshlrev_b32 v6, 3, v0
s_mov_b32 exec_lo, 0xffff
s_mov_b32 exec_hi, 0x0
buffer_load_dword v7, v6, s[8:11], s57 offen
s_mov_b64 exec, -1
ds_read_b64_tr_b16 v[12:13], v3 offset:53504
ds_read_b64_tr_b16 v[14:15], v3 offset:54528
s_waitcnt lgkmcnt(10)
v_mfma_f32_32x32x16_bf16 v[96:111], a[12:15], v[16:19], v[96:111]
buffer_store_dwordx4 v[32:35], v0, s[8:11], s34 offen offset:0 sc1
s_add_u32 m0, s29, 1024
s_add_u32 s33, s30, 5120
buffer_load_dwordx4 v1, s[40:43], s33 offen lds
ds_read_b64_tr_b16 v[16:17], v3 offset:57344
ds_read_b64_tr_b16 v[18:19], v3 offset:58368
s_waitcnt lgkmcnt(10)
v_mfma_f32_32x32x16_bf16 v[112:127], a[12:15], v[20:23], v[112:127]
buffer_store_dwordx4 v[36:39], v0, s[8:11], s34 offen offset:1024 sc1
ds_read_b64_tr_b16 v[20:21], v3 offset:57600
ds_read_b64_tr_b16 v[22:23], v3 offset:58624
s_waitcnt lgkmcnt(10)
v_mfma_f32_32x32x16_bf16 v[96:111], a[16:19], v[24:27], v[96:111]
v_mul_f32 v48, s96, v48
v_mul_f32 v49, s96, v49
v_cvt_pk_bf16_f32 v48, v48, v49
v_mul_f32 v50, s96, v50
v_mul_f32 v51, s96, v51
v_cvt_pk_bf16_f32 v49, v50, v51
s_add_u32 m0, s29, 2048
s_add_u32 s33, s30, 10240
buffer_load_dwordx4 v1, s[40:43], s33 offen lds
ds_read_b64_tr_b16 v[24:25], v3 offset:61440
ds_read_b64_tr_b16 v[26:27], v3 offset:62464
s_waitcnt lgkmcnt(10)
v_mfma_f32_32x32x16_bf16 v[112:127], a[16:19], v[28:31], v[112:127]
v_mul_f32 v52, s96, v52
v_mul_f32 v53, s96, v53
v_cvt_pk_bf16_f32 v50, v52, v53
v_mul_f32 v54, s96, v54
v_mul_f32 v55, s96, v55
v_cvt_pk_bf16_f32 v51, v54, v55
ds_read_b64_tr_b16 v[28:29], v3 offset:61696
ds_read_b64_tr_b16 v[30:31], v3 offset:62720
s_waitcnt lgkmcnt(10)
v_mfma_f32_32x32x16_bf16 v[96:111], a[20:23], v[8:11], v[96:111]
v_mul_f32 v56, s96, v56
v_mul_f32 v57, s96, v57
v_cvt_pk_bf16_f32 v52, v56, v57
v_mul_f32 v58, s96, v58
v_mul_f32 v59, s96, v59
v_cvt_pk_bf16_f32 v53, v58, v59
s_add_u32 m0, s29, 3072
s_add_u32 s33, s30, 15360
buffer_load_dwordx4 v1, s[40:43], s33 offen lds
ds_read_b64_tr_b16 v[8:9], v3 offset:33280
ds_read_b64_tr_b16 v[10:11], v3 offset:34304
s_waitcnt lgkmcnt(10)
v_mfma_f32_32x32x16_bf16 v[112:127], a[20:23], v[12:15], v[112:127]
v_mul_f32 v60, s96, v60
v_mul_f32 v61, s96, v61
v_cvt_pk_bf16_f32 v54, v60, v61
v_mul_f32 v62, s96, v62
v_mul_f32 v63, s96, v63
v_cvt_pk_bf16_f32 v55, v62, v63
ds_read_b64_tr_b16 v[12:13], v3 offset:33536
ds_read_b64_tr_b16 v[14:15], v3 offset:34560
s_waitcnt lgkmcnt(10)
v_mfma_f32_32x32x16_bf16 v[96:111], a[24:27], v[16:19], v[96:111]
buffer_store_dwordx4 v[48:51], v0, s[8:11], s34 offen offset:2048 sc1
ds_read_b64_tr_b16 v[16:17], v3 offset:37376
ds_read_b64_tr_b16 v[18:19], v3 offset:38400
s_waitcnt lgkmcnt(10)
v_mfma_f32_32x32x16_bf16 v[112:127], a[24:27], v[20:23], v[112:127]
buffer_store_dwordx4 v[52:55], v0, s[8:11], s34 offen offset:3072 sc1
ds_read_b64_tr_b16 v[20:21], v3 offset:37632
ds_read_b64_tr_b16 v[22:23], v3 offset:38656
s_waitcnt lgkmcnt(10)
v_mfma_f32_32x32x16_bf16 v[96:111], a[28:31], v[24:27], v[96:111]
v_mul_f32 v64, s96, v64
v_mul_f32 v65, s96, v65
v_cvt_pk_bf16_f32 v64, v64, v65
v_mul_f32 v66, s96, v66
v_mul_f32 v67, s96, v67
v_cvt_pk_bf16_f32 v65, v66, v67
ds_read_b64_tr_b16 v[24:25], v3 offset:41472
ds_read_b64_tr_b16 v[26:27], v3 offset:42496
s_waitcnt lgkmcnt(10)
v_mfma_f32_32x32x16_bf16 v[112:127], a[28:31], v[28:31], v[112:127]
v_mul_f32 v68, s96, v68
v_mul_f32 v69, s96, v69
v_cvt_pk_bf16_f32 v66, v68, v69
v_mul_f32 v70, s96, v70
v_mul_f32 v71, s96, v71
v_cvt_pk_bf16_f32 v67, v70, v71
ds_read_b64_tr_b16 v[28:29], v3 offset:41728
ds_read_b64_tr_b16 v[30:31], v3 offset:42752
s_waitcnt lgkmcnt(10)
v_mfma_f32_32x32x16_bf16 v[96:111], a[32:35], v[8:11], v[96:111]
v_mul_f32 v72, s96, v72
v_mul_f32 v73, s96, v73
v_cvt_pk_bf16_f32 v68, v72, v73
v_mul_f32 v74, s96, v74
v_mul_f32 v75, s96, v75
v_cvt_pk_bf16_f32 v69, v74, v75
ds_read_b64_tr_b16 v[8:9], v3 offset:45568
ds_read_b64_tr_b16 v[10:11], v3 offset:46592
s_waitcnt lgkmcnt(10)
v_mfma_f32_32x32x16_bf16 v[112:127], a[32:35], v[12:15], v[112:127]
v_mul_f32 v76, s96, v76
v_mul_f32 v77, s96, v77
v_cvt_pk_bf16_f32 v70, v76, v77
v_mul_f32 v78, s96, v78
v_mul_f32 v79, s96, v79
v_cvt_pk_bf16_f32 v71, v78, v79
ds_read_b64_tr_b16 v[12:13], v3 offset:45824
ds_read_b64_tr_b16 v[14:15], v3 offset:46848
s_waitcnt lgkmcnt(10)
v_mfma_f32_32x32x16_bf16 v[96:111], a[36:39], v[16:19], v[96:111]
s_add_u32 s34, s34, 4096
buffer_store_dwordx4 v[64:67], v0, s[8:11], s34 offen offset:0 sc1
ds_read_b64_tr_b16 v[16:17], v3 offset:49664
ds_read_b64_tr_b16 v[18:19], v3 offset:50688
s_waitcnt lgkmcnt(10)
v_mfma_f32_32x32x16_bf16 v[112:127], a[36:39], v[20:23], v[112:127]
buffer_store_dwordx4 v[68:71], v0, s[8:11], s34 offen offset:1024 sc1
ds_read_b64_tr_b16 v[20:21], v3 offset:49920
ds_read_b64_tr_b16 v[22:23], v3 offset:50944
s_waitcnt lgkmcnt(10)
v_mfma_f32_32x32x16_bf16 v[96:111], a[40:43], v[24:27], v[96:111]
v_mul_f32 v80, s96, v80
v_mul_f32 v81, s96, v81
v_cvt_pk_bf16_f32 v80, v80, v81
v_mul_f32 v82, s96, v82
v_mul_f32 v83, s96, v83
v_cvt_pk_bf16_f32 v81, v82, v83
ds_read_b64_tr_b16 v[24:25], v3 offset:53760
ds_read_b64_tr_b16 v[26:27], v3 offset:54784
s_waitcnt lgkmcnt(10)
v_mfma_f32_32x32x16_bf16 v[112:127], a[40:43], v[28:31], v[112:127]
v_mul_f32 v84, s96, v84
v_mul_f32 v85, s96, v85
v_cvt_pk_bf16_f32 v82, v84, v85
v_mul_f32 v86, s96, v86
v_mul_f32 v87, s96, v87
v_cvt_pk_bf16_f32 v83, v86, v87
ds_read_b64_tr_b16 v[28:29], v3 offset:54016
ds_read_b64_tr_b16 v[30:31], v3 offset:55040
s_waitcnt lgkmcnt(10)
v_mfma_f32_32x32x16_bf16 v[96:111], a[44:47], v[8:11], v[96:111]
v_mul_f32 v88, s96, v88
v_mul_f32 v89, s96, v89
v_cvt_pk_bf16_f32 v84, v88, v89
v_mul_f32 v90, s96, v90
v_mul_f32 v91, s96, v91
v_cvt_pk_bf16_f32 v85, v90, v91
ds_read_b64_tr_b16 v[8:9], v3 offset:57856
ds_read_b64_tr_b16 v[10:11], v3 offset:58880
s_waitcnt lgkmcnt(10)
v_mfma_f32_32x32x16_bf16 v[112:127], a[44:47], v[12:15], v[112:127]
v_mul_f32 v92, s96, v92
v_mul_f32 v93, s96, v93
v_cvt_pk_bf16_f32 v86, v92, v93
v_mul_f32 v94, s96, v94
v_mul_f32 v95, s96, v95
v_cvt_pk_bf16_f32 v87, v94, v95
ds_read_b64_tr_b16 v[12:13], v3 offset:58112
ds_read_b64_tr_b16 v[14:15], v3 offset:59136
s_waitcnt lgkmcnt(10)
v_mfma_f32_32x32x16_bf16 v[96:111], a[48:51], v[16:19], v[96:111]
buffer_store_dwordx4 v[80:83], v0, s[8:11], s34 offen offset:2048 sc1
ds_read_b64_tr_b16 v[16:17], v3 offset:61952
ds_read_b64_tr_b16 v[18:19], v3 offset:62976
s_waitcnt lgkmcnt(10)
v_mfma_f32_32x32x16_bf16 v[112:127], a[48:51], v[20:23], v[112:127]
buffer_store_dwordx4 v[84:87], v0, s[8:11], s34 offen offset:3072 sc1
ds_read_b64_tr_b16 v[20:21], v3 offset:62208
ds_read_b64_tr_b16 v[22:23], v3 offset:63232
s_waitcnt lgkmcnt(10)
v_mfma_f32_32x32x16_bf16 v[96:111], a[52:55], v[24:27], v[96:111]
s_barrier
ds_read_b64_tr_b16 v[24:25], v4 offset:0
ds_read_b64_tr_b16 v[26:27], v4 offset:1024
s_waitcnt lgkmcnt(10)
v_mfma_f32_32x32x16_bf16 v[112:127], a[52:55], v[28:31], v[112:127]
ds_read_b64_tr_b16 v[28:29], v4 offset:256
ds_read_b64_tr_b16 v[30:31], v4 offset:1280
s_waitcnt lgkmcnt(10)
v_mfma_f32_32x32x16_bf16 v[96:111], a[56:59], v[8:11], v[96:111]
ds_read_b64_tr_b16 v[8:9], v4 offset:4096
ds_read_b64_tr_b16 v[10:11], v4 offset:5120
s_waitcnt lgkmcnt(10)
v_mfma_f32_32x32x16_bf16 v[112:127], a[56:59], v[12:15], v[112:127]
ds_read_b64_tr_b16 v[12:13], v4 offset:4352
ds_read_b64_tr_b16 v[14:15], v4 offset:5376
s_waitcnt lgkmcnt(10)
v_mfma_f32_32x32x16_bf16 v[96:111], a[60:63], v[16:19], v[96:111]
ds_read_b64_tr_b16 v[16:17], v4 offset:8192
ds_read_b64_tr_b16 v[18:19], v4 offset:9216
s_waitcnt lgkmcnt(10)
v_mfma_f32_32x32x16_bf16 v[112:127], a[60:63], v[20:23], v[112:127]
s_add_u32 s33, s60, 0
buffer_load_dwordx4 v[80:83], v0, s[8:11], s33 offen offset:0 sc1
ds_read_b64_tr_b16 v[20:21], v4 offset:8448
ds_read_b64_tr_b16 v[22:23], v4 offset:9472
s_waitcnt lgkmcnt(10)
v_mfma_f32_32x32x16_bf16 v[96:111], a[64:67], v[24:27], v[96:111]
s_add_u32 s33, s60, 0
buffer_load_dwordx4 v[84:87], v0, s[8:11], s33 offen offset:1024 sc1
ds_read_b64_tr_b16 v[24:25], v4 offset:12288
ds_read_b64_tr_b16 v[26:27], v4 offset:13312
s_waitcnt lgkmcnt(10)
v_mfma_f32_32x32x16_bf16 v[112:127], a[64:67], v[28:31], v[112:127]
s_add_u32 s33, s60, 0
buffer_load_dwordx4 v[88:91], v0, s[8:11], s33 offen offset:2048 sc1
ds_read_b64_tr_b16 v[28:29], v4 offset:12544
ds_read_b64_tr_b16 v[30:31], v4 offset:13568
s_waitcnt lgkmcnt(10)
v_mfma_f32_32x32x16_bf16 v[96:111], a[68:71], v[8:11], v[96:111]
s_add_u32 s33, s60, 0
buffer_load_dwordx4 v[92:95], v0, s[8:11], s33 offen offset:3072 sc1
ds_read_b64_tr_b16 v[8:9], v4 offset:16384
ds_read_b64_tr_b16 v[10:11], v4 offset:17408
s_waitcnt lgkmcnt(10)
v_mfma_f32_32x32x16_bf16 v[112:127], a[68:71], v[12:15], v[112:127]
ds_read_b64_tr_b16 v[12:13], v4 offset:16640
ds_read_b64_tr_b16 v[14:15], v4 offset:17664
s_waitcnt lgkmcnt(10)
v_mfma_f32_32x32x16_bf16 v[96:111], a[72:75], v[16:19], v[96:111]
s_add_u32 m0, s29, 32768
s_add_u32 s33, s30, 327680
buffer_load_dwordx4 v1, s[40:43], s33 offen lds
ds_read_b64_tr_b16 v[16:17], v4 offset:20480
ds_read_b64_tr_b16 v[18:19], v4 offset:21504
s_waitcnt lgkmcnt(10)
v_mfma_f32_32x32x16_bf16 v[112:127], a[72:75], v[20:23], v[112:127]
ds_read_b64_tr_b16 v[20:21], v4 offset:20736
ds_read_b64_tr_b16 v[22:23], v4 offset:21760
s_waitcnt lgkmcnt(10)
v_mfma_f32_32x32x16_bf16 v[96:111], a[76:79], v[24:27], v[96:111]
s_add_u32 m0, s29, 33792
s_add_u32 s33, s30, 332800
buffer_load_dwordx4 v1, s[40:43], s33 offen lds
ds_read_b64_tr_b16 v[24:25], v4 offset:24576
ds_read_b64_tr_b16 v[26:27], v4 offset:25600
s_waitcnt lgkmcnt(10)
v_mfma_f32_32x32x16_bf16 v[112:127], a[76:79], v[28:31], v[112:127]
ds_read_b64_tr_b16 v[28:29], v4 offset:24832
ds_read_b64_tr_b16 v[30:31], v4 offset:25856
s_waitcnt lgkmcnt(10)
v_mfma_f32_32x32x16_bf16 v[96:111], a[80:83], v[8:11], v[96:111]
s_add_u32 m0, s29, 34816
s_add_u32 s33, s30, 337920
buffer_load_dwordx4 v1, s[40:43], s33 offen lds
ds_read_b64_tr_b16 v[8:9], v4 offset:28672
ds_read_b64_tr_b16 v[10:11], v4 offset:29696
s_waitcnt lgkmcnt(10)
v_mfma_f32_32x32x16_bf16 v[112:127], a[80:83], v[12:15], v[112:127]
ds_read_b64_tr_b16 v[12:13], v4 offset:28928
ds_read_b64_tr_b16 v[14:15], v4 offset:29952
s_waitcnt lgkmcnt(10)
v_mfma_f32_32x32x16_bf16 v[96:111], a[84:87], v[16:19], v[96:111]
s_add_u32 m0, s29, 35840
s_add_u32 s33, s30, 343040
buffer_load_dwordx4 v1, s[40:43], s33 offen lds
ds_read_b64_tr_b16 v[16:17], v4 offset:512
ds_read_b64_tr_b16 v[18:19], v4 offset:1536
s_waitcnt lgkmcnt(10)
v_mfma_f32_32x32x16_bf16 v[112:127], a[84:87], v[20:23], v[112:127]
ds_read_b64_tr_b16 v[20:21], v4 offset:768
ds_read_b64_tr_b16 v[22:23], v4 offset:1792
s_waitcnt lgkmcnt(10)
v_mfma_f32_32x32x16_bf16 v[96:111], a[88:91], v[24:27], v[96:111]
s_waitcnt vmcnt(19)
ds_read_b64_tr_b16 v[24:25], v4 offset:4608
ds_read_b64_tr_b16 v[26:27], v4 offset:5632
s_waitcnt lgkmcnt(10)
v_mfma_f32_32x32x16_bf16 v[112:127], a[88:91], v[28:31], v[112:127]
v_lshrrev_b32 v7, 9, v0
ds_read_b64_tr_b16 v[28:29], v4 offset:4864
ds_read_b64_tr_b16 v[30:31], v4 offset:5888
s_waitcnt lgkmcnt(10)
v_mfma_f32_32x32x16_bf16 v[96:111], a[92:95], v[8:11], v[96:111]
v_lshlrev_b32 v6, 10, v7
ds_read_b64_tr_b16 v[8:9], v4 offset:8704
ds_read_b64_tr_b16 v[10:11], v4 offset:9728
s_waitcnt lgkmcnt(10)
v_mfma_f32_32x32x16_bf16 v[112:127], a[92:95], v[12:15], v[112:127]
v_and_b32 v2, 0xc0, v0
ds_read_b64_tr_b16 v[12:13], v4 offset:8960
ds_read_b64_tr_b16 v[14:15], v4 offset:9984
s_waitcnt lgkmcnt(10)
v_mfma_f32_32x32x16_bf16 v[96:111], a[96:99], v[16:19], v[96:111]
v_add_u32 v6, v6, v2
ds_read_b64_tr_b16 v[16:17], v4 offset:12800
ds_read_b64_tr_b16 v[18:19], v4 offset:13824
s_waitcnt lgkmcnt(10)
v_mfma_f32_32x32x16_bf16 v[112:127], a[96:99], v[20:23], v[112:127]
v_bfe_u32 v2, v0, 8, 1
ds_read_b64_tr_b16 v[20:21], v4 offset:13056
ds_read_b64_tr_b16 v[22:23], v4 offset:14080
s_waitcnt lgkmcnt(10)
v_mfma_f32_32x32x16_bf16 v[96:111], a[100:103], v[24:27], v[96:111]
v_lshl_add_u32 v6, v2, 5, v6
ds_read_b64_tr_b16 v[24:25], v4 offset:16896
ds_read_b64_tr_b16 v[26:27], v4 offset:17920
s_waitcnt lgkmcnt(10)
v_mfma_f32_32x32x16_bf16 v[112:127], a[100:103], v[28:31], v[112:127]
v_bfe_u32 v2, v0, 4, 2
ds_read_b64_tr_b16 v[28:29], v4 offset:17152
ds_read_b64_tr_b16 v[30:31], v4 offset:18176
s_waitcnt lgkmcnt(10)
v_mfma_f32_32x32x16_bf16 v[96:111], a[104:107], v[8:11], v[96:111]
v_lshl_add_u32 v6, v2, 3, v6
ds_read_b64_tr_b16 v[8:9], v4 offset:20992
ds_read_b64_tr_b16 v[10:11], v4 offset:22016
s_waitcnt lgkmcnt(10)
v_mfma_f32_32x32x16_bf16 v[112:127], a[104:107], v[12:15], v[112:127]
v_add_u32 v6, s28, v6
ds_read_b64_tr_b16 v[12:13], v4 offset:21248
ds_read_b64_tr_b16 v[14:15], v4 offset:22272
s_waitcnt lgkmcnt(10)
v_mfma_f32_32x32x16_bf16 v[96:111], a[108:111], v[16:19], v[96:111]
v_bfe_u32 v2, v0, 4, 5
ds_read_b64_tr_b16 v[16:17], v4 offset:25088
ds_read_b64_tr_b16 v[18:19], v4 offset:26112
s_waitcnt lgkmcnt(10)
v_mfma_f32_32x32x16_bf16 v[112:127], a[108:111], v[20:23], v[112:127]
v_add_u32 v2, s61, v2
ds_read_b64_tr_b16 v[20:21], v4 offset:25344
ds_read_b64_tr_b16 v[22:23], v4 offset:26368
s_waitcnt lgkmcnt(10)
v_mfma_f32_32x32x16_bf16 v[96:111], a[112:115], v[24:27], v[96:111]
v_cmp_gt_u32 vcc, 0x800, v2
ds_read_b64_tr_b16 v[24:25], v4 offset:29184
ds_read_b64_tr_b16 v[26:27], v4 offset:30208
s_waitcnt lgkmcnt(10)
v_mfma_f32_32x32x16_bf16 v[112:127], a[112:115], v[28:31], v[112:127]
v_and_b32 v64, 31, v2
ds_read_b64_tr_b16 v[28:29], v4 offset:29440
ds_read_b64_tr_b16 v[30:31], v4 offset:30464
s_waitcnt lgkmcnt(10)
v_mfma_f32_32x32x16_bf16 v[96:111], a[116:119], v[8:11], v[96:111]
v_bfe_u32 v2, v2, 5, 6
s_barrier
ds_read_b64_tr_b16 v[8:9], v4 offset:32768
ds_read_b64_tr_b16 v[10:11], v4 offset:33792
s_waitcnt lgkmcnt(10)
v_mfma_f32_32x32x16_bf16 v[112:127], a[116:119], v[12:15], v[112:127]
v_mul_u32_u24 v2, 0xa000, v2
ds_read_b64_tr_b16 v[12:13], v4 offset:33024
ds_read_b64_tr_b16 v[14:15], v4 offset:34048
s_waitcnt lgkmcnt(10)
v_mfma_f32_32x32x16_bf16 v[96:111], a[120:123], v[16:19], v[96:111]
v_lshl_add_u32 v2, v64, 4, v2
ds_read_b64_tr_b16 v[16:17], v4 offset:36864
ds_read_b64_tr_b16 v[18:19], v4 offset:37888
s_waitcnt lgkmcnt(10)
v_mfma_f32_32x32x16_bf16 v[112:127], a[120:123], v[20:23], v[112:127]
v_lshl_add_u32 v2, v7, 9, v2
ds_read_b64_tr_b16 v[20:21], v4 offset:37120
ds_read_b64_tr_b16 v[22:23], v4 offset:38144
s_waitcnt lgkmcnt(10)
v_mfma_f32_32x32x16_bf16 v[96:111], a[124:127], v[24:27], v[96:111]
v_add_u32 v7, 0x10000, v6
ds_read_b64_tr_b16 v[24:25], v4 offset:40960
ds_read_b64_tr_b16 v[26:27], v4 offset:41984
s_waitcnt lgkmcnt(10)
v_mfma_f32_32x32x16_bf16 v[112:127], a[124:127], v[28:31], v[112:127]
ds_read_b64_tr_b16 v[28:29], v4 offset:41216
ds_read_b64_tr_b16 v[30:31], v4 offset:42240
s_waitcnt lgkmcnt(10)
v_mfma_f32_32x32x16_bf16 v[32:47], a[0:3], v[8:11], 0
ds_read_b64_tr_b16 v[8:9], v4 offset:45056
ds_read_b64_tr_b16 v[10:11], v4 offset:46080
s_waitcnt lgkmcnt(10)
v_mfma_f32_32x32x16_bf16 v[48:63], a[0:3], v[12:15], 0
s_add_u32 s33, s60, 4096
buffer_load_dwordx4 a[0:3], v0, s[8:11], s33 offen offset:0 sc1
ds_read_b64_tr_b16 v[12:13], v4 offset:45312
ds_read_b64_tr_b16 v[14:15], v4 offset:46336
s_waitcnt lgkmcnt(10)
v_mfma_f32_32x32x16_bf16 v[32:47], a[4:7], v[16:19], v[32:47]
v_cvt_pk_bf16_f32 v96, v96, v97
v_cvt_pk_bf16_f32 v97, v98, v99
ds_read_b64_tr_b16 v[16:17], v4 offset:49152
ds_read_b64_tr_b16 v[18:19], v4 offset:50176
s_waitcnt lgkmcnt(10)
v_mfma_f32_32x32x16_bf16 v[48:63], a[4:7], v[20:23], v[48:63]
v_cvt_pk_bf16_f32 v98, v100, v101
v_cvt_pk_bf16_f32 v99, v102, v103
s_add_u32 s33, s60, 4096
buffer_load_dwordx4 a[4:7], v0, s[8:11], s33 offen offset:1024 sc1
ds_read_b64_tr_b16 v[20:21], v4 offset:49408
ds_read_b64_tr_b16 v[22:23], v4 offset:50432
s_waitcnt lgkmcnt(10)
v_mfma_f32_32x32x16_bf16 v[32:47], a[8:11], v[24:27], v[32:47]
v_cvt_pk_bf16_f32 v100, v104, v105
v_cvt_pk_bf16_f32 v101, v106, v107
s_add_u32 m0, s29, 65536
s_add_u32 s33, s30, 655360
buffer_load_dwordx4 v1, s[40:43], s33 offen lds
ds_read_b64_tr_b16 v[24:25], v4 offset:53248
ds_read_b64_tr_b16 v[26:27], v4 offset:54272
s_waitcnt lgkmcnt(10)
v_mfma_f32_32x32x16_bf16 v[48:63], a[8:11], v[28:31], v[48:63]
v_cvt_pk_bf16_f32 v102, v108, v109
v_cvt_pk_bf16_f32 v103, v110, v111
s_add_u32 s33, s60, 4096
buffer_load_dwordx4 a[8:11], v0, s[8:11], s33 offen offset:2048 sc1
ds_read_b64_tr_b16 v[28:29], v4 offset:53504
ds_read_b64_tr_b16 v[30:31], v4 offset:54528
s_waitcnt lgkmcnt(10)
v_mfma_f32_32x32x16_bf16 v[32:47], a[12:15], v[8:11], v[32:47]
buffer_store_dwordx4 v[96:99], v0, s[8:11], s35 offen offset:0 sc1
s_add_u32 m0, s29, 66560
s_add_u32 s33, s30, 660480
buffer_load_dwordx4 v1, s[40:43], s33 offen lds
ds_read_b64_tr_b16 v[8:9], v4 offset:57344
ds_read_b64_tr_b16 v[10:11], v4 offset:58368
s_waitcnt lgkmcnt(10)
v_mfma_f32_32x32x16_bf16 v[48:63], a[12:15], v[12:15], v[48:63]
buffer_store_dwordx4 v[100:103], v0, s[8:11], s35 offen offset:1024 sc1
s_add_u32 s35, s35, 4096
s_add_u32 s33, s60, 4096
buffer_load_dwordx4 a[12:15], v0, s[8:11], s33 offen offset:3072 sc1
ds_read_b64_tr_b16 v[12:13], v4 offset:57600
ds_read_b64_tr_b16 v[14:15], v4 offset:58624
s_waitcnt lgkmcnt(10)
v_mfma_f32_32x32x16_bf16 v[32:47], a[16:19], v[16:19], v[32:47]
v_cvt_pk_bf16_f32 v112, v112, v113
v_cvt_pk_bf16_f32 v113, v114, v115
s_add_u32 m0, s29, 67584
s_add_u32 s33, s30, 665600
buffer_load_dwordx4 v1, s[40:43], s33 offen lds
ds_read_b64_tr_b16 v[16:17], v4 offset:61440
ds_read_b64_tr_b16 v[18:19], v4 offset:62464
s_waitcnt lgkmcnt(10)
v_mfma_f32_32x32x16_bf16 v[48:63], a[16:19], v[20:23], v[48:63]
v_cvt_pk_bf16_f32 v114, v116, v117
v_cvt_pk_bf16_f32 v115, v118, v119
s_add_u32 s33, s60, 8192
buffer_load_dwordx4 a[16:19], v0, s[8:11], s33 offen offset:0 sc1
ds_read_b64_tr_b16 v[20:21], v4 offset:61696
ds_read_b64_tr_b16 v[22:23], v4 offset:62720
s_waitcnt lgkmcnt(10)
v_mfma_f32_32x32x16_bf16 v[32:47], a[20:23], v[24:27], v[32:47]
v_cvt_pk_bf16_f32 v116, v120, v121
v_cvt_pk_bf16_f32 v117, v122, v123
s_add_u32 m0, s29, 68608
s_add_u32 s33, s30, 670720
buffer_load_dwordx4 v1, s[40:43], s33 offen lds
ds_read_b64_tr_b16 v[24:25], v4 offset:33280
ds_read_b64_tr_b16 v[26:27], v4 offset:34304
s_waitcnt lgkmcnt(10)
v_mfma_f32_32x32x16_bf16 v[48:63], a[20:23], v[28:31], v[48:63]
v_cvt_pk_bf16_f32 v118, v124, v125
v_cvt_pk_bf16_f32 v119, v126, v127
s_add_u32 s33, s60, 8192
buffer_load_dwordx4 a[20:23], v0, s[8:11], s33 offen offset:1024 sc1
ds_read_b64_tr_b16 v[28:29], v4 offset:33536
ds_read_b64_tr_b16 v[30:31], v4 offset:34560
s_waitcnt lgkmcnt(10)
v_mfma_f32_32x32x16_bf16 v[32:47], a[24:27], v[8:11], v[32:47]
buffer_store_dwordx4 v[112:115], v0, s[8:11], s35 offen offset:0 sc1
v_bfe_u32 v1, v0, 2, 7
ds_read_b64_tr_b16 v[8:9], v4 offset:37376
ds_read_b64_tr_b16 v[10:11], v4 offset:38400
s_waitcnt lgkmcnt(10)
v_mfma_f32_32x32x16_bf16 v[48:63], a[24:27], v[12:15], v[48:63]
buffer_store_dwordx4 v[116:119], v0, s[8:11], s35 offen offset:1024 sc1
s_add_u32 s35, s35, 4096
s_add_u32 s33, s60, 8192
buffer_load_dwordx4 a[24:27], v0, s[8:11], s33 offen offset:2048 sc1
ds_read_b64_tr_b16 v[12:13], v4 offset:37632
ds_read_b64_tr_b16 v[14:15], v4 offset:38656
s_waitcnt lgkmcnt(10)
v_mfma_f32_32x32x16_bf16 v[32:47], a[28:31], v[16:19], v[32:47]
buffer_load_dword v1, v1, s[8:11], s56 offen sc1
ds_read_b64_tr_b16 v[16:17], v4 offset:41472
ds_read_b64_tr_b16 v[18:19], v4 offset:42496
s_waitcnt lgkmcnt(10)
v_mfma_f32_32x32x16_bf16 v[48:63], a[28:31], v[20:23], v[48:63]
s_add_u32 s33, s60, 8192
buffer_load_dwordx4 a[28:31], v0, s[8:11], s33 offen offset:3072 sc1
ds_read_b64_tr_b16 v[20:21], v4 offset:41728
ds_read_b64_tr_b16 v[22:23], v4 offset:42752
s_waitcnt lgkmcnt(10)
v_mfma_f32_32x32x16_bf16 v[32:47], a[32:35], v[24:27], v[32:47]
s_add_u32 s33, s60, 20480
buffer_load_dwordx4 v[96:99], v0, s[8:11], s33 offen offset:0 sc1
ds_read_b64_tr_b16 v[24:25], v4 offset:45568
ds_read_b64_tr_b16 v[26:27], v4 offset:46592
s_waitcnt lgkmcnt(10)
v_mfma_f32_32x32x16_bf16 v[48:63], a[32:35], v[28:31], v[48:63]
s_add_u32 s33, s60, 12288
buffer_load_dwordx4 a[32:35], v0, s[8:11], s33 offen offset:0 sc1
ds_read_b64_tr_b16 v[28:29], v4 offset:45824
ds_read_b64_tr_b16 v[30:31], v4 offset:46848
s_waitcnt lgkmcnt(10)
v_mfma_f32_32x32x16_bf16 v[32:47], a[36:39], v[8:11], v[32:47]
s_add_u32 s33, s60, 20480
buffer_load_dwordx4 v[100:103], v0, s[8:11], s33 offen offset:1024 sc1
ds_read_b64_tr_b16 v[8:9], v4 offset:49664
ds_read_b64_tr_b16 v[10:11], v4 offset:50688
s_waitcnt lgkmcnt(10)
v_mfma_f32_32x32x16_bf16 v[48:63], a[36:39], v[12:15], v[48:63]
s_add_u32 s33, s60, 12288
buffer_load_dwordx4 a[36:39], v0, s[8:11], s33 offen offset:1024 sc1
ds_read_b64_tr_b16 v[12:13], v4 offset:49920
ds_read_b64_tr_b16 v[14:15], v4 offset:50944
s_waitcnt lgkmcnt(10)
v_mfma_f32_32x32x16_bf16 v[32:47], a[40:43], v[16:19], v[32:47]
s_add_u32 s33, s60, 20480
buffer_load_dwordx4 v[104:107], v0, s[8:11], s33 offen offset:2048 sc1
ds_read_b64_tr_b16 v[16:17], v4 offset:53760
ds_read_b64_tr_b16 v[18:19], v4 offset:54784
s_waitcnt lgkmcnt(10)
v_mfma_f32_32x32x16_bf16 v[48:63], a[40:43], v[20:23], v[48:63]
s_add_u32 s33, s60, 12288
buffer_load_dwordx4 a[40:43], v0, s[8:11], s33 offen offset:2048 sc1
ds_read_b64_tr_b16 v[20:21], v4 offset:54016
ds_read_b64_tr_b16 v[22:23], v4 offset:55040
s_waitcnt lgkmcnt(10)
v_mfma_f32_32x32x16_bf16 v[32:47], a[44:47], v[24:27], v[32:47]
s_add_u32 s33, s60, 20480
buffer_load_dwordx4 v[108:111], v0, s[8:11], s33 offen offset:3072 sc1
ds_read_b64_tr_b16 v[24:25], v4 offset:57856
ds_read_b64_tr_b16 v[26:27], v4 offset:58880
s_waitcnt lgkmcnt(10)
v_mfma_f32_32x32x16_bf16 v[48:63], a[44:47], v[28:31], v[48:63]
s_add_u32 s33, s60, 12288
buffer_load_dwordx4 a[44:47], v0, s[8:11], s33 offen offset:3072 sc1
ds_read_b64_tr_b16 v[28:29], v4 offset:58112
ds_read_b64_tr_b16 v[30:31], v4 offset:59136
s_waitcnt lgkmcnt(10)
v_mfma_f32_32x32x16_bf16 v[32:47], a[48:51], v[8:11], v[32:47]
s_add_u32 s33, s60, 24576
buffer_load_dwordx4 v[112:115], v0, s[8:11], s33 offen offset:0 sc1
ds_read_b64_tr_b16 v[8:9], v4 offset:61952
ds_read_b64_tr_b16 v[10:11], v4 offset:62976
s_waitcnt lgkmcnt(10)
v_mfma_f32_32x32x16_bf16 v[48:63], a[48:51], v[12:15], v[48:63]
s_add_u32 s33, s60, 16384
buffer_load_dwordx4 a[48:51], v0, s[8:11], s33 offen offset:0 sc1
ds_read_b64_tr_b16 v[12:13], v4 offset:62208
ds_read_b64_tr_b16 v[14:15], v4 offset:63232
s_waitcnt lgkmcnt(10)
v_mfma_f32_32x32x16_bf16 v[32:47], a[52:55], v[16:19], v[32:47]
s_add_u32 s33, s60, 24576
buffer_load_dwordx4 v[116:119], v0, s[8:11], s33 offen offset:1024 sc1
s_barrier
ds_read_b64_tr_b16 v[16:17], v5 offset:0
ds_read_b64_tr_b16 v[18:19], v5 offset:1024
s_waitcnt lgkmcnt(10)
v_mfma_f32_32x32x16_bf16 v[48:63], a[52:55], v[20:23], v[48:63]
s_add_u32 s33, s60, 16384
buffer_load_dwordx4 a[52:55], v0, s[8:11], s33 offen offset:1024 sc1
ds_read_b64_tr_b16 v[20:21], v5 offset:256
ds_read_b64_tr_b16 v[22:23], v5 offset:1280
s_waitcnt lgkmcnt(10)
v_mfma_f32_32x32x16_bf16 v[32:47], a[56:59], v[24:27], v[32:47]
s_add_u32 s33, s60, 24576
buffer_load_dwordx4 v[120:123], v0, s[8:11], s33 offen offset:2048 sc1
ds_read_b64_tr_b16 v[24:25], v5 offset:4096
ds_read_b64_tr_b16 v[26:27], v5 offset:5120
s_waitcnt lgkmcnt(10)
v_mfma_f32_32x32x16_bf16 v[48:63], a[56:59], v[28:31], v[48:63]
s_add_u32 s33, s60, 16384
buffer_load_dwordx4 a[56:59], v0, s[8:11], s33 offen offset:2048 sc1
ds_read_b64_tr_b16 v[28:29], v5 offset:4352
ds_read_b64_tr_b16 v[30:31], v5 offset:5376
s_waitcnt lgkmcnt(10)
v_mfma_f32_32x32x16_bf16 v[32:47], a[60:63], v[8:11], v[32:47]
s_add_u32 s33, s60, 24576
buffer_load_dwordx4 v[124:127], v0, s[8:11], s33 offen offset:3072 sc1
ds_read_b64_tr_b16 v[8:9], v5 offset:8192
ds_read_b64_tr_b16 v[10:11], v5 offset:9216
s_waitcnt lgkmcnt(10)
v_mfma_f32_32x32x16_bf16 v[48:63], a[60:63], v[12:15], v[48:63]
s_add_u32 s33, s60, 16384
buffer_load_dwordx4 a[60:63], v0, s[8:11], s33 offen offset:3072 sc1
ds_read_b64_tr_b16 v[12:13], v5 offset:8448
ds_read_b64_tr_b16 v[14:15], v5 offset:9472
s_waitcnt lgkmcnt(10)
v_mfma_f32_32x32x16_bf16 v[32:47], a[64:67], v[16:19], v[32:47]
ds_read_b64_tr_b16 v[16:17], v5 offset:12288
ds_read_b64_tr_b16 v[18:19], v5 offset:13312
s_waitcnt lgkmcnt(10)
v_mfma_f32_32x32x16_bf16 v[48:63], a[64:67], v[20:23], v[48:63]
s_add_u32 s33, s60, 28672
buffer_load_dwordx4 a[64:67], v0, s[8:11], s33 offen offset:0 sc1
ds_read_b64_tr_b16 v[20:21], v5 offset:12544
ds_read_b64_tr_b16 v[22:23], v5 offset:13568
s_waitcnt lgkmcnt(10)
v_mfma_f32_32x32x16_bf16 v[32:47], a[68:71], v[24:27], v[32:47]
ds_read_b64_tr_b16 v[24:25], v5 offset:16384
ds_read_b64_tr_b16 v[26:27], v5 offset:17408
s_waitcnt lgkmcnt(10)
v_mfma_f32_32x32x16_bf16 v[48:63], a[68:71], v[28:31], v[48:63]
s_add_u32 s33, s60, 28672
buffer_load_dwordx4 a[68:71], v0, s[8:11], s33 offen offset:1024 sc1
ds_read_b64_tr_b16 v[28:29], v5 offset:16640
ds_read_b64_tr_b16 v[30:31], v5 offset:17664
s_waitcnt lgkmcnt(10)
v_mfma_f32_32x32x16_bf16 v[32:47], a[72:75], v[8:11], v[32:47]
ds_read_b64_tr_b16 v[8:9], v5 offset:20480
ds_read_b64_tr_b16 v[10:11], v5 offset:21504
s_waitcnt lgkmcnt(10)
v_mfma_f32_32x32x16_bf16 v[48:63], a[72:75], v[12:15], v[48:63]
s_add_u32 s33, s60, 28672
buffer_load_dwordx4 a[72:75], v0, s[8:11], s33 offen offset:2048 sc1
ds_read_b64_tr_b16 v[12:13], v5 offset:20736
ds_read_b64_tr_b16 v[14:15], v5 offset:21760
s_waitcnt lgkmcnt(10)
v_mfma_f32_32x32x16_bf16 v[32:47], a[76:79], v[16:19], v[32:47]
ds_read_b64_tr_b16 v[16:17], v5 offset:24576
ds_read_b64_tr_b16 v[18:19], v5 offset:25600
s_waitcnt lgkmcnt(10)
v_mfma_f32_32x32x16_bf16 v[48:63], a[76:79], v[20:23], v[48:63]
s_add_u32 s33, s60, 28672
buffer_load_dwordx4 a[76:79], v0, s[8:11], s33 offen offset:3072 sc1
ds_read_b64_tr_b16 v[20:21], v5 offset:24832
ds_read_b64_tr_b16 v[22:23], v5 offset:25856
s_waitcnt lgkmcnt(10)
v_mfma_f32_32x32x16_bf16 v[32:47], a[80:83], v[24:27], v[32:47]
ds_read_b64_tr_b16 v[24:25], v5 offset:28672
ds_read_b64_tr_b16 v[26:27], v5 offset:29696
s_waitcnt lgkmcnt(10)
v_mfma_f32_32x32x16_bf16 v[48:63], a[80:83], v[28:31], v[48:63]
s_add_u32 s33, s60, 32768
buffer_load_dwordx4 a[80:83], v0, s[8:11], s33 offen offset:0 sc1
ds_read_b64_tr_b16 v[28:29], v5 offset:28928
ds_read_b64_tr_b16 v[30:31], v5 offset:29952
s_waitcnt lgkmcnt(10)
v_mfma_f32_32x32x16_bf16 v[32:47], a[84:87], v[8:11], v[32:47]
ds_read_b64_tr_b16 v[8:9], v5 offset:512
ds_read_b64_tr_b16 v[10:11], v5 offset:1536
s_waitcnt lgkmcnt(10)
v_mfma_f32_32x32x16_bf16 v[48:63], a[84:87], v[12:15], v[48:63]
s_add_u32 s33, s60, 32768
buffer_load_dwordx4 a[84:87], v0, s[8:11], s33 offen offset:1024 sc1
ds_read_b64_tr_b16 v[12:13], v5 offset:768
ds_read_b64_tr_b16 v[14:15], v5 offset:1792
s_waitcnt lgkmcnt(10)
v_mfma_f32_32x32x16_bf16 v[32:47], a[88:91], v[16:19], v[32:47]
ds_read_b64_tr_b16 v[16:17], v5 offset:4608
ds_read_b64_tr_b16 v[18:19], v5 offset:5632
s_waitcnt lgkmcnt(10)
v_mfma_f32_32x32x16_bf16 v[48:63], a[88:91], v[20:23], v[48:63]
s_add_u32 s33, s60, 32768
buffer_load_dwordx4 a[88:91], v0, s[8:11], s33 offen offset:2048 sc1
ds_read_b64_tr_b16 v[20:21], v5 offset:4864
ds_read_b64_tr_b16 v[22:23], v5 offset:5888
s_waitcnt lgkmcnt(10)
v_mfma_f32_32x32x16_bf16 v[32:47], a[92:95], v[24:27], v[32:47]
ds_read_b64_tr_b16 v[24:25], v5 offset:8704
ds_read_b64_tr_b16 v[26:27], v5 offset:9728
s_waitcnt lgkmcnt(10)
v_mfma_f32_32x32x16_bf16 v[48:63], a[92:95], v[28:31], v[48:63]
s_add_u32 s33, s60, 32768
buffer_load_dwordx4 a[92:95], v0, s[8:11], s33 offen offset:3072 sc1
ds_read_b64_tr_b16 v[28:29], v5 offset:8960
ds_read_b64_tr_b16 v[30:31], v5 offset:9984
s_waitcnt lgkmcnt(10)
v_mfma_f32_32x32x16_bf16 v[32:47], a[96:99], v[8:11], v[32:47]
ds_read_b64_tr_b16 v[8:9], v5 offset:12800
ds_read_b64_tr_b16 v[10:11], v5 offset:13824
s_waitcnt lgkmcnt(10)
v_mfma_f32_32x32x16_bf16 v[48:63], a[96:99], v[12:15], v[48:63]
s_add_u32 s33, s60, 36864
buffer_load_dwordx4 a[96:99], v0, s[8:11], s33 offen offset:0 sc1
ds_read_b64_tr_b16 v[12:13], v5 offset:13056
ds_read_b64_tr_b16 v[14:15], v5 offset:14080
s_waitcnt lgkmcnt(10)
v_mfma_f32_32x32x16_bf16 v[32:47], a[100:103], v[16:19], v[32:47]
ds_read_b64_tr_b16 v[16:17], v5 offset:16896
ds_read_b64_tr_b16 v[18:19], v5 offset:17920
s_waitcnt lgkmcnt(10)
v_mfma_f32_32x32x16_bf16 v[48:63], a[100:103], v[20:23], v[48:63]
s_add_u32 s33, s60, 36864
buffer_load_dwordx4 a[100:103], v0, s[8:11], s33 offen offset:1024 sc1
ds_read_b64_tr_b16 v[20:21], v5 offset:17152
ds_read_b64_tr_b16 v[22:23], v5 offset:18176
s_waitcnt lgkmcnt(10)
v_mfma_f32_32x32x16_bf16 v[32:47], a[104:107], v[24:27], v[32:47]
ds_read_b64_tr_b16 v[24:25], v5 offset:20992
ds_read_b64_tr_b16 v[26:27], v5 offset:22016
s_waitcnt lgkmcnt(10)
v_mfma_f32_32x32x16_bf16 v[48:63], a[104:107], v[28:31], v[48:63]
s_add_u32 s33, s60, 36864
buffer_load_dwordx4 a[104:107], v0, s[8:11], s33 offen offset:2048 sc1
ds_read_b64_tr_b16 v[28:29], v5 offset:21248
ds_read_b64_tr_b16 v[30:31], v5 offset:22272
s_waitcnt lgkmcnt(10)
v_mfma_f32_32x32x16_bf16 v[32:47], a[108:111], v[8:11], v[32:47]
ds_read_b64_tr_b16 v[8:9], v5 offset:25088
ds_read_b64_tr_b16 v[10:11], v5 offset:26112
s_waitcnt lgkmcnt(10)
v_mfma_f32_32x32x16_bf16 v[48:63], a[108:111], v[12:15], v[48:63]
s_add_u32 s33, s60, 36864
buffer_load_dwordx4 a[108:111], v0, s[8:11], s33 offen offset:3072 sc1
ds_read_b64_tr_b16 v[12:13], v5 offset:25344
ds_read_b64_tr_b16 v[14:15], v5 offset:26368
s_waitcnt lgkmcnt(10)
v_mfma_f32_32x32x16_bf16 v[32:47], a[112:115], v[16:19], v[32:47]
ds_read_b64_tr_b16 v[16:17], v5 offset:29184
ds_read_b64_tr_b16 v[18:19], v5 offset:30208
s_waitcnt lgkmcnt(10)
v_mfma_f32_32x32x16_bf16 v[48:63], a[112:115], v[20:23], v[48:63]
ds_read_b64_tr_b16 v[20:21], v5 offset:29440
ds_read_b64_tr_b16 v[22:23], v5 offset:30464
s_waitcnt lgkmcnt(10)
v_mfma_f32_32x32x16_bf16 v[32:47], a[116:119], v[24:27], v[32:47]
s_waitcnt vmcnt(34)
s_barrier
ds_read_b64_tr_b16 v[24:25], v6 offset:0
ds_read_b64_tr_b16 v[26:27], v6 offset:2048
s_waitcnt lgkmcnt(10)
v_mfma_f32_32x32x16_bf16 v[48:63], a[116:119], v[28:31], v[48:63]
ds_read_b64_tr_b16 v[28:29], v6 offset:4096
ds_read_b64_tr_b16 v[30:31], v6 offset:6144
s_waitcnt lgkmcnt(10)
v_mfma_f32_32x32x16_bf16 v[32:47], a[120:123], v[8:11], v[32:47]
ds_read_b64_tr_b16 v[8:9], v6 offset:8192
ds_read_b64_tr_b16 v[10:11], v6 offset:10240
s_waitcnt lgkmcnt(10)
v_mfma_f32_32x32x16_bf16 v[48:63], a[120:123], v[12:15], v[48:63]
ds_read_b64_tr_b16 v[12:13], v6 offset:12288
ds_read_b64_tr_b16 v[14:15], v6 offset:14336
s_waitcnt lgkmcnt(10)
v_mfma_f32_32x32x16_bf16 v[32:47], a[124:127], v[16:19], v[32:47]
ds_read_b64_tr_b16 v[16:17], v6 offset:16384
ds_read_b64_tr_b16 v[18:19], v6 offset:18432
s_waitcnt lgkmcnt(10)
v_mfma_f32_32x32x16_bf16 v[48:63], a[124:127], v[20:23], v[48:63]
ds_read_b64_tr_b16 v[20:21], v6 offset:20480
ds_read_b64_tr_b16 v[22:23], v6 offset:22528
s_waitcnt lgkmcnt(10)
v_mfma_f32_32x32x16_bf16 v[64:79], v[24:27], v[80:83], 0
ds_read_b64_tr_b16 v[24:25], v6 offset:24576
ds_read_b64_tr_b16 v[26:27], v6 offset:26624
s_waitcnt lgkmcnt(10)
v_mfma_f32_32x32x16_bf16 v[64:79], v[28:31], v[84:87], v[64:79]
v_cvt_pk_bf16_f32 v32, v32, v33
v_cvt_pk_bf16_f32 v33, v34, v35
ds_read_b64_tr_b16 v[28:29], v6 offset:28672
ds_read_b64_tr_b16 v[30:31], v6 offset:30720
s_waitcnt lgkmcnt(10)
v_mfma_f32_32x32x16_bf16 v[64:79], v[8:11], v[88:91], v[64:79]
v_cvt_pk_bf16_f32 v34, v36, v37
v_cvt_pk_bf16_f32 v35, v38, v39
ds_read_b64_tr_b16 v[8:9], v6 offset:512
ds_read_b64_tr_b16 v[10:11], v6 offset:2560
s_waitcnt lgkmcnt(10)
v_mfma_f32_32x32x16_bf16 v[64:79], v[12:15], v[92:95], v[64:79]
v_cvt_pk_bf16_f32 v36, v40, v41
v_cvt_pk_bf16_f32 v37, v42, v43
ds_read_b64_tr_b16 v[12:13], v6 offset:4608
ds_read_b64_tr_b16 v[14:15], v6 offset:6656
s_waitcnt lgkmcnt(10)
v_mfma_f32_32x32x16_bf16 v[64:79], v[16:19], a[0:3], v[64:79]
v_cvt_pk_bf16_f32 v38, v44, v45
v_cvt_pk_bf16_f32 v39, v46, v47
ds_read_b64_tr_b16 v[16:17], v6 offset:8704
ds_read_b64_tr_b16 v[18:19], v6 offset:10752
s_waitcnt lgkmcnt(10)
v_mfma_f32_32x32x16_bf16 v[64:79], v[20:23], a[4:7], v[64:79]
buffer_store_dwordx4 v[32:35], v0, s[8:11], s35 offen offset:0 sc1
ds_read_b64_tr_b16 v[20:21], v6 offset:12800
ds_read_b64_tr_b16 v[22:23], v6 offset:14848
s_waitcnt lgkmcnt(10)
v_mfma_f32_32x32x16_bf16 v[64:79], v[24:27], a[8:11], v[64:79]
buffer_store_dwordx4 v[36:39], v0, s[8:11], s35 offen offset:1024 sc1
s_add_u32 s35, s35, 4096
ds_read_b64_tr_b16 v[24:25], v6 offset:16896
ds_read_b64_tr_b16 v[26:27], v6 offset:18944
s_waitcnt lgkmcnt(10)
v_mfma_f32_32x32x16_bf16 v[64:79], v[28:31], a[12:15], v[64:79]
v_cvt_pk_bf16_f32 v48, v48, v49
v_cvt_pk_bf16_f32 v49, v50, v51
ds_read_b64_tr_b16 v[28:29], v6 offset:20992
ds_read_b64_tr_b16 v[30:31], v6 offset:23040
s_waitcnt lgkmcnt(10)
v_mfma_f32_32x32x16_bf16 v[64:79], v[8:11], a[16:19], v[64:79]
v_cvt_pk_bf16_f32 v50, v52, v53
v_cvt_pk_bf16_f32 v51, v54, v55
ds_read_b64_tr_b16 v[8:9], v6 offset:25088
ds_read_b64_tr_b16 v[10:11], v6 offset:27136
s_waitcnt lgkmcnt(10)
s_waitcnt vmcnt(35)
v_mfma_f32_32x32x16_bf16 v[64:79], v[12:15], a[20:23], v[64:79]
v_cvt_pk_bf16_f32 v52, v56, v57
v_cvt_pk_bf16_f32 v53, v58, v59
ds_read_b64_tr_b16 v[12:13], v6 offset:29184
ds_read_b64_tr_b16 v[14:15], v6 offset:31232
s_waitcnt lgkmcnt(10)
s_waitcnt vmcnt(32)
v_mfma_f32_32x32x16_bf16 v[64:79], v[16:19], a[24:27], v[64:79]
v_cvt_pk_bf16_f32 v54, v60, v61
v_cvt_pk_bf16_f32 v55, v62, v63
ds_read_b64_tr_b16 v[16:17], v6 offset:32768
ds_read_b64_tr_b16 v[18:19], v6 offset:34816
s_waitcnt lgkmcnt(10)
s_waitcnt vmcnt(30)
v_mfma_f32_32x32x16_bf16 v[64:79], v[20:23], a[28:31], v[64:79]
buffer_store_dwordx4 v[48:51], v0, s[8:11], s35 offen offset:0 sc1
ds_read_b64_tr_b16 v[20:21], v6 offset:36864
ds_read_b64_tr_b16 v[22:23], v6 offset:38912
s_waitcnt lgkmcnt(10)
s_waitcnt vmcnt(29)
v_mfma_f32_32x32x16_bf16 v[64:79], v[24:27], a[32:35], v[64:79]
buffer_store_dwordx4 v[52:55], v0, s[8:11], s35 offen offset:1024 sc1
s_add_u32 s35, s35, 4096
ds_read_b64_tr_b16 v[24:25], v6 offset:40960
ds_read_b64_tr_b16 v[26:27], v6 offset:43008
s_waitcnt lgkmcnt(10)
s_waitcnt vmcnt(28)
v_mfma_f32_32x32x16_bf16 v[64:79], v[28:31], a[36:39], v[64:79]
ds_read_b64_tr_b16 v[28:29], v6 offset:45056
ds_read_b64_tr_b16 v[30:31], v6 offset:47104
s_waitcnt lgkmcnt(10)
s_waitcnt vmcnt(26)
v_mfma_f32_32x32x16_bf16 v[64:79], v[8:11], a[40:43], v[64:79]
ds_read_b64_tr_b16 v[8:9], v6 offset:49152
ds_read_b64_tr_b16 v[10:11], v6 offset:51200
s_waitcnt lgkmcnt(10)
s_waitcnt vmcnt(24)
v_mfma_f32_32x32x16_bf16 v[64:79], v[12:15], a[44:47], v[64:79]
ds_read_b64_tr_b16 v[12:13], v6 offset:53248
ds_read_b64_tr_b16 v[14:15], v6 offset:55296
s_waitcnt lgkmcnt(10)
s_waitcnt vmcnt(22)
v_mfma_f32_32x32x16_bf16 v[64:79], v[16:19], a[48:51], v[64:79]
ds_read_b64_tr_b16 v[16:17], v6 offset:57344
ds_read_b64_tr_b16 v[18:19], v6 offset:59392
s_waitcnt lgkmcnt(10)
s_waitcnt vmcnt(20)
v_mfma_f32_32x32x16_bf16 v[64:79], v[20:23], a[52:55], v[64:79]
ds_read_b64_tr_b16 v[20:21], v6 offset:61440
ds_read_b64_tr_b16 v[22:23], v6 offset:63488
s_waitcnt lgkmcnt(10)
s_waitcnt vmcnt(18)
v_mfma_f32_32x32x16_bf16 v[64:79], v[24:27], a[56:59], v[64:79]
ds_read_b64_tr_b16 v[24:25], v6 offset:33280
ds_read_b64_tr_b16 v[26:27], v6 offset:35328
s_waitcnt lgkmcnt(10)
s_waitcnt vmcnt(16)
v_mfma_f32_32x32x16_bf16 v[64:79], v[28:31], a[60:63], v[64:79]
ds_read_b64_tr_b16 v[28:29], v6 offset:37376
ds_read_b64_tr_b16 v[30:31], v6 offset:39424
s_waitcnt lgkmcnt(10)
v_mfma_f32_32x32x16_bf16 v[64:79], v[8:11], v[96:99], v[64:79]
ds_read_b64_tr_b16 v[8:9], v6 offset:41472
ds_read_b64_tr_b16 v[10:11], v6 offset:43520
s_waitcnt lgkmcnt(10)
v_mfma_f32_32x32x16_bf16 v[64:79], v[12:15], v[100:103], v[64:79]
ds_read_b64_tr_b16 v[12:13], v6 offset:45568
ds_read_b64_tr_b16 v[14:15], v6 offset:47616
s_waitcnt lgkmcnt(10)
v_mfma_f32_32x32x16_bf16 v[64:79], v[16:19], v[104:107], v[64:79]
ds_read_b64_tr_b16 v[16:17], v6 offset:49664
ds_read_b64_tr_b16 v[18:19], v6 offset:51712
s_waitcnt lgkmcnt(10)
v_mfma_f32_32x32x16_bf16 v[64:79], v[20:23], v[108:111], v[64:79]
ds_read_b64_tr_b16 v[20:21], v6 offset:53760
ds_read_b64_tr_b16 v[22:23], v6 offset:55808
s_waitcnt lgkmcnt(10)
v_mfma_f32_32x32x16_bf16 v[64:79], v[24:27], v[112:115], v[64:79]
ds_read_b64_tr_b16 v[24:25], v6 offset:57856
ds_read_b64_tr_b16 v[26:27], v6 offset:59904
s_waitcnt lgkmcnt(10)
v_mfma_f32_32x32x16_bf16 v[64:79], v[28:31], v[116:119], v[64:79]
ds_read_b64_tr_b16 v[28:29], v6 offset:61952
ds_read_b64_tr_b16 v[30:31], v6 offset:64000
s_waitcnt lgkmcnt(10)
v_mfma_f32_32x32x16_bf16 v[64:79], v[8:11], v[120:123], v[64:79]
ds_read_b64_tr_b16 v[8:9], v7 offset:0
ds_read_b64_tr_b16 v[10:11], v7 offset:2048
s_waitcnt lgkmcnt(10)
v_mfma_f32_32x32x16_bf16 v[64:79], v[12:15], v[124:127], v[64:79]
ds_read_b64_tr_b16 v[12:13], v7 offset:4096
ds_read_b64_tr_b16 v[14:15], v7 offset:6144
s_waitcnt lgkmcnt(10)
s_waitcnt vmcnt(15)
v_mfma_f32_32x32x16_bf16 v[64:79], v[16:19], a[64:67], v[64:79]
ds_read_b64_tr_b16 v[16:17], v7 offset:8192
ds_read_b64_tr_b16 v[18:19], v7 offset:10240
s_waitcnt lgkmcnt(10)
s_waitcnt vmcnt(14)
v_mfma_f32_32x32x16_bf16 v[64:79], v[20:23], a[68:71], v[64:79]
ds_read_b64_tr_b16 v[20:21], v7 offset:12288
ds_read_b64_tr_b16 v[22:23], v7 offset:14336
s_waitcnt lgkmcnt(10)
s_waitcnt vmcnt(13)
v_mfma_f32_32x32x16_bf16 v[64:79], v[24:27], a[72:75], v[64:79]
ds_read_b64_tr_b16 v[24:25], v7 offset:16384
ds_read_b64_tr_b16 v[26:27], v7 offset:18432
s_waitcnt lgkmcnt(10)
s_waitcnt vmcnt(12)
v_mfma_f32_32x32x16_bf16 v[64:79], v[28:31], a[76:79], v[64:79]
ds_read_b64_tr_b16 v[28:29], v7 offset:20480
ds_read_b64_tr_b16 v[30:31], v7 offset:22528
s_waitcnt lgkmcnt(10)
s_waitcnt vmcnt(11)
v_mfma_f32_32x32x16_bf16 v[64:79], v[8:11], a[80:83], v[64:79]
ds_read_b64_tr_b16 v[8:9], v7 offset:24576
ds_read_b64_tr_b16 v[10:11], v7 offset:26624
s_waitcnt lgkmcnt(10)
s_waitcnt vmcnt(10)
v_mfma_f32_32x32x16_bf16 v[64:79], v[12:15], a[84:87], v[64:79]
ds_read_b64_tr_b16 v[12:13], v7 offset:28672
ds_read_b64_tr_b16 v[14:15], v7 offset:30720
s_waitcnt lgkmcnt(10)
s_waitcnt vmcnt(9)
v_mfma_f32_32x32x16_bf16 v[64:79], v[16:19], a[88:91], v[64:79]
s_waitcnt lgkmcnt(8)
s_waitcnt vmcnt(8)
v_mfma_f32_32x32x16_bf16 v[64:79], v[20:23], a[92:95], v[64:79]
s_waitcnt lgkmcnt(6)
s_waitcnt vmcnt(7)
v_mfma_f32_32x32x16_bf16 v[64:79], v[24:27], a[96:99], v[64:79]
s_waitcnt lgkmcnt(4)
s_waitcnt vmcnt(6)
v_mfma_f32_32x32x16_bf16 v[64:79], v[28:31], a[100:103], v[64:79]
s_waitcnt lgkmcnt(2)
s_waitcnt vmcnt(5)
v_mfma_f32_32x32x16_bf16 v[64:79], v[8:11], a[104:107], v[64:79]
s_waitcnt lgkmcnt(0)
s_waitcnt vmcnt(4)
v_mfma_f32_32x32x16_bf16 v[64:79], v[12:15], a[108:111], v[64:79]
s_nop 11
v_mul_f32 v64, v1, v64
v_mul_f32 v65, v1, v65
v_mul_f32 v66, v1, v66
v_mul_f32 v67, v1, v67
v_mul_f32 v68, v1, v68
v_mul_f32 v69, v1, v69
v_mul_f32 v70, v1, v70
v_mul_f32 v71, v1, v71
v_mul_f32 v72, v1, v72
v_mul_f32 v73, v1, v73
v_mul_f32 v74, v1, v74
v_mul_f32 v75, v1, v75
v_mul_f32 v76, v1, v76
v_mul_f32 v77, v1, v77
v_mul_f32 v78, v1, v78
v_mul_f32 v79, v1, v79
v_mov_b32 v32, 0xbdd2d3e8
v_mul_f32 v33, v64, v64
v_mul_f32 v34, v65, v65
v_mul_f32 v35, v66, v66
v_mul_f32 v36, v67, v67
v_mul_f32 v37, v68, v68
v_mul_f32 v38, v69, v69
v_mul_f32 v39, v70, v70
v_mul_f32 v40, v71, v71
v_mul_f32 v41, v72, v72
v_mul_f32 v42, v73, v73
v_mul_f32 v43, v74, v74
v_mul_f32 v44, v75, v75
v_mul_f32 v45, v76, v76
v_mul_f32 v46, v77, v77
v_mul_f32 v47, v78, v78
v_mul_f32 v48, v79, v79
v_fmaak_f32 v33, v33, v32, 0xc0135761
v_fmaak_f32 v34, v34, v32, 0xc0135761
v_fmaak_f32 v35, v35, v32, 0xc0135761
v_fmaak_f32 v36, v36, v32, 0xc0135761
v_fmaak_f32 v37, v37, v32, 0xc0135761
v_fmaak_f32 v38, v38, v32, 0xc0135761
v_fmaak_f32 v39, v39, v32, 0xc0135761
v_fmaak_f32 v40, v40, v32, 0xc0135761
v_fmaak_f32 v41, v41, v32, 0xc0135761
v_fmaak_f32 v42, v42, v32, 0xc0135761
v_fmaak_f32 v43, v43, v32, 0xc0135761
v_fmaak_f32 v44, v44, v32, 0xc0135761
v_fmaak_f32 v45, v45, v32, 0xc0135761
v_fmaak_f32 v46, v46, v32, 0xc0135761
v_fmaak_f32 v47, v47, v32, 0xc0135761
v_fmaak_f32 v48, v48, v32, 0xc0135761
v_mul_f32 v33, v33, v64
v_mul_f32 v34, v34, v65
v_mul_f32 v35, v35, v66
v_mul_f32 v36, v36, v67
v_mul_f32 v37, v37, v68
v_mul_f32 v38, v38, v69
v_mul_f32 v39, v39, v70
v_mul_f32 v40, v40, v71
v_mul_f32 v41, v41, v72
v_mul_f32 v42, v42, v73
v_mul_f32 v43, v43, v74
v_mul_f32 v44, v44, v75
v_mul_f32 v45, v45, v76
v_mul_f32 v46, v46, v77
v_mul_f32 v47, v47, v78
v_mul_f32 v48, v48, v79
v_exp_f32 v33, v33
v_exp_f32 v34, v34
v_exp_f32 v35, v35
v_exp_f32 v36, v36
v_exp_f32 v37, v37
v_exp_f32 v38, v38
v_exp_f32 v39, v39
v_exp_f32 v40, v40
v_exp_f32 v41, v41
v_exp_f32 v42, v42
v_exp_f32 v43, v43
v_exp_f32 v44, v44
v_exp_f32 v45, v45
v_exp_f32 v46, v46
v_exp_f32 v47, v47
v_exp_f32 v48, v48
v_add_f32 v33, 1.0, v33
v_add_f32 v34, 1.0, v34
v_add_f32 v35, 1.0, v35
v_add_f32 v36, 1.0, v36
v_add_f32 v37, 1.0, v37
v_add_f32 v38, 1.0, v38
v_add_f32 v39, 1.0, v39
v_add_f32 v40, 1.0, v40
v_add_f32 v41, 1.0, v41
v_add_f32 v42, 1.0, v42
v_add_f32 v43, 1.0, v43
v_add_f32 v44, 1.0, v44
v_add_f32 v45, 1.0, v45
v_add_f32 v46, 1.0, v46
v_add_f32 v47, 1.0, v47
v_add_f32 v48, 1.0, v48
v_rcp_f32 v33, v33
v_rcp_f32 v34, v34
v_rcp_f32 v35, v35
v_rcp_f32 v36, v36
v_rcp_f32 v37, v37
v_rcp_f32 v38, v38
v_rcp_f32 v39, v39
v_rcp_f32 v40, v40
v_rcp_f32 v41, v41
v_rcp_f32 v42, v42
v_rcp_f32 v43, v43
v_rcp_f32 v44, v44
v_rcp_f32 v45, v45
v_rcp_f32 v46, v46
v_rcp_f32 v47, v47
v_rcp_f32 v48, v48
v_mul_f32 v64, v64, v33
v_mul_f32 v65, v65, v34
v_mul_f32 v66, v66, v35
v_mul_f32 v67, v67, v36
v_mul_f32 v68, v68, v37
v_mul_f32 v69, v69, v38
v_mul_f32 v70, v70, v39
v_mul_f32 v71, v71, v40
v_mul_f32 v72, v72, v41
v_mul_f32 v73, v73, v42
v_mul_f32 v74, v74, v43
v_mul_f32 v75, v75, v44
v_mul_f32 v76, v76, v45
v_mul_f32 v77, v77, v46
v_mul_f32 v78, v78, v47
v_mul_f32 v79, v79, v48
v_cvt_pk_bf16_f32 v64, v64, v65
v_cvt_pk_bf16_f32 v65, v66, v67
v_cvt_pk_bf16_f32 v66, v68, v69
v_cvt_pk_bf16_f32 v67, v70, v71
v_cvt_pk_bf16_f32 v68, v72, v73
v_cvt_pk_bf16_f32 v69, v74, v75
v_cvt_pk_bf16_f32 v70, v76, v77
v_cvt_pk_bf16_f32 v71, v78, v79
v_cndmask_b32 v64, 0, v64, vcc
v_cndmask_b32 v65, 0, v65, vcc
v_cndmask_b32 v66, 0, v66, vcc
v_cndmask_b32 v67, 0, v67, vcc
v_cndmask_b32 v68, 0, v68, vcc
v_cndmask_b32 v69, 0, v69, vcc
v_cndmask_b32 v70, 0, v70, vcc
v_cndmask_b32 v71, 0, v71, vcc
buffer_store_dwordx4 v[64:67], v2, s[8:11], s32 offen offset:0 sc1
buffer_store_dwordx4 v[68:71], v2, s[8:11], s32 offen offset:1024 sc1
s_endpgm
Ll1_pk:
s_sub_u32 s25, s2, 160
s_sub_u32 s26, s25, 42
ds_read_b64_tr_b16 v[12:13], v3 offset:24832
ds_read_b64_tr_b16 v[14:15], v3 offset:25856
s_waitcnt lgkmcnt(10)
v_mfma_f32_32x32x16_bf16 v[32:47], v[16:19], a[116:119], v[32:47]
s_cmp_ge_u32 s25, 42
s_cselect_b32 s54, s54, 0
s_cselect_b64 s[56:57], -1, 0
s_cselect_b32 s26, s26, 0
v_lshrrev_b32 v1, 6, v0
ds_read_b64_tr_b16 v[16:17], v3 offset:25088
ds_read_b64_tr_b16 v[18:19], v3 offset:26112
s_waitcnt lgkmcnt(10)
v_mfma_f32_32x32x16_bf16 v[48:63], v[20:23], a[116:119], v[48:63]
v_mul_u32_u24 v1, 3456, v1
v_and_b32 v7, 0x30, v0
ds_read_b64_tr_b16 v[20:21], v3 offset:25344
ds_read_b64_tr_b16 v[22:23], v3 offset:26368
s_waitcnt lgkmcnt(10)
v_mfma_f32_32x32x16_bf16 v[64:79], v[24:27], a[116:119], v[64:79]
v_add_u32 v1, v1, v7
s_mul_i32 s30, s24, 276480
ds_read_b64_tr_b16 v[24:25], v3 offset:28672
ds_read_b64_tr_b16 v[26:27], v3 offset:29696
s_waitcnt lgkmcnt(10)
v_mfma_f32_32x32x16_bf16 v[80:95], v[28:31], a[116:119], v[80:95]
s_lshl_b32 s27, s26, 6
s_add_u32 s30, s30, s27
ds_read_b64_tr_b16 v[28:29], v3 offset:28928
ds_read_b64_tr_b16 v[30:31], v3 offset:29952
s_waitcnt lgkmcnt(10)
v_mfma_f32_32x32x16_bf16 v[32:47], v[8:11], a[120:123], v[32:47]
s_mul_i32 s59, s24, 5120
s_sub_u32 s27, s25, 64
ds_read_b64_tr_b16 v[8:9], v3 offset:29184
ds_read_b64_tr_b16 v[10:11], v3 offset:30208
s_waitcnt lgkmcnt(10)
v_mfma_f32_32x32x16_bf16 v[48:63], v[12:15], a[120:123], v[48:63]
s_cmp_ge_u32 s25, 64
s_cselect_b64 s[44:45], s[48:49], s[44:45]
s_cselect_b32 s46, s50, s46
s_cselect_b32 s27, s27, s25
s_cselect_b32 s28, 54, 128
s_cselect_b32 s61, 5242880, 0
s_mul_i32 s60, s27, 81920
ds_read_b64_tr_b16 v[12:13], v3 offset:29440
ds_read_b64_tr_b16 v[14:15], v3 offset:30464
s_waitcnt lgkmcnt(10)
v_mfma_f32_32x32x16_bf16 v[64:79], v[16:19], a[120:123], v[64:79]
s_add_u32 s60, s60, s59
s_mul_i32 s28, s28, s24
s_waitcnt vmcnt(4)
s_barrier
ds_read_b64_tr_b16 v[16:17], v3 offset:32768
ds_read_b64_tr_b16 v[18:19], v3 offset:33792
s_waitcnt lgkmcnt(10)
v_mfma_f32_32x32x16_bf16 v[80:95], v[20:23], a[120:123], v[80:95]
s_lshl_b32 s27, s27, 1
s_add_u32 s28, s28, s27
ds_read_b64_tr_b16 v[20:21], v3 offset:33024
ds_read_b64_tr_b16 v[22:23], v3 offset:34048
s_waitcnt lgkmcnt(10)
v_mfma_f32_32x32x16_bf16 v[32:47], v[24:27], a[124:127], v[32:47]
s_mul_i32 s28, s28, 5120
s_add_u32 s61, s61, s28
ds_read_b64_tr_b16 v[24:25], v3 offset:36864
ds_read_b64_tr_b16 v[26:27], v3 offset:37888
s_waitcnt lgkmcnt(10)
v_mfma_f32_32x32x16_bf16 v[48:63], v[28:31], a[124:127], v[48:63]
s_add_u32 s61, s61, 71303168
s_mul_i32 s27, s26, 52
ds_read_b64_tr_b16 v[28:29], v3 offset:37120
ds_read_b64_tr_b16 v[30:31], v3 offset:38144
s_waitcnt lgkmcnt(10)
v_mfma_f32_32x32x16_bf16 v[64:79], v[8:11], a[124:127], v[64:79]
s_lshr_b32 s27, s27, 8
s_mul_i32 s28, s27, 195
ds_read_b64_tr_b16 v[8:9], v3 offset:40960
ds_read_b64_tr_b16 v[10:11], v3 offset:41984
s_waitcnt lgkmcnt(10)
v_mfma_f32_32x32x16_bf16 v[80:95], v[12:15], a[124:127], v[80:95]
s_add_u32 s28, s28, s26
s_mul_i32 s27, s24, 25
ds_read_b64_tr_b16 v[12:13], v3 offset:41216
ds_read_b64_tr_b16 v[14:15], v3 offset:42240
s_waitcnt lgkmcnt(10)
v_mfma_f32_32x32x16_bf16 v[96:111], a[0:3], v[16:19], 0
s_add_u32 s28, s28, s27
s_lshl_b32 s28, s28, 10
ds_read_b64_tr_b16 v[16:17], v3 offset:45056
ds_read_b64_tr_b16 v[18:19], v3 offset:46080
s_waitcnt lgkmcnt(10)
v_mfma_f32_32x32x16_bf16 v[112:127], a[0:3], v[20:23], 0
s_add_u32 s32, s28, 80740352
v_lshrrev_b32 v7, 9, v0
ds_read_b64_tr_b16 v[20:21], v3 offset:45312
ds_read_b64_tr_b16 v[22:23], v3 offset:46336
s_waitcnt lgkmcnt(10)
v_mfma_f32_32x32x16_bf16 v[96:111], a[4:7], v[24:27], v[96:111]
v_mul_f32 v32, s96, v32
v_mul_f32 v33, s96, v33
v_cvt_pk_bf16_f32 v32, v32, v33
v_mul_f32 v34, s96, v34
v_mul_f32 v35, s96, v35
v_cvt_pk_bf16_f32 v33, v34, v35
v_lshlrev_b32 v6, 8, v7
v_and_b32 v2, 0xc0, v0
ds_read_b64_tr_b16 v[24:25], v3 offset:49152
ds_read_b64_tr_b16 v[26:27], v3 offset:50176
s_waitcnt lgkmcnt(10)
v_mfma_f32_32x32x16_bf16 v[112:127], a[4:7], v[28:31], v[112:127]
v_mul_f32 v36, s96, v36
v_mul_f32 v37, s96, v37
v_cvt_pk_bf16_f32 v34, v36, v37
v_mul_f32 v38, s96, v38
v_mul_f32 v39, s96, v39
v_cvt_pk_bf16_f32 v35, v38, v39
v_add_u32 v6, v6, v2
v_bfe_u32 v2, v0, 8, 1
ds_read_b64_tr_b16 v[28:29], v3 offset:49408
ds_read_b64_tr_b16 v[30:31], v3 offset:50432
s_waitcnt lgkmcnt(10)
v_mfma_f32_32x32x16_bf16 v[96:111], a[8:11], v[8:11], v[96:111]
v_mul_f32 v40, s96, v40
v_mul_f32 v41, s96, v41
v_cvt_pk_bf16_f32 v36, v40, v41
v_mul_f32 v42, s96, v42
v_mul_f32 v43, s96, v43
v_cvt_pk_bf16_f32 v37, v42, v43
v_lshl_add_u32 v6, v2, 5, v6
v_bfe_u32 v2, v0, 4, 2
ds_read_b64_tr_b16 v[8:9], v3 offset:53248
ds_read_b64_tr_b16 v[10:11], v3 offset:54272
s_waitcnt lgkmcnt(10)
v_mfma_f32_32x32x16_bf16 v[112:127], a[8:11], v[12:15], v[112:127]
v_mul_f32 v44, s96, v44
v_mul_f32 v45, s96, v45
v_cvt_pk_bf16_f32 v38, v44, v45
v_mul_f32 v46, s96, v46
v_mul_f32 v47, s96, v47
v_cvt_pk_bf16_f32 v39, v46, v47
v_lshl_add_u32 v6, v2, 3, v6
v_add_u32 v6, s59, v6
ds_read_b64_tr_b16 v[12:13], v3 offset:53504
ds_read_b64_tr_b16 v[14:15], v3 offset:54528
s_waitcnt lgkmcnt(10)
v_mfma_f32_32x32x16_bf16 v[96:111], a[12:15], v[16:19], v[96:111]
buffer_store_dwordx4 v[32:35], v0, s[8:11], s34 offen offset:0 sc1
v_lshlrev_b32 v7, 4, v7
v_bfe_u32 v2, v0, 8, 1
ds_read_b64_tr_b16 v[16:17], v3 offset:57344
ds_read_b64_tr_b16 v[18:19], v3 offset:58368
s_waitcnt lgkmcnt(10)
v_mfma_f32_32x32x16_bf16 v[112:127], a[12:15], v[20:23], v[112:127]
buffer_store_dwordx4 v[36:39], v0, s[8:11], s34 offen offset:1024 sc1
v_lshl_add_u32 v7, v2, 2, v7
v_bfe_u32 v2, v0, 6, 2
ds_read_b64_tr_b16 v[20:21], v3 offset:57600
ds_read_b64_tr_b16 v[22:23], v3 offset:58624
s_waitcnt lgkmcnt(10)
v_mfma_f32_32x32x16_bf16 v[96:111], a[16:19], v[24:27], v[96:111]
v_mul_f32 v48, s96, v48
v_mul_f32 v49, s96, v49
v_cvt_pk_bf16_f32 v48, v48, v49
v_mul_f32 v50, s96, v50
v_mul_f32 v51, s96, v51
v_cvt_pk_bf16_f32 v49, v50, v51
v_add_u32 v7, v7, v2
v_mul_u32_u24 v7, 1280, v7
ds_read_b64_tr_b16 v[24:25], v3 offset:61440
ds_read_b64_tr_b16 v[26:27], v3 offset:62464
s_waitcnt lgkmcnt(10)
v_mfma_f32_32x32x16_bf16 v[112:127], a[16:19], v[28:31], v[112:127]
v_mul_f32 v52, s96, v52
v_mul_f32 v53, s96, v53
v_cvt_pk_bf16_f32 v50, v52, v53
v_mul_f32 v54, s96, v54
v_mul_f32 v55, s96, v55
v_cvt_pk_bf16_f32 v51, v54, v55
v_bfe_u32 v2, v0, 4, 2
v_lshl_add_u32 v7, v2, 3, v7
ds_read_b64_tr_b16 v[28:29], v3 offset:61696
ds_read_b64_tr_b16 v[30:31], v3 offset:62720
s_waitcnt lgkmcnt(10)
v_mfma_f32_32x32x16_bf16 v[96:111], a[20:23], v[8:11], v[96:111]
v_mul_f32 v56, s96, v56
v_mul_f32 v57, s96, v57
v_cvt_pk_bf16_f32 v52, v56, v57
v_mul_f32 v58, s96, v58
v_mul_f32 v59, s96, v59
v_cvt_pk_bf16_f32 v53, v58, v59
s_mul_i32 s27, s24, 160
s_add_u32 s27, s27, 40960
ds_read_b64_tr_b16 v[8:9], v3 offset:33280
ds_read_b64_tr_b16 v[10:11], v3 offset:34304
s_waitcnt lgkmcnt(10)
v_mfma_f32_32x32x16_bf16 v[112:127], a[20:23], v[12:15], v[112:127]
v_mul_f32 v60, s96, v60
v_mul_f32 v61, s96, v61
v_cvt_pk_bf16_f32 v54, v60, v61
v_mul_f32 v62, s96, v62
v_mul_f32 v63, s96, v63
v_cvt_pk_bf16_f32 v55, v62, v63
v_add_u32 v7, s27, v7
ds_read_b64_tr_b16 v[12:13], v3 offset:33536
ds_read_b64_tr_b16 v[14:15], v3 offset:34560
s_waitcnt lgkmcnt(10)
v_mfma_f32_32x32x16_bf16 v[96:111], a[24:27], v[16:19], v[96:111]
buffer_store_dwordx4 v[48:51], v0, s[8:11], s34 offen offset:2048 sc1
ds_read_b64_tr_b16 v[16:17], v3 offset:37376
ds_read_b64_tr_b16 v[18:19], v3 offset:38400
s_waitcnt lgkmcnt(10)
v_mfma_f32_32x32x16_bf16 v[112:127], a[24:27], v[20:23], v[112:127]
buffer_store_dwordx4 v[52:55], v0, s[8:11], s34 offen offset:3072 sc1
ds_read_b64_tr_b16 v[20:21], v3 offset:37632
ds_read_b64_tr_b16 v[22:23], v3 offset:38656
s_waitcnt lgkmcnt(10)
v_mfma_f32_32x32x16_bf16 v[96:111], a[28:31], v[24:27], v[96:111]
v_mul_f32 v64, s96, v64
v_mul_f32 v65, s96, v65
v_cvt_pk_bf16_f32 v64, v64, v65
v_mul_f32 v66, s96, v66
v_mul_f32 v67, s96, v67
v_cvt_pk_bf16_f32 v65, v66, v67
ds_read_b64_tr_b16 v[24:25], v3 offset:41472
ds_read_b64_tr_b16 v[26:27], v3 offset:42496
s_waitcnt lgkmcnt(10)
v_mfma_f32_32x32x16_bf16 v[112:127], a[28:31], v[28:31], v[112:127]
v_mul_f32 v68, s96, v68
v_mul_f32 v69, s96, v69
v_cvt_pk_bf16_f32 v66, v68, v69
v_mul_f32 v70, s96, v70
v_mul_f32 v71, s96, v71
v_cvt_pk_bf16_f32 v67, v70, v71
ds_read_b64_tr_b16 v[28:29], v3 offset:41728
ds_read_b64_tr_b16 v[30:31], v3 offset:42752
s_waitcnt lgkmcnt(10)
v_mfma_f32_32x32x16_bf16 v[96:111], a[32:35], v[8:11], v[96:111]
v_mul_f32 v72, s96, v72
v_mul_f32 v73, s96, v73
v_cvt_pk_bf16_f32 v68, v72, v73
v_mul_f32 v74, s96, v74
v_mul_f32 v75, s96, v75
v_cvt_pk_bf16_f32 v69, v74, v75
ds_read_b64_tr_b16 v[8:9], v3 offset:45568
ds_read_b64_tr_b16 v[10:11], v3 offset:46592
s_waitcnt lgkmcnt(10)
v_mfma_f32_32x32x16_bf16 v[112:127], a[32:35], v[12:15], v[112:127]
v_mul_f32 v76, s96, v76
v_mul_f32 v77, s96, v77
v_cvt_pk_bf16_f32 v70, v76, v77
v_mul_f32 v78, s96, v78
v_mul_f32 v79, s96, v79
v_cvt_pk_bf16_f32 v71, v78, v79
ds_read_b64_tr_b16 v[12:13], v3 offset:45824
ds_read_b64_tr_b16 v[14:15], v3 offset:46848
s_waitcnt lgkmcnt(10)
v_mfma_f32_32x32x16_bf16 v[96:111], a[36:39], v[16:19], v[96:111]
s_add_u32 s34, s34, 4096
buffer_store_dwordx4 v[64:67], v0, s[8:11], s34 offen offset:0 sc1
ds_read_b64_tr_b16 v[16:17], v3 offset:49664
ds_read_b64_tr_b16 v[18:19], v3 offset:50688
s_waitcnt lgkmcnt(10)
v_mfma_f32_32x32x16_bf16 v[112:127], a[36:39], v[20:23], v[112:127]
buffer_store_dwordx4 v[68:71], v0, s[8:11], s34 offen offset:1024 sc1
ds_read_b64_tr_b16 v[20:21], v3 offset:49920
ds_read_b64_tr_b16 v[22:23], v3 offset:50944
s_waitcnt lgkmcnt(10)
v_mfma_f32_32x32x16_bf16 v[96:111], a[40:43], v[24:27], v[96:111]
v_mul_f32 v80, s96, v80
v_mul_f32 v81, s96, v81
v_cvt_pk_bf16_f32 v80, v80, v81
v_mul_f32 v82, s96, v82
v_mul_f32 v83, s96, v83
v_cvt_pk_bf16_f32 v81, v82, v83
ds_read_b64_tr_b16 v[24:25], v3 offset:53760
ds_read_b64_tr_b16 v[26:27], v3 offset:54784
s_waitcnt lgkmcnt(10)
v_mfma_f32_32x32x16_bf16 v[112:127], a[40:43], v[28:31], v[112:127]
v_mul_f32 v84, s96, v84
v_mul_f32 v85, s96, v85
v_cvt_pk_bf16_f32 v82, v84, v85
v_mul_f32 v86, s96, v86
v_mul_f32 v87, s96, v87
v_cvt_pk_bf16_f32 v83, v86, v87
ds_read_b64_tr_b16 v[28:29], v3 offset:54016
ds_read_b64_tr_b16 v[30:31], v3 offset:55040
s_waitcnt lgkmcnt(10)
v_mfma_f32_32x32x16_bf16 v[96:111], a[44:47], v[8:11], v[96:111]
v_mul_f32 v88, s96, v88
v_mul_f32 v89, s96, v89
v_cvt_pk_bf16_f32 v84, v88, v89
v_mul_f32 v90, s96, v90
v_mul_f32 v91, s96, v91
v_cvt_pk_bf16_f32 v85, v90, v91
ds_read_b64_tr_b16 v[8:9], v3 offset:57856
ds_read_b64_tr_b16 v[10:11], v3 offset:58880
s_waitcnt lgkmcnt(10)
v_mfma_f32_32x32x16_bf16 v[112:127], a[44:47], v[12:15], v[112:127]
v_mul_f32 v92, s96, v92
v_mul_f32 v93, s96, v93
v_cvt_pk_bf16_f32 v86, v92, v93
v_mul_f32 v94, s96, v94
v_mul_f32 v95, s96, v95
v_cvt_pk_bf16_f32 v87, v94, v95
ds_read_b64_tr_b16 v[12:13], v3 offset:58112
ds_read_b64_tr_b16 v[14:15], v3 offset:59136
s_waitcnt lgkmcnt(10)
v_mfma_f32_32x32x16_bf16 v[96:111], a[48:51], v[16:19], v[96:111]
buffer_store_dwordx4 v[80:83], v0, s[8:11], s34 offen offset:2048 sc1
ds_read_b64_tr_b16 v[16:17], v3 offset:61952
ds_read_b64_tr_b16 v[18:19], v3 offset:62976
s_waitcnt lgkmcnt(10)
v_mfma_f32_32x32x16_bf16 v[112:127], a[48:51], v[20:23], v[112:127]
buffer_store_dwordx4 v[84:87], v0, s[8:11], s34 offen offset:3072 sc1
ds_read_b64_tr_b16 v[20:21], v3 offset:62208
ds_read_b64_tr_b16 v[22:23], v3 offset:63232
s_waitcnt lgkmcnt(10)
v_mfma_f32_32x32x16_bf16 v[96:111], a[52:55], v[24:27], v[96:111]
s_barrier
ds_read_b64_tr_b16 v[24:25], v4 offset:0
ds_read_b64_tr_b16 v[26:27], v4 offset:1024
s_waitcnt lgkmcnt(10)
v_mfma_f32_32x32x16_bf16 v[112:127], a[52:55], v[28:31], v[112:127]
ds_read_b64_tr_b16 v[28:29], v4 offset:256
ds_read_b64_tr_b16 v[30:31], v4 offset:1280
s_waitcnt lgkmcnt(10)
v_mfma_f32_32x32x16_bf16 v[96:111], a[56:59], v[8:11], v[96:111]
ds_read_b64_tr_b16 v[8:9], v4 offset:4096
ds_read_b64_tr_b16 v[10:11], v4 offset:5120
s_waitcnt lgkmcnt(10)
v_mfma_f32_32x32x16_bf16 v[112:127], a[56:59], v[12:15], v[112:127]
ds_read_b64_tr_b16 v[12:13], v4 offset:4352
ds_read_b64_tr_b16 v[14:15], v4 offset:5376
s_waitcnt lgkmcnt(10)
v_mfma_f32_32x32x16_bf16 v[96:111], a[60:63], v[16:19], v[96:111]
ds_read_b64_tr_b16 v[16:17], v4 offset:8192
ds_read_b64_tr_b16 v[18:19], v4 offset:9216
s_waitcnt lgkmcnt(10)
v_mfma_f32_32x32x16_bf16 v[112:127], a[60:63], v[20:23], v[112:127]
ds_read_b64_tr_b16 v[20:21], v4 offset:8448
ds_read_b64_tr_b16 v[22:23], v4 offset:9472
s_waitcnt lgkmcnt(10)
v_mfma_f32_32x32x16_bf16 v[96:111], a[64:67], v[24:27], v[96:111]
ds_read_b64_tr_b16 v[24:25], v4 offset:12288
ds_read_b64_tr_b16 v[26:27], v4 offset:13312
s_waitcnt lgkmcnt(10)
v_mfma_f32_32x32x16_bf16 v[112:127], a[64:67], v[28:31], v[112:127]
ds_read_b64_tr_b16 v[28:29], v4 offset:12544
ds_read_b64_tr_b16 v[30:31], v4 offset:13568
s_waitcnt lgkmcnt(10)
v_mfma_f32_32x32x16_bf16 v[96:111], a[68:71], v[8:11], v[96:111]
ds_read_b64_tr_b16 v[8:9], v4 offset:16384
ds_read_b64_tr_b16 v[10:11], v4 offset:17408
s_waitcnt lgkmcnt(10)
v_mfma_f32_32x32x16_bf16 v[112:127], a[68:71], v[12:15], v[112:127]
ds_read_b64_tr_b16 v[12:13], v4 offset:16640
ds_read_b64_tr_b16 v[14:15], v4 offset:17664
s_waitcnt lgkmcnt(10)
v_mfma_f32_32x32x16_bf16 v[96:111], a[72:75], v[16:19], v[96:111]
s_add_u32 m0, s59, 0
s_add_u32 s33, s30, 0
buffer_load_dwordx4 v1, s[52:55], s33 offen lds
ds_read_b64_tr_b16 v[16:17], v4 offset:20480
ds_read_b64_tr_b16 v[18:19], v4 offset:21504
s_waitcnt lgkmcnt(10)
v_mfma_f32_32x32x16_bf16 v[112:127], a[72:75], v[20:23], v[112:127]
ds_read_b64_tr_b16 v[20:21], v4 offset:20736
ds_read_b64_tr_b16 v[22:23], v4 offset:21760
s_waitcnt lgkmcnt(10)
v_mfma_f32_32x32x16_bf16 v[96:111], a[76:79], v[24:27], v[96:111]
s_add_u32 m0, s59, 1024
s_add_u32 s33, s30, 55296
buffer_load_dwordx4 v1, s[52:55], s33 offen lds
ds_read_b64_tr_b16 v[24:25], v4 offset:24576
ds_read_b64_tr_b16 v[26:27], v4 offset:25600
s_waitcnt lgkmcnt(10)
v_mfma_f32_32x32x16_bf16 v[112:127], a[76:79], v[28:31], v[112:127]
ds_read_b64_tr_b16 v[28:29], v4 offset:24832
ds_read_b64_tr_b16 v[30:31], v4 offset:25856
s_waitcnt lgkmcnt(10)
v_mfma_f32_32x32x16_bf16 v[96:111], a[80:83], v[8:11], v[96:111]
s_add_u32 m0, s59, 2048
s_add_u32 s33, s30, 110592
buffer_load_dwordx4 v1, s[52:55], s33 offen lds
ds_read_b64_tr_b16 v[8:9], v4 offset:28672
ds_read_b64_tr_b16 v[10:11], v4 offset:29696
s_waitcnt lgkmcnt(10)
v_mfma_f32_32x32x16_bf16 v[112:127], a[80:83], v[12:15], v[112:127]
ds_read_b64_tr_b16 v[12:13], v4 offset:28928
ds_read_b64_tr_b16 v[14:15], v4 offset:29952
s_waitcnt lgkmcnt(10)
v_mfma_f32_32x32x16_bf16 v[96:111], a[84:87], v[16:19], v[96:111]
s_add_u32 m0, s59, 3072
s_add_u32 s33, s30, 165888
buffer_load_dwordx4 v1, s[52:55], s33 offen lds
ds_read_b64_tr_b16 v[16:17], v4 offset:512
ds_read_b64_tr_b16 v[18:19], v4 offset:1536
s_waitcnt lgkmcnt(10)
v_mfma_f32_32x32x16_bf16 v[112:127], a[84:87], v[20:23], v[112:127]
ds_read_b64_tr_b16 v[20:21], v4 offset:768
ds_read_b64_tr_b16 v[22:23], v4 offset:1792
s_waitcnt lgkmcnt(10)
v_mfma_f32_32x32x16_bf16 v[96:111], a[88:91], v[24:27], v[96:111]
s_add_u32 m0, s59, 4096
s_add_u32 s33, s30, 221184
buffer_load_dwordx4 v1, s[52:55], s33 offen lds
ds_read_b64_tr_b16 v[24:25], v4 offset:4608
ds_read_b64_tr_b16 v[26:27], v4 offset:5632
s_waitcnt lgkmcnt(10)
v_mfma_f32_32x32x16_bf16 v[112:127], a[88:91], v[28:31], v[112:127]
ds_read_b64_tr_b16 v[28:29], v4 offset:4864
ds_read_b64_tr_b16 v[30:31], v4 offset:5888
s_waitcnt lgkmcnt(10)
v_mfma_f32_32x32x16_bf16 v[96:111], a[92:95], v[8:11], v[96:111]
ds_read_b64_tr_b16 v[8:9], v4 offset:8704
ds_read_b64_tr_b16 v[10:11], v4 offset:9728
s_waitcnt lgkmcnt(10)
v_mfma_f32_32x32x16_bf16 v[112:127], a[92:95], v[12:15], v[112:127]
ds_read_b64_tr_b16 v[12:13], v4 offset:8960
ds_read_b64_tr_b16 v[14:15], v4 offset:9984
s_waitcnt lgkmcnt(10)
v_mfma_f32_32x32x16_bf16 v[96:111], a[96:99], v[16:19], v[96:111]
ds_read_b64_tr_b16 v[16:17], v4 offset:12800
ds_read_b64_tr_b16 v[18:19], v4 offset:13824
s_waitcnt lgkmcnt(10)
v_mfma_f32_32x32x16_bf16 v[112:127], a[96:99], v[20:23], v[112:127]
ds_read_b64_tr_b16 v[20:21], v4 offset:13056
ds_read_b64_tr_b16 v[22:23], v4 offset:14080
s_waitcnt lgkmcnt(10)
v_mfma_f32_32x32x16_bf16 v[96:111], a[100:103], v[24:27], v[96:111]
ds_read_b64_tr_b16 v[24:25], v4 offset:16896
ds_read_b64_tr_b16 v[26:27], v4 offset:17920
s_waitcnt lgkmcnt(10)
v_mfma_f32_32x32x16_bf16 v[112:127], a[100:103], v[28:31], v[112:127]
ds_read_b64_tr_b16 v[28:29], v4 offset:17152
ds_read_b64_tr_b16 v[30:31], v4 offset:18176
s_waitcnt lgkmcnt(10)
v_mfma_f32_32x32x16_bf16 v[96:111], a[104:107], v[8:11], v[96:111]
ds_read_b64_tr_b16 v[8:9], v4 offset:20992
ds_read_b64_tr_b16 v[10:11], v4 offset:22016
s_waitcnt lgkmcnt(10)
v_mfma_f32_32x32x16_bf16 v[112:127], a[104:107], v[12:15], v[112:127]
ds_read_b64_tr_b16 v[12:13], v4 offset:21248
ds_read_b64_tr_b16 v[14:15], v4 offset:22272
s_waitcnt lgkmcnt(10)
v_mfma_f32_32x32x16_bf16 v[96:111], a[108:111], v[16:19], v[96:111]
ds_read_b64_tr_b16 v[16:17], v4 offset:25088
ds_read_b64_tr_b16 v[18:19], v4 offset:26112
s_waitcnt lgkmcnt(10)
v_mfma_f32_32x32x16_bf16 v[112:127], a[108:111], v[20:23], v[112:127]
ds_read_b64_tr_b16 v[20:21], v4 offset:25344
ds_read_b64_tr_b16 v[22:23], v4 offset:26368
s_waitcnt lgkmcnt(10)
v_mfma_f32_32x32x16_bf16 v[96:111], a[112:115], v[24:27], v[96:111]
ds_read_b64_tr_b16 v[24:25], v4 offset:29184
ds_read_b64_tr_b16 v[26:27], v4 offset:30208
s_waitcnt lgkmcnt(10)
v_mfma_f32_32x32x16_bf16 v[112:127], a[112:115], v[28:31], v[112:127]
ds_read_b64_tr_b16 v[28:29], v4 offset:29440
ds_read_b64_tr_b16 v[30:31], v4 offset:30464
s_waitcnt lgkmcnt(10)
v_mfma_f32_32x32x16_bf16 v[96:111], a[116:119], v[8:11], v[96:111]
s_barrier
ds_read_b64_tr_b16 v[8:9], v4 offset:32768
ds_read_b64_tr_b16 v[10:11], v4 offset:33792
s_waitcnt lgkmcnt(10)
v_mfma_f32_32x32x16_bf16 v[112:127], a[116:119], v[12:15], v[112:127]
ds_read_b64_tr_b16 v[12:13], v4 offset:33024
ds_read_b64_tr_b16 v[14:15], v4 offset:34048
s_waitcnt lgkmcnt(10)
v_mfma_f32_32x32x16_bf16 v[96:111], a[120:123], v[16:19], v[96:111]
ds_read_b64_tr_b16 v[16:17], v4 offset:36864
ds_read_b64_tr_b16 v[18:19], v4 offset:37888
s_waitcnt lgkmcnt(10)
v_mfma_f32_32x32x16_bf16 v[112:127], a[120:123], v[20:23], v[112:127]
ds_read_b64_tr_b16 v[20:21], v4 offset:37120
ds_read_b64_tr_b16 v[22:23], v4 offset:38144
s_waitcnt lgkmcnt(10)
v_mfma_f32_32x32x16_bf16 v[96:111], a[124:127], v[24:27], v[96:111]
ds_read_b64_tr_b16 v[24:25], v4 offset:40960
ds_read_b64_tr_b16 v[26:27], v4 offset:41984
s_waitcnt lgkmcnt(10)
v_mfma_f32_32x32x16_bf16 v[112:127], a[124:127], v[28:31], v[112:127]
ds_read_b64_tr_b16 v[28:29], v4 offset:41216
ds_read_b64_tr_b16 v[30:31], v4 offset:42240
s_waitcnt lgkmcnt(10)
v_mfma_f32_32x32x16_bf16 v[32:47], a[0:3], v[8:11], 0
ds_read_b64_tr_b16 v[8:9], v4 offset:45056
ds_read_b64_tr_b16 v[10:11], v4 offset:46080
s_waitcnt lgkmcnt(10)
v_mfma_f32_32x32x16_bf16 v[48:63], a[0:3], v[12:15], 0
ds_read_b64_tr_b16 v[12:13], v4 offset:45312
ds_read_b64_tr_b16 v[14:15], v4 offset:46336
s_waitcnt lgkmcnt(10)
v_mfma_f32_32x32x16_bf16 v[32:47], a[4:7], v[16:19], v[32:47]
v_cvt_pk_bf16_f32 v96, v96, v97
v_cvt_pk_bf16_f32 v97, v98, v99
ds_read_b64_tr_b16 v[16:17], v4 offset:49152
ds_read_b64_tr_b16 v[18:19], v4 offset:50176
s_waitcnt lgkmcnt(10)
v_mfma_f32_32x32x16_bf16 v[48:63], a[4:7], v[20:23], v[48:63]
v_cvt_pk_bf16_f32 v98, v100, v101
v_cvt_pk_bf16_f32 v99, v102, v103
ds_read_b64_tr_b16 v[20:21], v4 offset:49408
ds_read_b64_tr_b16 v[22:23], v4 offset:50432
s_waitcnt lgkmcnt(10)
v_mfma_f32_32x32x16_bf16 v[32:47], a[8:11], v[24:27], v[32:47]
v_cvt_pk_bf16_f32 v100, v104, v105
v_cvt_pk_bf16_f32 v101, v106, v107
s_add_u32 m0, s59, 40960
s_add_u32 s33, s60, 0
buffer_load_dwordx4 v0, s[44:47], s33 offen lds
ds_read_b64_tr_b16 v[24:25], v4 offset:53248
ds_read_b64_tr_b16 v[26:27], v4 offset:54272
s_waitcnt lgkmcnt(10)
v_mfma_f32_32x32x16_bf16 v[48:63], a[8:11], v[28:31], v[48:63]
v_cvt_pk_bf16_f32 v102, v108, v109
v_cvt_pk_bf16_f32 v103, v110, v111
ds_read_b64_tr_b16 v[28:29], v4 offset:53504
ds_read_b64_tr_b16 v[30:31], v4 offset:54528
s_waitcnt lgkmcnt(10)
v_mfma_f32_32x32x16_bf16 v[32:47], a[12:15], v[8:11], v[32:47]
buffer_store_dwordx4 v[96:99], v0, s[8:11], s35 offen offset:0 sc1
ds_read_b64_tr_b16 v[8:9], v4 offset:57344
ds_read_b64_tr_b16 v[10:11], v4 offset:58368
s_waitcnt lgkmcnt(10)
v_mfma_f32_32x32x16_bf16 v[48:63], a[12:15], v[12:15], v[48:63]
buffer_store_dwordx4 v[100:103], v0, s[8:11], s35 offen offset:1024 sc1
s_add_u32 s35, s35, 4096
ds_read_b64_tr_b16 v[12:13], v4 offset:57600
ds_read_b64_tr_b16 v[14:15], v4 offset:58624
s_waitcnt lgkmcnt(10)
v_mfma_f32_32x32x16_bf16 v[32:47], a[16:19], v[16:19], v[32:47]
v_cvt_pk_bf16_f32 v112, v112, v113
v_cvt_pk_bf16_f32 v113, v114, v115
ds_read_b64_tr_b16 v[16:17], v4 offset:61440
ds_read_b64_tr_b16 v[18:19], v4 offset:62464
s_waitcnt lgkmcnt(10)
v_mfma_f32_32x32x16_bf16 v[48:63], a[16:19], v[20:23], v[48:63]
v_cvt_pk_bf16_f32 v114, v116, v117
v_cvt_pk_bf16_f32 v115, v118, v119
ds_read_b64_tr_b16 v[20:21], v4 offset:61696
ds_read_b64_tr_b16 v[22:23], v4 offset:62720
s_waitcnt lgkmcnt(10)
v_mfma_f32_32x32x16_bf16 v[32:47], a[20:23], v[24:27], v[32:47]
v_cvt_pk_bf16_f32 v116, v120, v121
v_cvt_pk_bf16_f32 v117, v122, v123
ds_read_b64_tr_b16 v[24:25], v4 offset:33280
ds_read_b64_tr_b16 v[26:27], v4 offset:34304
s_waitcnt lgkmcnt(10)
v_mfma_f32_32x32x16_bf16 v[48:63], a[20:23], v[28:31], v[48:63]
v_cvt_pk_bf16_f32 v118, v124, v125
v_cvt_pk_bf16_f32 v119, v126, v127
ds_read_b64_tr_b16 v[28:29], v4 offset:33536
ds_read_b64_tr_b16 v[30:31], v4 offset:34560
s_waitcnt lgkmcnt(10)
v_mfma_f32_32x32x16_bf16 v[32:47], a[24:27], v[8:11], v[32:47]
buffer_store_dwordx4 v[112:115], v0, s[8:11], s35 offen offset:0 sc1
ds_read_b64_tr_b16 v[8:9], v4 offset:37376
ds_read_b64_tr_b16 v[10:11], v4 offset:38400
s_waitcnt lgkmcnt(10)
v_mfma_f32_32x32x16_bf16 v[48:63], a[24:27], v[12:15], v[48:63]
buffer_store_dwordx4 v[116:119], v0, s[8:11], s35 offen offset:1024 sc1
s_add_u32 s35, s35, 4096
ds_read_b64_tr_b16 v[12:13], v4 offset:37632
ds_read_b64_tr_b16 v[14:15], v4 offset:38656
s_waitcnt lgkmcnt(10)
v_mfma_f32_32x32x16_bf16 v[32:47], a[28:31], v[16:19], v[32:47]
s_add_u32 m0, s59, 41984
s_add_u32 s33, s60, 1024
buffer_load_dwordx4 v0, s[44:47], s33 offen lds
ds_read_b64_tr_b16 v[16:17], v4 offset:41472
ds_read_b64_tr_b16 v[18:19], v4 offset:42496
s_waitcnt lgkmcnt(10)
v_mfma_f32_32x32x16_bf16 v[48:63], a[28:31], v[20:23], v[48:63]
ds_read_b64_tr_b16 v[20:21], v4 offset:41728
ds_read_b64_tr_b16 v[22:23], v4 offset:42752
s_waitcnt lgkmcnt(10)
v_mfma_f32_32x32x16_bf16 v[32:47], a[32:35], v[24:27], v[32:47]
s_add_u32 m0, s59, 43008
s_add_u32 s33, s60, 2048
buffer_load_dwordx4 v0, s[44:47], s33 offen lds
ds_read_b64_tr_b16 v[24:25], v4 offset:45568
ds_read_b64_tr_b16 v[26:27], v4 offset:46592
s_waitcnt lgkmcnt(10)
v_mfma_f32_32x32x16_bf16 v[48:63], a[32:35], v[28:31], v[48:63]
ds_read_b64_tr_b16 v[28:29], v4 offset:45824
ds_read_b64_tr_b16 v[30:31], v4 offset:46848
s_waitcnt lgkmcnt(10)
v_mfma_f32_32x32x16_bf16 v[32:47], a[36:39], v[8:11], v[32:47]
s_add_u32 m0, s59, 44032
s_add_u32 s33, s60, 3072
buffer_load_dwordx4 v0, s[44:47], s33 offen lds
ds_read_b64_tr_b16 v[8:9], v4 offset:49664
ds_read_b64_tr_b16 v[10:11], v4 offset:50688
s_waitcnt lgkmcnt(10)
v_mfma_f32_32x32x16_bf16 v[48:63], a[36:39], v[12:15], v[48:63]
ds_read_b64_tr_b16 v[12:13], v4 offset:49920
ds_read_b64_tr_b16 v[14:15], v4 offset:50944
s_waitcnt lgkmcnt(10)
v_mfma_f32_32x32x16_bf16 v[32:47], a[40:43], v[16:19], v[32:47]
s_add_u32 m0, s59, 45056
s_add_u32 s33, s60, 4096
buffer_load_dwordx4 v0, s[44:47], s33 offen lds
ds_read_b64_tr_b16 v[16:17], v4 offset:53760
ds_read_b64_tr_b16 v[18:19], v4 offset:54784
s_waitcnt lgkmcnt(10)
v_mfma_f32_32x32x16_bf16 v[48:63], a[40:43], v[20:23], v[48:63]
ds_read_b64_tr_b16 v[20:21], v4 offset:54016
ds_read_b64_tr_b16 v[22:23], v4 offset:55040
s_waitcnt lgkmcnt(10)
v_mfma_f32_32x32x16_bf16 v[32:47], a[44:47], v[24:27], v[32:47]
ds_read_b64_tr_b16 v[24:25], v4 offset:57856
ds_read_b64_tr_b16 v[26:27], v4 offset:58880
s_waitcnt lgkmcnt(10)
v_mfma_f32_32x32x16_bf16 v[48:63], a[44:47], v[28:31], v[48:63]
s_waitcnt vmcnt(9)
ds_read_b64_tr_b16 v[64:65], v6 offset:0
ds_read_b64_tr_b16 v[66:67], v6 offset:512
ds_read_b64_tr_b16 v[28:29], v4 offset:58112
ds_read_b64_tr_b16 v[30:31], v4 offset:59136
s_waitcnt lgkmcnt(12)
v_mfma_f32_32x32x16_bf16 v[32:47], a[48:51], v[8:11], v[32:47]
ds_read_b64_tr_b16 v[68:69], v6 offset:1024
ds_read_b64_tr_b16 v[70:71], v6 offset:1536
ds_read_b64_tr_b16 v[8:9], v4 offset:61952
ds_read_b64_tr_b16 v[10:11], v4 offset:62976
s_waitcnt lgkmcnt(14)
v_mfma_f32_32x32x16_bf16 v[48:63], a[48:51], v[12:15], v[48:63]
ds_read_b64_tr_b16 v[72:73], v6 offset:2048
ds_read_b64_tr_b16 v[74:75], v6 offset:2560
ds_read_b64_tr_b16 v[12:13], v4 offset:62208
ds_read_b64_tr_b16 v[14:15], v4 offset:63232
s_waitcnt lgkmcnt(15)
v_mfma_f32_32x32x16_bf16 v[32:47], a[52:55], v[16:19], v[32:47]
ds_read_b64_tr_b16 v[76:77], v6 offset:3072
ds_read_b64_tr_b16 v[78:79], v6 offset:3584
s_barrier
ds_read_b64_tr_b16 v[16:17], v5 offset:0
ds_read_b64_tr_b16 v[18:19], v5 offset:1024
s_waitcnt lgkmcnt(15)
v_mfma_f32_32x32x16_bf16 v[48:63], a[52:55], v[20:23], v[48:63]
ds_read_b64_tr_b16 v[80:81], v6 offset:4096
ds_read_b64_tr_b16 v[82:83], v6 offset:4608
ds_read_b64_tr_b16 v[20:21], v5 offset:256
ds_read_b64_tr_b16 v[22:23], v5 offset:1280
v_mfma_f32_32x32x16_bf16 v[32:47], a[56:59], v[24:27], v[32:47]
ds_read_b64_tr_b16 v[24:25], v5 offset:4096
ds_read_b64_tr_b16 v[26:27], v5 offset:5120
s_waitcnt lgkmcnt(15)
v_mfma_f32_32x32x16_bf16 v[48:63], a[56:59], v[28:31], v[48:63]
ds_read_b64_tr_b16 v[28:29], v5 offset:4352
ds_read_b64_tr_b16 v[30:31], v5 offset:5376
s_waitcnt lgkmcnt(15)
v_mfma_f32_32x32x16_bf16 v[32:47], a[60:63], v[8:11], v[32:47]
ds_read_b64_tr_b16 v[8:9], v5 offset:8192
ds_read_b64_tr_b16 v[10:11], v5 offset:9216
s_waitcnt lgkmcnt(14)
v_mfma_f32_32x32x16_bf16 v[48:63], a[60:63], v[12:15], v[48:63]
ds_read_b64_tr_b16 v[12:13], v5 offset:8448
ds_read_b64_tr_b16 v[14:15], v5 offset:9472
s_waitcnt lgkmcnt(12)
v_mfma_f32_32x32x16_bf16 v[32:47], a[64:67], v[16:19], v[32:47]
ds_read_b64_tr_b16 v[16:17], v5 offset:12288
ds_read_b64_tr_b16 v[18:19], v5 offset:13312
s_waitcnt lgkmcnt(10)
v_mfma_f32_32x32x16_bf16 v[48:63], a[64:67], v[20:23], v[48:63]
s_mov_b64 exec, s[56:57]
buffer_store_dwordx4 v[64:67], v0, s[8:11], s32 offen sc1
s_mov_b64 exec, -1
s_add_u32 s32, s32, 5120
ds_read_b64_tr_b16 v[20:21], v5 offset:12544
ds_read_b64_tr_b16 v[22:23], v5 offset:13568
s_waitcnt lgkmcnt(10)
v_mfma_f32_32x32x16_bf16 v[32:47], a[68:71], v[24:27], v[32:47]
ds_read_b64_tr_b16 v[24:25], v5 offset:16384
ds_read_b64_tr_b16 v[26:27], v5 offset:17408
s_waitcnt lgkmcnt(10)
v_mfma_f32_32x32x16_bf16 v[48:63], a[68:71], v[28:31], v[48:63]
s_mov_b64 exec, s[56:57]
buffer_store_dwordx4 v[68:71], v0, s[8:11], s32 offen sc1
s_mov_b64 exec, -1
s_add_u32 s32, s32, 5120
ds_read_b64_tr_b16 v[28:29], v5 offset:16640
ds_read_b64_tr_b16 v[30:31], v5 offset:17664
s_waitcnt lgkmcnt(10)
v_mfma_f32_32x32x16_bf16 v[32:47], a[72:75], v[8:11], v[32:47]
s_add_u32 m0, s59, 81920
s_add_u32 s33, s60, 40960
buffer_load_dwordx4 v0, s[44:47], s33 offen lds
ds_read_b64_tr_b16 v[8:9], v5 offset:20480
ds_read_b64_tr_b16 v[10:11], v5 offset:21504
s_waitcnt lgkmcnt(10)
v_mfma_f32_32x32x16_bf16 v[48:63], a[72:75], v[12:15], v[48:63]
s_mov_b64 exec, s[56:57]
buffer_store_dwordx4 v[72:75], v0, s[8:11], s32 offen sc1
s_mov_b64 exec, -1
s_add_u32 s32, s32, 5120
ds_read_b64_tr_b16 v[12:13], v5 offset:20736
ds_read_b64_tr_b16 v[14:15], v5 offset:21760
s_waitcnt lgkmcnt(10)
v_mfma_f32_32x32x16_bf16 v[32:47], a[76:79], v[16:19], v[32:47]
s_add_u32 m0, s59, 82944
s_add_u32 s33, s60, 41984
buffer_load_dwordx4 v0, s[44:47], s33 offen lds
ds_read_b64_tr_b16 v[16:17], v5 offset:24576
ds_read_b64_tr_b16 v[18:19], v5 offset:25600
s_waitcnt lgkmcnt(10)
v_mfma_f32_32x32x16_bf16 v[48:63], a[76:79], v[20:23], v[48:63]
s_mov_b64 exec, s[56:57]
buffer_store_dwordx4 v[76:79], v0, s[8:11], s32 offen sc1
s_mov_b64 exec, -1
s_add_u32 s32, s32, 5120
ds_read_b64_tr_b16 v[20:21], v5 offset:24832
ds_read_b64_tr_b16 v[22:23], v5 offset:25856
s_waitcnt lgkmcnt(10)
v_mfma_f32_32x32x16_bf16 v[32:47], a[80:83], v[24:27], v[32:47]
s_add_u32 m0, s59, 83968
s_add_u32 s33, s60, 43008
buffer_load_dwordx4 v0, s[44:47], s33 offen lds
ds_read_b64_tr_b16 v[24:25], v5 offset:28672
ds_read_b64_tr_b16 v[26:27], v5 offset:29696
s_waitcnt lgkmcnt(10)
v_mfma_f32_32x32x16_bf16 v[48:63], a[80:83], v[28:31], v[48:63]
s_mov_b64 exec, s[56:57]
buffer_store_dwordx4 v[80:83], v0, s[8:11], s32 offen sc1
s_mov_b64 exec, -1
s_add_u32 s32, s32, 5120
ds_read_b64_tr_b16 v[28:29], v5 offset:28928
ds_read_b64_tr_b16 v[30:31], v5 offset:29952
s_waitcnt lgkmcnt(10)
v_mfma_f32_32x32x16_bf16 v[32:47], a[84:87], v[8:11], v[32:47]
s_add_u32 m0, s59, 84992
s_add_u32 s33, s60, 44032
buffer_load_dwordx4 v0, s[44:47], s33 offen lds
ds_read_b64_tr_b16 v[8:9], v5 offset:512
ds_read_b64_tr_b16 v[10:11], v5 offset:1536
s_waitcnt lgkmcnt(10)
v_mfma_f32_32x32x16_bf16 v[48:63], a[84:87], v[12:15], v[48:63]
ds_read_b64_tr_b16 v[12:13], v5 offset:768
ds_read_b64_tr_b16 v[14:15], v5 offset:1792
s_waitcnt lgkmcnt(10)
v_mfma_f32_32x32x16_bf16 v[32:47], a[88:91], v[16:19], v[32:47]
s_add_u32 m0, s59, 86016
s_add_u32 s33, s60, 45056
buffer_load_dwordx4 v0, s[44:47], s33 offen lds
ds_read_b64_tr_b16 v[16:17], v5 offset:4608
ds_read_b64_tr_b16 v[18:19], v5 offset:5632
s_waitcnt lgkmcnt(10)
v_mfma_f32_32x32x16_bf16 v[48:63], a[88:91], v[20:23], v[48:63]
v_dot2_f32_bf16 v84, v64, s58, 0
ds_read_b64_tr_b16 v[20:21], v5 offset:4864
ds_read_b64_tr_b16 v[22:23], v5 offset:5888
s_waitcnt lgkmcnt(10)
v_mfma_f32_32x32x16_bf16 v[32:47], a[92:95], v[24:27], v[32:47]
v_dot2_f32_bf16 v84, v65, s58, v84
ds_read_b64_tr_b16 v[24:25], v5 offset:8704
ds_read_b64_tr_b16 v[26:27], v5 offset:9728
s_waitcnt lgkmcnt(10)
v_mfma_f32_32x32x16_bf16 v[48:63], a[92:95], v[28:31], v[48:63]
v_dot2_f32_bf16 v84, v66, s58, v84
ds_read_b64_tr_b16 v[28:29], v5 offset:8960
ds_read_b64_tr_b16 v[30:31], v5 offset:9984
s_waitcnt lgkmcnt(10)
v_mfma_f32_32x32x16_bf16 v[32:47], a[96:99], v[8:11], v[32:47]
v_dot2_f32_bf16 v84, v67, s58, v84
ds_read_b64_tr_b16 v[8:9], v5 offset:12800
ds_read_b64_tr_b16 v[10:11], v5 offset:13824
s_waitcnt lgkmcnt(10)
v_mfma_f32_32x32x16_bf16 v[48:63], a[96:99], v[12:15], v[48:63]
v_dot2_f32_bf16 v84, v68, s58, v84
ds_read_b64_tr_b16 v[12:13], v5 offset:13056
ds_read_b64_tr_b16 v[14:15], v5 offset:14080
s_waitcnt lgkmcnt(10)
v_mfma_f32_32x32x16_bf16 v[32:47], a[100:103], v[16:19], v[32:47]
v_dot2_f32_bf16 v84, v69, s58, v84
ds_read_b64_tr_b16 v[16:17], v5 offset:16896
ds_read_b64_tr_b16 v[18:19], v5 offset:17920
s_waitcnt lgkmcnt(10)
v_mfma_f32_32x32x16_bf16 v[48:63], a[100:103], v[20:23], v[48:63]
v_dot2_f32_bf16 v84, v70, s58, v84
ds_read_b64_tr_b16 v[20:21], v5 offset:17152
ds_read_b64_tr_b16 v[22:23], v5 offset:18176
s_waitcnt lgkmcnt(10)
v_mfma_f32_32x32x16_bf16 v[32:47], a[104:107], v[24:27], v[32:47]
v_dot2_f32_bf16 v84, v71, s58, v84
ds_read_b64_tr_b16 v[24:25], v5 offset:20992
ds_read_b64_tr_b16 v[26:27], v5 offset:22016
s_waitcnt lgkmcnt(10)
v_mfma_f32_32x32x16_bf16 v[48:63], a[104:107], v[28:31], v[48:63]
v_dot2_f32_bf16 v84, v72, s58, v84
ds_read_b64_tr_b16 v[28:29], v5 offset:21248
ds_read_b64_tr_b16 v[30:31], v5 offset:22272
s_waitcnt lgkmcnt(10)
v_mfma_f32_32x32x16_bf16 v[32:47], a[108:111], v[8:11], v[32:47]
v_dot2_f32_bf16 v84, v73, s58, v84
ds_read_b64_tr_b16 v[8:9], v5 offset:25088
ds_read_b64_tr_b16 v[10:11], v5 offset:26112
s_waitcnt lgkmcnt(10)
v_mfma_f32_32x32x16_bf16 v[48:63], a[108:111], v[12:15], v[48:63]
v_dot2_f32_bf16 v84, v74, s58, v84
ds_read_b64_tr_b16 v[12:13], v5 offset:25344
ds_read_b64_tr_b16 v[14:15], v5 offset:26368
s_waitcnt lgkmcnt(10)
v_mfma_f32_32x32x16_bf16 v[32:47], a[112:115], v[16:19], v[32:47]
v_dot2_f32_bf16 v84, v75, s58, v84
ds_read_b64_tr_b16 v[16:17], v5 offset:29184
ds_read_b64_tr_b16 v[18:19], v5 offset:30208
s_waitcnt lgkmcnt(10)
v_mfma_f32_32x32x16_bf16 v[48:63], a[112:115], v[20:23], v[48:63]
v_dot2_f32_bf16 v84, v76, s58, v84
ds_read_b64_tr_b16 v[20:21], v5 offset:29440
ds_read_b64_tr_b16 v[22:23], v5 offset:30464
s_waitcnt lgkmcnt(10)
v_mfma_f32_32x32x16_bf16 v[32:47], a[116:119], v[24:27], v[32:47]
v_dot2_f32_bf16 v84, v77, s58, v84
s_waitcnt lgkmcnt(8)
v_mfma_f32_32x32x16_bf16 v[48:63], a[116:119], v[28:31], v[48:63]
v_dot2_f32_bf16 v84, v78, s58, v84
s_waitcnt lgkmcnt(6)
v_mfma_f32_32x32x16_bf16 v[32:47], a[120:123], v[8:11], v[32:47]
v_dot2_f32_bf16 v84, v79, s58, v84
s_waitcnt lgkmcnt(4)
v_mfma_f32_32x32x16_bf16 v[48:63], a[120:123], v[12:15], v[48:63]
v_dot2_f32_bf16 v84, v80, s58, v84
s_waitcnt lgkmcnt(2)
v_mfma_f32_32x32x16_bf16 v[32:47], a[124:127], v[16:19], v[32:47]
v_dot2_f32_bf16 v84, v81, s58, v84
s_waitcnt lgkmcnt(0)
v_mfma_f32_32x32x16_bf16 v[48:63], a[124:127], v[20:23], v[48:63]
v_dot2_f32_bf16 v84, v82, s58, v84
v_dot2_f32_bf16 v84, v83, s58, v84
s_nop 6
v_cvt_pk_bf16_f32 v32, v32, v33
v_cvt_pk_bf16_f32 v33, v34, v35
v_lshrrev_b32 v86, 2, v0
v_cvt_pk_bf16_f32 v34, v36, v37
v_cvt_pk_bf16_f32 v35, v38, v39
v_add_u32 v86, s59, v86
v_cvt_pk_bf16_f32 v36, v40, v41
v_cvt_pk_bf16_f32 v37, v42, v43
v_cvt_pk_bf16_f32 v38, v44, v45
v_cvt_pk_bf16_f32 v39, v46, v47
buffer_store_dwordx4 v[32:35], v0, s[8:11], s35 offen offset:0 sc1
ds_write_b32 v86, v84
buffer_store_dwordx4 v[36:39], v0, s[8:11], s35 offen offset:1024 sc1
s_add_u32 s35, s35, 4096
v_cvt_pk_bf16_f32 v48, v48, v49
v_cvt_pk_bf16_f32 v49, v50, v51
v_cvt_pk_bf16_f32 v50, v52, v53
v_cvt_pk_bf16_f32 v51, v54, v55
v_cvt_pk_bf16_f32 v52, v56, v57
v_cvt_pk_bf16_f32 v53, v58, v59
v_cvt_pk_bf16_f32 v54, v60, v61
v_cvt_pk_bf16_f32 v55, v62, v63
buffer_store_dwordx4 v[48:51], v0, s[8:11], s35 offen offset:0 sc1
buffer_store_dwordx4 v[52:55], v0, s[8:11], s35 offen offset:1024 sc1
s_add_u32 s35, s35, 4096
s_waitcnt vmcnt(4)
s_waitcnt lgkmcnt(0)
s_barrier
s_cmp_ge_u32 s25, 91
s_cbranch_scc1 Ll1_pk2
ds_read_b64_tr_b16 v[64:65], v7 offset:0
ds_read_b64_tr_b16 v[66:67], v7 offset:10240
ds_read_b64_tr_b16 v[68:69], v7 offset:32
ds_read_b64_tr_b16 v[70:71], v7 offset:10272
ds_read_b64_tr_b16 v[72:73], v7 offset:64
ds_read_b64_tr_b16 v[74:75], v7 offset:10304
ds_read_b64_tr_b16 v[76:77], v7 offset:96
ds_read_b64_tr_b16 v[78:79], v7 offset:10336
ds_read_b64_tr_b16 v[80:81], v7 offset:128
ds_read_b64_tr_b16 v[82:83], v7 offset:10368
s_waitcnt lgkmcnt(4)
ds_read_b64_tr_b16 v[84:85], v7 offset:40960
ds_read_b64_tr_b16 v[86:87], v7 offset:51200
ds_read_b64_tr_b16 v[88:89], v7 offset:40992
ds_read_b64_tr_b16 v[90:91], v7 offset:51232
ds_read_b64_tr_b16 v[92:93], v7 offset:41024
ds_read_b64_tr_b16 v[94:95], v7 offset:51264
ds_read_b64_tr_b16 v[96:97], v7 offset:41056
ds_read_b64_tr_b16 v[98:99], v7 offset:51296
ds_read_b64_tr_b16 v[100:101], v7 offset:41088
ds_read_b64_tr_b16 v[102:103], v7 offset:51328
s_waitcnt lgkmcnt(10)
buffer_store_dwordx4 v[64:67], v0, s[8:11], s61 offen offset:0 sc1
buffer_store_dwordx4 v[68:71], v0, s[8:11], s61 offen offset:1024 sc1
buffer_store_dwordx4 v[72:75], v0, s[8:11], s61 offen offset:2048 sc1
buffer_store_dwordx4 v[76:79], v0, s[8:11], s61 offen offset:3072 sc1
s_add_u32 s61, s61, 4096
buffer_store_dwordx4 v[80:83], v0, s[8:11], s61 offen offset:0 sc1
s_waitcnt lgkmcnt(0)
buffer_store_dwordx4 v[84:87], v0, s[8:11], s61 offen offset:1024 sc1
buffer_store_dwordx4 v[88:91], v0, s[8:11], s61 offen offset:2048 sc1
buffer_store_dwordx4 v[92:95], v0, s[8:11], s61 offen offset:3072 sc1
s_add_u32 s61, s61, 4096
buffer_store_dwordx4 v[96:99], v0, s[8:11], s61 offen offset:0 sc1
buffer_store_dwordx4 v[100:103], v0, s[8:11], s61 offen offset:1024 sc1
Ll1_pk2:
s_cmp_lg_u32 s24, 7
s_cbranch_scc1 Ll1_pk3
s_cmp_lt_u32 s25, 42
s_cbranch_scc1 Ll1_pk3
v_lshrrev_b32 v6, 2, v0
ds_read_b32 v8, v6 offset:0
ds_read_b32 v9, v6 offset:5120
ds_read_b32 v10, v6 offset:10240
ds_read_b32 v11, v6 offset:15360
ds_read_b32 v12, v6 offset:20480
ds_read_b32 v13, v6 offset:25600
ds_read_b32 v14, v6 offset:30720
ds_read_b32 v15, v6 offset:35840
s_waitcnt lgkmcnt(0)
v_add_f32 v8, v8, v9
v_add_f32 v8, v8, v10
v_add_f32 v8, v8, v11
v_add_f32 v8, v8, v12
v_add_f32 v8, v8, v13
v_add_f32 v8, v8, v14
v_add_f32 v8, v8, v15
v_mov_b32 v9, v8
s_nop 1
v_permlane32_swap_b32 v9, v8
v_add_f32 v8, v8, v9
s_lshl_b32 s27, s26, 7
s_add_u32 s27, s27, 79691776
s_mov_b32 exec_hi, 0
buffer_store_dword v8, v6, s[8:11], s27 offen sc1
s_mov_b64 exec, -1
Ll1_pk3:
Ll1_end:
s_endpgm
.globl l2_kernel
.p2align 8
.type l2_kernel,@function
l2_kernel:
s_load_dwordx2 s[4:5], s[0:1], 16
s_load_dwordx2 s[8:9], s[0:1], 104
s_load_dwordx2 s[12:13], s[0:1], 64
s_load_dwordx2 s[16:17], s[0:1], 96
s_mov_b32 s6, 0x500000
s_mov_b32 s7, 0x00020000
s_mov_b32 s10, 0x10000000
s_mov_b32 s11, 0x00020000
s_mov_b32 s14, 0xc8000
s_mov_b32 s15, 0x00020000
s_mov_b32 s18, 0x100
s_mov_b32 s19, 0x00020000
v_lshrrev_b32 v1, 6, v0
v_and_b32 v2, 63, v0
v_readfirstlane_b32 s24, v1
s_cmp_ge_u32 s2, 256
s_cbranch_scc1 Lat_end
s_and_b32 s25, s2, 7
s_lshl_b32 s25, s25, 2
s_bfe_u32 s39, s2, 0x20003
s_add_u32 s25, s25, s39
s_lshr_b32 s26, s2, 5
s_sub_u32 s31, 15, s26
s_sub_u32 s32, 7, s24
s_cmp_lt_u32 s24, 4
s_cselect_b32 s31, s31, s26
s_cselect_b32 s32, s24, s32
s_lshl_b32 s27, s31, 2
s_add_u32 s27, s27, s32
s_lshr_b32 s28, s27, 1
v_bfe_u32 v14, v2, 2, 2
v_and_b32 v15, 3, v2
v_lshrrev_b32 v1, 4, v2
v_lshlrev_b32 v4, 4, v15
v_lshl_add_u32 v4, v1, 6, v4
v_lshl_add_u32 v3, v14, 13, v4
v_lshlrev_b32 v13, 4, v2
v_add_u32 v0, 0x1000, v13
s_mul_i32 s33, s27, 40960
s_add_u32 s33, s33, 34603008
s_lshl_b32 s34, s24, 15
s_lshl_b32 s31, s25, 8
s_add_u32 s34, s34, s31
s_lshl_b32 s35, s24, 10
s_mov_b32 s38, 0
s_lshl_b32 s31, s39, 11
v_lshlrev_b32 v9, 7, v2
v_add_u32 v9, s31, v9
s_mul_i32 s40, s38, 1048576
s_add_u32 s40, s40, s34
s_lshl_b32 s45, s38, 13
s_add_u32 s45, s45, s33
s_add_u32 s38, s38, 1
s_cmp_eq_u32 s38, 5
s_cselect_b32 s38, 0, s38
s_lshr_b32 s39, s2, 3
s_cmp_ge_u32 s39, 22
s_waitcnt lgkmcnt(0)
s_cbranch_scc1 Lat_s5
s_add_u32 m0, s35, 65536
s_add_u32 s31, s40, 0
buffer_load_dwordx4 v3, s[4:7], s31 offen lds
s_add_u32 m0, s35, 73728
s_add_u32 s31, s40, 262144
buffer_load_dwordx4 v3, s[4:7], s31 offen lds
buffer_load_dwordx4 v[144:147], v13, s[8:11], s45 offen offset:0
buffer_load_dwordx4 v[148:151], v13, s[8:11], s45 offen offset:1024
buffer_load_dwordx4 v[152:155], v13, s[8:11], s45 offen offset:2048
buffer_load_dwordx4 v[156:159], v13, s[8:11], s45 offen offset:3072
s_mul_i32 s41, s38, 1048576
s_add_u32 s41, s41, s34
s_lshl_b32 s46, s38, 13
s_add_u32 s46, s46, s33
s_add_u32 s38, s38, 1
s_cmp_eq_u32 s38, 5
s_cselect_b32 s38, 0, s38
s_mul_i32 s42, s38, 1048576
s_add_u32 s42, s42, s34
s_lshl_b32 s47, s38, 13
s_add_u32 s47, s47, s33
s_add_u32 s38, s38, 1
s_cmp_eq_u32 s38, 5
s_cselect_b32 s38, 0, s38
s_barrier
s_add_u32 m0, s35, 81920
s_add_u32 s31, s40, 524288
buffer_load_dwordx4 v3, s[4:7], s31 offen lds
s_add_u32 m0, s35, 90112
s_add_u32 s31, s40, 786432
buffer_load_dwordx4 v3, s[4:7], s31 offen lds
buffer_load_dwordx4 v[160:163], v0, s[8:11], s45 offen offset:0
buffer_load_dwordx4 v[164:167], v0, s[8:11], s45 offen offset:1024
buffer_load_dwordx4 v[168:171], v0, s[8:11], s45 offen offset:2048
buffer_load_dwordx4 v[172:175], v0, s[8:11], s45 offen offset:3072
v_mul_u32_u24 v10, 52, v2
v_lshrrev_b32 v10, 8, v10
v_mul_u32_u24 v10, 163200, v10
v_lshl_add_u32 v12, v2, 7, v10
v_and_b32 v11, 1, v2
v_lshlrev_b32 v11, 7, v11
v_bfe_u32 v10, v2, 1, 3
v_lshl_add_u32 v10, v10, 13, v11
v_cmp_le_u32 vcc, 32, v2
s_nop 1
v_cndmask_b32 v12, v12, v10, vcc
v_bfe_u32 v10, v2, 1, 1
v_lshl_add_u32 v11, v10, 13, v11
v_bfe_u32 v10, v2, 2, 2
v_lshl_add_u32 v11, v10, 20, v11
v_cmp_le_u32 vcc, 48, v2
s_nop 1
v_cndmask_b32 v12, v12, v11, vcc
s_lshl_b32 s31, s39, 3
s_add_u32 s31, s31, s24
s_mul_i32 s20, s31, 640
s_lshr_b32 s21, s31, 5
s_and_b32 s22, s2, 7
s_lshl_b32 s22, s22, 3
s_add_u32 s21, s21, s22
s_mul_i32 s21, s21, 40960
s_and_b32 s31, s31, 31
s_lshl_b32 s31, s31, 8
s_add_u32 s21, s21, s31
s_add_u32 s21, s21, 40894464
s_lshl_b32 s22, s26, 3
s_add_u32 s22, s22, s24
s_lshl_b32 s22, s22, 14
s_lshl_b32 s31, s25, 8
s_add_u32 s22, s22, s31
s_add_u32 s22, s22, 1048576
s_mov_b32 exec_lo, 0
s_mov_b32 exec_hi, 0xf0000
buffer_load_dword v10, v12, s[4:7], s22 offen
s_mov_b64 exec, -1
s_mov_b64 exec, 0xffff
buffer_load_dword v10, v9, s[8:11], s46 offen
s_mov_b64 exec, -1
s_mov_b64 exec, 0x7fe0
buffer_load_dword v10, v12, s[12:15], s20 offen
s_mov_b32 exec_lo, 0
s_mov_b32 exec_hi, 0x3c
buffer_load_dword v10, v12, s[8:11], s21 offen
s_mov_b64 exec, -1
s_mul_i32 s43, s38, 1048576
s_add_u32 s43, s43, s34
s_lshl_b32 s48, s38, 13
s_add_u32 s48, s48, s33
s_add_u32 s38, s38, 1
s_cmp_eq_u32 s38, 5
s_cselect_b32 s38, 0, s38
s_mul_i32 s44, s38, 1048576
s_add_u32 s44, s44, s34
s_lshl_b32 s49, s38, 13
s_add_u32 s49, s49, s33
s_add_u32 s38, s38, 1
s_cmp_eq_u32 s38, 5
s_cselect_b32 s38, 0, s38
v_lshrrev_b32 v1, 5, v2
v_lshlrev_b32 v4, 10, v1
v_lshl_add_u32 v4, v14, 6, v4
v_bfe_u32 v14, v2, 4, 1
v_lshl_add_u32 v4, v14, 5, v4
v_lshl_add_u32 v4, v15, 3, v4
v_add_u32 v5, 0x10000, v4
v_add_u32 v6, 0x20000, v4
v_add_u32 v7, 0x10000, v13
s_and_b32 s31, s32, 1
s_lshl_b32 s31, s31, 5
v_and_b32 v11, 31, v2
v_add_u32 v11, s31, v11
v_lshlrev_b32 v15, 2, v1
v_sub_u32 v11, v11, v15
v_and_b32 v15, 15, v2
v_lshlrev_b32 v15, 4, v15
v_lshl_add_u32 v15, v14, 10, v15
v_lshl_add_u32 v1, v1, 8, v15
s_lshl_b32 s29, s25, 20
s_lshr_b32 s36, s27, 1
s_lshl_b32 s36, s36, 7
s_lshl_b32 s31, s25, 2
s_add_u32 s36, s36, s31
s_lshl_b32 s36, s36, 12
s_and_b32 s31, s27, 1
s_lshl_b32 s31, s31, 11
s_add_u32 s36, s36, s31
s_add_u32 s36, s36, 54525952
s_and_b32 s37, s24, 3
s_lshl_b32 s37, s37, 13
s_lshr_b32 s34, s37, 1
Lat_join:
s_cmp_ge_u32 s24, 4
s_cbranch_scc1 Lat_B
s_waitcnt vmcnt(14)
s_barrier
ds_read_b64_tr_b16 v[208:209], v5 offset:0
ds_read_b64_tr_b16 v[210:211], v5 offset:2048
ds_read_b64_tr_b16 v[212:213], v5 offset:256
ds_read_b64_tr_b16 v[214:215], v5 offset:2304
ds_read_b64_tr_b16 v[216:217], v5 offset:512
ds_read_b64_tr_b16 v[218:219], v5 offset:2560
ds_read_b64_tr_b16 v[220:221], v5 offset:768
ds_read_b64_tr_b16 v[222:223], v5 offset:2816
ds_read_b64_tr_b16 v[224:225], v5 offset:4096
ds_read_b64_tr_b16 v[226:227], v5 offset:6144
ds_read_b64_tr_b16 v[228:229], v5 offset:4352
ds_read_b64_tr_b16 v[230:231], v5 offset:6400
s_mov_b64 exec, 0x1ff8000
buffer_load_dword v10, v12, s[12:15], s20 offen
s_mov_b32 exec_lo, 0
s_mov_b32 exec_hi, 0x3c0
buffer_load_dword v10, v12, s[8:11], s21 offen
s_mov_b64 exec, -1
s_mov_b32 exec_lo, 0
s_mov_b32 exec_hi, 0xf00000
buffer_load_dword v10, v12, s[4:7], s22 offen
s_mov_b64 exec, -1
s_mov_b64 exec, 0xffff
buffer_load_dword v10, v9, s[8:11], s47 offen
s_mov_b64 exec, -1
ds_read_b64_tr_b16 v[232:233], v5 offset:4608
ds_read_b64_tr_b16 v[234:235], v5 offset:6656
s_waitcnt vmcnt(14)
s_waitcnt lgkmcnt(12)
v_mfma_f32_32x32x16_bf16 v[16:31], v[208:211], v[144:147], 0
s_add_u32 m0, s35, 0
s_add_u32 s31, s41, 0
buffer_load_dwordx4 v3, s[4:7], s31 offen lds
ds_read_b64_tr_b16 v[236:237], v5 offset:4864
ds_read_b64_tr_b16 v[238:239], v5 offset:6912
s_waitcnt lgkmcnt(12)
v_mfma_f32_32x32x16_bf16 v[32:47], v[212:215], v[144:147], 0
ds_read_b64_tr_b16 v[208:209], v5 offset:8192
ds_read_b64_tr_b16 v[210:211], v5 offset:10240
s_waitcnt lgkmcnt(12)
v_mfma_f32_32x32x16_bf16 v[48:63], v[216:219], v[144:147], 0
s_add_u32 m0, s35, 8192
s_add_u32 s31, s41, 262144
buffer_load_dwordx4 v3, s[4:7], s31 offen lds
ds_read_b64_tr_b16 v[212:213], v5 offset:8448
ds_read_b64_tr_b16 v[214:215], v5 offset:10496
s_waitcnt lgkmcnt(12)
v_mfma_f32_32x32x16_bf16 v[64:79], v[220:223], v[144:147], 0
ds_read_b64_tr_b16 v[216:217], v5 offset:8704
ds_read_b64_tr_b16 v[218:219], v5 offset:10752
s_waitcnt lgkmcnt(12)
v_mfma_f32_32x32x16_bf16 v[16:31], v[224:227], v[148:151], v[16:31]
s_add_u32 m0, s35, 16384
s_add_u32 s31, s41, 524288
buffer_load_dwordx4 v3, s[4:7], s31 offen lds
ds_read_b64_tr_b16 v[220:221], v5 offset:8960
ds_read_b64_tr_b16 v[222:223], v5 offset:11008
s_waitcnt lgkmcnt(12)
v_mfma_f32_32x32x16_bf16 v[32:47], v[228:231], v[148:151], v[32:47]
ds_read_b64_tr_b16 v[224:225], v5 offset:12288
ds_read_b64_tr_b16 v[226:227], v5 offset:14336
s_waitcnt lgkmcnt(12)
v_mfma_f32_32x32x16_bf16 v[48:63], v[232:235], v[148:151], v[48:63]
s_add_u32 m0, s35, 24576
s_add_u32 s31, s41, 786432
buffer_load_dwordx4 v3, s[4:7], s31 offen lds
ds_read_b64_tr_b16 v[228:229], v5 offset:12544
ds_read_b64_tr_b16 v[230:231], v5 offset:14592
s_waitcnt lgkmcnt(12)
v_mfma_f32_32x32x16_bf16 v[64:79], v[236:239], v[148:151], v[64:79]
ds_read_b64_tr_b16 v[232:233], v5 offset:12800
ds_read_b64_tr_b16 v[234:235], v5 offset:14848
s_waitcnt lgkmcnt(12)
v_mfma_f32_32x32x16_bf16 v[16:31], v[208:211], v[152:155], v[16:31]
buffer_load_dwordx4 v[176:179], v13, s[8:11], s46 offen offset:0
ds_read_b64_tr_b16 v[236:237], v5 offset:13056
ds_read_b64_tr_b16 v[238:239], v5 offset:15104
s_waitcnt lgkmcnt(12)
v_mfma_f32_32x32x16_bf16 v[32:47], v[212:215], v[152:155], v[32:47]
s_waitcnt vmcnt(17)
s_barrier
ds_read_b64_tr_b16 v[208:209], v5 offset:16384
ds_read_b64_tr_b16 v[210:211], v5 offset:18432
s_waitcnt lgkmcnt(12)
v_mfma_f32_32x32x16_bf16 v[48:63], v[216:219], v[152:155], v[48:63]
buffer_load_dwordx4 v[180:183], v13, s[8:11], s46 offen offset:1024
ds_read_b64_tr_b16 v[212:213], v5 offset:16640
ds_read_b64_tr_b16 v[214:215], v5 offset:18688
s_waitcnt lgkmcnt(12)
v_mfma_f32_32x32x16_bf16 v[64:79], v[220:223], v[152:155], v[64:79]
ds_read_b64_tr_b16 v[216:217], v5 offset:16896
ds_read_b64_tr_b16 v[218:219], v5 offset:18944
s_waitcnt lgkmcnt(12)
v_mfma_f32_32x32x16_bf16 v[16:31], v[224:227], v[156:159], v[16:31]
buffer_load_dwordx4 v[184:187], v13, s[8:11], s46 offen offset:2048
ds_read_b64_tr_b16 v[220:221], v5 offset:17152
ds_read_b64_tr_b16 v[222:223], v5 offset:19200
s_waitcnt lgkmcnt(12)
v_mfma_f32_32x32x16_bf16 v[32:47], v[228:231], v[156:159], v[32:47]
ds_read_b64_tr_b16 v[224:225], v5 offset:20480
ds_read_b64_tr_b16 v[226:227], v5 offset:22528
s_waitcnt lgkmcnt(12)
v_mfma_f32_32x32x16_bf16 v[48:63], v[232:235], v[156:159], v[48:63]
buffer_load_dwordx4 v[188:191], v13, s[8:11], s46 offen offset:3072
ds_read_b64_tr_b16 v[228:229], v5 offset:20736
ds_read_b64_tr_b16 v[230:231], v5 offset:22784
s_waitcnt lgkmcnt(12)
v_mfma_f32_32x32x16_bf16 v[64:79], v[236:239], v[156:159], v[64:79]
ds_read_b64_tr_b16 v[232:233], v5 offset:20992
ds_read_b64_tr_b16 v[234:235], v5 offset:23040
s_waitcnt vmcnt(16)
s_waitcnt lgkmcnt(12)
v_mfma_f32_32x32x16_bf16 v[16:31], v[208:211], v[160:163], v[16:31]
buffer_load_dwordx4 v[192:195], v0, s[8:11], s46 offen offset:0
ds_read_b64_tr_b16 v[236:237], v5 offset:21248
ds_read_b64_tr_b16 v[238:239], v5 offset:23296
s_waitcnt lgkmcnt(12)
v_mfma_f32_32x32x16_bf16 v[32:47], v[212:215], v[160:163], v[32:47]
ds_read_b64_tr_b16 v[208:209], v5 offset:24576
ds_read_b64_tr_b16 v[210:211], v5 offset:26624
s_waitcnt lgkmcnt(12)
v_mfma_f32_32x32x16_bf16 v[48:63], v[216:219], v[160:163], v[48:63]
buffer_load_dwordx4 v[196:199], v0, s[8:11], s46 offen offset:1024
ds_read_b64_tr_b16 v[212:213], v5 offset:24832
ds_read_b64_tr_b16 v[214:215], v5 offset:26880
s_waitcnt lgkmcnt(12)
v_mfma_f32_32x32x16_bf16 v[64:79], v[220:223], v[160:163], v[64:79]
ds_read_b64_tr_b16 v[216:217], v5 offset:25088
ds_read_b64_tr_b16 v[218:219], v5 offset:27136
s_waitcnt lgkmcnt(12)
v_mfma_f32_32x32x16_bf16 v[16:31], v[224:227], v[164:167], v[16:31]
buffer_load_dwordx4 v[200:203], v0, s[8:11], s46 offen offset:2048
ds_read_b64_tr_b16 v[220:221], v5 offset:25344
ds_read_b64_tr_b16 v[222:223], v5 offset:27392
s_waitcnt lgkmcnt(12)
v_mfma_f32_32x32x16_bf16 v[32:47], v[228:231], v[164:167], v[32:47]
ds_read_b64_tr_b16 v[224:225], v5 offset:28672
ds_read_b64_tr_b16 v[226:227], v5 offset:30720
s_waitcnt lgkmcnt(12)
v_mfma_f32_32x32x16_bf16 v[48:63], v[232:235], v[164:167], v[48:63]
buffer_load_dwordx4 v[204:207], v0, s[8:11], s46 offen offset:3072
ds_read_b64_tr_b16 v[228:229], v5 offset:28928
ds_read_b64_tr_b16 v[230:231], v5 offset:30976
s_waitcnt lgkmcnt(12)
v_mfma_f32_32x32x16_bf16 v[64:79], v[236:239], v[164:167], v[64:79]
ds_read_b64_tr_b16 v[232:233], v5 offset:29184
ds_read_b64_tr_b16 v[234:235], v5 offset:31232
s_waitcnt lgkmcnt(12)
v_mfma_f32_32x32x16_bf16 v[16:31], v[208:211], v[168:171], v[16:31]
s_mov_b32 exec_lo, 0
s_mov_b32 exec_hi, 0xf000000
buffer_load_dword v10, v12, s[4:7], s22 offen
s_mov_b64 exec, -1
s_mov_b64 exec, 0xffff
buffer_load_dword v10, v9, s[8:11], s48 offen
s_mov_b64 exec, -1
ds_read_b64_tr_b16 v[236:237], v5 offset:29440
ds_read_b64_tr_b16 v[238:239], v5 offset:31488
s_waitcnt lgkmcnt(12)
v_mfma_f32_32x32x16_bf16 v[32:47], v[212:215], v[168:171], v[32:47]
s_waitcnt vmcnt(10)
s_barrier
s_cmp_lt_u32 s39, 22
s_cbranch_scc1 Lat_nf
s_cmp_lg_u32 s24, 0
s_cbranch_scc1 Lat_nf
s_lshl_b32 s61, s61, 2
v_mov_b32 v8, 1
v_mov_b32 v14, 0
s_mov_b64 exec, 1
buffer_atomic_add v8, v14, s[16:19], s61 offen sc1
s_mov_b64 exec, -1
Lat_nf:
ds_read_b64_tr_b16 v[208:209], v4 offset:0
ds_read_b64_tr_b16 v[210:211], v4 offset:2048
s_waitcnt lgkmcnt(12)
v_mfma_f32_32x32x16_bf16 v[48:63], v[216:219], v[168:171], v[48:63]
ds_read_b64_tr_b16 v[212:213], v4 offset:256
ds_read_b64_tr_b16 v[214:215], v4 offset:2304
s_waitcnt lgkmcnt(12)
v_mfma_f32_32x32x16_bf16 v[64:79], v[220:223], v[168:171], v[64:79]
ds_read_b64_tr_b16 v[216:217], v4 offset:512
ds_read_b64_tr_b16 v[218:219], v4 offset:2560
s_waitcnt lgkmcnt(12)
v_mfma_f32_32x32x16_bf16 v[16:31], v[224:227], v[172:175], v[16:31]
s_add_u32 m0, s35, 32768
s_add_u32 s31, s42, 0
buffer_load_dwordx4 v3, s[4:7], s31 offen lds
ds_read_b64_tr_b16 v[220:221], v4 offset:768
ds_read_b64_tr_b16 v[222:223], v4 offset:2816
s_waitcnt lgkmcnt(12)
v_mfma_f32_32x32x16_bf16 v[32:47], v[228:231], v[172:175], v[32:47]
ds_read_b64_tr_b16 v[224:225], v4 offset:4096
ds_read_b64_tr_b16 v[226:227], v4 offset:6144
s_waitcnt lgkmcnt(12)
v_mfma_f32_32x32x16_bf16 v[48:63], v[232:235], v[172:175], v[48:63]
s_add_u32 m0, s35, 40960
s_add_u32 s31, s42, 262144
buffer_load_dwordx4 v3, s[4:7], s31 offen lds
ds_read_b64_tr_b16 v[228:229], v4 offset:4352
ds_read_b64_tr_b16 v[230:231], v4 offset:6400
s_waitcnt lgkmcnt(12)
v_mfma_f32_32x32x16_bf16 v[64:79], v[236:239], v[172:175], v[64:79]
ds_read_b64_tr_b16 v[232:233], v4 offset:4608
ds_read_b64_tr_b16 v[234:235], v4 offset:6656
s_waitcnt vmcnt(8)
s_waitcnt lgkmcnt(12)
v_mfma_f32_32x32x16_bf16 v[16:31], v[208:211], v[176:179], v[16:31]
s_add_u32 m0, s35, 49152
s_add_u32 s31, s42, 524288
buffer_load_dwordx4 v3, s[4:7], s31 offen lds
ds_read_b64_tr_b16 v[236:237], v4 offset:4864
ds_read_b64_tr_b16 v[238:239], v4 offset:6912
s_waitcnt lgkmcnt(12)
v_mfma_f32_32x32x16_bf16 v[32:47], v[212:215], v[176:179], v[32:47]
ds_read_b64_tr_b16 v[208:209], v4 offset:8192
ds_read_b64_tr_b16 v[210:211], v4 offset:10240
s_waitcnt lgkmcnt(12)
v_mfma_f32_32x32x16_bf16 v[48:63], v[216:219], v[176:179], v[48:63]
s_add_u32 m0, s35, 57344
s_add_u32 s31, s42, 786432
buffer_load_dwordx4 v3, s[4:7], s31 offen lds
ds_read_b64_tr_b16 v[212:213], v4 offset:8448
ds_read_b64_tr_b16 v[214:215], v4 offset:10496
s_waitcnt lgkmcnt(12)
v_mfma_f32_32x32x16_bf16 v[64:79], v[220:223], v[176:179], v[64:79]
ds_read_b64_tr_b16 v[216:217], v4 offset:8704
ds_read_b64_tr_b16 v[218:219], v4 offset:10752
s_waitcnt lgkmcnt(12)
v_mfma_f32_32x32x16_bf16 v[16:31], v[224:227], v[180:183], v[16:31]
buffer_load_dwordx4 v[112:115], v13, s[8:11], s47 offen offset:0
ds_read_b64_tr_b16 v[220:221], v4 offset:8960
ds_read_b64_tr_b16 v[222:223], v4 offset:11008
s_waitcnt lgkmcnt(12)
v_mfma_f32_32x32x16_bf16 v[32:47], v[228:231], v[180:183], v[32:47]
ds_read_b64_tr_b16 v[224:225], v4 offset:12288
ds_read_b64_tr_b16 v[226:227], v4 offset:14336
s_waitcnt lgkmcnt(12)
v_mfma_f32_32x32x16_bf16 v[48:63], v[232:235], v[180:183], v[48:63]
buffer_load_dwordx4 v[116:119], v13, s[8:11], s47 offen offset:1024
ds_read_b64_tr_b16 v[228:229], v4 offset:12544
ds_read_b64_tr_b16 v[230:231], v4 offset:14592
s_waitcnt lgkmcnt(12)
v_mfma_f32_32x32x16_bf16 v[64:79], v[236:239], v[180:183], v[64:79]
ds_read_b64_tr_b16 v[232:233], v4 offset:12800
ds_read_b64_tr_b16 v[234:235], v4 offset:14848
s_waitcnt lgkmcnt(12)
v_mfma_f32_32x32x16_bf16 v[16:31], v[208:211], v[184:187], v[16:31]
buffer_load_dwordx4 v[120:123], v13, s[8:11], s47 offen offset:2048
ds_read_b64_tr_b16 v[236:237], v4 offset:13056
ds_read_b64_tr_b16 v[238:239], v4 offset:15104
s_waitcnt lgkmcnt(12)
v_mfma_f32_32x32x16_bf16 v[32:47], v[212:215], v[184:187], v[32:47]
ds_read_b64_tr_b16 v[208:209], v4 offset:16384
ds_read_b64_tr_b16 v[210:211], v4 offset:18432
s_waitcnt lgkmcnt(12)
v_mfma_f32_32x32x16_bf16 v[48:63], v[216:219], v[184:187], v[48:63]
buffer_load_dwordx4 v[124:127], v13, s[8:11], s47 offen offset:3072
ds_read_b64_tr_b16 v[212:213], v4 offset:16640
ds_read_b64_tr_b16 v[214:215], v4 offset:18688
s_waitcnt lgkmcnt(12)
v_mfma_f32_32x32x16_bf16 v[64:79], v[220:223], v[184:187], v[64:79]
ds_read_b64_tr_b16 v[216:217], v4 offset:16896
ds_read_b64_tr_b16 v[218:219], v4 offset:18944
s_waitcnt lgkmcnt(12)
v_mfma_f32_32x32x16_bf16 v[16:31], v[224:227], v[188:191], v[16:31]
buffer_load_dwordx4 v[128:131], v0, s[8:11], s47 offen offset:0
ds_read_b64_tr_b16 v[220:221], v4 offset:17152
ds_read_b64_tr_b16 v[222:223], v4 offset:19200
s_waitcnt lgkmcnt(12)
v_mfma_f32_32x32x16_bf16 v[32:47], v[228:231], v[188:191], v[32:47]
ds_read_b64_tr_b16 v[224:225], v4 offset:20480
ds_read_b64_tr_b16 v[226:227], v4 offset:22528
s_waitcnt lgkmcnt(12)
v_mfma_f32_32x32x16_bf16 v[48:63], v[232:235], v[188:191], v[48:63]
buffer_load_dwordx4 v[132:135], v0, s[8:11], s47 offen offset:1024
ds_read_b64_tr_b16 v[228:229], v4 offset:20736
ds_read_b64_tr_b16 v[230:231], v4 offset:22784
s_waitcnt lgkmcnt(12)
v_mfma_f32_32x32x16_bf16 v[64:79], v[236:239], v[188:191], v[64:79]
ds_read_b64_tr_b16 v[232:233], v4 offset:20992
ds_read_b64_tr_b16 v[234:235], v4 offset:23040
s_waitcnt vmcnt(12)
s_waitcnt lgkmcnt(12)
v_mfma_f32_32x32x16_bf16 v[16:31], v[208:211], v[192:195], v[16:31]
buffer_load_dwordx4 v[136:139], v0, s[8:11], s47 offen offset:2048
ds_read_b64_tr_b16 v[236:237], v4 offset:21248
ds_read_b64_tr_b16 v[238:239], v4 offset:23296
s_waitcnt lgkmcnt(12)
v_mfma_f32_32x32x16_bf16 v[32:47], v[212:215], v[192:195], v[32:47]
ds_read_b64_tr_b16 v[208:209], v4 offset:24576
ds_read_b64_tr_b16 v[210:211], v4 offset:26624
s_waitcnt lgkmcnt(12)
v_mfma_f32_32x32x16_bf16 v[48:63], v[216:219], v[192:195], v[48:63]
buffer_load_dwordx4 v[140:143], v0, s[8:11], s47 offen offset:3072
ds_read_b64_tr_b16 v[212:213], v4 offset:24832
ds_read_b64_tr_b16 v[214:215], v4 offset:26880
s_waitcnt lgkmcnt(12)
v_mfma_f32_32x32x16_bf16 v[64:79], v[220:223], v[192:195], v[64:79]
ds_read_b64_tr_b16 v[216:217], v4 offset:25088
ds_read_b64_tr_b16 v[218:219], v4 offset:27136
s_waitcnt lgkmcnt(12)
v_mfma_f32_32x32x16_bf16 v[16:31], v[224:227], v[196:199], v[16:31]
s_mov_b32 exec_lo, 0
s_mov_b32 exec_hi, 0xf0000000
buffer_load_dword v10, v12, s[4:7], s22 offen
s_mov_b64 exec, -1
s_mov_b64 exec, 0xffff
buffer_load_dword v10, v9, s[8:11], s49 offen
s_mov_b64 exec, -1
ds_read_b64_tr_b16 v[220:221], v4 offset:25344
ds_read_b64_tr_b16 v[222:223], v4 offset:27392
s_waitcnt lgkmcnt(12)
v_mfma_f32_32x32x16_bf16 v[32:47], v[228:231], v[196:199], v[32:47]
ds_read_b64_tr_b16 v[224:225], v4 offset:28672
ds_read_b64_tr_b16 v[226:227], v4 offset:30720
s_waitcnt lgkmcnt(12)
v_mfma_f32_32x32x16_bf16 v[48:63], v[232:235], v[196:199], v[48:63]
ds_read_b64_tr_b16 v[228:229], v4 offset:28928
ds_read_b64_tr_b16 v[230:231], v4 offset:30976
s_waitcnt lgkmcnt(12)
v_mfma_f32_32x32x16_bf16 v[64:79], v[236:239], v[196:199], v[64:79]
ds_read_b64_tr_b16 v[232:233], v4 offset:29184
ds_read_b64_tr_b16 v[234:235], v4 offset:31232
s_waitcnt lgkmcnt(12)
v_mfma_f32_32x32x16_bf16 v[16:31], v[208:211], v[200:203], v[16:31]
s_add_u32 m0, s35, 98304
s_add_u32 s31, s43, 0
buffer_load_dwordx4 v3, s[4:7], s31 offen lds
ds_read_b64_tr_b16 v[236:237], v4 offset:29440
ds_read_b64_tr_b16 v[238:239], v4 offset:31488
s_waitcnt lgkmcnt(12)
v_mfma_f32_32x32x16_bf16 v[32:47], v[212:215], v[200:203], v[32:47]
s_waitcnt vmcnt(11)
s_barrier
ds_read_b64_tr_b16 v[208:209], v4 offset:32768
ds_read_b64_tr_b16 v[210:211], v4 offset:34816
s_waitcnt lgkmcnt(12)
v_mfma_f32_32x32x16_bf16 v[48:63], v[216:219], v[200:203], v[48:63]
s_add_u32 m0, s35, 106496
s_add_u32 s31, s43, 262144
buffer_load_dwordx4 v3, s[4:7], s31 offen lds
ds_read_b64_tr_b16 v[212:213], v4 offset:33024
ds_read_b64_tr_b16 v[214:215], v4 offset:35072
s_waitcnt lgkmcnt(12)
v_mfma_f32_32x32x16_bf16 v[64:79], v[220:223], v[200:203], v[64:79]
ds_read_b64_tr_b16 v[216:217], v4 offset:33280
ds_read_b64_tr_b16 v[218:219], v4 offset:35328
s_waitcnt lgkmcnt(12)
v_mfma_f32_32x32x16_bf16 v[16:31], v[224:227], v[204:207], v[16:31]
s_add_u32 m0, s35, 114688
s_add_u32 s31, s43, 524288
buffer_load_dwordx4 v3, s[4:7], s31 offen lds
ds_read_b64_tr_b16 v[220:221], v4 offset:33536
ds_read_b64_tr_b16 v[222:223], v4 offset:35584
s_waitcnt lgkmcnt(12)
v_mfma_f32_32x32x16_bf16 v[32:47], v[228:231], v[204:207], v[32:47]
ds_read_b64_tr_b16 v[224:225], v4 offset:36864
ds_read_b64_tr_b16 v[226:227], v4 offset:38912
s_waitcnt lgkmcnt(12)
v_mfma_f32_32x32x16_bf16 v[48:63], v[232:235], v[204:207], v[48:63]
s_add_u32 m0, s35, 122880
s_add_u32 s31, s43, 786432
buffer_load_dwordx4 v3, s[4:7], s31 offen lds
ds_read_b64_tr_b16 v[228:229], v4 offset:37120
ds_read_b64_tr_b16 v[230:231], v4 offset:39168
s_waitcnt lgkmcnt(12)
v_mfma_f32_32x32x16_bf16 v[64:79], v[236:239], v[204:207], v[64:79]
ds_read_b64_tr_b16 v[232:233], v4 offset:37376
ds_read_b64_tr_b16 v[234:235], v4 offset:39424
s_waitcnt vmcnt(10)
s_waitcnt lgkmcnt(12)
v_mfma_f32_32x32x16_bf16 v[16:31], v[208:211], v[112:115], v[16:31]
buffer_load_dwordx4 v[80:83], v13, s[8:11], s48 offen offset:0
ds_read_b64_tr_b16 v[236:237], v4 offset:37632
ds_read_b64_tr_b16 v[238:239], v4 offset:39680
s_waitcnt lgkmcnt(12)
v_mfma_f32_32x32x16_bf16 v[32:47], v[212:215], v[112:115], v[32:47]
v_mov_b32 v176, 0
ds_read_b64_tr_b16 v[208:209], v4 offset:40960
ds_read_b64_tr_b16 v[210:211], v4 offset:43008
s_waitcnt lgkmcnt(12)
v_mfma_f32_32x32x16_bf16 v[48:63], v[216:219], v[112:115], v[48:63]
buffer_load_dwordx4 v[84:87], v13, s[8:11], s48 offen offset:1024
v_mov_b32 v177, 0
ds_read_b64_tr_b16 v[212:213], v4 offset:41216
ds_read_b64_tr_b16 v[214:215], v4 offset:43264
s_waitcnt lgkmcnt(12)
v_mfma_f32_32x32x16_bf16 v[64:79], v[220:223], v[112:115], v[64:79]
v_mov_b32 v178, 0
ds_read_b64_tr_b16 v[216:217], v4 offset:41472
ds_read_b64_tr_b16 v[218:219], v4 offset:43520
s_waitcnt lgkmcnt(12)
v_mfma_f32_32x32x16_bf16 v[16:31], v[224:227], v[116:119], v[16:31]
buffer_load_dwordx4 v[88:91], v13, s[8:11], s48 offen offset:2048
v_mov_b32 v179, 0
ds_read_b64_tr_b16 v[220:221], v4 offset:41728
ds_read_b64_tr_b16 v[222:223], v4 offset:43776
s_waitcnt lgkmcnt(12)
v_mfma_f32_32x32x16_bf16 v[32:47], v[228:231], v[116:119], v[32:47]
v_mov_b32 v180, 0
ds_read_b64_tr_b16 v[224:225], v4 offset:45056
ds_read_b64_tr_b16 v[226:227], v4 offset:47104
s_waitcnt lgkmcnt(12)
v_mfma_f32_32x32x16_bf16 v[48:63], v[232:235], v[116:119], v[48:63]
buffer_load_dwordx4 v[92:95], v13, s[8:11], s48 offen offset:3072
v_mov_b32 v181, 0
ds_read_b64_tr_b16 v[228:229], v4 offset:45312
ds_read_b64_tr_b16 v[230:231], v4 offset:47360
s_waitcnt lgkmcnt(12)
v_mfma_f32_32x32x16_bf16 v[64:79], v[236:239], v[116:119], v[64:79]
v_mov_b32 v182, 0
ds_read_b64_tr_b16 v[232:233], v4 offset:45568
ds_read_b64_tr_b16 v[234:235], v4 offset:47616
s_waitcnt lgkmcnt(12)
v_mfma_f32_32x32x16_bf16 v[16:31], v[208:211], v[120:123], v[16:31]
buffer_load_dwordx4 v[96:99], v0, s[8:11], s48 offen offset:0
v_mov_b32 v183, 0
ds_read_b64_tr_b16 v[236:237], v4 offset:45824
ds_read_b64_tr_b16 v[238:239], v4 offset:47872
s_waitcnt lgkmcnt(12)
v_mfma_f32_32x32x16_bf16 v[32:47], v[212:215], v[120:123], v[32:47]
v_mov_b32 v184, 0
ds_read_b64_tr_b16 v[208:209], v4 offset:49152
ds_read_b64_tr_b16 v[210:211], v4 offset:51200
s_waitcnt lgkmcnt(12)
v_mfma_f32_32x32x16_bf16 v[48:63], v[216:219], v[120:123], v[48:63]
buffer_load_dwordx4 v[100:103], v0, s[8:11], s48 offen offset:1024
v_mov_b32 v185, 0
ds_read_b64_tr_b16 v[212:213], v4 offset:49408
ds_read_b64_tr_b16 v[214:215], v4 offset:51456
s_waitcnt lgkmcnt(12)
v_mfma_f32_32x32x16_bf16 v[64:79], v[220:223], v[120:123], v[64:79]
v_mov_b32 v186, 0
ds_read_b64_tr_b16 v[216:217], v4 offset:49664
ds_read_b64_tr_b16 v[218:219], v4 offset:51712
s_waitcnt lgkmcnt(12)
v_mfma_f32_32x32x16_bf16 v[16:31], v[224:227], v[124:127], v[16:31]
buffer_load_dwordx4 v[104:107], v0, s[8:11], s48 offen offset:2048
v_mov_b32 v187, 0
ds_read_b64_tr_b16 v[220:221], v4 offset:49920
ds_read_b64_tr_b16 v[222:223], v4 offset:51968
s_waitcnt lgkmcnt(12)
v_mfma_f32_32x32x16_bf16 v[32:47], v[228:231], v[124:127], v[32:47]
v_mov_b32 v188, 0
ds_read_b64_tr_b16 v[224:225], v4 offset:53248
ds_read_b64_tr_b16 v[226:227], v4 offset:55296
s_waitcnt lgkmcnt(12)
v_mfma_f32_32x32x16_bf16 v[48:63], v[232:235], v[124:127], v[48:63]
buffer_load_dwordx4 v[108:111], v0, s[8:11], s48 offen offset:3072
v_mov_b32 v189, 0
ds_read_b64_tr_b16 v[228:229], v4 offset:53504
ds_read_b64_tr_b16 v[230:231], v4 offset:55552
s_waitcnt lgkmcnt(12)
v_mfma_f32_32x32x16_bf16 v[64:79], v[236:239], v[124:127], v[64:79]
v_mov_b32 v190, 0
ds_read_b64_tr_b16 v[232:233], v4 offset:53760
ds_read_b64_tr_b16 v[234:235], v4 offset:55808
s_waitcnt vmcnt(14)
s_waitcnt lgkmcnt(12)
v_mfma_f32_32x32x16_bf16 v[16:31], v[208:211], v[128:131], v[16:31]
v_mov_b32 v191, 0
ds_read_b64_tr_b16 v[236:237], v4 offset:54016
ds_read_b64_tr_b16 v[238:239], v4 offset:56064
s_waitcnt lgkmcnt(12)
v_mfma_f32_32x32x16_bf16 v[32:47], v[212:215], v[128:131], v[32:47]
v_mov_b32 v192, 0
ds_read_b64_tr_b16 v[208:209], v4 offset:57344
ds_read_b64_tr_b16 v[210:211], v4 offset:59392
s_waitcnt lgkmcnt(12)
v_mfma_f32_32x32x16_bf16 v[48:63], v[216:219], v[128:131], v[48:63]
v_mov_b32 v193, 0
ds_read_b64_tr_b16 v[212:213], v4 offset:57600
ds_read_b64_tr_b16 v[214:215], v4 offset:59648
s_waitcnt lgkmcnt(12)
v_mfma_f32_32x32x16_bf16 v[64:79], v[220:223], v[128:131], v[64:79]
v_mov_b32 v194, 0
ds_read_b64_tr_b16 v[216:217], v4 offset:57856
ds_read_b64_tr_b16 v[218:219], v4 offset:59904
s_waitcnt lgkmcnt(12)
v_mfma_f32_32x32x16_bf16 v[16:31], v[224:227], v[132:135], v[16:31]
s_add_u32 m0, s35, 131072
s_add_u32 s31, s44, 0
buffer_load_dwordx4 v3, s[4:7], s31 offen lds
v_mov_b32 v195, 0
ds_read_b64_tr_b16 v[220:221], v4 offset:58112
ds_read_b64_tr_b16 v[222:223], v4 offset:60160
s_waitcnt lgkmcnt(12)
v_mfma_f32_32x32x16_bf16 v[32:47], v[228:231], v[132:135], v[32:47]
v_mov_b32 v196, 0
ds_read_b64_tr_b16 v[224:225], v4 offset:61440
ds_read_b64_tr_b16 v[226:227], v4 offset:63488
s_waitcnt lgkmcnt(12)
v_mfma_f32_32x32x16_bf16 v[48:63], v[232:235], v[132:135], v[48:63]
s_add_u32 m0, s35, 139264
s_add_u32 s31, s44, 262144
buffer_load_dwordx4 v3, s[4:7], s31 offen lds
v_mov_b32 v197, 0
ds_read_b64_tr_b16 v[228:229], v4 offset:61696
ds_read_b64_tr_b16 v[230:231], v4 offset:63744
s_waitcnt lgkmcnt(12)
v_mfma_f32_32x32x16_bf16 v[64:79], v[236:239], v[132:135], v[64:79]
v_mov_b32 v198, 0
ds_read_b64_tr_b16 v[232:233], v4 offset:61952
ds_read_b64_tr_b16 v[234:235], v4 offset:64000
s_waitcnt lgkmcnt(12)
v_mfma_f32_32x32x16_bf16 v[16:31], v[208:211], v[136:139], v[16:31]
s_add_u32 m0, s35, 147456
s_add_u32 s31, s44, 524288
buffer_load_dwordx4 v3, s[4:7], s31 offen lds
v_mov_b32 v199, 0
ds_read_b64_tr_b16 v[236:237], v4 offset:62208
ds_read_b64_tr_b16 v[238:239], v4 offset:64256
s_waitcnt lgkmcnt(12)
v_mfma_f32_32x32x16_bf16 v[32:47], v[212:215], v[136:139], v[32:47]
v_mov_b32 v200, 0
s_waitcnt vmcnt(11)
s_barrier
ds_read_b64_tr_b16 v[208:209], v5 offset:32768
ds_read_b64_tr_b16 v[210:211], v5 offset:34816
s_waitcnt lgkmcnt(12)
v_mfma_f32_32x32x16_bf16 v[48:63], v[216:219], v[136:139], v[48:63]
s_add_u32 m0, s35, 155648
s_add_u32 s31, s44, 786432
buffer_load_dwordx4 v3, s[4:7], s31 offen lds
v_mov_b32 v201, 0
ds_read_b64_tr_b16 v[212:213], v5 offset:33024
ds_read_b64_tr_b16 v[214:215], v5 offset:35072
s_waitcnt lgkmcnt(12)
v_mfma_f32_32x32x16_bf16 v[64:79], v[220:223], v[136:139], v[64:79]
v_mov_b32 v202, 0
ds_read_b64_tr_b16 v[216:217], v5 offset:33280
ds_read_b64_tr_b16 v[218:219], v5 offset:35328
s_waitcnt lgkmcnt(12)
v_mfma_f32_32x32x16_bf16 v[16:31], v[224:227], v[140:143], v[16:31]
buffer_load_dwordx4 v[144:147], v13, s[8:11], s49 offen offset:0
v_mov_b32 v203, 0
ds_read_b64_tr_b16 v[220:221], v5 offset:33536
ds_read_b64_tr_b16 v[222:223], v5 offset:35584
s_waitcnt lgkmcnt(12)
v_mfma_f32_32x32x16_bf16 v[32:47], v[228:231], v[140:143], v[32:47]
v_mov_b32 v204, 0
ds_read_b64_tr_b16 v[224:225], v5 offset:36864
ds_read_b64_tr_b16 v[226:227], v5 offset:38912
s_waitcnt lgkmcnt(12)
v_mfma_f32_32x32x16_bf16 v[48:63], v[232:235], v[140:143], v[48:63]
buffer_load_dwordx4 v[148:151], v13, s[8:11], s49 offen offset:1024
v_mov_b32 v205, 0
ds_read_b64_tr_b16 v[228:229], v5 offset:37120
ds_read_b64_tr_b16 v[230:231], v5 offset:39168
s_waitcnt lgkmcnt(12)
v_mfma_f32_32x32x16_bf16 v[64:79], v[236:239], v[140:143], v[64:79]
v_mov_b32 v206, 0
ds_read_b64_tr_b16 v[232:233], v5 offset:37376
ds_read_b64_tr_b16 v[234:235], v5 offset:39424
s_waitcnt vmcnt(10)
s_waitcnt lgkmcnt(12)
v_mfma_f32_32x32x16_bf16 v[16:31], v[208:211], v[80:83], v[16:31]
buffer_load_dwordx4 v[152:155], v13, s[8:11], s49 offen offset:2048
v_mov_b32 v207, 0
ds_read_b64_tr_b16 v[236:237], v5 offset:37632
ds_read_b64_tr_b16 v[238:239], v5 offset:39680
s_waitcnt lgkmcnt(12)
v_mfma_f32_32x32x16_bf16 v[32:47], v[212:215], v[80:83], v[32:47]
ds_read_b64_tr_b16 v[208:209], v5 offset:40960
ds_read_b64_tr_b16 v[210:211], v5 offset:43008
s_waitcnt lgkmcnt(12)
v_mfma_f32_32x32x16_bf16 v[48:63], v[216:219], v[80:83], v[48:63]
buffer_load_dwordx4 v[156:159], v13, s[8:11], s49 offen offset:3072
ds_read_b64_tr_b16 v[212:213], v5 offset:41216
ds_read_b64_tr_b16 v[214:215], v5 offset:43264
s_waitcnt lgkmcnt(12)
v_mfma_f32_32x32x16_bf16 v[64:79], v[220:223], v[80:83], v[64:79]
v_mov_b32 v112, 0
ds_read_b64_tr_b16 v[216:217], v5 offset:41472
ds_read_b64_tr_b16 v[218:219], v5 offset:43520
s_waitcnt lgkmcnt(12)
v_mfma_f32_32x32x16_bf16 v[16:31], v[224:227], v[84:87], v[16:31]
buffer_load_dwordx4 v[160:163], v0, s[8:11], s49 offen offset:0
v_mov_b32 v113, 0
ds_read_b64_tr_b16 v[220:221], v5 offset:41728
ds_read_b64_tr_b16 v[222:223], v5 offset:43776
s_waitcnt lgkmcnt(12)
v_mfma_f32_32x32x16_bf16 v[32:47], v[228:231], v[84:87], v[32:47]
v_mov_b32 v114, 0
ds_read_b64_tr_b16 v[224:225], v5 offset:45056
ds_read_b64_tr_b16 v[226:227], v5 offset:47104
s_waitcnt lgkmcnt(12)
v_mfma_f32_32x32x16_bf16 v[48:63], v[232:235], v[84:87], v[48:63]
buffer_load_dwordx4 v[164:167], v0, s[8:11], s49 offen offset:1024
v_mov_b32 v115, 0
ds_read_b64_tr_b16 v[228:229], v5 offset:45312
ds_read_b64_tr_b16 v[230:231], v5 offset:47360
s_waitcnt lgkmcnt(12)
v_mfma_f32_32x32x16_bf16 v[64:79], v[236:239], v[84:87], v[64:79]
v_mov_b32 v116, 0
ds_read_b64_tr_b16 v[232:233], v5 offset:45568
ds_read_b64_tr_b16 v[234:235], v5 offset:47616
s_waitcnt lgkmcnt(12)
v_mfma_f32_32x32x16_bf16 v[16:31], v[208:211], v[88:91], v[16:31]
buffer_load_dwordx4 v[168:171], v0, s[8:11], s49 offen offset:2048
v_mov_b32 v117, 0
ds_read_b64_tr_b16 v[236:237], v5 offset:45824
ds_read_b64_tr_b16 v[238:239], v5 offset:47872
s_waitcnt lgkmcnt(12)
v_mfma_f32_32x32x16_bf16 v[32:47], v[212:215], v[88:91], v[32:47]
v_mov_b32 v118, 0
ds_read_b64_tr_b16 v[208:209], v5 offset:49152
ds_read_b64_tr_b16 v[210:211], v5 offset:51200
s_waitcnt lgkmcnt(12)
v_mfma_f32_32x32x16_bf16 v[48:63], v[216:219], v[88:91], v[48:63]
buffer_load_dwordx4 v[172:175], v0, s[8:11], s49 offen offset:3072
v_mov_b32 v119, 0
ds_read_b64_tr_b16 v[212:213], v5 offset:49408
ds_read_b64_tr_b16 v[214:215], v5 offset:51456
s_waitcnt lgkmcnt(12)
v_mfma_f32_32x32x16_bf16 v[64:79], v[220:223], v[88:91], v[64:79]
v_mov_b32 v120, 0
ds_read_b64_tr_b16 v[216:217], v5 offset:49664
ds_read_b64_tr_b16 v[218:219], v5 offset:51712
s_waitcnt lgkmcnt(12)
v_mfma_f32_32x32x16_bf16 v[16:31], v[224:227], v[92:95], v[16:31]
v_mov_b32 v121, 0
ds_read_b64_tr_b16 v[220:221], v5 offset:49920
ds_read_b64_tr_b16 v[222:223], v5 offset:51968
s_waitcnt lgkmcnt(12)
v_mfma_f32_32x32x16_bf16 v[32:47], v[228:231], v[92:95], v[32:47]
v_mov_b32 v122, 0
ds_read_b64_tr_b16 v[224:225], v5 offset:53248
ds_read_b64_tr_b16 v[226:227], v5 offset:55296
s_waitcnt lgkmcnt(12)
v_mfma_f32_32x32x16_bf16 v[48:63], v[232:235], v[92:95], v[48:63]
v_mov_b32 v123, 0
ds_read_b64_tr_b16 v[228:229], v5 offset:53504
ds_read_b64_tr_b16 v[230:231], v5 offset:55552
s_waitcnt lgkmcnt(12)
v_mfma_f32_32x32x16_bf16 v[64:79], v[236:239], v[92:95], v[64:79]
v_mov_b32 v124, 0
ds_read_b64_tr_b16 v[232:233], v5 offset:53760
ds_read_b64_tr_b16 v[234:235], v5 offset:55808
s_waitcnt vmcnt(12)
s_waitcnt lgkmcnt(12)
v_mfma_f32_32x32x16_bf16 v[16:31], v[208:211], v[96:99], v[16:31]
v_mov_b32 v125, 0
ds_read_b64_tr_b16 v[236:237], v5 offset:54016
ds_read_b64_tr_b16 v[238:239], v5 offset:56064
s_waitcnt lgkmcnt(12)
v_mfma_f32_32x32x16_bf16 v[32:47], v[212:215], v[96:99], v[32:47]
v_mov_b32 v126, 0
ds_read_b64_tr_b16 v[208:209], v5 offset:57344
ds_read_b64_tr_b16 v[210:211], v5 offset:59392
s_waitcnt lgkmcnt(12)
v_mfma_f32_32x32x16_bf16 v[48:63], v[216:219], v[96:99], v[48:63]
v_mov_b32 v127, 0
ds_read_b64_tr_b16 v[212:213], v5 offset:57600
ds_read_b64_tr_b16 v[214:215], v5 offset:59648
s_waitcnt lgkmcnt(12)
v_mfma_f32_32x32x16_bf16 v[64:79], v[220:223], v[96:99], v[64:79]
ds_read_b64_tr_b16 v[216:217], v5 offset:57856
ds_read_b64_tr_b16 v[218:219], v5 offset:59904
s_waitcnt lgkmcnt(12)
v_mfma_f32_32x32x16_bf16 v[16:31], v[224:227], v[100:103], v[16:31]
ds_read_b64_tr_b16 v[220:221], v5 offset:58112
ds_read_b64_tr_b16 v[222:223], v5 offset:60160
s_waitcnt lgkmcnt(12)
v_mfma_f32_32x32x16_bf16 v[32:47], v[228:231], v[100:103], v[32:47]
ds_read_b64_tr_b16 v[224:225], v5 offset:61440
ds_read_b64_tr_b16 v[226:227], v5 offset:63488
s_waitcnt lgkmcnt(12)
v_mfma_f32_32x32x16_bf16 v[48:63], v[232:235], v[100:103], v[48:63]
ds_read_b64_tr_b16 v[228:229], v5 offset:61696
ds_read_b64_tr_b16 v[230:231], v5 offset:63744
s_waitcnt lgkmcnt(12)
v_mfma_f32_32x32x16_bf16 v[64:79], v[236:239], v[100:103], v[64:79]
ds_read_b64_tr_b16 v[232:233], v5 offset:61952
ds_read_b64_tr_b16 v[234:235], v5 offset:64000
s_waitcnt lgkmcnt(12)
v_mfma_f32_32x32x16_bf16 v[16:31], v[208:211], v[104:107], v[16:31]
ds_read_b64_tr_b16 v[236:237], v5 offset:62208
ds_read_b64_tr_b16 v[238:239], v5 offset:64256
s_waitcnt lgkmcnt(12)
v_mfma_f32_32x32x16_bf16 v[32:47], v[212:215], v[104:107], v[32:47]
s_waitcnt vmcnt(8)
s_barrier
ds_read_b64_tr_b16 v[208:209], v6 offset:0
ds_read_b64_tr_b16 v[210:211], v6 offset:2048
s_waitcnt lgkmcnt(12)
v_mfma_f32_32x32x16_bf16 v[48:63], v[216:219], v[104:107], v[48:63]
ds_read_b64_tr_b16 v[212:213], v6 offset:256
ds_read_b64_tr_b16 v[214:215], v6 offset:2304
s_waitcnt lgkmcnt(12)
v_mfma_f32_32x32x16_bf16 v[64:79], v[220:223], v[104:107], v[64:79]
ds_read_b64_tr_b16 v[216:217], v6 offset:512
ds_read_b64_tr_b16 v[218:219], v6 offset:2560
s_waitcnt lgkmcnt(12)
v_mfma_f32_32x32x16_bf16 v[16:31], v[224:227], v[108:111], v[16:31]
ds_read_b64_tr_b16 v[220:221], v6 offset:768
ds_read_b64_tr_b16 v[222:223], v6 offset:2816
s_waitcnt lgkmcnt(12)
v_mfma_f32_32x32x16_bf16 v[32:47], v[228:231], v[108:111], v[32:47]
ds_read_b64_tr_b16 v[224:225], v6 offset:4096
ds_read_b64_tr_b16 v[226:227], v6 offset:6144
s_waitcnt lgkmcnt(12)
v_mfma_f32_32x32x16_bf16 v[48:63], v[232:235], v[108:111], v[48:63]
ds_read_b64_tr_b16 v[228:229], v6 offset:4352
ds_read_b64_tr_b16 v[230:231], v6 offset:6400
s_waitcnt lgkmcnt(12)
v_mfma_f32_32x32x16_bf16 v[64:79], v[236:239], v[108:111], v[64:79]
ds_read_b64_tr_b16 v[232:233], v6 offset:4608
ds_read_b64_tr_b16 v[234:235], v6 offset:6656
s_waitcnt vmcnt(4)
s_waitcnt lgkmcnt(12)
v_mfma_f32_32x32x16_bf16 v[16:31], v[208:211], v[144:147], v[16:31]
ds_read_b64_tr_b16 v[236:237], v6 offset:4864
ds_read_b64_tr_b16 v[238:239], v6 offset:6912
s_waitcnt lgkmcnt(12)
v_mfma_f32_32x32x16_bf16 v[32:47], v[212:215], v[144:147], v[32:47]
ds_read_b64_tr_b16 v[208:209], v6 offset:8192
ds_read_b64_tr_b16 v[210:211], v6 offset:10240
s_waitcnt lgkmcnt(12)
v_mfma_f32_32x32x16_bf16 v[48:63], v[216:219], v[144:147], v[48:63]
ds_read_b64_tr_b16 v[212:213], v6 offset:8448
ds_read_b64_tr_b16 v[214:215], v6 offset:10496
s_waitcnt lgkmcnt(12)
v_mfma_f32_32x32x16_bf16 v[64:79], v[220:223], v[144:147], v[64:79]
ds_read_b64_tr_b16 v[216:217], v6 offset:8704
ds_read_b64_tr_b16 v[218:219], v6 offset:10752
s_waitcnt lgkmcnt(12)
v_mfma_f32_32x32x16_bf16 v[16:31], v[224:227], v[148:151], v[16:31]
ds_read_b64_tr_b16 v[220:221], v6 offset:8960
ds_read_b64_tr_b16 v[222:223], v6 offset:11008
s_waitcnt lgkmcnt(12)
v_mfma_f32_32x32x16_bf16 v[32:47], v[228:231], v[148:151], v[32:47]
ds_read_b64_tr_b16 v[224:225], v6 offset:12288
ds_read_b64_tr_b16 v[226:227], v6 offset:14336
s_waitcnt lgkmcnt(12)
v_mfma_f32_32x32x16_bf16 v[48:63], v[232:235], v[148:151], v[48:63]
ds_read_b64_tr_b16 v[228:229], v6 offset:12544
ds_read_b64_tr_b16 v[230:231], v6 offset:14592
s_waitcnt lgkmcnt(12)
v_mfma_f32_32x32x16_bf16 v[64:79], v[236:239], v[148:151], v[64:79]
ds_read_b64_tr_b16 v[232:233], v6 offset:12800
ds_read_b64_tr_b16 v[234:235], v6 offset:14848
s_waitcnt lgkmcnt(12)
v_mfma_f32_32x32x16_bf16 v[16:31], v[208:211], v[152:155], v[16:31]
ds_read_b64_tr_b16 v[236:237], v6 offset:13056
ds_read_b64_tr_b16 v[238:239], v6 offset:15104
s_waitcnt lgkmcnt(12)
v_mfma_f32_32x32x16_bf16 v[32:47], v[212:215], v[152:155], v[32:47]
ds_read_b64_tr_b16 v[208:209], v6 offset:16384
ds_read_b64_tr_b16 v[210:211], v6 offset:18432
s_waitcnt lgkmcnt(12)
v_mfma_f32_32x32x16_bf16 v[48:63], v[216:219], v[152:155], v[48:63]
ds_read_b64_tr_b16 v[212:213], v6 offset:16640
ds_read_b64_tr_b16 v[214:215], v6 offset:18688
s_waitcnt lgkmcnt(12)
v_mfma_f32_32x32x16_bf16 v[64:79], v[220:223], v[152:155], v[64:79]
ds_read_b64_tr_b16 v[216:217], v6 offset:16896
ds_read_b64_tr_b16 v[218:219], v6 offset:18944
s_waitcnt lgkmcnt(12)
v_mfma_f32_32x32x16_bf16 v[16:31], v[224:227], v[156:159], v[16:31]
ds_read_b64_tr_b16 v[220:221], v6 offset:17152
ds_read_b64_tr_b16 v[222:223], v6 offset:19200
s_waitcnt lgkmcnt(12)
v_mfma_f32_32x32x16_bf16 v[32:47], v[228:231], v[156:159], v[32:47]
ds_read_b64_tr_b16 v[224:225], v6 offset:20480
ds_read_b64_tr_b16 v[226:227], v6 offset:22528
s_waitcnt lgkmcnt(12)
v_mfma_f32_32x32x16_bf16 v[48:63], v[232:235], v[156:159], v[48:63]
ds_read_b64_tr_b16 v[228:229], v6 offset:20736
ds_read_b64_tr_b16 v[230:231], v6 offset:22784
s_waitcnt lgkmcnt(12)
v_mfma_f32_32x32x16_bf16 v[64:79], v[236:239], v[156:159], v[64:79]
ds_read_b64_tr_b16 v[232:233], v6 offset:20992
ds_read_b64_tr_b16 v[234:235], v6 offset:23040
s_waitcnt vmcnt(0)
s_waitcnt lgkmcnt(12)
v_mfma_f32_32x32x16_bf16 v[16:31], v[208:211], v[160:163], v[16:31]
ds_read_b64_tr_b16 v[236:237], v6 offset:21248
ds_read_b64_tr_b16 v[238:239], v6 offset:23296
s_waitcnt lgkmcnt(12)
v_mfma_f32_32x32x16_bf16 v[32:47], v[212:215], v[160:163], v[32:47]
ds_read_b64_tr_b16 v[208:209], v6 offset:24576
ds_read_b64_tr_b16 v[210:211], v6 offset:26624
s_waitcnt lgkmcnt(12)
v_mfma_f32_32x32x16_bf16 v[48:63], v[216:219], v[160:163], v[48:63]
ds_read_b64_tr_b16 v[212:213], v6 offset:24832
ds_read_b64_tr_b16 v[214:215], v6 offset:26880
s_waitcnt lgkmcnt(12)
v_mfma_f32_32x32x16_bf16 v[64:79], v[220:223], v[160:163], v[64:79]
ds_read_b64_tr_b16 v[216:217], v6 offset:25088
ds_read_b64_tr_b16 v[218:219], v6 offset:27136
s_waitcnt lgkmcnt(12)
v_mfma_f32_32x32x16_bf16 v[16:31], v[224:227], v[164:167], v[16:31]
ds_read_b64_tr_b16 v[220:221], v6 offset:25344
ds_read_b64_tr_b16 v[222:223], v6 offset:27392
s_waitcnt lgkmcnt(12)
v_mfma_f32_32x32x16_bf16 v[32:47], v[228:231], v[164:167], v[32:47]
ds_read_b64_tr_b16 v[224:225], v6 offset:28672
ds_read_b64_tr_b16 v[226:227], v6 offset:30720
s_waitcnt lgkmcnt(12)
v_mfma_f32_32x32x16_bf16 v[48:63], v[232:235], v[164:167], v[48:63]
ds_read_b64_tr_b16 v[228:229], v6 offset:28928
ds_read_b64_tr_b16 v[230:231], v6 offset:30976
s_waitcnt lgkmcnt(12)
v_mfma_f32_32x32x16_bf16 v[64:79], v[236:239], v[164:167], v[64:79]
ds_read_b64_tr_b16 v[232:233], v6 offset:29184
ds_read_b64_tr_b16 v[234:235], v6 offset:31232
s_waitcnt lgkmcnt(12)
v_mfma_f32_32x32x16_bf16 v[16:31], v[208:211], v[168:171], v[16:31]
ds_read_b64_tr_b16 v[236:237], v6 offset:29440
ds_read_b64_tr_b16 v[238:239], v6 offset:31488
s_waitcnt lgkmcnt(12)
v_mfma_f32_32x32x16_bf16 v[32:47], v[212:215], v[168:171], v[32:47]
s_waitcnt lgkmcnt(10)
v_mfma_f32_32x32x16_bf16 v[48:63], v[216:219], v[168:171], v[48:63]
s_waitcnt lgkmcnt(8)
v_mfma_f32_32x32x16_bf16 v[64:79], v[220:223], v[168:171], v[64:79]
s_waitcnt lgkmcnt(6)
v_mfma_f32_32x32x16_bf16 v[16:31], v[224:227], v[172:175], v[16:31]
s_waitcnt lgkmcnt(4)
v_mfma_f32_32x32x16_bf16 v[32:47], v[228:231], v[172:175], v[32:47]
s_waitcnt lgkmcnt(2)
v_mfma_f32_32x32x16_bf16 v[48:63], v[232:235], v[172:175], v[48:63]
s_waitcnt lgkmcnt(0)
v_mfma_f32_32x32x16_bf16 v[64:79], v[236:239], v[172:175], v[64:79]
s_mov_b32 s38, 0x10000
s_barrier
ds_read_b128 v[208:211], v7 offset:16384
ds_read_b128 v[212:215], v7 offset:17408
ds_read_b128 v[216:219], v7 offset:18432
ds_read_b128 v[220:223], v7 offset:19456
ds_read_b128 v[224:227], v7 offset:20480
ds_read_b128 v[228:231], v7 offset:21504
ds_read_b128 v[232:235], v7 offset:22528
v_cvt_pk_bf16_f32 v80, v16, v17
v_cvt_pk_bf16_f32 v81, v18, v19
v_cvt_pk_bf16_f32 v82, v20, v21
v_cvt_pk_bf16_f32 v83, v22, v23
v_cvt_pk_bf16_f32 v84, v24, v25
v_cvt_pk_bf16_f32 v85, v26, v27
v_cvt_pk_bf16_f32 v86, v28, v29
v_cvt_pk_bf16_f32 v87, v30, v31
v_cvt_pk_bf16_f32 v88, v32, v33
v_cvt_pk_bf16_f32 v89, v34, v35
v_cvt_pk_bf16_f32 v90, v36, v37
v_cvt_pk_bf16_f32 v91, v38, v39
v_cvt_pk_bf16_f32 v92, v40, v41
v_cvt_pk_bf16_f32 v93, v42, v43
v_cvt_pk_bf16_f32 v94, v44, v45
v_cvt_pk_bf16_f32 v95, v46, v47
v_cvt_pk_bf16_f32 v96, v48, v49
v_cvt_pk_bf16_f32 v97, v50, v51
v_cvt_pk_bf16_f32 v98, v52, v53
v_cvt_pk_bf16_f32 v99, v54, v55
v_cvt_pk_bf16_f32 v100, v56, v57
v_cvt_pk_bf16_f32 v101, v58, v59
v_cvt_pk_bf16_f32 v102, v60, v61
v_cvt_pk_bf16_f32 v103, v62, v63
v_cvt_pk_bf16_f32 v104, v64, v65
v_cvt_pk_bf16_f32 v105, v66, v67
v_cvt_pk_bf16_f32 v106, v68, v69
v_cvt_pk_bf16_f32 v107, v70, v71
v_cvt_pk_bf16_f32 v108, v72, v73
v_cvt_pk_bf16_f32 v109, v74, v75
v_cvt_pk_bf16_f32 v110, v76, v77
v_cvt_pk_bf16_f32 v111, v78, v79
v_mov_b32 v8, 0
v_mov_b32 v9, 0
v_mov_b32 v12, 0xf149f2ca
ds_read_b128 v[236:239], v7 offset:23552
v_mov_b32 v144, 0
v_mov_b32 v145, 0
s_waitcnt lgkmcnt(7)
v_mfma_f32_32x32x16_bf16 v[16:31], v[208:211], v[80:83], v[112:127]
ds_read_b128 v[208:211], v7 offset:24576
v_mov_b32 v146, 0
v_mov_b32 v147, 0
s_waitcnt lgkmcnt(7)
v_mfma_f32_32x32x16_bf16 v[16:31], v[212:215], v[84:87], v[16:31]
ds_read_b128 v[212:215], v7 offset:25600
v_mov_b32 v148, 0
v_mov_b32 v149, 0
s_waitcnt lgkmcnt(7)
v_mfma_f32_32x32x16_bf16 v[16:31], v[216:219], v[88:91], v[16:31]
ds_read_b128 v[216:219], v7 offset:26624
v_mov_b32 v150, 0
v_mov_b32 v151, 0
s_waitcnt lgkmcnt(7)
v_mfma_f32_32x32x16_bf16 v[16:31], v[220:223], v[92:95], v[16:31]
ds_read_b128 v[220:223], v7 offset:27648
v_mov_b32 v152, 0
v_mov_b32 v153, 0
s_waitcnt lgkmcnt(7)
v_mfma_f32_32x32x16_bf16 v[16:31], v[224:227], v[96:99], v[16:31]
ds_read_b128 v[224:227], v7 offset:28672
v_mov_b32 v154, 0
v_mov_b32 v155, 0
s_waitcnt lgkmcnt(7)
v_mfma_f32_32x32x16_bf16 v[16:31], v[228:231], v[100:103], v[16:31]
ds_read_b128 v[228:231], v7 offset:29696
v_mov_b32 v156, 0
v_mov_b32 v157, 0
s_waitcnt lgkmcnt(7)
v_mfma_f32_32x32x16_bf16 v[16:31], v[232:235], v[104:107], v[16:31]
ds_read_b128 v[232:235], v7 offset:30720
v_mov_b32 v158, 0
v_mov_b32 v159, 0
s_waitcnt lgkmcnt(7)
v_mfma_f32_32x32x16_bf16 v[16:31], v[236:239], v[108:111], v[16:31]
ds_read_b128 v[236:239], v7 offset:31744
v_mov_b32 v160, 0
v_mov_b32 v161, 0
s_waitcnt lgkmcnt(7)
v_mfma_f32_32x32x16_bf16 v[32:47], v[208:211], v[80:83], v[112:127]
s_add_u32 s38, s38, 0x8000
s_cmp_eq_u32 s38, 0x18000
s_cselect_b32 s38, 0, s38
s_barrier
v_add_u32 v7, s38, v13
ds_read_b128 v[208:211], v7 offset:16384
v_mov_b32 v162, 0
v_mov_b32 v163, 0
s_waitcnt lgkmcnt(7)
v_mfma_f32_32x32x16_bf16 v[32:47], v[212:215], v[84:87], v[32:47]
ds_read_b128 v[212:215], v7 offset:17408
v_mov_b32 v164, 0
v_mov_b32 v165, 0
s_waitcnt lgkmcnt(7)
v_mfma_f32_32x32x16_bf16 v[32:47], v[216:219], v[88:91], v[32:47]
ds_read_b128 v[216:219], v7 offset:18432
v_mov_b32 v166, 0
v_mov_b32 v167, 0
s_waitcnt lgkmcnt(7)
v_mfma_f32_32x32x16_bf16 v[32:47], v[220:223], v[92:95], v[32:47]
ds_read_b128 v[220:223], v7 offset:19456
v_mov_b32 v168, 0
v_mov_b32 v169, 0
s_waitcnt lgkmcnt(7)
v_mfma_f32_32x32x16_bf16 v[32:47], v[224:227], v[96:99], v[32:47]
ds_read_b128 v[224:227], v7 offset:20480
v_mov_b32 v170, 0
v_mov_b32 v171, 0
s_waitcnt lgkmcnt(7)
v_mfma_f32_32x32x16_bf16 v[32:47], v[228:231], v[100:103], v[32:47]
ds_read_b128 v[228:231], v7 offset:21504
v_mov_b32 v172, 0
v_mov_b32 v173, 0
s_waitcnt lgkmcnt(7)
v_mfma_f32_32x32x16_bf16 v[32:47], v[232:235], v[104:107], v[32:47]
ds_read_b128 v[232:235], v7 offset:22528
v_mov_b32 v174, 0
v_mov_b32 v175, 0
s_waitcnt lgkmcnt(7)
v_mfma_f32_32x32x16_bf16 v[32:47], v[236:239], v[108:111], v[32:47]
LatA_q1:
s_nop 11
v_max3_f32 v10, v16, v17, v18
v_max3_f32 v10, v10, v19, v20
v_max3_f32 v10, v10, v21, v22
v_max3_f32 v10, v10, v23, v24
v_max3_f32 v10, v10, v25, v26
v_max3_f32 v10, v10, v27, v28
v_max3_f32 v10, v10, v29, v30
v_max3_f32 v10, v10, v31, v32
v_max3_f32 v10, v10, v33, v34
v_max3_f32 v10, v10, v35, v36
v_max3_f32 v10, v10, v37, v38
v_max3_f32 v10, v10, v39, v40
v_max3_f32 v10, v10, v41, v42
v_max3_f32 v10, v10, v43, v44
v_max3_f32 v10, v10, v45, v46
v_max_f32 v10, v10, v47
v_mov_b32 v14, v10
s_nop 1
v_permlane32_swap_b32 v14, v10
v_max_f32 v10, v10, v14
v_sub_f32 v112, 0, v10
v_sub_f32 v113, 0, v10
v_sub_f32 v114, 0, v10
v_sub_f32 v115, 0, v10
v_sub_f32 v116, 0, v10
v_sub_f32 v117, 0, v10
v_sub_f32 v118, 0, v10
v_sub_f32 v119, 0, v10
v_sub_f32 v120, 0, v10
v_sub_f32 v121, 0, v10
v_sub_f32 v122, 0, v10
v_sub_f32 v123, 0, v10
v_sub_f32 v124, 0, v10
v_sub_f32 v125, 0, v10
v_sub_f32 v126, 0, v10
v_sub_f32 v127, 0, v10
v_sub_f32 v16, v16, v10
v_sub_f32 v17, v17, v10
v_sub_f32 v18, v18, v10
v_sub_f32 v19, v19, v10
v_sub_f32 v20, v20, v10
v_sub_f32 v21, v21, v10
v_sub_f32 v22, v22, v10
v_sub_f32 v23, v23, v10
v_sub_f32 v24, v24, v10
v_sub_f32 v25, v25, v10
v_sub_f32 v26, v26, v10
v_sub_f32 v27, v27, v10
v_sub_f32 v28, v28, v10
v_sub_f32 v29, v29, v10
v_sub_f32 v30, v30, v10
v_sub_f32 v31, v31, v10
v_sub_f32 v32, v32, v10
v_sub_f32 v33, v33, v10
v_sub_f32 v34, v34, v10
v_sub_f32 v35, v35, v10
v_sub_f32 v36, v36, v10
v_sub_f32 v37, v37, v10
v_sub_f32 v38, v38, v10
v_sub_f32 v39, v39, v10
v_sub_f32 v40, v40, v10
v_sub_f32 v41, v41, v10
v_sub_f32 v42, v42, v10
v_sub_f32 v43, v43, v10
v_sub_f32 v44, v44, v10
v_sub_f32 v45, v45, v10
v_sub_f32 v46, v46, v10
v_sub_f32 v47, v47, v10
s_setprio 1
LatA_loop:
s_cmp_eq_u32 s28, 1
s_cbranch_scc1 LatA_m0
ds_read_b128 v[236:239], v7 offset:23552
v_exp_f32 v16, v16
v_exp_f32 v17, v17
s_waitcnt lgkmcnt(6)
v_mfma_f32_32x32x16_bf16 v[48:63], v[208:211], v[80:83], v[112:127]
ds_read_b128 v[208:211], v7 offset:24576
v_exp_f32 v18, v18
v_cvt_pk_bf16_f32 v128, v16, v17
v_add_f32 v8, v8, v16
v_add_f32 v9, v9, v17
v_mfma_f32_32x32x16_bf16 v[48:63], v[212:215], v[84:87], v[48:63]
ds_read_b128 v[212:215], v7 offset:25600
v_exp_f32 v19, v19
v_add_f32 v8, v8, v18
s_waitcnt lgkmcnt(6)
v_mfma_f32_32x32x16_bf16 v[48:63], v[216:219], v[88:91], v[48:63]
ds_read_b128 v[216:219], v7 offset:26624
v_exp_f32 v20, v20
v_cvt_pk_bf16_f32 v129, v18, v19
v_add_f32 v9, v9, v19
v_mfma_f32_32x32x16_bf16 v[48:63], v[220:223], v[92:95], v[48:63]
ds_read_b128 v[220:223], v7 offset:27648
v_exp_f32 v21, v21
v_exp_f32 v22, v22
s_waitcnt lgkmcnt(6)
v_mfma_f32_32x32x16_bf16 v[48:63], v[224:227], v[96:99], v[48:63]
ds_read_b128 v[224:227], v7 offset:28672
v_exp_f32 v23, v23
v_cvt_pk_bf16_f32 v130, v20, v21
v_add_f32 v8, v8, v20
v_add_f32 v9, v9, v21
v_mfma_f32_32x32x16_bf16 v[48:63], v[228:231], v[100:103], v[48:63]
ds_read_b128 v[228:231], v7 offset:29696
v_exp_f32 v24, v24
v_cvt_pk_bf16_f32 v131, v22, v23
v_add_f32 v8, v8, v22
s_waitcnt lgkmcnt(6)
v_mfma_f32_32x32x16_bf16 v[48:63], v[232:235], v[104:107], v[48:63]
ds_read_b128 v[232:235], v7 offset:30720
v_exp_f32 v25, v25
v_add_f32 v9, v9, v23
v_add_f32 v8, v8, v24
v_mfma_f32_32x32x16_bf16 v[48:63], v[236:239], v[108:111], v[48:63]
ds_read_b128 v[236:239], v7 offset:31744
v_exp_f32 v26, v26
v_exp_f32 v27, v27
v_cvt_pk_bf16_f32 v132, v24, v25
s_waitcnt lgkmcnt(6)
v_mfma_f32_32x32x16_bf16 v[64:79], v[208:211], v[80:83], v[112:127]
ds_read_b128 v[208:211], v7 offset:0
v_exp_f32 v28, v28
v_cvt_pk_bf16_f32 v133, v26, v27
v_add_f32 v9, v9, v25
v_add_f32 v8, v8, v26
v_mfma_f32_32x32x16_bf16 v[64:79], v[212:215], v[84:87], v[64:79]
ds_read_b128 v[212:215], v7 offset:4096
v_exp_f32 v29, v29
v_max3_f32 v10, v48, v49, v50
v_add_f32 v9, v9, v27
s_waitcnt lgkmcnt(6)
v_mfma_f32_32x32x16_bf16 v[64:79], v[216:219], v[88:91], v[64:79]
ds_read_b128 v[216:219], v7 offset:8192
v_exp_f32 v30, v30
v_cvt_pk_bf16_f32 v134, v28, v29
v_max3_f32 v10, v10, v51, v52
v_add_f32 v8, v8, v28
v_mfma_f32_32x32x16_bf16 v[64:79], v[220:223], v[92:95], v[64:79]
ds_read_b128 v[220:223], v7 offset:12288
v_exp_f32 v31, v31
v_max3_f32 v10, v10, v53, v54
v_add_f32 v9, v9, v29
s_waitcnt lgkmcnt(6)
v_mfma_f32_32x32x16_bf16 v[64:79], v[224:227], v[96:99], v[64:79]
ds_read_b128 v[224:227], v7 offset:1024
v_exp_f32 v32, v32
v_exp_f32 v33, v33
v_cvt_pk_bf16_f32 v135, v30, v31
v_max3_f32 v10, v10, v55, v56
v_mfma_f32_32x32x16_bf16 v[64:79], v[228:231], v[100:103], v[64:79]
ds_read_b128 v[228:231], v7 offset:5120
v_exp_f32 v34, v34
v_cvt_pk_bf16_f32 v136, v32, v33
v_max3_f32 v10, v10, v57, v58
s_waitcnt lgkmcnt(6)
v_mfma_f32_32x32x16_bf16 v[64:79], v[232:235], v[104:107], v[64:79]
ds_read_b128 v[232:235], v7 offset:9216
v_exp_f32 v35, v35
v_max3_f32 v10, v10, v59, v60
v_add_f32 v8, v8, v30
v_mfma_f32_32x32x16_bf16 v[64:79], v[236:239], v[108:111], v[64:79]
ds_read_b128 v[236:239], v7 offset:13312
v_exp_f32 v36, v36
v_cvt_pk_bf16_f32 v137, v34, v35
v_max3_f32 v10, v10, v61, v62
s_waitcnt lgkmcnt(6)
v_mfma_f32_32x32x16_bf16 v[144:159], v[208:211], v[128:131], v[144:159]
ds_read_b128 v[208:211], v7 offset:2048
v_exp_f32 v37, v37
v_exp_f32 v38, v38
v_mfma_f32_32x32x16_bf16 v[160:175], v[212:215], v[128:131], v[160:175]
ds_read_b128 v[212:215], v7 offset:6144
v_exp_f32 v39, v39
v_cvt_pk_bf16_f32 v138, v36, v37
v_max3_f32 v10, v10, v63, v64
s_waitcnt lgkmcnt(6)
v_mfma_f32_32x32x16_bf16 v[176:191], v[216:219], v[128:131], v[176:191]
ds_read_b128 v[216:219], v7 offset:10240
v_exp_f32 v40, v40
v_cvt_pk_bf16_f32 v139, v38, v39
v_max3_f32 v10, v10, v65, v66
v_mfma_f32_32x32x16_bf16 v[192:207], v[220:223], v[128:131], v[192:207]
ds_read_b128 v[220:223], v7 offset:14336
v_exp_f32 v41, v41
v_max3_f32 v10, v10, v67, v68
v_add_f32 v9, v9, v31
s_waitcnt lgkmcnt(6)
v_mfma_f32_32x32x16_bf16 v[144:159], v[224:227], v[132:135], v[144:159]
ds_read_b128 v[224:227], v7 offset:3072
v_exp_f32 v42, v42
v_exp_f32 v43, v43
v_cvt_pk_bf16_f32 v140, v40, v41
v_max3_f32 v10, v10, v69, v70
v_mfma_f32_32x32x16_bf16 v[160:175], v[228:231], v[132:135], v[160:175]
ds_read_b128 v[228:231], v7 offset:7168
v_exp_f32 v44, v44
v_cvt_pk_bf16_f32 v141, v42, v43
v_max3_f32 v10, v10, v71, v72
s_waitcnt lgkmcnt(6)
v_mfma_f32_32x32x16_bf16 v[176:191], v[232:235], v[132:135], v[176:191]
ds_read_b128 v[232:235], v7 offset:11264
v_exp_f32 v45, v45
v_max3_f32 v10, v10, v73, v74
v_add_f32 v8, v8, v32
v_mfma_f32_32x32x16_bf16 v[192:207], v[236:239], v[132:135], v[192:207]
s_add_u32 s38, s38, 0x8000
s_cmp_eq_u32 s38, 0x18000
s_cselect_b32 s38, 0, s38
ds_read_b128 v[236:239], v7 offset:15360
v_exp_f32 v46, v46
v_cvt_pk_bf16_f32 v142, v44, v45
v_max3_f32 v10, v10, v75, v76
s_waitcnt lgkmcnt(6)
v_mfma_f32_32x32x16_bf16 v[144:159], v[208:211], v[136:139], v[144:159]
s_barrier
v_add_u32 v7, s38, v13
ds_read_b128 v[208:211], v7 offset:16384
v_exp_f32 v47, v47
v_max3_f32 v10, v10, v77, v78
v_mfma_f32_32x32x16_bf16 v[160:175], v[212:215], v[136:139], v[160:175]
ds_read_b128 v[212:215], v7 offset:17408
v_cvt_pk_bf16_f32 v143, v46, v47
v_max_f32 v10, v10, v79
v_add_f32 v9, v9, v33
s_waitcnt lgkmcnt(6)
v_mfma_f32_32x32x16_bf16 v[176:191], v[216:219], v[136:139], v[176:191]
ds_read_b128 v[216:219], v7 offset:18432
v_add_f32 v8, v8, v34
v_add_f32 v9, v9, v35
v_add_f32 v8, v8, v36
v_mfma_f32_32x32x16_bf16 v[192:207], v[220:223], v[136:139], v[192:207]
ds_read_b128 v[220:223], v7 offset:19456
v_add_f32 v9, v9, v37
v_add_f32 v8, v8, v38
v_cmp_lt_f32 vcc, 0x41000000, v10
s_waitcnt lgkmcnt(6)
v_mfma_f32_32x32x16_bf16 v[144:159], v[224:227], v[140:143], v[144:159]
ds_read_b128 v[224:227], v7 offset:20480
v_add_f32 v9, v9, v39
v_add_f32 v8, v8, v40
v_add_f32 v9, v9, v41
v_mfma_f32_32x32x16_bf16 v[160:175], v[228:231], v[140:143], v[160:175]
ds_read_b128 v[228:231], v7 offset:21504
v_add_f32 v8, v8, v42
v_add_f32 v9, v9, v43
v_add_f32 v8, v8, v44
s_waitcnt lgkmcnt(6)
v_mfma_f32_32x32x16_bf16 v[176:191], v[232:235], v[140:143], v[176:191]
ds_read_b128 v[232:235], v7 offset:22528
v_add_f32 v9, v9, v45
v_add_f32 v8, v8, v46
v_add_f32 v9, v9, v47
v_mfma_f32_32x32x16_bf16 v[192:207], v[236:239], v[140:143], v[192:207]
s_cbranch_vccnz LatA_rs_1
LatA_rs_1r:
s_cmp_eq_u32 s28, 2
s_cbranch_scc1 LatA_m1
ds_read_b128 v[236:239], v7 offset:23552
v_exp_f32 v48, v48
v_exp_f32 v49, v49
s_waitcnt lgkmcnt(6)
v_mfma_f32_32x32x16_bf16 v[16:31], v[208:211], v[80:83], v[112:127]
ds_read_b128 v[208:211], v7 offset:24576
v_exp_f32 v50, v50
v_cvt_pk_bf16_f32 v128, v48, v49
v_add_f32 v8, v8, v48
v_add_f32 v9, v9, v49
v_mfma_f32_32x32x16_bf16 v[16:31], v[212:215], v[84:87], v[16:31]
ds_read_b128 v[212:215], v7 offset:25600
v_exp_f32 v51, v51
v_add_f32 v8, v8, v50
s_waitcnt lgkmcnt(6)
v_mfma_f32_32x32x16_bf16 v[16:31], v[216:219], v[88:91], v[16:31]
ds_read_b128 v[216:219], v7 offset:26624
v_exp_f32 v52, v52
v_cvt_pk_bf16_f32 v129, v50, v51
v_add_f32 v9, v9, v51
v_mfma_f32_32x32x16_bf16 v[16:31], v[220:223], v[92:95], v[16:31]
ds_read_b128 v[220:223], v7 offset:27648
v_exp_f32 v53, v53
v_exp_f32 v54, v54
s_waitcnt lgkmcnt(6)
v_mfma_f32_32x32x16_bf16 v[16:31], v[224:227], v[96:99], v[16:31]
ds_read_b128 v[224:227], v7 offset:28672
v_exp_f32 v55, v55
v_cvt_pk_bf16_f32 v130, v52, v53
v_add_f32 v8, v8, v52
v_add_f32 v9, v9, v53
v_mfma_f32_32x32x16_bf16 v[16:31], v[228:231], v[100:103], v[16:31]
ds_read_b128 v[228:231], v7 offset:29696
v_exp_f32 v56, v56
v_cvt_pk_bf16_f32 v131, v54, v55
v_add_f32 v8, v8, v54
s_waitcnt lgkmcnt(6)
v_mfma_f32_32x32x16_bf16 v[16:31], v[232:235], v[104:107], v[16:31]
ds_read_b128 v[232:235], v7 offset:30720
v_exp_f32 v57, v57
v_add_f32 v9, v9, v55
v_add_f32 v8, v8, v56
v_mfma_f32_32x32x16_bf16 v[16:31], v[236:239], v[108:111], v[16:31]
ds_read_b128 v[236:239], v7 offset:31744
v_exp_f32 v58, v58
v_exp_f32 v59, v59
v_cvt_pk_bf16_f32 v132, v56, v57
s_waitcnt lgkmcnt(6)
v_mfma_f32_32x32x16_bf16 v[32:47], v[208:211], v[80:83], v[112:127]
ds_read_b128 v[208:211], v7 offset:0
v_exp_f32 v60, v60
v_cvt_pk_bf16_f32 v133, v58, v59
v_add_f32 v9, v9, v57
v_add_f32 v8, v8, v58
v_mfma_f32_32x32x16_bf16 v[32:47], v[212:215], v[84:87], v[32:47]
ds_read_b128 v[212:215], v7 offset:4096
v_exp_f32 v61, v61
v_max3_f32 v10, v16, v17, v18
v_add_f32 v9, v9, v59
s_waitcnt lgkmcnt(6)
v_mfma_f32_32x32x16_bf16 v[32:47], v[216:219], v[88:91], v[32:47]
ds_read_b128 v[216:219], v7 offset:8192
v_exp_f32 v62, v62
v_cvt_pk_bf16_f32 v134, v60, v61
v_max3_f32 v10, v10, v19, v20
v_add_f32 v8, v8, v60
v_mfma_f32_32x32x16_bf16 v[32:47], v[220:223], v[92:95], v[32:47]
ds_read_b128 v[220:223], v7 offset:12288
v_exp_f32 v63, v63
v_max3_f32 v10, v10, v21, v22
v_add_f32 v9, v9, v61
s_waitcnt lgkmcnt(6)
v_mfma_f32_32x32x16_bf16 v[32:47], v[224:227], v[96:99], v[32:47]
ds_read_b128 v[224:227], v7 offset:1024
v_exp_f32 v64, v64
v_exp_f32 v65, v65
v_cvt_pk_bf16_f32 v135, v62, v63
v_max3_f32 v10, v10, v23, v24
v_mfma_f32_32x32x16_bf16 v[32:47], v[228:231], v[100:103], v[32:47]
ds_read_b128 v[228:231], v7 offset:5120
v_exp_f32 v66, v66
v_cvt_pk_bf16_f32 v136, v64, v65
v_max3_f32 v10, v10, v25, v26
s_waitcnt lgkmcnt(6)
v_mfma_f32_32x32x16_bf16 v[32:47], v[232:235], v[104:107], v[32:47]
ds_read_b128 v[232:235], v7 offset:9216
v_exp_f32 v67, v67
v_max3_f32 v10, v10, v27, v28
v_add_f32 v8, v8, v62
v_mfma_f32_32x32x16_bf16 v[32:47], v[236:239], v[108:111], v[32:47]
ds_read_b128 v[236:239], v7 offset:13312
v_exp_f32 v68, v68
v_cvt_pk_bf16_f32 v137, v66, v67
v_max3_f32 v10, v10, v29, v30
s_waitcnt lgkmcnt(6)
v_mfma_f32_32x32x16_bf16 v[144:159], v[208:211], v[128:131], v[144:159]
ds_read_b128 v[208:211], v7 offset:2048
v_exp_f32 v69, v69
v_exp_f32 v70, v70
v_mfma_f32_32x32x16_bf16 v[160:175], v[212:215], v[128:131], v[160:175]
ds_read_b128 v[212:215], v7 offset:6144
v_exp_f32 v71, v71
v_cvt_pk_bf16_f32 v138, v68, v69
v_max3_f32 v10, v10, v31, v32
s_waitcnt lgkmcnt(6)
v_mfma_f32_32x32x16_bf16 v[176:191], v[216:219], v[128:131], v[176:191]
ds_read_b128 v[216:219], v7 offset:10240
v_exp_f32 v72, v72
v_cvt_pk_bf16_f32 v139, v70, v71
v_max3_f32 v10, v10, v33, v34
v_mfma_f32_32x32x16_bf16 v[192:207], v[220:223], v[128:131], v[192:207]
ds_read_b128 v[220:223], v7 offset:14336
v_exp_f32 v73, v73
v_max3_f32 v10, v10, v35, v36
v_add_f32 v9, v9, v63
s_waitcnt lgkmcnt(6)
v_mfma_f32_32x32x16_bf16 v[144:159], v[224:227], v[132:135], v[144:159]
ds_read_b128 v[224:227], v7 offset:3072
v_exp_f32 v74, v74
v_exp_f32 v75, v75
v_cvt_pk_bf16_f32 v140, v72, v73
v_max3_f32 v10, v10, v37, v38
v_mfma_f32_32x32x16_bf16 v[160:175], v[228:231], v[132:135], v[160:175]
ds_read_b128 v[228:231], v7 offset:7168
v_exp_f32 v76, v76
v_cvt_pk_bf16_f32 v141, v74, v75
v_max3_f32 v10, v10, v39, v40
s_waitcnt lgkmcnt(6)
v_mfma_f32_32x32x16_bf16 v[176:191], v[232:235], v[132:135], v[176:191]
ds_read_b128 v[232:235], v7 offset:11264
v_exp_f32 v77, v77
v_max3_f32 v10, v10, v41, v42
v_add_f32 v8, v8, v64
v_mfma_f32_32x32x16_bf16 v[192:207], v[236:239], v[132:135], v[192:207]
s_add_u32 s38, s38, 0x8000
s_cmp_eq_u32 s38, 0x18000
s_cselect_b32 s38, 0, s38
ds_read_b128 v[236:239], v7 offset:15360
v_exp_f32 v78, v78
v_cvt_pk_bf16_f32 v142, v76, v77
v_max3_f32 v10, v10, v43, v44
s_waitcnt lgkmcnt(6)
v_mfma_f32_32x32x16_bf16 v[144:159], v[208:211], v[136:139], v[144:159]
s_barrier
v_add_u32 v7, s38, v13
ds_read_b128 v[208:211], v7 offset:16384
v_exp_f32 v79, v79
v_max3_f32 v10, v10, v45, v46
v_mfma_f32_32x32x16_bf16 v[160:175], v[212:215], v[136:139], v[160:175]
ds_read_b128 v[212:215], v7 offset:17408
v_cvt_pk_bf16_f32 v143, v78, v79
v_max_f32 v10, v10, v47
v_add_f32 v9, v9, v65
s_waitcnt lgkmcnt(6)
v_mfma_f32_32x32x16_bf16 v[176:191], v[216:219], v[136:139], v[176:191]
ds_read_b128 v[216:219], v7 offset:18432
v_add_f32 v8, v8, v66
v_add_f32 v9, v9, v67
v_add_f32 v8, v8, v68
v_mfma_f32_32x32x16_bf16 v[192:207], v[220:223], v[136:139], v[192:207]
ds_read_b128 v[220:223], v7 offset:19456
v_add_f32 v9, v9, v69
v_add_f32 v8, v8, v70
v_cmp_lt_f32 vcc, 0x41000000, v10
s_waitcnt lgkmcnt(6)
v_mfma_f32_32x32x16_bf16 v[144:159], v[224:227], v[140:143], v[144:159]
ds_read_b128 v[224:227], v7 offset:20480
v_add_f32 v9, v9, v71
v_add_f32 v8, v8, v72
v_add_f32 v9, v9, v73
v_mfma_f32_32x32x16_bf16 v[160:175], v[228:231], v[140:143], v[160:175]
ds_read_b128 v[228:231], v7 offset:21504
v_add_f32 v8, v8, v74
v_add_f32 v9, v9, v75
v_add_f32 v8, v8, v76
s_waitcnt lgkmcnt(6)
v_mfma_f32_32x32x16_bf16 v[176:191], v[232:235], v[140:143], v[176:191]
ds_read_b128 v[232:235], v7 offset:22528
v_add_f32 v9, v9, v77
v_add_f32 v8, v8, v78
v_add_f32 v9, v9, v79
v_mfma_f32_32x32x16_bf16 v[192:207], v[236:239], v[140:143], v[192:207]
s_cbranch_vccnz LatA_rs_2
LatA_rs_2r:
s_sub_u32 s28, s28, 2
s_branch LatA_loop
LatA_m0:
v_cmp_le_i32 s[44:45], 0, v11
v_cmp_le_i32 s[46:47], 1, v11
v_cmp_le_i32 s[48:49], 2, v11
v_cmp_le_i32 s[50:51], 3, v11
v_cndmask_b32 v48, v12, v112, s[44:45]
v_cmp_le_i32 s[44:45], 8, v11
v_cndmask_b32 v49, v12, v112, s[46:47]
v_cmp_le_i32 s[46:47], 9, v11
v_cndmask_b32 v50, v12, v112, s[48:49]
v_cmp_le_i32 s[48:49], 10, v11
v_cndmask_b32 v51, v12, v112, s[50:51]
v_cmp_le_i32 s[50:51], 11, v11
v_cndmask_b32 v52, v12, v112, s[44:45]
v_cmp_le_i32 s[44:45], 16, v11
v_cndmask_b32 v53, v12, v112, s[46:47]
v_cmp_le_i32 s[46:47], 17, v11
v_cndmask_b32 v54, v12, v112, s[48:49]
v_cmp_le_i32 s[48:49], 18, v11
v_cndmask_b32 v55, v12, v112, s[50:51]
v_cmp_le_i32 s[50:51], 19, v11
v_cndmask_b32 v56, v12, v112, s[44:45]
v_cmp_le_i32 s[44:45], 24, v11
v_cndmask_b32 v57, v12, v112, s[46:47]
v_cmp_le_i32 s[46:47], 25, v11
v_cndmask_b32 v58, v12, v112, s[48:49]
v_cmp_le_i32 s[48:49], 26, v11
v_cndmask_b32 v59, v12, v112, s[50:51]
v_cmp_le_i32 s[50:51], 27, v11
v_cndmask_b32 v60, v12, v112, s[44:45]
v_cmp_le_i32 s[44:45], 32, v11
v_cndmask_b32 v61, v12, v112, s[46:47]
v_cmp_le_i32 s[46:47], 33, v11
v_cndmask_b32 v62, v12, v112, s[48:49]
v_cmp_le_i32 s[48:49], 34, v11
v_cndmask_b32 v63, v12, v112, s[50:51]
v_cmp_le_i32 s[50:51], 35, v11
v_cndmask_b32 v64, v12, v112, s[44:45]
v_cmp_le_i32 s[44:45], 40, v11
v_cndmask_b32 v65, v12, v112, s[46:47]
v_cmp_le_i32 s[46:47], 41, v11
v_cndmask_b32 v66, v12, v112, s[48:49]
v_cmp_le_i32 s[48:49], 42, v11
v_cndmask_b32 v67, v12, v112, s[50:51]
v_cmp_le_i32 s[50:51], 43, v11
v_cndmask_b32 v68, v12, v112, s[44:45]
v_cmp_le_i32 s[44:45], 48, v11
v_cndmask_b32 v69, v12, v112, s[46:47]
v_cmp_le_i32 s[46:47], 49, v11
v_cndmask_b32 v70, v12, v112, s[48:49]
v_cmp_le_i32 s[48:49], 50, v11
v_cndmask_b32 v71, v12, v112, s[50:51]
v_cmp_le_i32 s[50:51], 51, v11
v_cndmask_b32 v72, v12, v112, s[44:45]
v_cmp_le_i32 s[44:45], 56, v11
v_cndmask_b32 v73, v12, v112, s[46:47]
v_cmp_le_i32 s[46:47], 57, v11
v_cndmask_b32 v74, v12, v112, s[48:49]
v_cmp_le_i32 s[48:49], 58, v11
v_cndmask_b32 v75, v12, v112, s[50:51]
v_cmp_le_i32 s[50:51], 59, v11
v_cndmask_b32 v76, v12, v112, s[44:45]
v_cndmask_b32 v77, v12, v112, s[46:47]
v_cndmask_b32 v78, v12, v112, s[48:49]
v_cndmask_b32 v79, v12, v112, s[50:51]
ds_read_b128 v[236:239], v7 offset:23552
v_exp_f32 v16, v16
v_exp_f32 v17, v17
s_waitcnt lgkmcnt(6)
v_mfma_f32_32x32x16_bf16 v[48:63], v[208:211], v[80:83], v[48:63]
ds_read_b128 v[208:211], v7 offset:24576
v_exp_f32 v18, v18
v_cvt_pk_bf16_f32 v128, v16, v17
v_add_f32 v8, v8, v16
v_add_f32 v9, v9, v17
v_mfma_f32_32x32x16_bf16 v[48:63], v[212:215], v[84:87], v[48:63]
ds_read_b128 v[212:215], v7 offset:25600
v_exp_f32 v19, v19
v_add_f32 v8, v8, v18
s_waitcnt lgkmcnt(6)
v_mfma_f32_32x32x16_bf16 v[48:63], v[216:219], v[88:91], v[48:63]
ds_read_b128 v[216:219], v7 offset:26624
v_exp_f32 v20, v20
v_cvt_pk_bf16_f32 v129, v18, v19
v_add_f32 v9, v9, v19
v_mfma_f32_32x32x16_bf16 v[48:63], v[220:223], v[92:95], v[48:63]
ds_read_b128 v[220:223], v7 offset:27648
v_exp_f32 v21, v21
v_exp_f32 v22, v22
s_waitcnt lgkmcnt(6)
v_mfma_f32_32x32x16_bf16 v[48:63], v[224:227], v[96:99], v[48:63]
ds_read_b128 v[224:227], v7 offset:28672
v_exp_f32 v23, v23
v_cvt_pk_bf16_f32 v130, v20, v21
v_add_f32 v8, v8, v20
v_add_f32 v9, v9, v21
v_mfma_f32_32x32x16_bf16 v[48:63], v[228:231], v[100:103], v[48:63]
ds_read_b128 v[228:231], v7 offset:29696
v_exp_f32 v24, v24
v_cvt_pk_bf16_f32 v131, v22, v23
v_add_f32 v8, v8, v22
s_waitcnt lgkmcnt(6)
v_mfma_f32_32x32x16_bf16 v[48:63], v[232:235], v[104:107], v[48:63]
ds_read_b128 v[232:235], v7 offset:30720
v_exp_f32 v25, v25
v_add_f32 v9, v9, v23
v_add_f32 v8, v8, v24
v_mfma_f32_32x32x16_bf16 v[48:63], v[236:239], v[108:111], v[48:63]
ds_read_b128 v[236:239], v7 offset:31744
v_exp_f32 v26, v26
v_exp_f32 v27, v27
v_cvt_pk_bf16_f32 v132, v24, v25
s_waitcnt lgkmcnt(6)
v_mfma_f32_32x32x16_bf16 v[64:79], v[208:211], v[80:83], v[64:79]
ds_read_b128 v[208:211], v7 offset:0
v_exp_f32 v28, v28
v_cvt_pk_bf16_f32 v133, v26, v27
v_add_f32 v9, v9, v25
v_add_f32 v8, v8, v26
v_mfma_f32_32x32x16_bf16 v[64:79], v[212:215], v[84:87], v[64:79]
ds_read_b128 v[212:215], v7 offset:4096
v_exp_f32 v29, v29
v_max3_f32 v10, v48, v49, v50
v_add_f32 v9, v9, v27
s_waitcnt lgkmcnt(6)
v_mfma_f32_32x32x16_bf16 v[64:79], v[216:219], v[88:91], v[64:79]
ds_read_b128 v[216:219], v7 offset:8192
v_exp_f32 v30, v30
v_cvt_pk_bf16_f32 v134, v28, v29
v_max3_f32 v10, v10, v51, v52
v_add_f32 v8, v8, v28
v_mfma_f32_32x32x16_bf16 v[64:79], v[220:223], v[92:95], v[64:79]
ds_read_b128 v[220:223], v7 offset:12288
v_exp_f32 v31, v31
v_max3_f32 v10, v10, v53, v54
v_add_f32 v9, v9, v29
s_waitcnt lgkmcnt(6)
v_mfma_f32_32x32x16_bf16 v[64:79], v[224:227], v[96:99], v[64:79]
ds_read_b128 v[224:227], v7 offset:1024
v_exp_f32 v32, v32
v_exp_f32 v33, v33
v_cvt_pk_bf16_f32 v135, v30, v31
v_max3_f32 v10, v10, v55, v56
v_mfma_f32_32x32x16_bf16 v[64:79], v[228:231], v[100:103], v[64:79]
ds_read_b128 v[228:231], v7 offset:5120
v_exp_f32 v34, v34
v_cvt_pk_bf16_f32 v136, v32, v33
v_max3_f32 v10, v10, v57, v58
s_waitcnt lgkmcnt(6)
v_mfma_f32_32x32x16_bf16 v[64:79], v[232:235], v[104:107], v[64:79]
ds_read_b128 v[232:235], v7 offset:9216
v_exp_f32 v35, v35
v_max3_f32 v10, v10, v59, v60
v_add_f32 v8, v8, v30
v_mfma_f32_32x32x16_bf16 v[64:79], v[236:239], v[108:111], v[64:79]
ds_read_b128 v[236:239], v7 offset:13312
v_exp_f32 v36, v36
v_cvt_pk_bf16_f32 v137, v34, v35
v_max3_f32 v10, v10, v61, v62
s_waitcnt lgkmcnt(6)
v_mfma_f32_32x32x16_bf16 v[144:159], v[208:211], v[128:131], v[144:159]
ds_read_b128 v[208:211], v7 offset:2048
v_exp_f32 v37, v37
v_exp_f32 v38, v38
v_mfma_f32_32x32x16_bf16 v[160:175], v[212:215], v[128:131], v[160:175]
ds_read_b128 v[212:215], v7 offset:6144
v_exp_f32 v39, v39
v_cvt_pk_bf16_f32 v138, v36, v37
v_max3_f32 v10, v10, v63, v64
s_waitcnt lgkmcnt(6)
v_mfma_f32_32x32x16_bf16 v[176:191], v[216:219], v[128:131], v[176:191]
ds_read_b128 v[216:219], v7 offset:10240
v_exp_f32 v40, v40
v_cvt_pk_bf16_f32 v139, v38, v39
v_max3_f32 v10, v10, v65, v66
v_mfma_f32_32x32x16_bf16 v[192:207], v[220:223], v[128:131], v[192:207]
ds_read_b128 v[220:223], v7 offset:14336
v_exp_f32 v41, v41
v_max3_f32 v10, v10, v67, v68
v_add_f32 v9, v9, v31
s_waitcnt lgkmcnt(6)
v_mfma_f32_32x32x16_bf16 v[144:159], v[224:227], v[132:135], v[144:159]
ds_read_b128 v[224:227], v7 offset:3072
v_exp_f32 v42, v42
v_exp_f32 v43, v43
v_cvt_pk_bf16_f32 v140, v40, v41
v_max3_f32 v10, v10, v69, v70
v_mfma_f32_32x32x16_bf16 v[160:175], v[228:231], v[132:135], v[160:175]
ds_read_b128 v[228:231], v7 offset:7168
v_exp_f32 v44, v44
v_cvt_pk_bf16_f32 v141, v42, v43
v_max3_f32 v10, v10, v71, v72
s_waitcnt lgkmcnt(6)
v_mfma_f32_32x32x16_bf16 v[176:191], v[232:235], v[132:135], v[176:191]
ds_read_b128 v[232:235], v7 offset:11264
v_exp_f32 v45, v45
v_max3_f32 v10, v10, v73, v74
v_add_f32 v8, v8, v32
v_mfma_f32_32x32x16_bf16 v[192:207], v[236:239], v[132:135], v[192:207]
s_add_u32 s38, s38, 0x8000
s_cmp_eq_u32 s38, 0x18000
s_cselect_b32 s38, 0, s38
ds_read_b128 v[236:239], v7 offset:15360
v_exp_f32 v46, v46
v_cvt_pk_bf16_f32 v142, v44, v45
v_max3_f32 v10, v10, v75, v76
s_waitcnt lgkmcnt(6)
v_mfma_f32_32x32x16_bf16 v[144:159], v[208:211], v[136:139], v[144:159]
s_barrier
v_add_u32 v7, s38, v13
v_exp_f32 v47, v47
v_max3_f32 v10, v10, v77, v78
v_mfma_f32_32x32x16_bf16 v[160:175], v[212:215], v[136:139], v[160:175]
v_cvt_pk_bf16_f32 v143, v46, v47
v_max_f32 v10, v10, v79
v_add_f32 v9, v9, v33
s_waitcnt lgkmcnt(4)
v_mfma_f32_32x32x16_bf16 v[176:191], v[216:219], v[136:139], v[176:191]
v_add_f32 v8, v8, v34
v_add_f32 v9, v9, v35
v_add_f32 v8, v8, v36
v_mfma_f32_32x32x16_bf16 v[192:207], v[220:223], v[136:139], v[192:207]
v_add_f32 v9, v9, v37
v_add_f32 v8, v8, v38
v_cmp_lt_f32 vcc, 0x41000000, v10
s_waitcnt lgkmcnt(2)
v_mfma_f32_32x32x16_bf16 v[144:159], v[224:227], v[140:143], v[144:159]
v_add_f32 v9, v9, v39
v_add_f32 v8, v8, v40
v_add_f32 v9, v9, v41
v_mfma_f32_32x32x16_bf16 v[160:175], v[228:231], v[140:143], v[160:175]
v_add_f32 v8, v8, v42
v_add_f32 v9, v9, v43
v_add_f32 v8, v8, v44
s_waitcnt lgkmcnt(0)
v_mfma_f32_32x32x16_bf16 v[176:191], v[232:235], v[140:143], v[176:191]
v_add_f32 v9, v9, v45
v_add_f32 v8, v8, v46
v_add_f32 v9, v9, v47
v_mfma_f32_32x32x16_bf16 v[192:207], v[236:239], v[140:143], v[192:207]
s_cbranch_vccnz LatA_rs_3
LatA_rs_3r:
ds_read_b128 v[208:211], v7 offset:0
ds_read_b128 v[212:215], v7 offset:4096
ds_read_b128 v[216:219], v7 offset:8192
ds_read_b128 v[220:223], v7 offset:12288
ds_read_b128 v[224:227], v7 offset:1024
ds_read_b128 v[228:231], v7 offset:5120
ds_read_b128 v[232:235], v7 offset:9216
v_exp_f32 v48, v48
v_exp_f32 v49, v49
v_exp_f32 v50, v50
v_exp_f32 v51, v51
v_exp_f32 v52, v52
v_exp_f32 v53, v53
v_exp_f32 v54, v54
v_exp_f32 v55, v55
v_cvt_pk_bf16_f32 v128, v48, v49
v_cvt_pk_bf16_f32 v129, v50, v51
v_cvt_pk_bf16_f32 v130, v52, v53
v_cvt_pk_bf16_f32 v131, v54, v55
ds_read_b128 v[236:239], v7 offset:13312
s_waitcnt lgkmcnt(7)
v_mfma_f32_32x32x16_bf16 v[144:159], v[208:211], v[128:131], v[144:159]
v_exp_f32 v56, v56
v_exp_f32 v57, v57
v_exp_f32 v58, v58
v_exp_f32 v59, v59
v_exp_f32 v60, v60
ds_read_b128 v[208:211], v7 offset:2048
s_waitcnt lgkmcnt(7)
v_mfma_f32_32x32x16_bf16 v[160:175], v[212:215], v[128:131], v[160:175]
v_exp_f32 v61, v61
v_exp_f32 v62, v62
v_exp_f32 v63, v63
v_cvt_pk_bf16_f32 v132, v56, v57
v_cvt_pk_bf16_f32 v133, v58, v59
ds_read_b128 v[212:215], v7 offset:6144
s_waitcnt lgkmcnt(7)
v_mfma_f32_32x32x16_bf16 v[176:191], v[216:219], v[128:131], v[176:191]
v_cvt_pk_bf16_f32 v134, v60, v61
v_cvt_pk_bf16_f32 v135, v62, v63
v_add_f32 v8, v8, v48
v_add_f32 v9, v9, v49
v_add_f32 v8, v8, v50
ds_read_b128 v[216:219], v7 offset:10240
s_waitcnt lgkmcnt(7)
v_mfma_f32_32x32x16_bf16 v[192:207], v[220:223], v[128:131], v[192:207]
v_add_f32 v9, v9, v51
v_add_f32 v8, v8, v52
v_add_f32 v9, v9, v53
v_add_f32 v8, v8, v54
v_add_f32 v9, v9, v55
ds_read_b128 v[220:223], v7 offset:14336
s_waitcnt lgkmcnt(7)
v_mfma_f32_32x32x16_bf16 v[144:159], v[224:227], v[132:135], v[144:159]
v_exp_f32 v64, v64
v_exp_f32 v65, v65
v_exp_f32 v66, v66
v_exp_f32 v67, v67
v_exp_f32 v68, v68
ds_read_b128 v[224:227], v7 offset:3072
s_waitcnt lgkmcnt(7)
v_mfma_f32_32x32x16_bf16 v[160:175], v[228:231], v[132:135], v[160:175]
v_exp_f32 v69, v69
v_exp_f32 v70, v70
v_exp_f32 v71, v71
v_cvt_pk_bf16_f32 v136, v64, v65
v_cvt_pk_bf16_f32 v137, v66, v67
ds_read_b128 v[228:231], v7 offset:7168
s_waitcnt lgkmcnt(7)
v_mfma_f32_32x32x16_bf16 v[176:191], v[232:235], v[132:135], v[176:191]
v_cvt_pk_bf16_f32 v138, v68, v69
v_cvt_pk_bf16_f32 v139, v70, v71
v_add_f32 v8, v8, v56
v_add_f32 v9, v9, v57
v_add_f32 v8, v8, v58
ds_read_b128 v[232:235], v7 offset:11264
s_waitcnt lgkmcnt(7)
v_mfma_f32_32x32x16_bf16 v[192:207], v[236:239], v[132:135], v[192:207]
v_add_f32 v9, v9, v59
v_add_f32 v8, v8, v60
v_add_f32 v9, v9, v61
v_add_f32 v8, v8, v62
v_add_f32 v9, v9, v63
ds_read_b128 v[236:239], v7 offset:15360
s_waitcnt lgkmcnt(7)
v_mfma_f32_32x32x16_bf16 v[144:159], v[208:211], v[136:139], v[144:159]
v_exp_f32 v72, v72
v_exp_f32 v73, v73
v_exp_f32 v74, v74
v_exp_f32 v75, v75
v_exp_f32 v76, v76
s_waitcnt lgkmcnt(6)
v_mfma_f32_32x32x16_bf16 v[160:175], v[212:215], v[136:139], v[160:175]
v_exp_f32 v77, v77
v_exp_f32 v78, v78
v_exp_f32 v79, v79
v_cvt_pk_bf16_f32 v140, v72, v73
v_cvt_pk_bf16_f32 v141, v74, v75
s_waitcnt lgkmcnt(5)
v_mfma_f32_32x32x16_bf16 v[176:191], v[216:219], v[136:139], v[176:191]
v_cvt_pk_bf16_f32 v142, v76, v77
v_cvt_pk_bf16_f32 v143, v78, v79
v_add_f32 v8, v8, v64
v_add_f32 v9, v9, v65
v_add_f32 v8, v8, v66
s_waitcnt lgkmcnt(4)
v_mfma_f32_32x32x16_bf16 v[192:207], v[220:223], v[136:139], v[192:207]
v_add_f32 v9, v9, v67
v_add_f32 v8, v8, v68
v_add_f32 v9, v9, v69
v_add_f32 v8, v8, v70
v_add_f32 v9, v9, v71
s_waitcnt lgkmcnt(3)
v_mfma_f32_32x32x16_bf16 v[144:159], v[224:227], v[140:143], v[144:159]
v_add_f32 v8, v8, v72
v_add_f32 v9, v9, v73
s_waitcnt lgkmcnt(2)
v_mfma_f32_32x32x16_bf16 v[160:175], v[228:231], v[140:143], v[160:175]
v_add_f32 v8, v8, v74
v_add_f32 v9, v9, v75
s_waitcnt lgkmcnt(1)
v_mfma_f32_32x32x16_bf16 v[176:191], v[232:235], v[140:143], v[176:191]
v_add_f32 v8, v8, v76
v_add_f32 v9, v9, v77
s_waitcnt lgkmcnt(0)
v_mfma_f32_32x32x16_bf16 v[192:207], v[236:239], v[140:143], v[192:207]
v_add_f32 v8, v8, v78
v_add_f32 v9, v9, v79
s_branch LatA_epi
LatA_m1:
v_cmp_le_i32 s[44:45], 0, v11
v_cmp_le_i32 s[46:47], 1, v11
v_cmp_le_i32 s[48:49], 2, v11
v_cmp_le_i32 s[50:51], 3, v11
v_cndmask_b32 v16, v12, v112, s[44:45]
v_cmp_le_i32 s[44:45], 8, v11
v_cndmask_b32 v17, v12, v112, s[46:47]
v_cmp_le_i32 s[46:47], 9, v11
v_cndmask_b32 v18, v12, v112, s[48:49]
v_cmp_le_i32 s[48:49], 10, v11
v_cndmask_b32 v19, v12, v112, s[50:51]
v_cmp_le_i32 s[50:51], 11, v11
v_cndmask_b32 v20, v12, v112, s[44:45]
v_cmp_le_i32 s[44:45], 16, v11
v_cndmask_b32 v21, v12, v112, s[46:47]
v_cmp_le_i32 s[46:47], 17, v11
v_cndmask_b32 v22, v12, v112, s[48:49]
v_cmp_le_i32 s[48:49], 18, v11
v_cndmask_b32 v23, v12, v112, s[50:51]
v_cmp_le_i32 s[50:51], 19, v11
v_cndmask_b32 v24, v12, v112, s[44:45]
v_cmp_le_i32 s[44:45], 24, v11
v_cndmask_b32 v25, v12, v112, s[46:47]
v_cmp_le_i32 s[46:47], 25, v11
v_cndmask_b32 v26, v12, v112, s[48:49]
v_cmp_le_i32 s[48:49], 26, v11
v_cndmask_b32 v27, v12, v112, s[50:51]
v_cmp_le_i32 s[50:51], 27, v11
v_cndmask_b32 v28, v12, v112, s[44:45]
v_cmp_le_i32 s[44:45], 32, v11
v_cndmask_b32 v29, v12, v112, s[46:47]
v_cmp_le_i32 s[46:47], 33, v11
v_cndmask_b32 v30, v12, v112, s[48:49]
v_cmp_le_i32 s[48:49], 34, v11
v_cndmask_b32 v31, v12, v112, s[50:51]
v_cmp_le_i32 s[50:51], 35, v11
v_cndmask_b32 v32, v12, v112, s[44:45]
v_cmp_le_i32 s[44:45], 40, v11
v_cndmask_b32 v33, v12, v112, s[46:47]
v_cmp_le_i32 s[46:47], 41, v11
v_cndmask_b32 v34, v12, v112, s[48:49]
v_cmp_le_i32 s[48:49], 42, v11
v_cndmask_b32 v35, v12, v112, s[50:51]
v_cmp_le_i32 s[50:51], 43, v11
v_cndmask_b32 v36, v12, v112, s[44:45]
v_cmp_le_i32 s[44:45], 48, v11
v_cndmask_b32 v37, v12, v112, s[46:47]
v_cmp_le_i32 s[46:47], 49, v11
v_cndmask_b32 v38, v12, v112, s[48:49]
v_cmp_le_i32 s[48:49], 50, v11
v_cndmask_b32 v39, v12, v112, s[50:51]
v_cmp_le_i32 s[50:51], 51, v11
v_cndmask_b32 v40, v12, v112, s[44:45]
v_cmp_le_i32 s[44:45], 56, v11
v_cndmask_b32 v41, v12, v112, s[46:47]
v_cmp_le_i32 s[46:47], 57, v11
v_cndmask_b32 v42, v12, v112, s[48:49]
v_cmp_le_i32 s[48:49], 58, v11
v_cndmask_b32 v43, v12, v112, s[50:51]
v_cmp_le_i32 s[50:51], 59, v11
v_cndmask_b32 v44, v12, v112, s[44:45]
v_cndmask_b32 v45, v12, v112, s[46:47]
v_cndmask_b32 v46, v12, v112, s[48:49]
v_cndmask_b32 v47, v12, v112, s[50:51]
ds_read_b128 v[236:239], v7 offset:23552
v_exp_f32 v48, v48
v_exp_f32 v49, v49
s_waitcnt lgkmcnt(6)
v_mfma_f32_32x32x16_bf16 v[16:31], v[208:211], v[80:83], v[16:31]
ds_read_b128 v[208:211], v7 offset:24576
v_exp_f32 v50, v50
v_cvt_pk_bf16_f32 v128, v48, v49
v_add_f32 v8, v8, v48
v_add_f32 v9, v9, v49
v_mfma_f32_32x32x16_bf16 v[16:31], v[212:215], v[84:87], v[16:31]
ds_read_b128 v[212:215], v7 offset:25600
v_exp_f32 v51, v51
v_add_f32 v8, v8, v50
s_waitcnt lgkmcnt(6)
v_mfma_f32_32x32x16_bf16 v[16:31], v[216:219], v[88:91], v[16:31]
ds_read_b128 v[216:219], v7 offset:26624
v_exp_f32 v52, v52
v_cvt_pk_bf16_f32 v129, v50, v51
v_add_f32 v9, v9, v51
v_mfma_f32_32x32x16_bf16 v[16:31], v[220:223], v[92:95], v[16:31]
ds_read_b128 v[220:223], v7 offset:27648
v_exp_f32 v53, v53
v_exp_f32 v54, v54
s_waitcnt lgkmcnt(6)
v_mfma_f32_32x32x16_bf16 v[16:31], v[224:227], v[96:99], v[16:31]
ds_read_b128 v[224:227], v7 offset:28672
v_exp_f32 v55, v55
v_cvt_pk_bf16_f32 v130, v52, v53
v_add_f32 v8, v8, v52
v_add_f32 v9, v9, v53
v_mfma_f32_32x32x16_bf16 v[16:31], v[228:231], v[100:103], v[16:31]
ds_read_b128 v[228:231], v7 offset:29696
v_exp_f32 v56, v56
v_cvt_pk_bf16_f32 v131, v54, v55
v_add_f32 v8, v8, v54
s_waitcnt lgkmcnt(6)
v_mfma_f32_32x32x16_bf16 v[16:31], v[232:235], v[104:107], v[16:31]
ds_read_b128 v[232:235], v7 offset:30720
v_exp_f32 v57, v57
v_add_f32 v9, v9, v55
v_add_f32 v8, v8, v56
v_mfma_f32_32x32x16_bf16 v[16:31], v[236:239], v[108:111], v[16:31]
ds_read_b128 v[236:239], v7 offset:31744
v_exp_f32 v58, v58
v_exp_f32 v59, v59
v_cvt_pk_bf16_f32 v132, v56, v57
s_waitcnt lgkmcnt(6)
v_mfma_f32_32x32x16_bf16 v[32:47], v[208:211], v[80:83], v[32:47]
ds_read_b128 v[208:211], v7 offset:0
v_exp_f32 v60, v60
v_cvt_pk_bf16_f32 v133, v58, v59
v_add_f32 v9, v9, v57
v_add_f32 v8, v8, v58
v_mfma_f32_32x32x16_bf16 v[32:47], v[212:215], v[84:87], v[32:47]
ds_read_b128 v[212:215], v7 offset:4096
v_exp_f32 v61, v61
v_max3_f32 v10, v16, v17, v18
v_add_f32 v9, v9, v59
s_waitcnt lgkmcnt(6)
v_mfma_f32_32x32x16_bf16 v[32:47], v[216:219], v[88:91], v[32:47]
ds_read_b128 v[216:219], v7 offset:8192
v_exp_f32 v62, v62
v_cvt_pk_bf16_f32 v134, v60, v61
v_max3_f32 v10, v10, v19, v20
v_add_f32 v8, v8, v60
v_mfma_f32_32x32x16_bf16 v[32:47], v[220:223], v[92:95], v[32:47]
ds_read_b128 v[220:223], v7 offset:12288
v_exp_f32 v63, v63
v_max3_f32 v10, v10, v21, v22
v_add_f32 v9, v9, v61
s_waitcnt lgkmcnt(6)
v_mfma_f32_32x32x16_bf16 v[32:47], v[224:227], v[96:99], v[32:47]
ds_read_b128 v[224:227], v7 offset:1024
v_exp_f32 v64, v64
v_exp_f32 v65, v65
v_cvt_pk_bf16_f32 v135, v62, v63
v_max3_f32 v10, v10, v23, v24
v_mfma_f32_32x32x16_bf16 v[32:47], v[228:231], v[100:103], v[32:47]
ds_read_b128 v[228:231], v7 offset:5120
v_exp_f32 v66, v66
v_cvt_pk_bf16_f32 v136, v64, v65
v_max3_f32 v10, v10, v25, v26
s_waitcnt lgkmcnt(6)
v_mfma_f32_32x32x16_bf16 v[32:47], v[232:235], v[104:107], v[32:47]
ds_read_b128 v[232:235], v7 offset:9216
v_exp_f32 v67, v67
v_max3_f32 v10, v10, v27, v28
v_add_f32 v8, v8, v62
v_mfma_f32_32x32x16_bf16 v[32:47], v[236:239], v[108:111], v[32:47]
ds_read_b128 v[236:239], v7 offset:13312
v_exp_f32 v68, v68
v_cvt_pk_bf16_f32 v137, v66, v67
v_max3_f32 v10, v10, v29, v30
s_waitcnt lgkmcnt(6)
v_mfma_f32_32x32x16_bf16 v[144:159], v[208:211], v[128:131], v[144:159]
ds_read_b128 v[208:211], v7 offset:2048
v_exp_f32 v69, v69
v_exp_f32 v70, v70
v_mfma_f32_32x32x16_bf16 v[160:175], v[212:215], v[128:131], v[160:175]
ds_read_b128 v[212:215], v7 offset:6144
v_exp_f32 v71, v71
v_cvt_pk_bf16_f32 v138, v68, v69
v_max3_f32 v10, v10, v31, v32
s_waitcnt lgkmcnt(6)
v_mfma_f32_32x32x16_bf16 v[176:191], v[216:219], v[128:131], v[176:191]
ds_read_b128 v[216:219], v7 offset:10240
v_exp_f32 v72, v72
v_cvt_pk_bf16_f32 v139, v70, v71
v_max3_f32 v10, v10, v33, v34
v_mfma_f32_32x32x16_bf16 v[192:207], v[220:223], v[128:131], v[192:207]
ds_read_b128 v[220:223], v7 offset:14336
v_exp_f32 v73, v73
v_max3_f32 v10, v10, v35, v36
v_add_f32 v9, v9, v63
s_waitcnt lgkmcnt(6)
v_mfma_f32_32x32x16_bf16 v[144:159], v[224:227], v[132:135], v[144:159]
ds_read_b128 v[224:227], v7 offset:3072
v_exp_f32 v74, v74
v_exp_f32 v75, v75
v_cvt_pk_bf16_f32 v140, v72, v73
v_max3_f32 v10, v10, v37, v38
v_mfma_f32_32x32x16_bf16 v[160:175], v[228:231], v[132:135], v[160:175]
ds_read_b128 v[228:231], v7 offset:7168
v_exp_f32 v76, v76
v_cvt_pk_bf16_f32 v141, v74, v75
v_max3_f32 v10, v10, v39, v40
s_waitcnt lgkmcnt(6)
v_mfma_f32_32x32x16_bf16 v[176:191], v[232:235], v[132:135], v[176:191]
ds_read_b128 v[232:235], v7 offset:11264
v_exp_f32 v77, v77
v_max3_f32 v10, v10, v41, v42
v_add_f32 v8, v8, v64
v_mfma_f32_32x32x16_bf16 v[192:207], v[236:239], v[132:135], v[192:207]
s_add_u32 s38, s38, 0x8000
s_cmp_eq_u32 s38, 0x18000
s_cselect_b32 s38, 0, s38
ds_read_b128 v[236:239], v7 offset:15360
v_exp_f32 v78, v78
v_cvt_pk_bf16_f32 v142, v76, v77
v_max3_f32 v10, v10, v43, v44
s_waitcnt lgkmcnt(6)
v_mfma_f32_32x32x16_bf16 v[144:159], v[208:211], v[136:139], v[144:159]
s_barrier
v_add_u32 v7, s38, v13
v_exp_f32 v79, v79
v_max3_f32 v10, v10, v45, v46
v_mfma_f32_32x32x16_bf16 v[160:175], v[212:215], v[136:139], v[160:175]
v_cvt_pk_bf16_f32 v143, v78, v79
v_max_f32 v10, v10, v47
v_add_f32 v9, v9, v65
s_waitcnt lgkmcnt(4)
v_mfma_f32_32x32x16_bf16 v[176:191], v[216:219], v[136:139], v[176:191]
v_add_f32 v8, v8, v66
v_add_f32 v9, v9, v67
v_add_f32 v8, v8, v68
v_mfma_f32_32x32x16_bf16 v[192:207], v[220:223], v[136:139], v[192:207]
v_add_f32 v9, v9, v69
v_add_f32 v8, v8, v70
v_cmp_lt_f32 vcc, 0x41000000, v10
s_waitcnt lgkmcnt(2)
v_mfma_f32_32x32x16_bf16 v[144:159], v[224:227], v[140:143], v[144:159]
v_add_f32 v9, v9, v71
v_add_f32 v8, v8, v72
v_add_f32 v9, v9, v73
v_mfma_f32_32x32x16_bf16 v[160:175], v[228:231], v[140:143], v[160:175]
v_add_f32 v8, v8, v74
v_add_f32 v9, v9, v75
v_add_f32 v8, v8, v76
s_waitcnt lgkmcnt(0)
v_mfma_f32_32x32x16_bf16 v[176:191], v[232:235], v[140:143], v[176:191]
v_add_f32 v9, v9, v77
v_add_f32 v8, v8, v78
v_add_f32 v9, v9, v79
v_mfma_f32_32x32x16_bf16 v[192:207], v[236:239], v[140:143], v[192:207]
s_cbranch_vccnz LatA_rs_4
LatA_rs_4r:
LatA_f0:
ds_read_b128 v[208:211], v7 offset:0
ds_read_b128 v[212:215], v7 offset:4096
ds_read_b128 v[216:219], v7 offset:8192
ds_read_b128 v[220:223], v7 offset:12288
ds_read_b128 v[224:227], v7 offset:1024
ds_read_b128 v[228:231], v7 offset:5120
ds_read_b128 v[232:235], v7 offset:9216
v_exp_f32 v16, v16
v_exp_f32 v17, v17
v_exp_f32 v18, v18
v_exp_f32 v19, v19
v_exp_f32 v20, v20
v_exp_f32 v21, v21
v_exp_f32 v22, v22
v_exp_f32 v23, v23
v_cvt_pk_bf16_f32 v128, v16, v17
v_cvt_pk_bf16_f32 v129, v18, v19
v_cvt_pk_bf16_f32 v130, v20, v21
v_cvt_pk_bf16_f32 v131, v22, v23
ds_read_b128 v[236:239], v7 offset:13312
s_waitcnt lgkmcnt(7)
v_mfma_f32_32x32x16_bf16 v[144:159], v[208:211], v[128:131], v[144:159]
v_exp_f32 v24, v24
v_exp_f32 v25, v25
v_exp_f32 v26, v26
v_exp_f32 v27, v27
v_exp_f32 v28, v28
ds_read_b128 v[208:211], v7 offset:2048
s_waitcnt lgkmcnt(7)
v_mfma_f32_32x32x16_bf16 v[160:175], v[212:215], v[128:131], v[160:175]
v_exp_f32 v29, v29
v_exp_f32 v30, v30
v_exp_f32 v31, v31
v_cvt_pk_bf16_f32 v132, v24, v25
v_cvt_pk_bf16_f32 v133, v26, v27
ds_read_b128 v[212:215], v7 offset:6144
s_waitcnt lgkmcnt(7)
v_mfma_f32_32x32x16_bf16 v[176:191], v[216:219], v[128:131], v[176:191]
v_cvt_pk_bf16_f32 v134, v28, v29
v_cvt_pk_bf16_f32 v135, v30, v31
v_add_f32 v8, v8, v16
v_add_f32 v9, v9, v17
v_add_f32 v8, v8, v18
ds_read_b128 v[216:219], v7 offset:10240
s_waitcnt lgkmcnt(7)
v_mfma_f32_32x32x16_bf16 v[192:207], v[220:223], v[128:131], v[192:207]
v_add_f32 v9, v9, v19
v_add_f32 v8, v8, v20
v_add_f32 v9, v9, v21
v_add_f32 v8, v8, v22
v_add_f32 v9, v9, v23
ds_read_b128 v[220:223], v7 offset:14336
s_waitcnt lgkmcnt(7)
v_mfma_f32_32x32x16_bf16 v[144:159], v[224:227], v[132:135], v[144:159]
v_exp_f32 v32, v32
v_exp_f32 v33, v33
v_exp_f32 v34, v34
v_exp_f32 v35, v35
v_exp_f32 v36, v36
ds_read_b128 v[224:227], v7 offset:3072
s_waitcnt lgkmcnt(7)
v_mfma_f32_32x32x16_bf16 v[160:175], v[228:231], v[132:135], v[160:175]
v_exp_f32 v37, v37
v_exp_f32 v38, v38
v_exp_f32 v39, v39
v_cvt_pk_bf16_f32 v136, v32, v33
v_cvt_pk_bf16_f32 v137, v34, v35
ds_read_b128 v[228:231], v7 offset:7168
s_waitcnt lgkmcnt(7)
v_mfma_f32_32x32x16_bf16 v[176:191], v[232:235], v[132:135], v[176:191]
v_cvt_pk_bf16_f32 v138, v36, v37
v_cvt_pk_bf16_f32 v139, v38, v39
v_add_f32 v8, v8, v24
v_add_f32 v9, v9, v25
v_add_f32 v8, v8, v26
ds_read_b128 v[232:235], v7 offset:11264
s_waitcnt lgkmcnt(7)
v_mfma_f32_32x32x16_bf16 v[192:207], v[236:239], v[132:135], v[192:207]
v_add_f32 v9, v9, v27
v_add_f32 v8, v8, v28
v_add_f32 v9, v9, v29
v_add_f32 v8, v8, v30
v_add_f32 v9, v9, v31
ds_read_b128 v[236:239], v7 offset:15360
s_waitcnt lgkmcnt(7)
v_mfma_f32_32x32x16_bf16 v[144:159], v[208:211], v[136:139], v[144:159]
v_exp_f32 v40, v40
v_exp_f32 v41, v41
v_exp_f32 v42, v42
v_exp_f32 v43, v43
v_exp_f32 v44, v44
s_barrier
s_waitcnt lgkmcnt(6)
v_mfma_f32_32x32x16_bf16 v[160:175], v[212:215], v[136:139], v[160:175]
v_exp_f32 v45, v45
v_exp_f32 v46, v46
v_exp_f32 v47, v47
v_cvt_pk_bf16_f32 v140, v40, v41
v_cvt_pk_bf16_f32 v141, v42, v43
s_waitcnt lgkmcnt(5)
v_mfma_f32_32x32x16_bf16 v[176:191], v[216:219], v[136:139], v[176:191]
v_cvt_pk_bf16_f32 v142, v44, v45
v_cvt_pk_bf16_f32 v143, v46, v47
v_add_f32 v8, v8, v32
v_add_f32 v9, v9, v33
v_add_f32 v8, v8, v34
s_waitcnt lgkmcnt(4)
v_mfma_f32_32x32x16_bf16 v[192:207], v[220:223], v[136:139], v[192:207]
v_add_f32 v9, v9, v35
v_add_f32 v8, v8, v36
v_add_f32 v9, v9, v37
v_add_f32 v8, v8, v38
v_add_f32 v9, v9, v39
s_waitcnt lgkmcnt(3)
v_mfma_f32_32x32x16_bf16 v[144:159], v[224:227], v[140:143], v[144:159]
v_add_f32 v8, v8, v40
v_add_f32 v9, v9, v41
s_waitcnt lgkmcnt(2)
v_mfma_f32_32x32x16_bf16 v[160:175], v[228:231], v[140:143], v[160:175]
v_add_f32 v8, v8, v42
v_add_f32 v9, v9, v43
s_waitcnt lgkmcnt(1)
v_mfma_f32_32x32x16_bf16 v[176:191], v[232:235], v[140:143], v[176:191]
v_add_f32 v8, v8, v44
v_add_f32 v9, v9, v45
s_waitcnt lgkmcnt(0)
v_mfma_f32_32x32x16_bf16 v[192:207], v[236:239], v[140:143], v[192:207]
v_add_f32 v8, v8, v46
v_add_f32 v9, v9, v47
s_branch LatA_epi
LatA_rs_1:
v_mov_b32 v14, v10
s_nop 1
v_permlane32_swap_b32 v14, v10
v_max3_f32 v10, v10, v14, 0
v_sub_f32 v14, 0, v10
v_exp_f32 v14, v14
v_sub_f32 v112, v112, v10
v_sub_f32 v113, v113, v10
v_sub_f32 v114, v114, v10
v_sub_f32 v115, v115, v10
v_sub_f32 v116, v116, v10
v_sub_f32 v117, v117, v10
v_sub_f32 v118, v118, v10
v_sub_f32 v119, v119, v10
v_sub_f32 v120, v120, v10
v_sub_f32 v121, v121, v10
v_sub_f32 v122, v122, v10
v_sub_f32 v123, v123, v10
v_sub_f32 v124, v124, v10
v_sub_f32 v125, v125, v10
v_sub_f32 v126, v126, v10
v_sub_f32 v127, v127, v10
v_sub_f32 v48, v48, v10
v_sub_f32 v49, v49, v10
v_sub_f32 v50, v50, v10
v_sub_f32 v51, v51, v10
v_sub_f32 v52, v52, v10
v_sub_f32 v53, v53, v10
v_sub_f32 v54, v54, v10
v_sub_f32 v55, v55, v10
v_sub_f32 v56, v56, v10
v_sub_f32 v57, v57, v10
v_sub_f32 v58, v58, v10
v_sub_f32 v59, v59, v10
v_sub_f32 v60, v60, v10
v_sub_f32 v61, v61, v10
v_sub_f32 v62, v62, v10
v_sub_f32 v63, v63, v10
v_sub_f32 v64, v64, v10
v_sub_f32 v65, v65, v10
v_sub_f32 v66, v66, v10
v_sub_f32 v67, v67, v10
v_sub_f32 v68, v68, v10
v_sub_f32 v69, v69, v10
v_sub_f32 v70, v70, v10
v_sub_f32 v71, v71, v10
v_sub_f32 v72, v72, v10
v_sub_f32 v73, v73, v10
v_sub_f32 v74, v74, v10
v_sub_f32 v75, v75, v10
v_sub_f32 v76, v76, v10
v_sub_f32 v77, v77, v10
v_sub_f32 v78, v78, v10
v_sub_f32 v79, v79, v10
v_mul_f32 v8, v8, v14
v_mul_f32 v9, v9, v14
v_mul_f32 v144, v144, v14
v_mul_f32 v145, v145, v14
v_mul_f32 v146, v146, v14
v_mul_f32 v147, v147, v14
v_mul_f32 v148, v148, v14
v_mul_f32 v149, v149, v14
v_mul_f32 v150, v150, v14
v_mul_f32 v151, v151, v14
v_mul_f32 v152, v152, v14
v_mul_f32 v153, v153, v14
v_mul_f32 v154, v154, v14
v_mul_f32 v155, v155, v14
v_mul_f32 v156, v156, v14
v_mul_f32 v157, v157, v14
v_mul_f32 v158, v158, v14
v_mul_f32 v159, v159, v14
v_mul_f32 v160, v160, v14
v_mul_f32 v161, v161, v14
v_mul_f32 v162, v162, v14
v_mul_f32 v163, v163, v14
v_mul_f32 v164, v164, v14
v_mul_f32 v165, v165, v14
v_mul_f32 v166, v166, v14
v_mul_f32 v167, v167, v14
v_mul_f32 v168, v168, v14
v_mul_f32 v169, v169, v14
v_mul_f32 v170, v170, v14
v_mul_f32 v171, v171, v14
v_mul_f32 v172, v172, v14
v_mul_f32 v173, v173, v14
v_mul_f32 v174, v174, v14
v_mul_f32 v175, v175, v14
v_mul_f32 v176, v176, v14
v_mul_f32 v177, v177, v14
v_mul_f32 v178, v178, v14
v_mul_f32 v179, v179, v14
v_mul_f32 v180, v180, v14
v_mul_f32 v181, v181, v14
v_mul_f32 v182, v182, v14
v_mul_f32 v183, v183, v14
v_mul_f32 v184, v184, v14
v_mul_f32 v185, v185, v14
v_mul_f32 v186, v186, v14
v_mul_f32 v187, v187, v14
v_mul_f32 v188, v188, v14
v_mul_f32 v189, v189, v14
v_mul_f32 v190, v190, v14
v_mul_f32 v191, v191, v14
v_mul_f32 v192, v192, v14
v_mul_f32 v193, v193, v14
v_mul_f32 v194, v194, v14
v_mul_f32 v195, v195, v14
v_mul_f32 v196, v196, v14
v_mul_f32 v197, v197, v14
v_mul_f32 v198, v198, v14
v_mul_f32 v199, v199, v14
v_mul_f32 v200, v200, v14
v_mul_f32 v201, v201, v14
v_mul_f32 v202, v202, v14
v_mul_f32 v203, v203, v14
v_mul_f32 v204, v204, v14
v_mul_f32 v205, v205, v14
v_mul_f32 v206, v206, v14
v_mul_f32 v207, v207, v14
s_nop 1
s_branch LatA_rs_1r
LatA_rs_2:
v_mov_b32 v14, v10
s_nop 1
v_permlane32_swap_b32 v14, v10
v_max3_f32 v10, v10, v14, 0
v_sub_f32 v14, 0, v10
v_exp_f32 v14, v14
v_sub_f32 v112, v112, v10
v_sub_f32 v113, v113, v10
v_sub_f32 v114, v114, v10
v_sub_f32 v115, v115, v10
v_sub_f32 v116, v116, v10
v_sub_f32 v117, v117, v10
v_sub_f32 v118, v118, v10
v_sub_f32 v119, v119, v10
v_sub_f32 v120, v120, v10
v_sub_f32 v121, v121, v10
v_sub_f32 v122, v122, v10
v_sub_f32 v123, v123, v10
v_sub_f32 v124, v124, v10
v_sub_f32 v125, v125, v10
v_sub_f32 v126, v126, v10
v_sub_f32 v127, v127, v10
v_sub_f32 v16, v16, v10
v_sub_f32 v17, v17, v10
v_sub_f32 v18, v18, v10
v_sub_f32 v19, v19, v10
v_sub_f32 v20, v20, v10
v_sub_f32 v21, v21, v10
v_sub_f32 v22, v22, v10
v_sub_f32 v23, v23, v10
v_sub_f32 v24, v24, v10
v_sub_f32 v25, v25, v10
v_sub_f32 v26, v26, v10
v_sub_f32 v27, v27, v10
v_sub_f32 v28, v28, v10
v_sub_f32 v29, v29, v10
v_sub_f32 v30, v30, v10
v_sub_f32 v31, v31, v10
v_sub_f32 v32, v32, v10
v_sub_f32 v33, v33, v10
v_sub_f32 v34, v34, v10
v_sub_f32 v35, v35, v10
v_sub_f32 v36, v36, v10
v_sub_f32 v37, v37, v10
v_sub_f32 v38, v38, v10
v_sub_f32 v39, v39, v10
v_sub_f32 v40, v40, v10
v_sub_f32 v41, v41, v10
v_sub_f32 v42, v42, v10
v_sub_f32 v43, v43, v10
v_sub_f32 v44, v44, v10
v_sub_f32 v45, v45, v10
v_sub_f32 v46, v46, v10
v_sub_f32 v47, v47, v10
v_mul_f32 v8, v8, v14
v_mul_f32 v9, v9, v14
v_mul_f32 v144, v144, v14
v_mul_f32 v145, v145, v14
v_mul_f32 v146, v146, v14
v_mul_f32 v147, v147, v14
v_mul_f32 v148, v148, v14
v_mul_f32 v149, v149, v14
v_mul_f32 v150, v150, v14
v_mul_f32 v151, v151, v14
v_mul_f32 v152, v152, v14
v_mul_f32 v153, v153, v14
v_mul_f32 v154, v154, v14
v_mul_f32 v155, v155, v14
v_mul_f32 v156, v156, v14
v_mul_f32 v157, v157, v14
v_mul_f32 v158, v158, v14
v_mul_f32 v159, v159, v14
v_mul_f32 v160, v160, v14
v_mul_f32 v161, v161, v14
v_mul_f32 v162, v162, v14
v_mul_f32 v163, v163, v14
v_mul_f32 v164, v164, v14
v_mul_f32 v165, v165, v14
v_mul_f32 v166, v166, v14
v_mul_f32 v167, v167, v14
v_mul_f32 v168, v168, v14
v_mul_f32 v169, v169, v14
v_mul_f32 v170, v170, v14
v_mul_f32 v171, v171, v14
v_mul_f32 v172, v172, v14
v_mul_f32 v173, v173, v14
v_mul_f32 v174, v174, v14
v_mul_f32 v175, v175, v14
v_mul_f32 v176, v176, v14
v_mul_f32 v177, v177, v14
v_mul_f32 v178, v178, v14
v_mul_f32 v179, v179, v14
v_mul_f32 v180, v180, v14
v_mul_f32 v181, v181, v14
v_mul_f32 v182, v182, v14
v_mul_f32 v183, v183, v14
v_mul_f32 v184, v184, v14
v_mul_f32 v185, v185, v14
v_mul_f32 v186, v186, v14
v_mul_f32 v187, v187, v14
v_mul_f32 v188, v188, v14
v_mul_f32 v189, v189, v14
v_mul_f32 v190, v190, v14
v_mul_f32 v191, v191, v14
v_mul_f32 v192, v192, v14
v_mul_f32 v193, v193, v14
v_mul_f32 v194, v194, v14
v_mul_f32 v195, v195, v14
v_mul_f32 v196, v196, v14
v_mul_f32 v197, v197, v14
v_mul_f32 v198, v198, v14
v_mul_f32 v199, v199, v14
v_mul_f32 v200, v200, v14
v_mul_f32 v201, v201, v14
v_mul_f32 v202, v202, v14
v_mul_f32 v203, v203, v14
v_mul_f32 v204, v204, v14
v_mul_f32 v205, v205, v14
v_mul_f32 v206, v206, v14
v_mul_f32 v207, v207, v14
s_nop 1
s_branch LatA_rs_2r
LatA_rs_3:
v_mov_b32 v14, v10
s_nop 1
v_permlane32_swap_b32 v14, v10
v_max3_f32 v10, v10, v14, 0
v_sub_f32 v14, 0, v10
v_exp_f32 v14, v14
v_sub_f32 v112, v112, v10
v_sub_f32 v113, v113, v10
v_sub_f32 v114, v114, v10
v_sub_f32 v115, v115, v10
v_sub_f32 v116, v116, v10
v_sub_f32 v117, v117, v10
v_sub_f32 v118, v118, v10
v_sub_f32 v119, v119, v10
v_sub_f32 v120, v120, v10
v_sub_f32 v121, v121, v10
v_sub_f32 v122, v122, v10
v_sub_f32 v123, v123, v10
v_sub_f32 v124, v124, v10
v_sub_f32 v125, v125, v10
v_sub_f32 v126, v126, v10
v_sub_f32 v127, v127, v10
v_sub_f32 v48, v48, v10
v_sub_f32 v49, v49, v10
v_sub_f32 v50, v50, v10
v_sub_f32 v51, v51, v10
v_sub_f32 v52, v52, v10
v_sub_f32 v53, v53, v10
v_sub_f32 v54, v54, v10
v_sub_f32 v55, v55, v10
v_sub_f32 v56, v56, v10
v_sub_f32 v57, v57, v10
v_sub_f32 v58, v58, v10
v_sub_f32 v59, v59, v10
v_sub_f32 v60, v60, v10
v_sub_f32 v61, v61, v10
v_sub_f32 v62, v62, v10
v_sub_f32 v63, v63, v10
v_sub_f32 v64, v64, v10
v_sub_f32 v65, v65, v10
v_sub_f32 v66, v66, v10
v_sub_f32 v67, v67, v10
v_sub_f32 v68, v68, v10
v_sub_f32 v69, v69, v10
v_sub_f32 v70, v70, v10
v_sub_f32 v71, v71, v10
v_sub_f32 v72, v72, v10
v_sub_f32 v73, v73, v10
v_sub_f32 v74, v74, v10
v_sub_f32 v75, v75, v10
v_sub_f32 v76, v76, v10
v_sub_f32 v77, v77, v10
v_sub_f32 v78, v78, v10
v_sub_f32 v79, v79, v10
v_mul_f32 v8, v8, v14
v_mul_f32 v9, v9, v14
v_mul_f32 v144, v144, v14
v_mul_f32 v145, v145, v14
v_mul_f32 v146, v146, v14
v_mul_f32 v147, v147, v14
v_mul_f32 v148, v148, v14
v_mul_f32 v149, v149, v14
v_mul_f32 v150, v150, v14
v_mul_f32 v151, v151, v14
v_mul_f32 v152, v152, v14
v_mul_f32 v153, v153, v14
v_mul_f32 v154, v154, v14
v_mul_f32 v155, v155, v14
v_mul_f32 v156, v156, v14
v_mul_f32 v157, v157, v14
v_mul_f32 v158, v158, v14
v_mul_f32 v159, v159, v14
v_mul_f32 v160, v160, v14
v_mul_f32 v161, v161, v14
v_mul_f32 v162, v162, v14
v_mul_f32 v163, v163, v14
v_mul_f32 v164, v164, v14
v_mul_f32 v165, v165, v14
v_mul_f32 v166, v166, v14
v_mul_f32 v167, v167, v14
v_mul_f32 v168, v168, v14
v_mul_f32 v169, v169, v14
v_mul_f32 v170, v170, v14
v_mul_f32 v171, v171, v14
v_mul_f32 v172, v172, v14
v_mul_f32 v173, v173, v14
v_mul_f32 v174, v174, v14
v_mul_f32 v175, v175, v14
v_mul_f32 v176, v176, v14
v_mul_f32 v177, v177, v14
v_mul_f32 v178, v178, v14
v_mul_f32 v179, v179, v14
v_mul_f32 v180, v180, v14
v_mul_f32 v181, v181, v14
v_mul_f32 v182, v182, v14
v_mul_f32 v183, v183, v14
v_mul_f32 v184, v184, v14
v_mul_f32 v185, v185, v14
v_mul_f32 v186, v186, v14
v_mul_f32 v187, v187, v14
v_mul_f32 v188, v188, v14
v_mul_f32 v189, v189, v14
v_mul_f32 v190, v190, v14
v_mul_f32 v191, v191, v14
v_mul_f32 v192, v192, v14
v_mul_f32 v193, v193, v14
v_mul_f32 v194, v194, v14
v_mul_f32 v195, v195, v14
v_mul_f32 v196, v196, v14
v_mul_f32 v197, v197, v14
v_mul_f32 v198, v198, v14
v_mul_f32 v199, v199, v14
v_mul_f32 v200, v200, v14
v_mul_f32 v201, v201, v14
v_mul_f32 v202, v202, v14
v_mul_f32 v203, v203, v14
v_mul_f32 v204, v204, v14
v_mul_f32 v205, v205, v14
v_mul_f32 v206, v206, v14
v_mul_f32 v207, v207, v14
s_nop 1
s_branch LatA_rs_3r
LatA_rs_4:
v_mov_b32 v14, v10
s_nop 1
v_permlane32_swap_b32 v14, v10
v_max3_f32 v10, v10, v14, 0
v_sub_f32 v14, 0, v10
v_exp_f32 v14, v14
v_sub_f32 v112, v112, v10
v_sub_f32 v113, v113, v10
v_sub_f32 v114, v114, v10
v_sub_f32 v115, v115, v10
v_sub_f32 v116, v116, v10
v_sub_f32 v117, v117, v10
v_sub_f32 v118, v118, v10
v_sub_f32 v119, v119, v10
v_sub_f32 v120, v120, v10
v_sub_f32 v121, v121, v10
v_sub_f32 v122, v122, v10
v_sub_f32 v123, v123, v10
v_sub_f32 v124, v124, v10
v_sub_f32 v125, v125, v10
v_sub_f32 v126, v126, v10
v_sub_f32 v127, v127, v10
v_sub_f32 v16, v16, v10
v_sub_f32 v17, v17, v10
v_sub_f32 v18, v18, v10
v_sub_f32 v19, v19, v10
v_sub_f32 v20, v20, v10
v_sub_f32 v21, v21, v10
v_sub_f32 v22, v22, v10
v_sub_f32 v23, v23, v10
v_sub_f32 v24, v24, v10
v_sub_f32 v25, v25, v10
v_sub_f32 v26, v26, v10
v_sub_f32 v27, v27, v10
v_sub_f32 v28, v28, v10
v_sub_f32 v29, v29, v10
v_sub_f32 v30, v30, v10
v_sub_f32 v31, v31, v10
v_sub_f32 v32, v32, v10
v_sub_f32 v33, v33, v10
v_sub_f32 v34, v34, v10
v_sub_f32 v35, v35, v10
v_sub_f32 v36, v36, v10
v_sub_f32 v37, v37, v10
v_sub_f32 v38, v38, v10
v_sub_f32 v39, v39, v10
v_sub_f32 v40, v40, v10
v_sub_f32 v41, v41, v10
v_sub_f32 v42, v42, v10
v_sub_f32 v43, v43, v10
v_sub_f32 v44, v44, v10
v_sub_f32 v45, v45, v10
v_sub_f32 v46, v46, v10
v_sub_f32 v47, v47, v10
v_mul_f32 v8, v8, v14
v_mul_f32 v9, v9, v14
v_mul_f32 v144, v144, v14
v_mul_f32 v145, v145, v14
v_mul_f32 v146, v146, v14
v_mul_f32 v147, v147, v14
v_mul_f32 v148, v148, v14
v_mul_f32 v149, v149, v14
v_mul_f32 v150, v150, v14
v_mul_f32 v151, v151, v14
v_mul_f32 v152, v152, v14
v_mul_f32 v153, v153, v14
v_mul_f32 v154, v154, v14
v_mul_f32 v155, v155, v14
v_mul_f32 v156, v156, v14
v_mul_f32 v157, v157, v14
v_mul_f32 v158, v158, v14
v_mul_f32 v159, v159, v14
v_mul_f32 v160, v160, v14
v_mul_f32 v161, v161, v14
v_mul_f32 v162, v162, v14
v_mul_f32 v163, v163, v14
v_mul_f32 v164, v164, v14
v_mul_f32 v165, v165, v14
v_mul_f32 v166, v166, v14
v_mul_f32 v167, v167, v14
v_mul_f32 v168, v168, v14
v_mul_f32 v169, v169, v14
v_mul_f32 v170, v170, v14
v_mul_f32 v171, v171, v14
v_mul_f32 v172, v172, v14
v_mul_f32 v173, v173, v14
v_mul_f32 v174, v174, v14
v_mul_f32 v175, v175, v14
v_mul_f32 v176, v176, v14
v_mul_f32 v177, v177, v14
v_mul_f32 v178, v178, v14
v_mul_f32 v179, v179, v14
v_mul_f32 v180, v180, v14
v_mul_f32 v181, v181, v14
v_mul_f32 v182, v182, v14
v_mul_f32 v183, v183, v14
v_mul_f32 v184, v184, v14
v_mul_f32 v185, v185, v14
v_mul_f32 v186, v186, v14
v_mul_f32 v187, v187, v14
v_mul_f32 v188, v188, v14
v_mul_f32 v189, v189, v14
v_mul_f32 v190, v190, v14
v_mul_f32 v191, v191, v14
v_mul_f32 v192, v192, v14
v_mul_f32 v193, v193, v14
v_mul_f32 v194, v194, v14
v_mul_f32 v195, v195, v14
v_mul_f32 v196, v196, v14
v_mul_f32 v197, v197, v14
v_mul_f32 v198, v198, v14
v_mul_f32 v199, v199, v14
v_mul_f32 v200, v200, v14
v_mul_f32 v201, v201, v14
v_mul_f32 v202, v202, v14
v_mul_f32 v203, v203, v14
v_mul_f32 v204, v204, v14
v_mul_f32 v205, v205, v14
v_mul_f32 v206, v206, v14
v_mul_f32 v207, v207, v14
s_nop 1
s_branch LatA_rs_4r
LatA_epi:
v_add_f32 v8, v8, v9
v_mov_b32 v14, v8
s_nop 1
v_permlane32_swap_b32 v14, v8
v_add_f32 v8, v8, v14
v_rcp_f32 v8, v8
s_nop 3
v_mul_f32 v144, v144, v8
v_mul_f32 v145, v145, v8
v_cvt_pk_bf16_f32 v16, v144, v145
v_mul_f32 v146, v146, v8
v_mul_f32 v147, v147, v8
v_cvt_pk_bf16_f32 v17, v146, v147
v_mul_f32 v148, v148, v8
v_mul_f32 v149, v149, v8
v_cvt_pk_bf16_f32 v18, v148, v149
v_mul_f32 v150, v150, v8
v_mul_f32 v151, v151, v8
v_cvt_pk_bf16_f32 v19, v150, v151
v_mul_f32 v152, v152, v8
v_mul_f32 v153, v153, v8
v_cvt_pk_bf16_f32 v20, v152, v153
v_mul_f32 v154, v154, v8
v_mul_f32 v155, v155, v8
v_cvt_pk_bf16_f32 v21, v154, v155
v_mul_f32 v156, v156, v8
v_mul_f32 v157, v157, v8
v_cvt_pk_bf16_f32 v22, v156, v157
v_mul_f32 v158, v158, v8
v_mul_f32 v159, v159, v8
v_cvt_pk_bf16_f32 v23, v158, v159
buffer_store_dwordx4 v[16:19], v1, s[8:11], s36 offen offset:0
buffer_store_dwordx4 v[20:23], v1, s[8:11], s36 offen offset:512
s_add_u32 s36, s36, 4096
v_mul_f32 v160, v160, v8
v_mul_f32 v161, v161, v8
v_cvt_pk_bf16_f32 v24, v160, v161
v_mul_f32 v162, v162, v8
v_mul_f32 v163, v163, v8
v_cvt_pk_bf16_f32 v25, v162, v163
v_mul_f32 v164, v164, v8
v_mul_f32 v165, v165, v8
v_cvt_pk_bf16_f32 v26, v164, v165
v_mul_f32 v166, v166, v8
v_mul_f32 v167, v167, v8
v_cvt_pk_bf16_f32 v27, v166, v167
v_mul_f32 v168, v168, v8
v_mul_f32 v169, v169, v8
v_cvt_pk_bf16_f32 v28, v168, v169
v_mul_f32 v170, v170, v8
v_mul_f32 v171, v171, v8
v_cvt_pk_bf16_f32 v29, v170, v171
v_mul_f32 v172, v172, v8
v_mul_f32 v173, v173, v8
v_cvt_pk_bf16_f32 v30, v172, v173
v_mul_f32 v174, v174, v8
v_mul_f32 v175, v175, v8
v_cvt_pk_bf16_f32 v31, v174, v175
buffer_store_dwordx4 v[24:27], v1, s[8:11], s36 offen offset:0
buffer_store_dwordx4 v[28:31], v1, s[8:11], s36 offen offset:512
s_add_u32 s36, s36, 4096
v_mul_f32 v176, v176, v8
v_mul_f32 v177, v177, v8
v_cvt_pk_bf16_f32 v32, v176, v177
v_mul_f32 v178, v178, v8
v_mul_f32 v179, v179, v8
v_cvt_pk_bf16_f32 v33, v178, v179
v_mul_f32 v180, v180, v8
v_mul_f32 v181, v181, v8
v_cvt_pk_bf16_f32 v34, v180, v181
v_mul_f32 v182, v182, v8
v_mul_f32 v183, v183, v8
v_cvt_pk_bf16_f32 v35, v182, v183
v_mul_f32 v184, v184, v8
v_mul_f32 v185, v185, v8
v_cvt_pk_bf16_f32 v36, v184, v185
v_mul_f32 v186, v186, v8
v_mul_f32 v187, v187, v8
v_cvt_pk_bf16_f32 v37, v186, v187
v_mul_f32 v188, v188, v8
v_mul_f32 v189, v189, v8
v_cvt_pk_bf16_f32 v38, v188, v189
v_mul_f32 v190, v190, v8
v_mul_f32 v191, v191, v8
v_cvt_pk_bf16_f32 v39, v190, v191
buffer_store_dwordx4 v[32:35], v1, s[8:11], s36 offen offset:0
buffer_store_dwordx4 v[36:39], v1, s[8:11], s36 offen offset:512
s_add_u32 s36, s36, 4096
v_mul_f32 v192, v192, v8
v_mul_f32 v193, v193, v8
v_cvt_pk_bf16_f32 v40, v192, v193
v_mul_f32 v194, v194, v8
v_mul_f32 v195, v195, v8
v_cvt_pk_bf16_f32 v41, v194, v195
v_mul_f32 v196, v196, v8
v_mul_f32 v197, v197, v8
v_cvt_pk_bf16_f32 v42, v196, v197
v_mul_f32 v198, v198, v8
v_mul_f32 v199, v199, v8
v_cvt_pk_bf16_f32 v43, v198, v199
v_mul_f32 v200, v200, v8
v_mul_f32 v201, v201, v8
v_cvt_pk_bf16_f32 v44, v200, v201
v_mul_f32 v202, v202, v8
v_mul_f32 v203, v203, v8
v_cvt_pk_bf16_f32 v45, v202, v203
v_mul_f32 v204, v204, v8
v_mul_f32 v205, v205, v8
v_cvt_pk_bf16_f32 v46, v204, v205
v_mul_f32 v206, v206, v8
v_mul_f32 v207, v207, v8
v_cvt_pk_bf16_f32 v47, v206, v207
buffer_store_dwordx4 v[40:43], v1, s[8:11], s36 offen offset:0
buffer_store_dwordx4 v[44:47], v1, s[8:11], s36 offen offset:512
s_endpgm
Lat_B:
s_waitcnt vmcnt(14)
s_barrier
ds_read_b64_tr_b16 v[208:209], v5 offset:0
ds_read_b64_tr_b16 v[210:211], v5 offset:2048
ds_read_b64_tr_b16 v[212:213], v5 offset:256
ds_read_b64_tr_b16 v[214:215], v5 offset:2304
ds_read_b64_tr_b16 v[216:217], v5 offset:512
ds_read_b64_tr_b16 v[218:219], v5 offset:2560
ds_read_b64_tr_b16 v[220:221], v5 offset:768
ds_read_b64_tr_b16 v[222:223], v5 offset:2816
ds_read_b64_tr_b16 v[224:225], v5 offset:4096
ds_read_b64_tr_b16 v[226:227], v5 offset:6144
ds_read_b64_tr_b16 v[228:229], v5 offset:4352
ds_read_b64_tr_b16 v[230:231], v5 offset:6400
s_mov_b64 exec, 0x1ff8000
buffer_load_dword v10, v12, s[12:15], s20 offen
s_mov_b32 exec_lo, 0
s_mov_b32 exec_hi, 0x3c0
buffer_load_dword v10, v12, s[8:11], s21 offen
s_mov_b64 exec, -1
s_mov_b32 exec_lo, 0
s_mov_b32 exec_hi, 0xf00000
buffer_load_dword v10, v12, s[4:7], s22 offen
s_mov_b64 exec, -1
s_mov_b64 exec, 0xffff
buffer_load_dword v10, v9, s[8:11], s47 offen
s_mov_b64 exec, -1
ds_read_b64_tr_b16 v[232:233], v5 offset:4608
ds_read_b64_tr_b16 v[234:235], v5 offset:6656
s_waitcnt vmcnt(14)
s_waitcnt lgkmcnt(12)
v_mfma_f32_32x32x16_bf16 v[16:31], v[208:211], v[144:147], 0
s_add_u32 m0, s35, 0
s_add_u32 s31, s41, 0
buffer_load_dwordx4 v3, s[4:7], s31 offen lds
ds_read_b64_tr_b16 v[236:237], v5 offset:4864
ds_read_b64_tr_b16 v[238:239], v5 offset:6912
s_waitcnt lgkmcnt(12)
v_mfma_f32_32x32x16_bf16 v[32:47], v[212:215], v[144:147], 0
ds_read_b64_tr_b16 v[208:209], v5 offset:8192
ds_read_b64_tr_b16 v[210:211], v5 offset:10240
s_waitcnt lgkmcnt(12)
v_mfma_f32_32x32x16_bf16 v[48:63], v[216:219], v[144:147], 0
s_add_u32 m0, s35, 8192
s_add_u32 s31, s41, 262144
buffer_load_dwordx4 v3, s[4:7], s31 offen lds
ds_read_b64_tr_b16 v[212:213], v5 offset:8448
ds_read_b64_tr_b16 v[214:215], v5 offset:10496
s_waitcnt lgkmcnt(12)
v_mfma_f32_32x32x16_bf16 v[64:79], v[220:223], v[144:147], 0
ds_read_b64_tr_b16 v[216:217], v5 offset:8704
ds_read_b64_tr_b16 v[218:219], v5 offset:10752
s_waitcnt lgkmcnt(12)
v_mfma_f32_32x32x16_bf16 v[16:31], v[224:227], v[148:151], v[16:31]
s_add_u32 m0, s35, 16384
s_add_u32 s31, s41, 524288
buffer_load_dwordx4 v3, s[4:7], s31 offen lds
ds_read_b64_tr_b16 v[220:221], v5 offset:8960
ds_read_b64_tr_b16 v[222:223], v5 offset:11008
s_waitcnt lgkmcnt(12)
v_mfma_f32_32x32x16_bf16 v[32:47], v[228:231], v[148:151], v[32:47]
ds_read_b64_tr_b16 v[224:225], v5 offset:12288
ds_read_b64_tr_b16 v[226:227], v5 offset:14336
s_waitcnt lgkmcnt(12)
v_mfma_f32_32x32x16_bf16 v[48:63], v[232:235], v[148:151], v[48:63]
s_add_u32 m0, s35, 24576
s_add_u32 s31, s41, 786432
buffer_load_dwordx4 v3, s[4:7], s31 offen lds
ds_read_b64_tr_b16 v[228:229], v5 offset:12544
ds_read_b64_tr_b16 v[230:231], v5 offset:14592
s_waitcnt lgkmcnt(12)
v_mfma_f32_32x32x16_bf16 v[64:79], v[236:239], v[148:151], v[64:79]
ds_read_b64_tr_b16 v[232:233], v5 offset:12800
ds_read_b64_tr_b16 v[234:235], v5 offset:14848
s_waitcnt lgkmcnt(12)
v_mfma_f32_32x32x16_bf16 v[16:31], v[208:211], v[152:155], v[16:31]
buffer_load_dwordx4 v[176:179], v13, s[8:11], s46 offen offset:0
ds_read_b64_tr_b16 v[236:237], v5 offset:13056
ds_read_b64_tr_b16 v[238:239], v5 offset:15104
s_waitcnt lgkmcnt(12)
v_mfma_f32_32x32x16_bf16 v[32:47], v[212:215], v[152:155], v[32:47]
s_waitcnt vmcnt(17)
s_barrier
ds_read_b64_tr_b16 v[208:209], v5 offset:16384
ds_read_b64_tr_b16 v[210:211], v5 offset:18432
s_waitcnt lgkmcnt(12)
v_mfma_f32_32x32x16_bf16 v[48:63], v[216:219], v[152:155], v[48:63]
buffer_load_dwordx4 v[180:183], v13, s[8:11], s46 offen offset:1024
ds_read_b64_tr_b16 v[212:213], v5 offset:16640
ds_read_b64_tr_b16 v[214:215], v5 offset:18688
s_waitcnt lgkmcnt(12)
v_mfma_f32_32x32x16_bf16 v[64:79], v[220:223], v[152:155], v[64:79]
ds_read_b64_tr_b16 v[216:217], v5 offset:16896
ds_read_b64_tr_b16 v[218:219], v5 offset:18944
s_waitcnt lgkmcnt(12)
v_mfma_f32_32x32x16_bf16 v[16:31], v[224:227], v[156:159], v[16:31]
buffer_load_dwordx4 v[184:187], v13, s[8:11], s46 offen offset:2048
ds_read_b64_tr_b16 v[220:221], v5 offset:17152
ds_read_b64_tr_b16 v[222:223], v5 offset:19200
s_waitcnt lgkmcnt(12)
v_mfma_f32_32x32x16_bf16 v[32:47], v[228:231], v[156:159], v[32:47]
ds_read_b64_tr_b16 v[224:225], v5 offset:20480
ds_read_b64_tr_b16 v[226:227], v5 offset:22528
s_waitcnt lgkmcnt(12)
v_mfma_f32_32x32x16_bf16 v[48:63], v[232:235], v[156:159], v[48:63]
buffer_load_dwordx4 v[188:191], v13, s[8:11], s46 offen offset:3072
ds_read_b64_tr_b16 v[228:229], v5 offset:20736
ds_read_b64_tr_b16 v[230:231], v5 offset:22784
s_waitcnt lgkmcnt(12)
v_mfma_f32_32x32x16_bf16 v[64:79], v[236:239], v[156:159], v[64:79]
ds_read_b64_tr_b16 v[232:233], v5 offset:20992
ds_read_b64_tr_b16 v[234:235], v5 offset:23040
s_waitcnt vmcnt(16)
s_waitcnt lgkmcnt(12)
v_mfma_f32_32x32x16_bf16 v[16:31], v[208:211], v[160:163], v[16:31]
buffer_load_dwordx4 v[192:195], v0, s[8:11], s46 offen offset:0
ds_read_b64_tr_b16 v[236:237], v5 offset:21248
ds_read_b64_tr_b16 v[238:239], v5 offset:23296
s_waitcnt lgkmcnt(12)
v_mfma_f32_32x32x16_bf16 v[32:47], v[212:215], v[160:163], v[32:47]
ds_read_b64_tr_b16 v[208:209], v5 offset:24576
ds_read_b64_tr_b16 v[210:211], v5 offset:26624
s_waitcnt lgkmcnt(12)
v_mfma_f32_32x32x16_bf16 v[48:63], v[216:219], v[160:163], v[48:63]
buffer_load_dwordx4 v[196:199], v0, s[8:11], s46 offen offset:1024
ds_read_b64_tr_b16 v[212:213], v5 offset:24832
ds_read_b64_tr_b16 v[214:215], v5 offset:26880
s_waitcnt lgkmcnt(12)
v_mfma_f32_32x32x16_bf16 v[64:79], v[220:223], v[160:163], v[64:79]
ds_read_b64_tr_b16 v[216:217], v5 offset:25088
ds_read_b64_tr_b16 v[218:219], v5 offset:27136
s_waitcnt lgkmcnt(12)
v_mfma_f32_32x32x16_bf16 v[16:31], v[224:227], v[164:167], v[16:31]
buffer_load_dwordx4 v[200:203], v0, s[8:11], s46 offen offset:2048
ds_read_b64_tr_b16 v[220:221], v5 offset:25344
ds_read_b64_tr_b16 v[222:223], v5 offset:27392
s_waitcnt lgkmcnt(12)
v_mfma_f32_32x32x16_bf16 v[32:47], v[228:231], v[164:167], v[32:47]
ds_read_b64_tr_b16 v[224:225], v5 offset:28672
ds_read_b64_tr_b16 v[226:227], v5 offset:30720
s_waitcnt lgkmcnt(12)
v_mfma_f32_32x32x16_bf16 v[48:63], v[232:235], v[164:167], v[48:63]
buffer_load_dwordx4 v[204:207], v0, s[8:11], s46 offen offset:3072
ds_read_b64_tr_b16 v[228:229], v5 offset:28928
ds_read_b64_tr_b16 v[230:231], v5 offset:30976
s_waitcnt lgkmcnt(12)
v_mfma_f32_32x32x16_bf16 v[64:79], v[236:239], v[164:167], v[64:79]
ds_read_b64_tr_b16 v[232:233], v5 offset:29184
ds_read_b64_tr_b16 v[234:235], v5 offset:31232
s_waitcnt lgkmcnt(12)
v_mfma_f32_32x32x16_bf16 v[16:31], v[208:211], v[168:171], v[16:31]
s_mov_b32 exec_lo, 0
s_mov_b32 exec_hi, 0xf000000
buffer_load_dword v10, v12, s[4:7], s22 offen
s_mov_b64 exec, -1
s_mov_b64 exec, 0xffff
buffer_load_dword v10, v9, s[8:11], s48 offen
s_mov_b64 exec, -1
ds_read_b64_tr_b16 v[236:237], v5 offset:29440
ds_read_b64_tr_b16 v[238:239], v5 offset:31488
s_waitcnt lgkmcnt(12)
v_mfma_f32_32x32x16_bf16 v[32:47], v[212:215], v[168:171], v[32:47]
s_waitcnt vmcnt(10)
s_barrier
ds_read_b64_tr_b16 v[208:209], v4 offset:0
ds_read_b64_tr_b16 v[210:211], v4 offset:2048
s_waitcnt lgkmcnt(12)
v_mfma_f32_32x32x16_bf16 v[48:63], v[216:219], v[168:171], v[48:63]
ds_read_b64_tr_b16 v[212:213], v4 offset:256
ds_read_b64_tr_b16 v[214:215], v4 offset:2304
s_waitcnt lgkmcnt(12)
v_mfma_f32_32x32x16_bf16 v[64:79], v[220:223], v[168:171], v[64:79]
ds_read_b64_tr_b16 v[216:217], v4 offset:512
ds_read_b64_tr_b16 v[218:219], v4 offset:2560
s_waitcnt lgkmcnt(12)
v_mfma_f32_32x32x16_bf16 v[16:31], v[224:227], v[172:175], v[16:31]
s_add_u32 m0, s35, 32768
s_add_u32 s31, s42, 0
buffer_load_dwordx4 v3, s[4:7], s31 offen lds
ds_read_b64_tr_b16 v[220:221], v4 offset:768
ds_read_b64_tr_b16 v[222:223], v4 offset:2816
s_waitcnt lgkmcnt(12)
v_mfma_f32_32x32x16_bf16 v[32:47], v[228:231], v[172:175], v[32:47]
ds_read_b64_tr_b16 v[224:225], v4 offset:4096
ds_read_b64_tr_b16 v[226:227], v4 offset:6144
s_waitcnt lgkmcnt(12)
v_mfma_f32_32x32x16_bf16 v[48:63], v[232:235], v[172:175], v[48:63]
s_add_u32 m0, s35, 40960
s_add_u32 s31, s42, 262144
buffer_load_dwordx4 v3, s[4:7], s31 offen lds
ds_read_b64_tr_b16 v[228:229], v4 offset:4352
ds_read_b64_tr_b16 v[230:231], v4 offset:6400
s_waitcnt lgkmcnt(12)
v_mfma_f32_32x32x16_bf16 v[64:79], v[236:239], v[172:175], v[64:79]
ds_read_b64_tr_b16 v[232:233], v4 offset:4608
ds_read_b64_tr_b16 v[234:235], v4 offset:6656
s_waitcnt vmcnt(8)
s_waitcnt lgkmcnt(12)
v_mfma_f32_32x32x16_bf16 v[16:31], v[208:211], v[176:179], v[16:31]
s_add_u32 m0, s35, 49152
s_add_u32 s31, s42, 524288
buffer_load_dwordx4 v3, s[4:7], s31 offen lds
ds_read_b64_tr_b16 v[236:237], v4 offset:4864
ds_read_b64_tr_b16 v[238:239], v4 offset:6912
s_waitcnt lgkmcnt(12)
v_mfma_f32_32x32x16_bf16 v[32:47], v[212:215], v[176:179], v[32:47]
ds_read_b64_tr_b16 v[208:209], v4 offset:8192
ds_read_b64_tr_b16 v[210:211], v4 offset:10240
s_waitcnt lgkmcnt(12)
v_mfma_f32_32x32x16_bf16 v[48:63], v[216:219], v[176:179], v[48:63]
s_add_u32 m0, s35, 57344
s_add_u32 s31, s42, 786432
buffer_load_dwordx4 v3, s[4:7], s31 offen lds
ds_read_b64_tr_b16 v[212:213], v4 offset:8448
ds_read_b64_tr_b16 v[214:215], v4 offset:10496
s_waitcnt lgkmcnt(12)
v_mfma_f32_32x32x16_bf16 v[64:79], v[220:223], v[176:179], v[64:79]
ds_read_b64_tr_b16 v[216:217], v4 offset:8704
ds_read_b64_tr_b16 v[218:219], v4 offset:10752
s_waitcnt lgkmcnt(12)
v_mfma_f32_32x32x16_bf16 v[16:31], v[224:227], v[180:183], v[16:31]
buffer_load_dwordx4 v[112:115], v13, s[8:11], s47 offen offset:0
ds_read_b64_tr_b16 v[220:221], v4 offset:8960
ds_read_b64_tr_b16 v[222:223], v4 offset:11008
s_waitcnt lgkmcnt(12)
v_mfma_f32_32x32x16_bf16 v[32:47], v[228:231], v[180:183], v[32:47]
ds_read_b64_tr_b16 v[224:225], v4 offset:12288
ds_read_b64_tr_b16 v[226:227], v4 offset:14336
s_waitcnt lgkmcnt(12)
v_mfma_f32_32x32x16_bf16 v[48:63], v[232:235], v[180:183], v[48:63]
buffer_load_dwordx4 v[116:119], v13, s[8:11], s47 offen offset:1024
ds_read_b64_tr_b16 v[228:229], v4 offset:12544
ds_read_b64_tr_b16 v[230:231], v4 offset:14592
s_waitcnt lgkmcnt(12)
v_mfma_f32_32x32x16_bf16 v[64:79], v[236:239], v[180:183], v[64:79]
ds_read_b64_tr_b16 v[232:233], v4 offset:12800
ds_read_b64_tr_b16 v[234:235], v4 offset:14848
s_waitcnt lgkmcnt(12)
v_mfma_f32_32x32x16_bf16 v[16:31], v[208:211], v[184:187], v[16:31]
buffer_load_dwordx4 v[120:123], v13, s[8:11], s47 offen offset:2048
ds_read_b64_tr_b16 v[236:237], v4 offset:13056
ds_read_b64_tr_b16 v[238:239], v4 offset:15104
s_waitcnt lgkmcnt(12)
v_mfma_f32_32x32x16_bf16 v[32:47], v[212:215], v[184:187], v[32:47]
ds_read_b64_tr_b16 v[208:209], v4 offset:16384
ds_read_b64_tr_b16 v[210:211], v4 offset:18432
s_waitcnt lgkmcnt(12)
v_mfma_f32_32x32x16_bf16 v[48:63], v[216:219], v[184:187], v[48:63]
buffer_load_dwordx4 v[124:127], v13, s[8:11], s47 offen offset:3072
ds_read_b64_tr_b16 v[212:213], v4 offset:16640
ds_read_b64_tr_b16 v[214:215], v4 offset:18688
s_waitcnt lgkmcnt(12)
v_mfma_f32_32x32x16_bf16 v[64:79], v[220:223], v[184:187], v[64:79]
ds_read_b64_tr_b16 v[216:217], v4 offset:16896
ds_read_b64_tr_b16 v[218:219], v4 offset:18944
s_waitcnt lgkmcnt(12)
v_mfma_f32_32x32x16_bf16 v[16:31], v[224:227], v[188:191], v[16:31]
buffer_load_dwordx4 v[128:131], v0, s[8:11], s47 offen offset:0
ds_read_b64_tr_b16 v[220:221], v4 offset:17152
ds_read_b64_tr_b16 v[222:223], v4 offset:19200
s_waitcnt lgkmcnt(12)
v_mfma_f32_32x32x16_bf16 v[32:47], v[228:231], v[188:191], v[32:47]
ds_read_b64_tr_b16 v[224:225], v4 offset:20480
ds_read_b64_tr_b16 v[226:227], v4 offset:22528
s_waitcnt lgkmcnt(12)
v_mfma_f32_32x32x16_bf16 v[48:63], v[232:235], v[188:191], v[48:63]
buffer_load_dwordx4 v[132:135], v0, s[8:11], s47 offen offset:1024
ds_read_b64_tr_b16 v[228:229], v4 offset:20736
ds_read_b64_tr_b16 v[230:231], v4 offset:22784
s_waitcnt lgkmcnt(12)
v_mfma_f32_32x32x16_bf16 v[64:79], v[236:239], v[188:191], v[64:79]
ds_read_b64_tr_b16 v[232:233], v4 offset:20992
ds_read_b64_tr_b16 v[234:235], v4 offset:23040
s_waitcnt vmcnt(12)
s_waitcnt lgkmcnt(12)
v_mfma_f32_32x32x16_bf16 v[16:31], v[208:211], v[192:195], v[16:31]
buffer_load_dwordx4 v[136:139], v0, s[8:11], s47 offen offset:2048
ds_read_b64_tr_b16 v[236:237], v4 offset:21248
ds_read_b64_tr_b16 v[238:239], v4 offset:23296
s_waitcnt lgkmcnt(12)
v_mfma_f32_32x32x16_bf16 v[32:47], v[212:215], v[192:195], v[32:47]
ds_read_b64_tr_b16 v[208:209], v4 offset:24576
ds_read_b64_tr_b16 v[210:211], v4 offset:26624
s_waitcnt lgkmcnt(12)
v_mfma_f32_32x32x16_bf16 v[48:63], v[216:219], v[192:195], v[48:63]
buffer_load_dwordx4 v[140:143], v0, s[8:11], s47 offen offset:3072
ds_read_b64_tr_b16 v[212:213], v4 offset:24832
ds_read_b64_tr_b16 v[214:215], v4 offset:26880
s_waitcnt lgkmcnt(12)
v_mfma_f32_32x32x16_bf16 v[64:79], v[220:223], v[192:195], v[64:79]
ds_read_b64_tr_b16 v[216:217], v4 offset:25088
ds_read_b64_tr_b16 v[218:219], v4 offset:27136
s_waitcnt lgkmcnt(12)
v_mfma_f32_32x32x16_bf16 v[16:31], v[224:227], v[196:199], v[16:31]
s_mov_b32 exec_lo, 0
s_mov_b32 exec_hi, 0xf0000000
buffer_load_dword v10, v12, s[4:7], s22 offen
s_mov_b64 exec, -1
s_mov_b64 exec, 0xffff
buffer_load_dword v10, v9, s[8:11], s49 offen
s_mov_b64 exec, -1
ds_read_b64_tr_b16 v[220:221], v4 offset:25344
ds_read_b64_tr_b16 v[222:223], v4 offset:27392
s_waitcnt lgkmcnt(12)
v_mfma_f32_32x32x16_bf16 v[32:47], v[228:231], v[196:199], v[32:47]
ds_read_b64_tr_b16 v[224:225], v4 offset:28672
ds_read_b64_tr_b16 v[226:227], v4 offset:30720
s_waitcnt lgkmcnt(12)
v_mfma_f32_32x32x16_bf16 v[48:63], v[232:235], v[196:199], v[48:63]
ds_read_b64_tr_b16 v[228:229], v4 offset:28928
ds_read_b64_tr_b16 v[230:231], v4 offset:30976
s_waitcnt lgkmcnt(12)
v_mfma_f32_32x32x16_bf16 v[64:79], v[236:239], v[196:199], v[64:79]
ds_read_b64_tr_b16 v[232:233], v4 offset:29184
ds_read_b64_tr_b16 v[234:235], v4 offset:31232
s_waitcnt lgkmcnt(12)
v_mfma_f32_32x32x16_bf16 v[16:31], v[208:211], v[200:203], v[16:31]
s_add_u32 m0, s35, 98304
s_add_u32 s31, s43, 0
buffer_load_dwordx4 v3, s[4:7], s31 offen lds
ds_read_b64_tr_b16 v[236:237], v4 offset:29440
ds_read_b64_tr_b16 v[238:239], v4 offset:31488
s_waitcnt lgkmcnt(12)
v_mfma_f32_32x32x16_bf16 v[32:47], v[212:215], v[200:203], v[32:47]
s_add_u32 m0, s34, 81920
s_add_u32 s23, s29, 0
s_add_u32 s23, s23, s34
buffer_load_dwordx4 v13, s[8:11], s23 offen offset:0 lds
s_waitcnt vmcnt(12)
s_barrier
ds_read_b64_tr_b16 v[208:209], v4 offset:32768
ds_read_b64_tr_b16 v[210:211], v4 offset:34816
s_waitcnt lgkmcnt(12)
v_mfma_f32_32x32x16_bf16 v[48:63], v[216:219], v[200:203], v[48:63]
s_add_u32 m0, s35, 106496
s_add_u32 s31, s43, 262144
buffer_load_dwordx4 v3, s[4:7], s31 offen lds
ds_read_b64_tr_b16 v[212:213], v4 offset:33024
ds_read_b64_tr_b16 v[214:215], v4 offset:35072
s_waitcnt lgkmcnt(12)
v_mfma_f32_32x32x16_bf16 v[64:79], v[220:223], v[200:203], v[64:79]
s_add_u32 m0, s34, 81920
s_nop 0
buffer_load_dwordx4 v13, s[8:11], s23 offen offset:1024 lds
ds_read_b64_tr_b16 v[216:217], v4 offset:33280
ds_read_b64_tr_b16 v[218:219], v4 offset:35328
s_waitcnt lgkmcnt(12)
v_mfma_f32_32x32x16_bf16 v[16:31], v[224:227], v[204:207], v[16:31]
s_add_u32 m0, s35, 114688
s_add_u32 s31, s43, 524288
buffer_load_dwordx4 v3, s[4:7], s31 offen lds
ds_read_b64_tr_b16 v[220:221], v4 offset:33536
ds_read_b64_tr_b16 v[222:223], v4 offset:35584
s_waitcnt lgkmcnt(12)
v_mfma_f32_32x32x16_bf16 v[32:47], v[228:231], v[204:207], v[32:47]
s_add_u32 m0, s34, 81920
s_nop 0
buffer_load_dwordx4 v13, s[8:11], s23 offen offset:2048 lds
ds_read_b64_tr_b16 v[224:225], v4 offset:36864
ds_read_b64_tr_b16 v[226:227], v4 offset:38912
s_waitcnt lgkmcnt(12)
v_mfma_f32_32x32x16_bf16 v[48:63], v[232:235], v[204:207], v[48:63]
s_add_u32 m0, s35, 122880
s_add_u32 s31, s43, 786432
buffer_load_dwordx4 v3, s[4:7], s31 offen lds
ds_read_b64_tr_b16 v[228:229], v4 offset:37120
ds_read_b64_tr_b16 v[230:231], v4 offset:39168
s_waitcnt lgkmcnt(12)
v_mfma_f32_32x32x16_bf16 v[64:79], v[236:239], v[204:207], v[64:79]
s_add_u32 m0, s34, 81920
s_nop 0
buffer_load_dwordx4 v13, s[8:11], s23 offen offset:3072 lds
ds_read_b64_tr_b16 v[232:233], v4 offset:37376
ds_read_b64_tr_b16 v[234:235], v4 offset:39424
s_waitcnt vmcnt(14)
s_waitcnt lgkmcnt(12)
v_mfma_f32_32x32x16_bf16 v[16:31], v[208:211], v[112:115], v[16:31]
buffer_load_dwordx4 v[80:83], v13, s[8:11], s48 offen offset:0
ds_read_b64_tr_b16 v[236:237], v4 offset:37632
ds_read_b64_tr_b16 v[238:239], v4 offset:39680
s_waitcnt lgkmcnt(12)
v_mfma_f32_32x32x16_bf16 v[32:47], v[212:215], v[112:115], v[32:47]
v_mov_b32 v176, 0
ds_read_b64_tr_b16 v[208:209], v4 offset:40960
ds_read_b64_tr_b16 v[210:211], v4 offset:43008
s_waitcnt lgkmcnt(12)
v_mfma_f32_32x32x16_bf16 v[48:63], v[216:219], v[112:115], v[48:63]
buffer_load_dwordx4 v[84:87], v13, s[8:11], s48 offen offset:1024
v_mov_b32 v177, 0
ds_read_b64_tr_b16 v[212:213], v4 offset:41216
ds_read_b64_tr_b16 v[214:215], v4 offset:43264
s_waitcnt lgkmcnt(12)
v_mfma_f32_32x32x16_bf16 v[64:79], v[220:223], v[112:115], v[64:79]
v_mov_b32 v178, 0
ds_read_b64_tr_b16 v[216:217], v4 offset:41472
ds_read_b64_tr_b16 v[218:219], v4 offset:43520
s_waitcnt lgkmcnt(12)
v_mfma_f32_32x32x16_bf16 v[16:31], v[224:227], v[116:119], v[16:31]
buffer_load_dwordx4 v[88:91], v13, s[8:11], s48 offen offset:2048
v_mov_b32 v179, 0
ds_read_b64_tr_b16 v[220:221], v4 offset:41728
ds_read_b64_tr_b16 v[222:223], v4 offset:43776
s_waitcnt lgkmcnt(12)
v_mfma_f32_32x32x16_bf16 v[32:47], v[228:231], v[116:119], v[32:47]
v_mov_b32 v180, 0
ds_read_b64_tr_b16 v[224:225], v4 offset:45056
ds_read_b64_tr_b16 v[226:227], v4 offset:47104
s_waitcnt lgkmcnt(12)
v_mfma_f32_32x32x16_bf16 v[48:63], v[232:235], v[116:119], v[48:63]
buffer_load_dwordx4 v[92:95], v13, s[8:11], s48 offen offset:3072
v_mov_b32 v181, 0
ds_read_b64_tr_b16 v[228:229], v4 offset:45312
ds_read_b64_tr_b16 v[230:231], v4 offset:47360
s_waitcnt lgkmcnt(12)
v_mfma_f32_32x32x16_bf16 v[64:79], v[236:239], v[116:119], v[64:79]
v_mov_b32 v182, 0
ds_read_b64_tr_b16 v[232:233], v4 offset:45568
ds_read_b64_tr_b16 v[234:235], v4 offset:47616
s_waitcnt lgkmcnt(12)
v_mfma_f32_32x32x16_bf16 v[16:31], v[208:211], v[120:123], v[16:31]
buffer_load_dwordx4 v[96:99], v0, s[8:11], s48 offen offset:0
v_mov_b32 v183, 0
ds_read_b64_tr_b16 v[236:237], v4 offset:45824
ds_read_b64_tr_b16 v[238:239], v4 offset:47872
s_waitcnt lgkmcnt(12)
v_mfma_f32_32x32x16_bf16 v[32:47], v[212:215], v[120:123], v[32:47]
v_mov_b32 v184, 0
ds_read_b64_tr_b16 v[208:209], v4 offset:49152
ds_read_b64_tr_b16 v[210:211], v4 offset:51200
s_waitcnt lgkmcnt(12)
v_mfma_f32_32x32x16_bf16 v[48:63], v[216:219], v[120:123], v[48:63]
buffer_load_dwordx4 v[100:103], v0, s[8:11], s48 offen offset:1024
v_mov_b32 v185, 0
ds_read_b64_tr_b16 v[212:213], v4 offset:49408
ds_read_b64_tr_b16 v[214:215], v4 offset:51456
s_waitcnt lgkmcnt(12)
v_mfma_f32_32x32x16_bf16 v[64:79], v[220:223], v[120:123], v[64:79]
v_mov_b32 v186, 0
ds_read_b64_tr_b16 v[216:217], v4 offset:49664
ds_read_b64_tr_b16 v[218:219], v4 offset:51712
s_waitcnt lgkmcnt(12)
v_mfma_f32_32x32x16_bf16 v[16:31], v[224:227], v[124:127], v[16:31]
buffer_load_dwordx4 v[104:107], v0, s[8:11], s48 offen offset:2048
v_mov_b32 v187, 0
ds_read_b64_tr_b16 v[220:221], v4 offset:49920
ds_read_b64_tr_b16 v[222:223], v4 offset:51968
s_waitcnt lgkmcnt(12)
v_mfma_f32_32x32x16_bf16 v[32:47], v[228:231], v[124:127], v[32:47]
v_mov_b32 v188, 0
ds_read_b64_tr_b16 v[224:225], v4 offset:53248
ds_read_b64_tr_b16 v[226:227], v4 offset:55296
s_waitcnt lgkmcnt(12)
v_mfma_f32_32x32x16_bf16 v[48:63], v[232:235], v[124:127], v[48:63]
buffer_load_dwordx4 v[108:111], v0, s[8:11], s48 offen offset:3072
v_mov_b32 v189, 0
ds_read_b64_tr_b16 v[228:229], v4 offset:53504
ds_read_b64_tr_b16 v[230:231], v4 offset:55552
s_waitcnt lgkmcnt(12)
v_mfma_f32_32x32x16_bf16 v[64:79], v[236:239], v[124:127], v[64:79]
v_mov_b32 v190, 0
ds_read_b64_tr_b16 v[232:233], v4 offset:53760
ds_read_b64_tr_b16 v[234:235], v4 offset:55808
s_waitcnt vmcnt(18)
s_waitcnt lgkmcnt(12)
v_mfma_f32_32x32x16_bf16 v[16:31], v[208:211], v[128:131], v[16:31]
v_mov_b32 v191, 0
ds_read_b64_tr_b16 v[236:237], v4 offset:54016
ds_read_b64_tr_b16 v[238:239], v4 offset:56064
s_waitcnt lgkmcnt(12)
v_mfma_f32_32x32x16_bf16 v[32:47], v[212:215], v[128:131], v[32:47]
v_mov_b32 v192, 0
ds_read_b64_tr_b16 v[208:209], v4 offset:57344
ds_read_b64_tr_b16 v[210:211], v4 offset:59392
s_waitcnt lgkmcnt(12)
v_mfma_f32_32x32x16_bf16 v[48:63], v[216:219], v[128:131], v[48:63]
v_mov_b32 v193, 0
ds_read_b64_tr_b16 v[212:213], v4 offset:57600
ds_read_b64_tr_b16 v[214:215], v4 offset:59648
s_waitcnt lgkmcnt(12)
v_mfma_f32_32x32x16_bf16 v[64:79], v[220:223], v[128:131], v[64:79]
v_mov_b32 v194, 0
ds_read_b64_tr_b16 v[216:217], v4 offset:57856
ds_read_b64_tr_b16 v[218:219], v4 offset:59904
s_waitcnt lgkmcnt(12)
v_mfma_f32_32x32x16_bf16 v[16:31], v[224:227], v[132:135], v[16:31]
s_add_u32 m0, s35, 131072
s_add_u32 s31, s44, 0
buffer_load_dwordx4 v3, s[4:7], s31 offen lds
v_mov_b32 v195, 0
ds_read_b64_tr_b16 v[220:221], v4 offset:58112
ds_read_b64_tr_b16 v[222:223], v4 offset:60160
s_waitcnt lgkmcnt(12)
v_mfma_f32_32x32x16_bf16 v[32:47], v[228:231], v[132:135], v[32:47]
s_add_u32 m0, s37, 0
s_add_u32 s23, s29, 16384
s_add_u32 s23, s23, s37
buffer_load_dwordx4 v13, s[8:11], s23 offen offset:0 lds
v_mov_b32 v196, 0
ds_read_b64_tr_b16 v[224:225], v4 offset:61440
ds_read_b64_tr_b16 v[226:227], v4 offset:63488
s_waitcnt lgkmcnt(12)
v_mfma_f32_32x32x16_bf16 v[48:63], v[232:235], v[132:135], v[48:63]
s_add_u32 m0, s35, 139264
s_add_u32 s31, s44, 262144
buffer_load_dwordx4 v3, s[4:7], s31 offen lds
v_mov_b32 v197, 0
ds_read_b64_tr_b16 v[228:229], v4 offset:61696
ds_read_b64_tr_b16 v[230:231], v4 offset:63744
s_waitcnt lgkmcnt(12)
v_mfma_f32_32x32x16_bf16 v[64:79], v[236:239], v[132:135], v[64:79]
s_add_u32 m0, s37, 0
s_nop 0
buffer_load_dwordx4 v13, s[8:11], s23 offen offset:1024 lds
v_mov_b32 v198, 0
ds_read_b64_tr_b16 v[232:233], v4 offset:61952
ds_read_b64_tr_b16 v[234:235], v4 offset:64000
s_waitcnt lgkmcnt(12)
v_mfma_f32_32x32x16_bf16 v[16:31], v[208:211], v[136:139], v[16:31]
s_add_u32 m0, s35, 147456
s_add_u32 s31, s44, 524288
buffer_load_dwordx4 v3, s[4:7], s31 offen lds
v_mov_b32 v199, 0
ds_read_b64_tr_b16 v[236:237], v4 offset:62208
ds_read_b64_tr_b16 v[238:239], v4 offset:64256
s_waitcnt lgkmcnt(12)
v_mfma_f32_32x32x16_bf16 v[32:47], v[212:215], v[136:139], v[32:47]
s_add_u32 m0, s37, 0
s_nop 0
buffer_load_dwordx4 v13, s[8:11], s23 offen offset:2048 lds
v_mov_b32 v200, 0
s_waitcnt vmcnt(15)
s_barrier
ds_read_b64_tr_b16 v[208:209], v5 offset:32768
ds_read_b64_tr_b16 v[210:211], v5 offset:34816
s_waitcnt lgkmcnt(12)
v_mfma_f32_32x32x16_bf16 v[48:63], v[216:219], v[136:139], v[48:63]
s_add_u32 m0, s35, 155648
s_add_u32 s31, s44, 786432
buffer_load_dwordx4 v3, s[4:7], s31 offen lds
v_mov_b32 v201, 0
ds_read_b64_tr_b16 v[212:213], v5 offset:33024
ds_read_b64_tr_b16 v[214:215], v5 offset:35072
s_waitcnt lgkmcnt(12)
v_mfma_f32_32x32x16_bf16 v[64:79], v[220:223], v[136:139], v[64:79]
s_add_u32 m0, s37, 0
s_nop 0
buffer_load_dwordx4 v13, s[8:11], s23 offen offset:3072 lds
v_mov_b32 v202, 0
ds_read_b64_tr_b16 v[216:217], v5 offset:33280
ds_read_b64_tr_b16 v[218:219], v5 offset:35328
s_waitcnt lgkmcnt(12)
v_mfma_f32_32x32x16_bf16 v[16:31], v[224:227], v[140:143], v[16:31]
buffer_load_dwordx4 v[144:147], v13, s[8:11], s49 offen offset:0
v_mov_b32 v203, 0
ds_read_b64_tr_b16 v[220:221], v5 offset:33536
ds_read_b64_tr_b16 v[222:223], v5 offset:35584
s_waitcnt lgkmcnt(12)
v_mfma_f32_32x32x16_bf16 v[32:47], v[228:231], v[140:143], v[32:47]
s_add_u32 m0, s37, 4096
s_add_u32 s23, s29, 20480
s_add_u32 s23, s23, s37
buffer_load_dwordx4 v13, s[8:11], s23 offen offset:0 lds
v_mov_b32 v204, 0
ds_read_b64_tr_b16 v[224:225], v5 offset:36864
ds_read_b64_tr_b16 v[226:227], v5 offset:38912
s_waitcnt lgkmcnt(12)
v_mfma_f32_32x32x16_bf16 v[48:63], v[232:235], v[140:143], v[48:63]
buffer_load_dwordx4 v[148:151], v13, s[8:11], s49 offen offset:1024
v_mov_b32 v205, 0
ds_read_b64_tr_b16 v[228:229], v5 offset:37120
ds_read_b64_tr_b16 v[230:231], v5 offset:39168
s_waitcnt lgkmcnt(12)
v_mfma_f32_32x32x16_bf16 v[64:79], v[236:239], v[140:143], v[64:79]
s_add_u32 m0, s37, 4096
s_nop 0
buffer_load_dwordx4 v13, s[8:11], s23 offen offset:1024 lds
v_mov_b32 v206, 0
ds_read_b64_tr_b16 v[232:233], v5 offset:37376
ds_read_b64_tr_b16 v[234:235], v5 offset:39424
s_waitcnt vmcnt(16)
s_waitcnt lgkmcnt(12)
v_mfma_f32_32x32x16_bf16 v[16:31], v[208:211], v[80:83], v[16:31]
buffer_load_dwordx4 v[152:155], v13, s[8:11], s49 offen offset:2048
v_mov_b32 v207, 0
ds_read_b64_tr_b16 v[236:237], v5 offset:37632
ds_read_b64_tr_b16 v[238:239], v5 offset:39680
s_waitcnt lgkmcnt(12)
v_mfma_f32_32x32x16_bf16 v[32:47], v[212:215], v[80:83], v[32:47]
s_add_u32 m0, s37, 4096
s_nop 0
buffer_load_dwordx4 v13, s[8:11], s23 offen offset:2048 lds
ds_read_b64_tr_b16 v[208:209], v5 offset:40960
ds_read_b64_tr_b16 v[210:211], v5 offset:43008
s_waitcnt lgkmcnt(12)
v_mfma_f32_32x32x16_bf16 v[48:63], v[216:219], v[80:83], v[48:63]
buffer_load_dwordx4 v[156:159], v13, s[8:11], s49 offen offset:3072
ds_read_b64_tr_b16 v[212:213], v5 offset:41216
ds_read_b64_tr_b16 v[214:215], v5 offset:43264
s_waitcnt lgkmcnt(12)
v_mfma_f32_32x32x16_bf16 v[64:79], v[220:223], v[80:83], v[64:79]
s_add_u32 m0, s37, 4096
s_nop 0
buffer_load_dwordx4 v13, s[8:11], s23 offen offset:3072 lds
v_mov_b32 v112, 0
ds_read_b64_tr_b16 v[216:217], v5 offset:41472
ds_read_b64_tr_b16 v[218:219], v5 offset:43520
s_waitcnt lgkmcnt(12)
v_mfma_f32_32x32x16_bf16 v[16:31], v[224:227], v[84:87], v[16:31]
buffer_load_dwordx4 v[160:163], v0, s[8:11], s49 offen offset:0
v_mov_b32 v113, 0
ds_read_b64_tr_b16 v[220:221], v5 offset:41728
ds_read_b64_tr_b16 v[222:223], v5 offset:43776
s_waitcnt lgkmcnt(12)
v_mfma_f32_32x32x16_bf16 v[32:47], v[228:231], v[84:87], v[32:47]
v_mov_b32 v114, 0
ds_read_b64_tr_b16 v[224:225], v5 offset:45056
ds_read_b64_tr_b16 v[226:227], v5 offset:47104
s_waitcnt lgkmcnt(12)
v_mfma_f32_32x32x16_bf16 v[48:63], v[232:235], v[84:87], v[48:63]
buffer_load_dwordx4 v[164:167], v0, s[8:11], s49 offen offset:1024
v_mov_b32 v115, 0
ds_read_b64_tr_b16 v[228:229], v5 offset:45312
ds_read_b64_tr_b16 v[230:231], v5 offset:47360
s_waitcnt lgkmcnt(12)
v_mfma_f32_32x32x16_bf16 v[64:79], v[236:239], v[84:87], v[64:79]
v_mov_b32 v116, 0
ds_read_b64_tr_b16 v[232:233], v5 offset:45568
ds_read_b64_tr_b16 v[234:235], v5 offset:47616
s_waitcnt lgkmcnt(12)
v_mfma_f32_32x32x16_bf16 v[16:31], v[208:211], v[88:91], v[16:31]
buffer_load_dwordx4 v[168:171], v0, s[8:11], s49 offen offset:2048
v_mov_b32 v117, 0
ds_read_b64_tr_b16 v[236:237], v5 offset:45824
ds_read_b64_tr_b16 v[238:239], v5 offset:47872
s_waitcnt lgkmcnt(12)
v_mfma_f32_32x32x16_bf16 v[32:47], v[212:215], v[88:91], v[32:47]
v_mov_b32 v118, 0
ds_read_b64_tr_b16 v[208:209], v5 offset:49152
ds_read_b64_tr_b16 v[210:211], v5 offset:51200
s_waitcnt lgkmcnt(12)
v_mfma_f32_32x32x16_bf16 v[48:63], v[216:219], v[88:91], v[48:63]
buffer_load_dwordx4 v[172:175], v0, s[8:11], s49 offen offset:3072
v_mov_b32 v119, 0
ds_read_b64_tr_b16 v[212:213], v5 offset:49408
ds_read_b64_tr_b16 v[214:215], v5 offset:51456
s_waitcnt lgkmcnt(12)
v_mfma_f32_32x32x16_bf16 v[64:79], v[220:223], v[88:91], v[64:79]
v_mov_b32 v120, 0
ds_read_b64_tr_b16 v[216:217], v5 offset:49664
ds_read_b64_tr_b16 v[218:219], v5 offset:51712
s_waitcnt lgkmcnt(12)
v_mfma_f32_32x32x16_bf16 v[16:31], v[224:227], v[92:95], v[16:31]
s_add_u32 m0, s37, 32768
s_add_u32 s23, s29, 49152
s_add_u32 s23, s23, s37
buffer_load_dwordx4 v13, s[8:11], s23 offen offset:0 lds
v_mov_b32 v121, 0
ds_read_b64_tr_b16 v[220:221], v5 offset:49920
ds_read_b64_tr_b16 v[222:223], v5 offset:51968
s_waitcnt lgkmcnt(12)
v_mfma_f32_32x32x16_bf16 v[32:47], v[228:231], v[92:95], v[32:47]
v_mov_b32 v122, 0
ds_read_b64_tr_b16 v[224:225], v5 offset:53248
ds_read_b64_tr_b16 v[226:227], v5 offset:55296
s_waitcnt lgkmcnt(12)
v_mfma_f32_32x32x16_bf16 v[48:63], v[232:235], v[92:95], v[48:63]
s_add_u32 m0, s37, 32768
s_nop 0
buffer_load_dwordx4 v13, s[8:11], s23 offen offset:1024 lds
v_mov_b32 v123, 0
ds_read_b64_tr_b16 v[228:229], v5 offset:53504
ds_read_b64_tr_b16 v[230:231], v5 offset:55552
s_waitcnt lgkmcnt(12)
v_mfma_f32_32x32x16_bf16 v[64:79], v[236:239], v[92:95], v[64:79]
v_mov_b32 v124, 0
ds_read_b64_tr_b16 v[232:233], v5 offset:53760
ds_read_b64_tr_b16 v[234:235], v5 offset:55808
s_waitcnt vmcnt(22)
s_waitcnt lgkmcnt(12)
v_mfma_f32_32x32x16_bf16 v[16:31], v[208:211], v[96:99], v[16:31]
s_add_u32 m0, s37, 32768
s_nop 0
buffer_load_dwordx4 v13, s[8:11], s23 offen offset:2048 lds
v_mov_b32 v125, 0
ds_read_b64_tr_b16 v[236:237], v5 offset:54016
ds_read_b64_tr_b16 v[238:239], v5 offset:56064
s_waitcnt lgkmcnt(12)
v_mfma_f32_32x32x16_bf16 v[32:47], v[212:215], v[96:99], v[32:47]
v_mov_b32 v126, 0
ds_read_b64_tr_b16 v[208:209], v5 offset:57344
ds_read_b64_tr_b16 v[210:211], v5 offset:59392
s_waitcnt lgkmcnt(12)
v_mfma_f32_32x32x16_bf16 v[48:63], v[216:219], v[96:99], v[48:63]
s_add_u32 m0, s37, 32768
s_nop 0
buffer_load_dwordx4 v13, s[8:11], s23 offen offset:3072 lds
v_mov_b32 v127, 0
ds_read_b64_tr_b16 v[212:213], v5 offset:57600
ds_read_b64_tr_b16 v[214:215], v5 offset:59648
s_waitcnt lgkmcnt(12)
v_mfma_f32_32x32x16_bf16 v[64:79], v[220:223], v[96:99], v[64:79]
ds_read_b64_tr_b16 v[216:217], v5 offset:57856
ds_read_b64_tr_b16 v[218:219], v5 offset:59904
s_waitcnt lgkmcnt(12)
v_mfma_f32_32x32x16_bf16 v[16:31], v[224:227], v[100:103], v[16:31]
s_add_u32 m0, s37, 36864
s_add_u32 s23, s29, 53248
s_add_u32 s23, s23, s37
buffer_load_dwordx4 v13, s[8:11], s23 offen offset:0 lds
ds_read_b64_tr_b16 v[220:221], v5 offset:58112
ds_read_b64_tr_b16 v[222:223], v5 offset:60160
s_waitcnt lgkmcnt(12)
v_mfma_f32_32x32x16_bf16 v[32:47], v[228:231], v[100:103], v[32:47]
ds_read_b64_tr_b16 v[224:225], v5 offset:61440
ds_read_b64_tr_b16 v[226:227], v5 offset:63488
s_waitcnt lgkmcnt(12)
v_mfma_f32_32x32x16_bf16 v[48:63], v[232:235], v[100:103], v[48:63]
s_add_u32 m0, s37, 36864
s_nop 0
buffer_load_dwordx4 v13, s[8:11], s23 offen offset:1024 lds
ds_read_b64_tr_b16 v[228:229], v5 offset:61696
ds_read_b64_tr_b16 v[230:231], v5 offset:63744
s_waitcnt lgkmcnt(12)
v_mfma_f32_32x32x16_bf16 v[64:79], v[236:239], v[100:103], v[64:79]
ds_read_b64_tr_b16 v[232:233], v5 offset:61952
ds_read_b64_tr_b16 v[234:235], v5 offset:64000
s_waitcnt lgkmcnt(12)
v_mfma_f32_32x32x16_bf16 v[16:31], v[208:211], v[104:107], v[16:31]
s_add_u32 m0, s37, 36864
s_nop 0
buffer_load_dwordx4 v13, s[8:11], s23 offen offset:2048 lds
ds_read_b64_tr_b16 v[236:237], v5 offset:62208
ds_read_b64_tr_b16 v[238:239], v5 offset:64256
s_waitcnt lgkmcnt(12)
v_mfma_f32_32x32x16_bf16 v[32:47], v[212:215], v[104:107], v[32:47]
s_waitcnt vmcnt(20)
s_barrier
ds_read_b64_tr_b16 v[208:209], v6 offset:0
ds_read_b64_tr_b16 v[210:211], v6 offset:2048
s_waitcnt lgkmcnt(12)
v_mfma_f32_32x32x16_bf16 v[48:63], v[216:219], v[104:107], v[48:63]
s_add_u32 m0, s37, 36864
s_nop 0
buffer_load_dwordx4 v13, s[8:11], s23 offen offset:3072 lds
ds_read_b64_tr_b16 v[212:213], v6 offset:256
ds_read_b64_tr_b16 v[214:215], v6 offset:2304
s_waitcnt lgkmcnt(12)
v_mfma_f32_32x32x16_bf16 v[64:79], v[220:223], v[104:107], v[64:79]
ds_read_b64_tr_b16 v[216:217], v6 offset:512
ds_read_b64_tr_b16 v[218:219], v6 offset:2560
s_waitcnt lgkmcnt(12)
v_mfma_f32_32x32x16_bf16 v[16:31], v[224:227], v[108:111], v[16:31]
ds_read_b64_tr_b16 v[220:221], v6 offset:768
ds_read_b64_tr_b16 v[222:223], v6 offset:2816
s_waitcnt lgkmcnt(12)
v_mfma_f32_32x32x16_bf16 v[32:47], v[228:231], v[108:111], v[32:47]
ds_read_b64_tr_b16 v[224:225], v6 offset:4096
ds_read_b64_tr_b16 v[226:227], v6 offset:6144
s_waitcnt lgkmcnt(12)
v_mfma_f32_32x32x16_bf16 v[48:63], v[232:235], v[108:111], v[48:63]
ds_read_b64_tr_b16 v[228:229], v6 offset:4352
ds_read_b64_tr_b16 v[230:231], v6 offset:6400
s_waitcnt lgkmcnt(12)
v_mfma_f32_32x32x16_bf16 v[64:79], v[236:239], v[108:111], v[64:79]
ds_read_b64_tr_b16 v[232:233], v6 offset:4608
ds_read_b64_tr_b16 v[234:235], v6 offset:6656
s_waitcnt vmcnt(13)
s_waitcnt lgkmcnt(12)
v_mfma_f32_32x32x16_bf16 v[16:31], v[208:211], v[144:147], v[16:31]
ds_read_b64_tr_b16 v[236:237], v6 offset:4864
ds_read_b64_tr_b16 v[238:239], v6 offset:6912
s_waitcnt lgkmcnt(12)
v_mfma_f32_32x32x16_bf16 v[32:47], v[212:215], v[144:147], v[32:47]
ds_read_b64_tr_b16 v[208:209], v6 offset:8192
ds_read_b64_tr_b16 v[210:211], v6 offset:10240
s_waitcnt lgkmcnt(12)
v_mfma_f32_32x32x16_bf16 v[48:63], v[216:219], v[144:147], v[48:63]
ds_read_b64_tr_b16 v[212:213], v6 offset:8448
ds_read_b64_tr_b16 v[214:215], v6 offset:10496
s_waitcnt lgkmcnt(12)
v_mfma_f32_32x32x16_bf16 v[64:79], v[220:223], v[144:147], v[64:79]
ds_read_b64_tr_b16 v[216:217], v6 offset:8704
ds_read_b64_tr_b16 v[218:219], v6 offset:10752
s_waitcnt lgkmcnt(12)
v_mfma_f32_32x32x16_bf16 v[16:31], v[224:227], v[148:151], v[16:31]
ds_read_b64_tr_b16 v[220:221], v6 offset:8960
ds_read_b64_tr_b16 v[222:223], v6 offset:11008
s_waitcnt lgkmcnt(12)
v_mfma_f32_32x32x16_bf16 v[32:47], v[228:231], v[148:151], v[32:47]
ds_read_b64_tr_b16 v[224:225], v6 offset:12288
ds_read_b64_tr_b16 v[226:227], v6 offset:14336
s_waitcnt lgkmcnt(12)
v_mfma_f32_32x32x16_bf16 v[48:63], v[232:235], v[148:151], v[48:63]
ds_read_b64_tr_b16 v[228:229], v6 offset:12544
ds_read_b64_tr_b16 v[230:231], v6 offset:14592
s_waitcnt lgkmcnt(12)
v_mfma_f32_32x32x16_bf16 v[64:79], v[236:239], v[148:151], v[64:79]
ds_read_b64_tr_b16 v[232:233], v6 offset:12800
ds_read_b64_tr_b16 v[234:235], v6 offset:14848
s_waitcnt lgkmcnt(12)
v_mfma_f32_32x32x16_bf16 v[16:31], v[208:211], v[152:155], v[16:31]
ds_read_b64_tr_b16 v[236:237], v6 offset:13056
ds_read_b64_tr_b16 v[238:239], v6 offset:15104
s_waitcnt lgkmcnt(12)
v_mfma_f32_32x32x16_bf16 v[32:47], v[212:215], v[152:155], v[32:47]
ds_read_b64_tr_b16 v[208:209], v6 offset:16384
ds_read_b64_tr_b16 v[210:211], v6 offset:18432
s_waitcnt lgkmcnt(12)
v_mfma_f32_32x32x16_bf16 v[48:63], v[216:219], v[152:155], v[48:63]
ds_read_b64_tr_b16 v[212:213], v6 offset:16640
ds_read_b64_tr_b16 v[214:215], v6 offset:18688
s_waitcnt lgkmcnt(12)
v_mfma_f32_32x32x16_bf16 v[64:79], v[220:223], v[152:155], v[64:79]
ds_read_b64_tr_b16 v[216:217], v6 offset:16896
ds_read_b64_tr_b16 v[218:219], v6 offset:18944
s_waitcnt lgkmcnt(12)
v_mfma_f32_32x32x16_bf16 v[16:31], v[224:227], v[156:159], v[16:31]
ds_read_b64_tr_b16 v[220:221], v6 offset:17152
ds_read_b64_tr_b16 v[222:223], v6 offset:19200
s_waitcnt lgkmcnt(12)
v_mfma_f32_32x32x16_bf16 v[32:47], v[228:231], v[156:159], v[32:47]
ds_read_b64_tr_b16 v[224:225], v6 offset:20480
ds_read_b64_tr_b16 v[226:227], v6 offset:22528
s_waitcnt lgkmcnt(12)
v_mfma_f32_32x32x16_bf16 v[48:63], v[232:235], v[156:159], v[48:63]
ds_read_b64_tr_b16 v[228:229], v6 offset:20736
ds_read_b64_tr_b16 v[230:231], v6 offset:22784
s_waitcnt lgkmcnt(12)
v_mfma_f32_32x32x16_bf16 v[64:79], v[236:239], v[156:159], v[64:79]
ds_read_b64_tr_b16 v[232:233], v6 offset:20992
ds_read_b64_tr_b16 v[234:235], v6 offset:23040
s_waitcnt vmcnt(8)
s_waitcnt lgkmcnt(12)
v_mfma_f32_32x32x16_bf16 v[16:31], v[208:211], v[160:163], v[16:31]
ds_read_b64_tr_b16 v[236:237], v6 offset:21248
ds_read_b64_tr_b16 v[238:239], v6 offset:23296
s_waitcnt lgkmcnt(12)
v_mfma_f32_32x32x16_bf16 v[32:47], v[212:215], v[160:163], v[32:47]
ds_read_b64_tr_b16 v[208:209], v6 offset:24576
ds_read_b64_tr_b16 v[210:211], v6 offset:26624
s_waitcnt lgkmcnt(12)
v_mfma_f32_32x32x16_bf16 v[48:63], v[216:219], v[160:163], v[48:63]
ds_read_b64_tr_b16 v[212:213], v6 offset:24832
ds_read_b64_tr_b16 v[214:215], v6 offset:26880
s_waitcnt lgkmcnt(12)
v_mfma_f32_32x32x16_bf16 v[64:79], v[220:223], v[160:163], v[64:79]
ds_read_b64_tr_b16 v[216:217], v6 offset:25088
ds_read_b64_tr_b16 v[218:219], v6 offset:27136
s_waitcnt lgkmcnt(12)
v_mfma_f32_32x32x16_bf16 v[16:31], v[224:227], v[164:167], v[16:31]
ds_read_b64_tr_b16 v[220:221], v6 offset:25344
ds_read_b64_tr_b16 v[222:223], v6 offset:27392
s_waitcnt lgkmcnt(12)
v_mfma_f32_32x32x16_bf16 v[32:47], v[228:231], v[164:167], v[32:47]
ds_read_b64_tr_b16 v[224:225], v6 offset:28672
ds_read_b64_tr_b16 v[226:227], v6 offset:30720
s_waitcnt lgkmcnt(12)
v_mfma_f32_32x32x16_bf16 v[48:63], v[232:235], v[164:167], v[48:63]
ds_read_b64_tr_b16 v[228:229], v6 offset:28928
ds_read_b64_tr_b16 v[230:231], v6 offset:30976
s_waitcnt lgkmcnt(12)
v_mfma_f32_32x32x16_bf16 v[64:79], v[236:239], v[164:167], v[64:79]
ds_read_b64_tr_b16 v[232:233], v6 offset:29184
ds_read_b64_tr_b16 v[234:235], v6 offset:31232
s_waitcnt lgkmcnt(12)
v_mfma_f32_32x32x16_bf16 v[16:31], v[208:211], v[168:171], v[16:31]
ds_read_b64_tr_b16 v[236:237], v6 offset:29440
ds_read_b64_tr_b16 v[238:239], v6 offset:31488
s_waitcnt lgkmcnt(12)
v_mfma_f32_32x32x16_bf16 v[32:47], v[212:215], v[168:171], v[32:47]
s_waitcnt lgkmcnt(10)
v_mfma_f32_32x32x16_bf16 v[48:63], v[216:219], v[168:171], v[48:63]
s_waitcnt lgkmcnt(8)
v_mfma_f32_32x32x16_bf16 v[64:79], v[220:223], v[168:171], v[64:79]
s_waitcnt lgkmcnt(6)
v_mfma_f32_32x32x16_bf16 v[16:31], v[224:227], v[172:175], v[16:31]
s_waitcnt lgkmcnt(4)
v_mfma_f32_32x32x16_bf16 v[32:47], v[228:231], v[172:175], v[32:47]
s_waitcnt lgkmcnt(2)
v_mfma_f32_32x32x16_bf16 v[48:63], v[232:235], v[172:175], v[48:63]
s_waitcnt lgkmcnt(0)
v_mfma_f32_32x32x16_bf16 v[64:79], v[236:239], v[172:175], v[64:79]
s_mov_b32 s38, 0x10000
s_add_u32 s29, s29, 81920
s_add_u32 s29, s29, s37
s_lshl_b32 s31, s26, 1
s_add_u32 s31, s31, s28
s_sub_u32 s52, 29, s31
s_barrier
ds_read_b128 v[208:211], v7 offset:16384
ds_read_b128 v[212:215], v7 offset:17408
ds_read_b128 v[216:219], v7 offset:18432
ds_read_b128 v[220:223], v7 offset:19456
ds_read_b128 v[224:227], v7 offset:20480
ds_read_b128 v[228:231], v7 offset:21504
ds_read_b128 v[232:235], v7 offset:22528
s_and_b32 s61, s2, 7
s_lshl_b32 s61, s61, 1
s_sub_u32 s31, s39, 11
s_add_u32 s62, s61, 1
s_cmp_ge_u32 s39, 11
s_cselect_b32 s60, s31, s39
s_cselect_b32 s61, s62, s61
s_and_b32 s31, s24, 3
s_mul_i32 s53, s31, 5120
s_mul_i32 s54, s60, 204800
s_add_u32 s54, s54, s53
s_add_u32 s54, s54, 80740352
s_add_u32 s53, s53, 0x18000
s_cmp_lt_u32 s39, 22
s_cselect_b64 s[20:21], -1, 0
v_cvt_pk_bf16_f32 v80, v16, v17
v_cvt_pk_bf16_f32 v81, v18, v19
v_cvt_pk_bf16_f32 v82, v20, v21
v_cvt_pk_bf16_f32 v83, v22, v23
v_cvt_pk_bf16_f32 v84, v24, v25
v_cvt_pk_bf16_f32 v85, v26, v27
v_cvt_pk_bf16_f32 v86, v28, v29
v_cvt_pk_bf16_f32 v87, v30, v31
v_cvt_pk_bf16_f32 v88, v32, v33
v_cvt_pk_bf16_f32 v89, v34, v35
v_cvt_pk_bf16_f32 v90, v36, v37
v_cvt_pk_bf16_f32 v91, v38, v39
v_cvt_pk_bf16_f32 v92, v40, v41
v_cvt_pk_bf16_f32 v93, v42, v43
v_cvt_pk_bf16_f32 v94, v44, v45
v_cvt_pk_bf16_f32 v95, v46, v47
v_cvt_pk_bf16_f32 v96, v48, v49
v_cvt_pk_bf16_f32 v97, v50, v51
v_cvt_pk_bf16_f32 v98, v52, v53
v_cvt_pk_bf16_f32 v99, v54, v55
v_cvt_pk_bf16_f32 v100, v56, v57
v_cvt_pk_bf16_f32 v101, v58, v59
v_cvt_pk_bf16_f32 v102, v60, v61
v_cvt_pk_bf16_f32 v103, v62, v63
v_cvt_pk_bf16_f32 v104, v64, v65
v_cvt_pk_bf16_f32 v105, v66, v67
v_cvt_pk_bf16_f32 v106, v68, v69
v_cvt_pk_bf16_f32 v107, v70, v71
v_cvt_pk_bf16_f32 v108, v72, v73
v_cvt_pk_bf16_f32 v109, v74, v75
v_cvt_pk_bf16_f32 v110, v76, v77
v_cvt_pk_bf16_f32 v111, v78, v79
v_mov_b32 v8, 0
v_mov_b32 v9, 0
v_mov_b32 v12, 0xf149f2ca
s_cmp_lg_u32 s28, 0
s_cbranch_scc1 LatB_q0
v_cmp_le_i32 s[44:45], 0, v11
v_cmp_le_i32 s[46:47], 1, v11
v_cmp_le_i32 s[48:49], 2, v11
v_cmp_le_i32 s[50:51], 3, v11
v_cndmask_b32 v16, v12, v112, s[44:45]
v_cmp_le_i32 s[44:45], 8, v11
v_cndmask_b32 v17, v12, v112, s[46:47]
v_cmp_le_i32 s[46:47], 9, v11
v_cndmask_b32 v18, v12, v112, s[48:49]
v_cmp_le_i32 s[48:49], 10, v11
v_cndmask_b32 v19, v12, v112, s[50:51]
v_cmp_le_i32 s[50:51], 11, v11
v_cndmask_b32 v20, v12, v112, s[44:45]
v_cmp_le_i32 s[44:45], 16, v11
v_cndmask_b32 v21, v12, v112, s[46:47]
v_cmp_le_i32 s[46:47], 17, v11
v_cndmask_b32 v22, v12, v112, s[48:49]
v_cmp_le_i32 s[48:49], 18, v11
v_cndmask_b32 v23, v12, v112, s[50:51]
v_cmp_le_i32 s[50:51], 19, v11
v_cndmask_b32 v24, v12, v112, s[44:45]
v_cmp_le_i32 s[44:45], 24, v11
v_cndmask_b32 v25, v12, v112, s[46:47]
v_cmp_le_i32 s[46:47], 25, v11
v_cndmask_b32 v26, v12, v112, s[48:49]
v_cmp_le_i32 s[48:49], 26, v11
v_cndmask_b32 v27, v12, v112, s[50:51]
v_cmp_le_i32 s[50:51], 27, v11
v_cndmask_b32 v28, v12, v112, s[44:45]
v_cmp_le_i32 s[44:45], 32, v11
v_cndmask_b32 v29, v12, v112, s[46:47]
v_cmp_le_i32 s[46:47], 33, v11
v_cndmask_b32 v30, v12, v112, s[48:49]
v_cmp_le_i32 s[48:49], 34, v11
v_cndmask_b32 v31, v12, v112, s[50:51]
v_cmp_le_i32 s[50:51], 35, v11
v_cndmask_b32 v32, v12, v112, s[44:45]
v_cmp_le_i32 s[44:45], 40, v11
v_cndmask_b32 v33, v12, v112, s[46:47]
v_cmp_le_i32 s[46:47], 41, v11
v_cndmask_b32 v34, v12, v112, s[48:49]
v_cmp_le_i32 s[48:49], 42, v11
v_cndmask_b32 v35, v12, v112, s[50:51]
v_cmp_le_i32 s[50:51], 43, v11
v_cndmask_b32 v36, v12, v112, s[44:45]
v_cmp_le_i32 s[44:45], 48, v11
v_cndmask_b32 v37, v12, v112, s[46:47]
v_cmp_le_i32 s[46:47], 49, v11
v_cndmask_b32 v38, v12, v112, s[48:49]
v_cmp_le_i32 s[48:49], 50, v11
v_cndmask_b32 v39, v12, v112, s[50:51]
v_cmp_le_i32 s[50:51], 51, v11
v_cndmask_b32 v40, v12, v112, s[44:45]
v_cmp_le_i32 s[44:45], 56, v11
v_cndmask_b32 v41, v12, v112, s[46:47]
v_cmp_le_i32 s[46:47], 57, v11
v_cndmask_b32 v42, v12, v112, s[48:49]
v_cmp_le_i32 s[48:49], 58, v11
v_cndmask_b32 v43, v12, v112, s[50:51]
v_cmp_le_i32 s[50:51], 59, v11
v_cndmask_b32 v44, v12, v112, s[44:45]
v_cndmask_b32 v45, v12, v112, s[46:47]
v_cndmask_b32 v46, v12, v112, s[48:49]
v_cndmask_b32 v47, v12, v112, s[50:51]
ds_read_b128 v[236:239], v7 offset:23552
v_mov_b32 v144, 0
v_mov_b32 v145, 0
s_waitcnt lgkmcnt(7)
v_mfma_f32_32x32x16_bf16 v[16:31], v[208:211], v[80:83], v[16:31]
ds_read_b128 v[208:211], v7 offset:24576
v_mov_b32 v146, 0
v_mov_b32 v147, 0
s_waitcnt lgkmcnt(7)
v_mfma_f32_32x32x16_bf16 v[16:31], v[212:215], v[84:87], v[16:31]
ds_read_b128 v[212:215], v7 offset:25600
v_mov_b32 v148, 0
v_mov_b32 v149, 0
s_waitcnt lgkmcnt(7)
v_mfma_f32_32x32x16_bf16 v[16:31], v[216:219], v[88:91], v[16:31]
ds_read_b128 v[216:219], v7 offset:26624
v_mov_b32 v150, 0
v_mov_b32 v151, 0
s_waitcnt lgkmcnt(7)
v_mfma_f32_32x32x16_bf16 v[16:31], v[220:223], v[92:95], v[16:31]
ds_read_b128 v[220:223], v7 offset:27648
v_mov_b32 v152, 0
v_mov_b32 v153, 0
s_waitcnt lgkmcnt(7)
v_mfma_f32_32x32x16_bf16 v[16:31], v[224:227], v[96:99], v[16:31]
ds_read_b128 v[224:227], v7 offset:28672
v_mov_b32 v154, 0
v_mov_b32 v155, 0
s_waitcnt lgkmcnt(7)
v_mfma_f32_32x32x16_bf16 v[16:31], v[228:231], v[100:103], v[16:31]
ds_read_b128 v[228:231], v7 offset:29696
v_mov_b32 v156, 0
v_mov_b32 v157, 0
s_waitcnt lgkmcnt(7)
v_mfma_f32_32x32x16_bf16 v[16:31], v[232:235], v[104:107], v[16:31]
ds_read_b128 v[232:235], v7 offset:30720
v_mov_b32 v158, 0
v_mov_b32 v159, 0
s_waitcnt lgkmcnt(7)
v_mfma_f32_32x32x16_bf16 v[16:31], v[236:239], v[108:111], v[16:31]
ds_read_b128 v[236:239], v7 offset:31744
v_mov_b32 v160, 0
v_mov_b32 v161, 0
s_waitcnt lgkmcnt(7)
v_mfma_f32_32x32x16_bf16 v[32:47], v[208:211], v[80:83], v[32:47]
s_add_u32 s30, s38, s37
s_add_u32 s38, s38, 0x8000
s_cmp_eq_u32 s38, 0x18000
s_cselect_b32 s38, 0, s38
s_barrier
v_add_u32 v7, s38, v13
ds_read_b128 v[208:211], v7 offset:16384
v_mov_b32 v162, 0
v_mov_b32 v163, 0
s_waitcnt lgkmcnt(7)
v_mfma_f32_32x32x16_bf16 v[32:47], v[212:215], v[84:87], v[32:47]
ds_read_b128 v[212:215], v7 offset:17408
v_mov_b32 v164, 0
v_mov_b32 v165, 0
s_waitcnt lgkmcnt(7)
v_mfma_f32_32x32x16_bf16 v[32:47], v[216:219], v[88:91], v[32:47]
ds_read_b128 v[216:219], v7 offset:18432
v_mov_b32 v166, 0
v_mov_b32 v167, 0
s_waitcnt lgkmcnt(7)
v_mfma_f32_32x32x16_bf16 v[32:47], v[220:223], v[92:95], v[32:47]
ds_read_b128 v[220:223], v7 offset:19456
v_mov_b32 v168, 0
v_mov_b32 v169, 0
s_waitcnt lgkmcnt(7)
v_mfma_f32_32x32x16_bf16 v[32:47], v[224:227], v[96:99], v[32:47]
ds_read_b128 v[224:227], v7 offset:20480
v_mov_b32 v170, 0
v_mov_b32 v171, 0
s_waitcnt lgkmcnt(7)
v_mfma_f32_32x32x16_bf16 v[32:47], v[228:231], v[100:103], v[32:47]
ds_read_b128 v[228:231], v7 offset:21504
v_mov_b32 v172, 0
v_mov_b32 v173, 0
s_waitcnt lgkmcnt(7)
v_mfma_f32_32x32x16_bf16 v[32:47], v[232:235], v[104:107], v[32:47]
ds_read_b128 v[232:235], v7 offset:22528
v_mov_b32 v174, 0
v_mov_b32 v175, 0
s_waitcnt lgkmcnt(7)
v_mfma_f32_32x32x16_bf16 v[32:47], v[236:239], v[108:111], v[32:47]
s_branch LatB_q1
LatB_q0:
ds_read_b128 v[236:239], v7 offset:23552
v_mov_b32 v144, 0
v_mov_b32 v145, 0
s_waitcnt lgkmcnt(7)
v_mfma_f32_32x32x16_bf16 v[16:31], v[208:211], v[80:83], v[112:127]
ds_read_b128 v[208:211], v7 offset:24576
v_mov_b32 v146, 0
v_mov_b32 v147, 0
s_waitcnt lgkmcnt(7)
v_mfma_f32_32x32x16_bf16 v[16:31], v[212:215], v[84:87], v[16:31]
ds_read_b128 v[212:215], v7 offset:25600
v_mov_b32 v148, 0
v_mov_b32 v149, 0
s_waitcnt lgkmcnt(7)
v_mfma_f32_32x32x16_bf16 v[16:31], v[216:219], v[88:91], v[16:31]
ds_read_b128 v[216:219], v7 offset:26624
v_mov_b32 v150, 0
v_mov_b32 v151, 0
s_waitcnt lgkmcnt(7)
v_mfma_f32_32x32x16_bf16 v[16:31], v[220:223], v[92:95], v[16:31]
ds_read_b128 v[220:223], v7 offset:27648
v_mov_b32 v152, 0
v_mov_b32 v153, 0
s_waitcnt lgkmcnt(7)
v_mfma_f32_32x32x16_bf16 v[16:31], v[224:227], v[96:99], v[16:31]
ds_read_b128 v[224:227], v7 offset:28672
v_mov_b32 v154, 0
v_mov_b32 v155, 0
s_waitcnt lgkmcnt(7)
v_mfma_f32_32x32x16_bf16 v[16:31], v[228:231], v[100:103], v[16:31]
ds_read_b128 v[228:231], v7 offset:29696
v_mov_b32 v156, 0
v_mov_b32 v157, 0
s_waitcnt lgkmcnt(7)
v_mfma_f32_32x32x16_bf16 v[16:31], v[232:235], v[104:107], v[16:31]
ds_read_b128 v[232:235], v7 offset:30720
v_mov_b32 v158, 0
v_mov_b32 v159, 0
s_waitcnt lgkmcnt(7)
v_mfma_f32_32x32x16_bf16 v[16:31], v[236:239], v[108:111], v[16:31]
ds_read_b128 v[236:239], v7 offset:31744
v_mov_b32 v160, 0
v_mov_b32 v161, 0
s_waitcnt lgkmcnt(7)
v_mfma_f32_32x32x16_bf16 v[32:47], v[208:211], v[80:83], v[112:127]
s_add_u32 s30, s38, s37
s_add_u32 s38, s38, 0x8000
s_cmp_eq_u32 s38, 0x18000
s_cselect_b32 s38, 0, s38
s_barrier
v_add_u32 v7, s38, v13
ds_read_b128 v[208:211], v7 offset:16384
v_mov_b32 v162, 0
v_mov_b32 v163, 0
s_waitcnt lgkmcnt(7)
v_mfma_f32_32x32x16_bf16 v[32:47], v[212:215], v[84:87], v[32:47]
ds_read_b128 v[212:215], v7 offset:17408
v_mov_b32 v164, 0
v_mov_b32 v165, 0
s_waitcnt lgkmcnt(7)
v_mfma_f32_32x32x16_bf16 v[32:47], v[216:219], v[88:91], v[32:47]
ds_read_b128 v[216:219], v7 offset:18432
v_mov_b32 v166, 0
v_mov_b32 v167, 0
s_waitcnt lgkmcnt(7)
v_mfma_f32_32x32x16_bf16 v[32:47], v[220:223], v[92:95], v[32:47]
ds_read_b128 v[220:223], v7 offset:19456
v_mov_b32 v168, 0
v_mov_b32 v169, 0
s_waitcnt lgkmcnt(7)
v_mfma_f32_32x32x16_bf16 v[32:47], v[224:227], v[96:99], v[32:47]
ds_read_b128 v[224:227], v7 offset:20480
v_mov_b32 v170, 0
v_mov_b32 v171, 0
s_waitcnt lgkmcnt(7)
v_mfma_f32_32x32x16_bf16 v[32:47], v[228:231], v[100:103], v[32:47]
ds_read_b128 v[228:231], v7 offset:21504
v_mov_b32 v172, 0
v_mov_b32 v173, 0
s_waitcnt lgkmcnt(7)
v_mfma_f32_32x32x16_bf16 v[32:47], v[232:235], v[104:107], v[32:47]
ds_read_b128 v[232:235], v7 offset:22528
v_mov_b32 v174, 0
v_mov_b32 v175, 0
s_waitcnt lgkmcnt(7)
v_mfma_f32_32x32x16_bf16 v[32:47], v[236:239], v[108:111], v[32:47]
LatB_q1:
s_nop 11
v_max3_f32 v10, v16, v17, v18
v_max3_f32 v10, v10, v19, v20
v_max3_f32 v10, v10, v21, v22
v_max3_f32 v10, v10, v23, v24
v_max3_f32 v10, v10, v25, v26
v_max3_f32 v10, v10, v27, v28
v_max3_f32 v10, v10, v29, v30
v_max3_f32 v10, v10, v31, v32
v_max3_f32 v10, v10, v33, v34
v_max3_f32 v10, v10, v35, v36
v_max3_f32 v10, v10, v37, v38
v_max3_f32 v10, v10, v39, v40
v_max3_f32 v10, v10, v41, v42
v_max3_f32 v10, v10, v43, v44
v_max3_f32 v10, v10, v45, v46
v_max_f32 v10, v10, v47
v_mov_b32 v14, v10
s_nop 1
v_permlane32_swap_b32 v14, v10
v_max_f32 v10, v10, v14
v_sub_f32 v112, 0, v10
v_sub_f32 v113, 0, v10
v_sub_f32 v114, 0, v10
v_sub_f32 v115, 0, v10
v_sub_f32 v116, 0, v10
v_sub_f32 v117, 0, v10
v_sub_f32 v118, 0, v10
v_sub_f32 v119, 0, v10
v_sub_f32 v120, 0, v10
v_sub_f32 v121, 0, v10
v_sub_f32 v122, 0, v10
v_sub_f32 v123, 0, v10
v_sub_f32 v124, 0, v10
v_sub_f32 v125, 0, v10
v_sub_f32 v126, 0, v10
v_sub_f32 v127, 0, v10
v_sub_f32 v16, v16, v10
v_sub_f32 v17, v17, v10
v_sub_f32 v18, v18, v10
v_sub_f32 v19, v19, v10
v_sub_f32 v20, v20, v10
v_sub_f32 v21, v21, v10
v_sub_f32 v22, v22, v10
v_sub_f32 v23, v23, v10
v_sub_f32 v24, v24, v10
v_sub_f32 v25, v25, v10
v_sub_f32 v26, v26, v10
v_sub_f32 v27, v27, v10
v_sub_f32 v28, v28, v10
v_sub_f32 v29, v29, v10
v_sub_f32 v30, v30, v10
v_sub_f32 v31, v31, v10
v_sub_f32 v32, v32, v10
v_sub_f32 v33, v33, v10
v_sub_f32 v34, v34, v10
v_sub_f32 v35, v35, v10
v_sub_f32 v36, v36, v10
v_sub_f32 v37, v37, v10
v_sub_f32 v38, v38, v10
v_sub_f32 v39, v39, v10
v_sub_f32 v40, v40, v10
v_sub_f32 v41, v41, v10
v_sub_f32 v42, v42, v10
v_sub_f32 v43, v43, v10
v_sub_f32 v44, v44, v10
v_sub_f32 v45, v45, v10
v_sub_f32 v46, v46, v10
v_sub_f32 v47, v47, v10
s_cmp_eq_u32 s28, 0
s_cbranch_scc1 LatB_f0
LatB_loop:
s_cmp_eq_u32 s28, 1
s_cbranch_scc1 LatB_m0
ds_read_b128 v[236:239], v7 offset:23552
v_exp_f32 v16, v16
v_exp_f32 v17, v17
s_waitcnt lgkmcnt(6)
v_mfma_f32_32x32x16_bf16 v[48:63], v[208:211], v[80:83], v[112:127]
ds_read_b128 v[208:211], v7 offset:24576
s_add_u32 m0, s30, 0
s_nop 0
buffer_load_dwordx4 v13, s[8:11], s29 offen offset:0 lds
v_exp_f32 v18, v18
v_cvt_pk_bf16_f32 v128, v16, v17
v_add_f32 v8, v8, v16
v_mfma_f32_32x32x16_bf16 v[48:63], v[212:215], v[84:87], v[48:63]
ds_read_b128 v[212:215], v7 offset:25600
v_exp_f32 v19, v19
v_add_f32 v9, v9, v17
v_add_f32 v8, v8, v18
s_waitcnt lgkmcnt(6)
v_mfma_f32_32x32x16_bf16 v[48:63], v[216:219], v[88:91], v[48:63]
ds_read_b128 v[216:219], v7 offset:26624
buffer_load_dwordx4 v13, s[8:11], s29 offen offset:1024 lds
v_exp_f32 v20, v20
v_cvt_pk_bf16_f32 v129, v18, v19
v_add_f32 v9, v9, v19
v_mfma_f32_32x32x16_bf16 v[48:63], v[220:223], v[92:95], v[48:63]
ds_read_b128 v[220:223], v7 offset:27648
v_exp_f32 v21, v21
v_exp_f32 v22, v22
s_waitcnt lgkmcnt(6)
v_mfma_f32_32x32x16_bf16 v[48:63], v[224:227], v[96:99], v[48:63]
ds_read_b128 v[224:227], v7 offset:28672
buffer_load_dwordx4 v13, s[8:11], s29 offen offset:2048 lds
v_exp_f32 v23, v23
v_cvt_pk_bf16_f32 v130, v20, v21
v_add_f32 v8, v8, v20
v_mfma_f32_32x32x16_bf16 v[48:63], v[228:231], v[100:103], v[48:63]
ds_read_b128 v[228:231], v7 offset:29696
v_exp_f32 v24, v24
v_cvt_pk_bf16_f32 v131, v22, v23
v_add_f32 v9, v9, v21
s_waitcnt lgkmcnt(6)
v_mfma_f32_32x32x16_bf16 v[48:63], v[232:235], v[104:107], v[48:63]
ds_read_b128 v[232:235], v7 offset:30720
buffer_load_dwordx4 v13, s[8:11], s29 offen offset:3072 lds
v_exp_f32 v25, v25
v_add_f32 v8, v8, v22
v_add_f32 v9, v9, v23
v_mfma_f32_32x32x16_bf16 v[48:63], v[236:239], v[108:111], v[48:63]
ds_read_b128 v[236:239], v7 offset:31744
v_exp_f32 v26, v26
v_exp_f32 v27, v27
v_cvt_pk_bf16_f32 v132, v24, v25
s_waitcnt lgkmcnt(6)
v_mfma_f32_32x32x16_bf16 v[64:79], v[208:211], v[80:83], v[112:127]
ds_read_b128 v[208:211], v7 offset:0
s_add_u32 m0, s30, 4096
s_add_u32 s29, s29, 4096
buffer_load_dwordx4 v13, s[8:11], s29 offen offset:0 lds
v_exp_f32 v28, v28
v_cvt_pk_bf16_f32 v133, v26, v27
v_mfma_f32_32x32x16_bf16 v[64:79], v[212:215], v[84:87], v[64:79]
ds_read_b128 v[212:215], v7 offset:4096
v_exp_f32 v29, v29
v_max3_f32 v10, v48, v49, v50
v_add_f32 v8, v8, v24
s_waitcnt lgkmcnt(6)
v_mfma_f32_32x32x16_bf16 v[64:79], v[216:219], v[88:91], v[64:79]
ds_read_b128 v[216:219], v7 offset:8192
buffer_load_dwordx4 v13, s[8:11], s29 offen offset:1024 lds
v_exp_f32 v30, v30
v_cvt_pk_bf16_f32 v134, v28, v29
v_max3_f32 v10, v10, v51, v52
v_mfma_f32_32x32x16_bf16 v[64:79], v[220:223], v[92:95], v[64:79]
ds_read_b128 v[220:223], v7 offset:12288
v_exp_f32 v31, v31
v_max3_f32 v10, v10, v53, v54
v_add_f32 v9, v9, v25
s_waitcnt lgkmcnt(6)
v_mfma_f32_32x32x16_bf16 v[64:79], v[224:227], v[96:99], v[64:79]
ds_read_b128 v[224:227], v7 offset:1024
buffer_load_dwordx4 v13, s[8:11], s29 offen offset:2048 lds
v_exp_f32 v32, v32
v_exp_f32 v33, v33
v_cvt_pk_bf16_f32 v135, v30, v31
v_max3_f32 v10, v10, v55, v56
v_mfma_f32_32x32x16_bf16 v[64:79], v[228:231], v[100:103], v[64:79]
ds_read_b128 v[228:231], v7 offset:5120
v_exp_f32 v34, v34
v_cvt_pk_bf16_f32 v136, v32, v33
v_max3_f32 v10, v10, v57, v58
s_waitcnt lgkmcnt(6)
v_mfma_f32_32x32x16_bf16 v[64:79], v[232:235], v[104:107], v[64:79]
ds_read_b128 v[232:235], v7 offset:9216
buffer_load_dwordx4 v13, s[8:11], s29 offen offset:3072 lds
s_add_u32 s29, s29, 28672
v_exp_f32 v35, v35
v_max3_f32 v10, v10, v59, v60
v_mfma_f32_32x32x16_bf16 v[64:79], v[236:239], v[108:111], v[64:79]
ds_read_b128 v[236:239], v7 offset:13312
v_exp_f32 v36, v36
v_cvt_pk_bf16_f32 v137, v34, v35
v_max3_f32 v10, v10, v61, v62
s_waitcnt lgkmcnt(6)
v_mfma_f32_32x32x16_bf16 v[144:159], v[208:211], v[128:131], v[144:159]
ds_read_b128 v[208:211], v7 offset:2048
v_exp_f32 v37, v37
v_exp_f32 v38, v38
v_add_f32 v8, v8, v26
v_mfma_f32_32x32x16_bf16 v[160:175], v[212:215], v[128:131], v[160:175]
ds_read_b128 v[212:215], v7 offset:6144
v_exp_f32 v39, v39
v_cvt_pk_bf16_f32 v138, v36, v37
v_max3_f32 v10, v10, v63, v64
s_waitcnt lgkmcnt(6)
v_mfma_f32_32x32x16_bf16 v[176:191], v[216:219], v[128:131], v[176:191]
ds_read_b128 v[216:219], v7 offset:10240
v_exp_f32 v40, v40
v_cvt_pk_bf16_f32 v139, v38, v39
v_max3_f32 v10, v10, v65, v66
v_add_f32 v9, v9, v27
v_mfma_f32_32x32x16_bf16 v[192:207], v[220:223], v[128:131], v[192:207]
ds_read_b128 v[220:223], v7 offset:14336
v_exp_f32 v41, v41
v_max3_f32 v10, v10, v67, v68
v_add_f32 v8, v8, v28
s_waitcnt lgkmcnt(6)
v_mfma_f32_32x32x16_bf16 v[144:159], v[224:227], v[132:135], v[144:159]
ds_read_b128 v[224:227], v7 offset:3072
v_exp_f32 v42, v42
v_exp_f32 v43, v43
v_cvt_pk_bf16_f32 v140, v40, v41
v_max3_f32 v10, v10, v69, v70
v_mfma_f32_32x32x16_bf16 v[160:175], v[228:231], v[132:135], v[160:175]
ds_read_b128 v[228:231], v7 offset:7168
v_exp_f32 v44, v44
v_cvt_pk_bf16_f32 v141, v42, v43
v_max3_f32 v10, v10, v71, v72
s_waitcnt lgkmcnt(6)
v_mfma_f32_32x32x16_bf16 v[176:191], v[232:235], v[132:135], v[176:191]
ds_read_b128 v[232:235], v7 offset:11264
v_exp_f32 v45, v45
v_max3_f32 v10, v10, v73, v74
v_add_f32 v9, v9, v29
v_add_f32 v8, v8, v30
v_mfma_f32_32x32x16_bf16 v[192:207], v[236:239], v[132:135], v[192:207]
s_add_u32 s30, s38, s37
s_add_u32 s38, s38, 0x8000
s_cmp_eq_u32 s38, 0x18000
s_cselect_b32 s38, 0, s38
ds_read_b128 v[236:239], v7 offset:15360
v_exp_f32 v46, v46
v_cvt_pk_bf16_f32 v142, v44, v45
v_max3_f32 v10, v10, v75, v76
s_waitcnt lgkmcnt(6)
v_mfma_f32_32x32x16_bf16 v[144:159], v[208:211], v[136:139], v[144:159]
s_waitcnt vmcnt(8)
s_barrier
v_add_u32 v7, s38, v13
ds_read_b128 v[208:211], v7 offset:16384
v_exp_f32 v47, v47
v_max3_f32 v10, v10, v77, v78
v_mfma_f32_32x32x16_bf16 v[160:175], v[212:215], v[136:139], v[160:175]
ds_read_b128 v[212:215], v7 offset:17408
v_cvt_pk_bf16_f32 v143, v46, v47
v_max_f32 v10, v10, v79
v_add_f32 v9, v9, v31
s_waitcnt lgkmcnt(6)
v_mfma_f32_32x32x16_bf16 v[176:191], v[216:219], v[136:139], v[176:191]
ds_read_b128 v[216:219], v7 offset:18432
v_add_f32 v8, v8, v32
v_add_f32 v9, v9, v33
v_add_f32 v8, v8, v34
v_add_f32 v9, v9, v35
v_mfma_f32_32x32x16_bf16 v[192:207], v[220:223], v[136:139], v[192:207]
ds_read_b128 v[220:223], v7 offset:19456
v_add_f32 v8, v8, v36
v_add_f32 v9, v9, v37
v_cmp_lt_f32 vcc, 0x41000000, v10
s_waitcnt lgkmcnt(6)
v_mfma_f32_32x32x16_bf16 v[144:159], v[224:227], v[140:143], v[144:159]
ds_read_b128 v[224:227], v7 offset:20480
v_add_f32 v8, v8, v38
v_add_f32 v9, v9, v39
v_add_f32 v8, v8, v40
v_add_f32 v9, v9, v41
v_mfma_f32_32x32x16_bf16 v[160:175], v[228:231], v[140:143], v[160:175]
ds_read_b128 v[228:231], v7 offset:21504
v_add_f32 v8, v8, v42
v_add_f32 v9, v9, v43
v_add_f32 v8, v8, v44
s_waitcnt lgkmcnt(6)
v_mfma_f32_32x32x16_bf16 v[176:191], v[232:235], v[140:143], v[176:191]
ds_read_b128 v[232:235], v7 offset:22528
v_add_f32 v9, v9, v45
v_add_f32 v8, v8, v46
v_add_f32 v9, v9, v47
v_mfma_f32_32x32x16_bf16 v[192:207], v[236:239], v[140:143], v[192:207]
s_cbranch_vccnz LatB_rs_5
LatB_rs_5r:
s_cmp_eq_u32 s28, 2
s_cbranch_scc1 LatB_m1
ds_read_b128 v[236:239], v7 offset:23552
v_exp_f32 v48, v48
v_exp_f32 v49, v49
s_waitcnt lgkmcnt(6)
v_mfma_f32_32x32x16_bf16 v[16:31], v[208:211], v[80:83], v[112:127]
ds_read_b128 v[208:211], v7 offset:24576
s_add_u32 m0, s30, 0
s_nop 0
buffer_load_dwordx4 v13, s[8:11], s29 offen offset:0 lds
v_exp_f32 v50, v50
v_cvt_pk_bf16_f32 v128, v48, v49
v_add_f32 v8, v8, v48
v_mfma_f32_32x32x16_bf16 v[16:31], v[212:215], v[84:87], v[16:31]
ds_read_b128 v[212:215], v7 offset:25600
v_exp_f32 v51, v51
v_add_f32 v9, v9, v49
v_add_f32 v8, v8, v50
s_waitcnt lgkmcnt(6)
v_mfma_f32_32x32x16_bf16 v[16:31], v[216:219], v[88:91], v[16:31]
ds_read_b128 v[216:219], v7 offset:26624
buffer_load_dwordx4 v13, s[8:11], s29 offen offset:1024 lds
v_exp_f32 v52, v52
v_cvt_pk_bf16_f32 v129, v50, v51
v_add_f32 v9, v9, v51
v_mfma_f32_32x32x16_bf16 v[16:31], v[220:223], v[92:95], v[16:31]
ds_read_b128 v[220:223], v7 offset:27648
v_exp_f32 v53, v53
v_exp_f32 v54, v54
s_waitcnt lgkmcnt(6)
v_mfma_f32_32x32x16_bf16 v[16:31], v[224:227], v[96:99], v[16:31]
ds_read_b128 v[224:227], v7 offset:28672
buffer_load_dwordx4 v13, s[8:11], s29 offen offset:2048 lds
v_exp_f32 v55, v55
v_cvt_pk_bf16_f32 v130, v52, v53
v_add_f32 v8, v8, v52
v_mfma_f32_32x32x16_bf16 v[16:31], v[228:231], v[100:103], v[16:31]
ds_read_b128 v[228:231], v7 offset:29696
v_exp_f32 v56, v56
v_cvt_pk_bf16_f32 v131, v54, v55
v_add_f32 v9, v9, v53
s_waitcnt lgkmcnt(6)
v_mfma_f32_32x32x16_bf16 v[16:31], v[232:235], v[104:107], v[16:31]
ds_read_b128 v[232:235], v7 offset:30720
buffer_load_dwordx4 v13, s[8:11], s29 offen offset:3072 lds
v_exp_f32 v57, v57
v_add_f32 v8, v8, v54
v_add_f32 v9, v9, v55
v_mfma_f32_32x32x16_bf16 v[16:31], v[236:239], v[108:111], v[16:31]
ds_read_b128 v[236:239], v7 offset:31744
v_exp_f32 v58, v58
v_exp_f32 v59, v59
v_cvt_pk_bf16_f32 v132, v56, v57
s_waitcnt lgkmcnt(6)
v_mfma_f32_32x32x16_bf16 v[32:47], v[208:211], v[80:83], v[112:127]
ds_read_b128 v[208:211], v7 offset:0
s_add_u32 m0, s30, 4096
s_add_u32 s29, s29, 4096
buffer_load_dwordx4 v13, s[8:11], s29 offen offset:0 lds
v_exp_f32 v60, v60
v_cvt_pk_bf16_f32 v133, v58, v59
v_mfma_f32_32x32x16_bf16 v[32:47], v[212:215], v[84:87], v[32:47]
ds_read_b128 v[212:215], v7 offset:4096
v_exp_f32 v61, v61
v_max3_f32 v10, v16, v17, v18
v_add_f32 v8, v8, v56
s_waitcnt lgkmcnt(6)
v_mfma_f32_32x32x16_bf16 v[32:47], v[216:219], v[88:91], v[32:47]
ds_read_b128 v[216:219], v7 offset:8192
buffer_load_dwordx4 v13, s[8:11], s29 offen offset:1024 lds
v_exp_f32 v62, v62
v_cvt_pk_bf16_f32 v134, v60, v61
v_max3_f32 v10, v10, v19, v20
v_mfma_f32_32x32x16_bf16 v[32:47], v[220:223], v[92:95], v[32:47]
ds_read_b128 v[220:223], v7 offset:12288
v_exp_f32 v63, v63
v_max3_f32 v10, v10, v21, v22
v_add_f32 v9, v9, v57
s_waitcnt lgkmcnt(6)
v_mfma_f32_32x32x16_bf16 v[32:47], v[224:227], v[96:99], v[32:47]
ds_read_b128 v[224:227], v7 offset:1024
buffer_load_dwordx4 v13, s[8:11], s29 offen offset:2048 lds
v_exp_f32 v64, v64
v_exp_f32 v65, v65
v_cvt_pk_bf16_f32 v135, v62, v63
v_max3_f32 v10, v10, v23, v24
v_mfma_f32_32x32x16_bf16 v[32:47], v[228:231], v[100:103], v[32:47]
ds_read_b128 v[228:231], v7 offset:5120
v_exp_f32 v66, v66
v_cvt_pk_bf16_f32 v136, v64, v65
v_max3_f32 v10, v10, v25, v26
s_waitcnt lgkmcnt(6)
v_mfma_f32_32x32x16_bf16 v[32:47], v[232:235], v[104:107], v[32:47]
ds_read_b128 v[232:235], v7 offset:9216
buffer_load_dwordx4 v13, s[8:11], s29 offen offset:3072 lds
s_add_u32 s29, s29, 28672
v_exp_f32 v67, v67
v_max3_f32 v10, v10, v27, v28
v_mfma_f32_32x32x16_bf16 v[32:47], v[236:239], v[108:111], v[32:47]
ds_read_b128 v[236:239], v7 offset:13312
v_exp_f32 v68, v68
v_cvt_pk_bf16_f32 v137, v66, v67
v_max3_f32 v10, v10, v29, v30
s_waitcnt lgkmcnt(6)
v_mfma_f32_32x32x16_bf16 v[144:159], v[208:211], v[128:131], v[144:159]
ds_read_b128 v[208:211], v7 offset:2048
v_exp_f32 v69, v69
v_exp_f32 v70, v70
v_add_f32 v8, v8, v58
v_mfma_f32_32x32x16_bf16 v[160:175], v[212:215], v[128:131], v[160:175]
ds_read_b128 v[212:215], v7 offset:6144
v_exp_f32 v71, v71
v_cvt_pk_bf16_f32 v138, v68, v69
v_max3_f32 v10, v10, v31, v32
s_waitcnt lgkmcnt(6)
v_mfma_f32_32x32x16_bf16 v[176:191], v[216:219], v[128:131], v[176:191]
ds_read_b128 v[216:219], v7 offset:10240
v_exp_f32 v72, v72
v_cvt_pk_bf16_f32 v139, v70, v71
v_max3_f32 v10, v10, v33, v34
v_add_f32 v9, v9, v59
v_mfma_f32_32x32x16_bf16 v[192:207], v[220:223], v[128:131], v[192:207]
ds_read_b128 v[220:223], v7 offset:14336
v_exp_f32 v73, v73
v_max3_f32 v10, v10, v35, v36
v_add_f32 v8, v8, v60
s_waitcnt lgkmcnt(6)
v_mfma_f32_32x32x16_bf16 v[144:159], v[224:227], v[132:135], v[144:159]
ds_read_b128 v[224:227], v7 offset:3072
v_exp_f32 v74, v74
v_exp_f32 v75, v75
v_cvt_pk_bf16_f32 v140, v72, v73
v_max3_f32 v10, v10, v37, v38
v_mfma_f32_32x32x16_bf16 v[160:175], v[228:231], v[132:135], v[160:175]
ds_read_b128 v[228:231], v7 offset:7168
v_exp_f32 v76, v76
v_cvt_pk_bf16_f32 v141, v74, v75
v_max3_f32 v10, v10, v39, v40
s_waitcnt lgkmcnt(6)
v_mfma_f32_32x32x16_bf16 v[176:191], v[232:235], v[132:135], v[176:191]
ds_read_b128 v[232:235], v7 offset:11264
v_exp_f32 v77, v77
v_max3_f32 v10, v10, v41, v42
v_add_f32 v9, v9, v61
v_add_f32 v8, v8, v62
v_mfma_f32_32x32x16_bf16 v[192:207], v[236:239], v[132:135], v[192:207]
s_add_u32 s30, s38, s37
s_add_u32 s38, s38, 0x8000
s_cmp_eq_u32 s38, 0x18000
s_cselect_b32 s38, 0, s38
ds_read_b128 v[236:239], v7 offset:15360
v_exp_f32 v78, v78
v_cvt_pk_bf16_f32 v142, v76, v77
v_max3_f32 v10, v10, v43, v44
s_waitcnt lgkmcnt(6)
v_mfma_f32_32x32x16_bf16 v[144:159], v[208:211], v[136:139], v[144:159]
s_waitcnt vmcnt(8)
s_barrier
v_add_u32 v7, s38, v13
ds_read_b128 v[208:211], v7 offset:16384
v_exp_f32 v79, v79
v_max3_f32 v10, v10, v45, v46
v_mfma_f32_32x32x16_bf16 v[160:175], v[212:215], v[136:139], v[160:175]
ds_read_b128 v[212:215], v7 offset:17408
v_cvt_pk_bf16_f32 v143, v78, v79
v_max_f32 v10, v10, v47
v_add_f32 v9, v9, v63
s_waitcnt lgkmcnt(6)
v_mfma_f32_32x32x16_bf16 v[176:191], v[216:219], v[136:139], v[176:191]
ds_read_b128 v[216:219], v7 offset:18432
v_add_f32 v8, v8, v64
v_add_f32 v9, v9, v65
v_add_f32 v8, v8, v66
v_add_f32 v9, v9, v67
v_mfma_f32_32x32x16_bf16 v[192:207], v[220:223], v[136:139], v[192:207]
ds_read_b128 v[220:223], v7 offset:19456
v_add_f32 v8, v8, v68
v_add_f32 v9, v9, v69
v_cmp_lt_f32 vcc, 0x41000000, v10
s_waitcnt lgkmcnt(6)
v_mfma_f32_32x32x16_bf16 v[144:159], v[224:227], v[140:143], v[144:159]
ds_read_b128 v[224:227], v7 offset:20480
v_add_f32 v8, v8, v70
v_add_f32 v9, v9, v71
v_add_f32 v8, v8, v72
v_add_f32 v9, v9, v73
v_mfma_f32_32x32x16_bf16 v[160:175], v[228:231], v[140:143], v[160:175]
ds_read_b128 v[228:231], v7 offset:21504
v_add_f32 v8, v8, v74
v_add_f32 v9, v9, v75
v_add_f32 v8, v8, v76
s_waitcnt lgkmcnt(6)
v_mfma_f32_32x32x16_bf16 v[176:191], v[232:235], v[140:143], v[176:191]
ds_read_b128 v[232:235], v7 offset:22528
v_add_f32 v9, v9, v77
v_add_f32 v8, v8, v78
v_add_f32 v9, v9, v79
v_mfma_f32_32x32x16_bf16 v[192:207], v[236:239], v[140:143], v[192:207]
s_cbranch_vccnz LatB_rs_6
LatB_rs_6r:
s_sub_u32 s28, s28, 2
s_branch LatB_loop
LatB_m0:
v_cmp_le_i32 s[44:45], 0, v11
v_cmp_le_i32 s[46:47], 1, v11
v_cmp_le_i32 s[48:49], 2, v11
v_cmp_le_i32 s[50:51], 3, v11
v_cndmask_b32 v48, v12, v112, s[44:45]
v_cmp_le_i32 s[44:45], 8, v11
v_cndmask_b32 v49, v12, v112, s[46:47]
v_cmp_le_i32 s[46:47], 9, v11
v_cndmask_b32 v50, v12, v112, s[48:49]
v_cmp_le_i32 s[48:49], 10, v11
v_cndmask_b32 v51, v12, v112, s[50:51]
v_cmp_le_i32 s[50:51], 11, v11
v_cndmask_b32 v52, v12, v112, s[44:45]
v_cmp_le_i32 s[44:45], 16, v11
v_cndmask_b32 v53, v12, v112, s[46:47]
v_cmp_le_i32 s[46:47], 17, v11
v_cndmask_b32 v54, v12, v112, s[48:49]
v_cmp_le_i32 s[48:49], 18, v11
v_cndmask_b32 v55, v12, v112, s[50:51]
v_cmp_le_i32 s[50:51], 19, v11
v_cndmask_b32 v56, v12, v112, s[44:45]
v_cmp_le_i32 s[44:45], 24, v11
v_cndmask_b32 v57, v12, v112, s[46:47]
v_cmp_le_i32 s[46:47], 25, v11
v_cndmask_b32 v58, v12, v112, s[48:49]
v_cmp_le_i32 s[48:49], 26, v11
v_cndmask_b32 v59, v12, v112, s[50:51]
v_cmp_le_i32 s[50:51], 27, v11
v_cndmask_b32 v60, v12, v112, s[44:45]
v_cmp_le_i32 s[44:45], 32, v11
v_cndmask_b32 v61, v12, v112, s[46:47]
v_cmp_le_i32 s[46:47], 33, v11
v_cndmask_b32 v62, v12, v112, s[48:49]
v_cmp_le_i32 s[48:49], 34, v11
v_cndmask_b32 v63, v12, v112, s[50:51]
v_cmp_le_i32 s[50:51], 35, v11
v_cndmask_b32 v64, v12, v112, s[44:45]
v_cmp_le_i32 s[44:45], 40, v11
v_cndmask_b32 v65, v12, v112, s[46:47]
v_cmp_le_i32 s[46:47], 41, v11
v_cndmask_b32 v66, v12, v112, s[48:49]
v_cmp_le_i32 s[48:49], 42, v11
v_cndmask_b32 v67, v12, v112, s[50:51]
v_cmp_le_i32 s[50:51], 43, v11
v_cndmask_b32 v68, v12, v112, s[44:45]
v_cmp_le_i32 s[44:45], 48, v11
v_cndmask_b32 v69, v12, v112, s[46:47]
v_cmp_le_i32 s[46:47], 49, v11
v_cndmask_b32 v70, v12, v112, s[48:49]
v_cmp_le_i32 s[48:49], 50, v11
v_cndmask_b32 v71, v12, v112, s[50:51]
v_cmp_le_i32 s[50:51], 51, v11
v_cndmask_b32 v72, v12, v112, s[44:45]
v_cmp_le_i32 s[44:45], 56, v11
v_cndmask_b32 v73, v12, v112, s[46:47]
v_cmp_le_i32 s[46:47], 57, v11
v_cndmask_b32 v74, v12, v112, s[48:49]
v_cmp_le_i32 s[48:49], 58, v11
v_cndmask_b32 v75, v12, v112, s[50:51]
v_cmp_le_i32 s[50:51], 59, v11
v_cndmask_b32 v76, v12, v112, s[44:45]
v_cndmask_b32 v77, v12, v112, s[46:47]
v_cndmask_b32 v78, v12, v112, s[48:49]
v_cndmask_b32 v79, v12, v112, s[50:51]
ds_read_b128 v[236:239], v7 offset:23552
v_exp_f32 v16, v16
v_exp_f32 v17, v17
s_waitcnt lgkmcnt(6)
v_mfma_f32_32x32x16_bf16 v[48:63], v[208:211], v[80:83], v[48:63]
ds_read_b128 v[208:211], v7 offset:24576
s_add_u32 m0, s30, 0
s_nop 0
buffer_load_dwordx4 v13, s[8:11], s29 offen offset:0 lds
v_exp_f32 v18, v18
v_cvt_pk_bf16_f32 v128, v16, v17
v_add_f32 v8, v8, v16
v_mfma_f32_32x32x16_bf16 v[48:63], v[212:215], v[84:87], v[48:63]
ds_read_b128 v[212:215], v7 offset:25600
v_exp_f32 v19, v19
v_add_f32 v9, v9, v17
v_add_f32 v8, v8, v18
s_waitcnt lgkmcnt(6)
v_mfma_f32_32x32x16_bf16 v[48:63], v[216:219], v[88:91], v[48:63]
ds_read_b128 v[216:219], v7 offset:26624
buffer_load_dwordx4 v13, s[8:11], s29 offen offset:1024 lds
v_exp_f32 v20, v20
v_cvt_pk_bf16_f32 v129, v18, v19
v_add_f32 v9, v9, v19
v_mfma_f32_32x32x16_bf16 v[48:63], v[220:223], v[92:95], v[48:63]
ds_read_b128 v[220:223], v7 offset:27648
v_exp_f32 v21, v21
v_exp_f32 v22, v22
s_waitcnt lgkmcnt(6)
v_mfma_f32_32x32x16_bf16 v[48:63], v[224:227], v[96:99], v[48:63]
ds_read_b128 v[224:227], v7 offset:28672
buffer_load_dwordx4 v13, s[8:11], s29 offen offset:2048 lds
v_exp_f32 v23, v23
v_cvt_pk_bf16_f32 v130, v20, v21
v_add_f32 v8, v8, v20
v_mfma_f32_32x32x16_bf16 v[48:63], v[228:231], v[100:103], v[48:63]
ds_read_b128 v[228:231], v7 offset:29696
v_exp_f32 v24, v24
v_cvt_pk_bf16_f32 v131, v22, v23
v_add_f32 v9, v9, v21
s_waitcnt lgkmcnt(6)
v_mfma_f32_32x32x16_bf16 v[48:63], v[232:235], v[104:107], v[48:63]
ds_read_b128 v[232:235], v7 offset:30720
buffer_load_dwordx4 v13, s[8:11], s29 offen offset:3072 lds
v_exp_f32 v25, v25
v_add_f32 v8, v8, v22
v_add_f32 v9, v9, v23
v_mfma_f32_32x32x16_bf16 v[48:63], v[236:239], v[108:111], v[48:63]
ds_read_b128 v[236:239], v7 offset:31744
v_exp_f32 v26, v26
v_exp_f32 v27, v27
v_cvt_pk_bf16_f32 v132, v24, v25
s_waitcnt lgkmcnt(6)
v_mfma_f32_32x32x16_bf16 v[64:79], v[208:211], v[80:83], v[64:79]
ds_read_b128 v[208:211], v7 offset:0
s_add_u32 m0, s30, 4096
s_add_u32 s29, s29, 4096
buffer_load_dwordx4 v13, s[8:11], s29 offen offset:0 lds
v_exp_f32 v28, v28
v_cvt_pk_bf16_f32 v133, v26, v27
v_mfma_f32_32x32x16_bf16 v[64:79], v[212:215], v[84:87], v[64:79]
ds_read_b128 v[212:215], v7 offset:4096
v_exp_f32 v29, v29
v_max3_f32 v10, v48, v49, v50
v_add_f32 v8, v8, v24
s_waitcnt lgkmcnt(6)
v_mfma_f32_32x32x16_bf16 v[64:79], v[216:219], v[88:91], v[64:79]
ds_read_b128 v[216:219], v7 offset:8192
buffer_load_dwordx4 v13, s[8:11], s29 offen offset:1024 lds
v_exp_f32 v30, v30
v_cvt_pk_bf16_f32 v134, v28, v29
v_max3_f32 v10, v10, v51, v52
v_mfma_f32_32x32x16_bf16 v[64:79], v[220:223], v[92:95], v[64:79]
ds_read_b128 v[220:223], v7 offset:12288
v_exp_f32 v31, v31
v_max3_f32 v10, v10, v53, v54
v_add_f32 v9, v9, v25
s_waitcnt lgkmcnt(6)
v_mfma_f32_32x32x16_bf16 v[64:79], v[224:227], v[96:99], v[64:79]
ds_read_b128 v[224:227], v7 offset:1024
buffer_load_dwordx4 v13, s[8:11], s29 offen offset:2048 lds
v_exp_f32 v32, v32
v_exp_f32 v33, v33
v_cvt_pk_bf16_f32 v135, v30, v31
v_max3_f32 v10, v10, v55, v56
v_mfma_f32_32x32x16_bf16 v[64:79], v[228:231], v[100:103], v[64:79]
ds_read_b128 v[228:231], v7 offset:5120
v_exp_f32 v34, v34
v_cvt_pk_bf16_f32 v136, v32, v33
v_max3_f32 v10, v10, v57, v58
s_waitcnt lgkmcnt(6)
v_mfma_f32_32x32x16_bf16 v[64:79], v[232:235], v[104:107], v[64:79]
ds_read_b128 v[232:235], v7 offset:9216
buffer_load_dwordx4 v13, s[8:11], s29 offen offset:3072 lds
s_add_u32 s29, s29, 28672
v_exp_f32 v35, v35
v_max3_f32 v10, v10, v59, v60
v_mfma_f32_32x32x16_bf16 v[64:79], v[236:239], v[108:111], v[64:79]
ds_read_b128 v[236:239], v7 offset:13312
v_exp_f32 v36, v36
v_cvt_pk_bf16_f32 v137, v34, v35
v_max3_f32 v10, v10, v61, v62
s_waitcnt lgkmcnt(6)
v_mfma_f32_32x32x16_bf16 v[144:159], v[208:211], v[128:131], v[144:159]
ds_read_b128 v[208:211], v7 offset:2048
v_exp_f32 v37, v37
v_exp_f32 v38, v38
v_add_f32 v8, v8, v26
v_mfma_f32_32x32x16_bf16 v[160:175], v[212:215], v[128:131], v[160:175]
ds_read_b128 v[212:215], v7 offset:6144
v_exp_f32 v39, v39
v_cvt_pk_bf16_f32 v138, v36, v37
v_max3_f32 v10, v10, v63, v64
s_waitcnt lgkmcnt(6)
v_mfma_f32_32x32x16_bf16 v[176:191], v[216:219], v[128:131], v[176:191]
ds_read_b128 v[216:219], v7 offset:10240
v_exp_f32 v40, v40
v_cvt_pk_bf16_f32 v139, v38, v39
v_max3_f32 v10, v10, v65, v66
v_add_f32 v9, v9, v27
v_mfma_f32_32x32x16_bf16 v[192:207], v[220:223], v[128:131], v[192:207]
ds_read_b128 v[220:223], v7 offset:14336
v_exp_f32 v41, v41
v_max3_f32 v10, v10, v67, v68
v_add_f32 v8, v8, v28
s_waitcnt lgkmcnt(6)
v_mfma_f32_32x32x16_bf16 v[144:159], v[224:227], v[132:135], v[144:159]
ds_read_b128 v[224:227], v7 offset:3072
v_exp_f32 v42, v42
v_exp_f32 v43, v43
v_cvt_pk_bf16_f32 v140, v40, v41
v_max3_f32 v10, v10, v69, v70
v_mfma_f32_32x32x16_bf16 v[160:175], v[228:231], v[132:135], v[160:175]
ds_read_b128 v[228:231], v7 offset:7168
v_exp_f32 v44, v44
v_cvt_pk_bf16_f32 v141, v42, v43
v_max3_f32 v10, v10, v71, v72
s_waitcnt lgkmcnt(6)
v_mfma_f32_32x32x16_bf16 v[176:191], v[232:235], v[132:135], v[176:191]
ds_read_b128 v[232:235], v7 offset:11264
v_exp_f32 v45, v45
v_max3_f32 v10, v10, v73, v74
v_add_f32 v9, v9, v29
v_add_f32 v8, v8, v30
v_mfma_f32_32x32x16_bf16 v[192:207], v[236:239], v[132:135], v[192:207]
s_add_u32 s30, s38, s37
s_add_u32 s38, s38, 0x8000
s_cmp_eq_u32 s38, 0x18000
s_cselect_b32 s38, 0, s38
ds_read_b128 v[236:239], v7 offset:15360
v_exp_f32 v46, v46
v_cvt_pk_bf16_f32 v142, v44, v45
v_max3_f32 v10, v10, v75, v76
s_waitcnt lgkmcnt(6)
v_mfma_f32_32x32x16_bf16 v[144:159], v[208:211], v[136:139], v[144:159]
s_waitcnt vmcnt(8)
s_barrier
v_add_u32 v7, s38, v13
v_exp_f32 v47, v47
v_max3_f32 v10, v10, v77, v78
v_mfma_f32_32x32x16_bf16 v[160:175], v[212:215], v[136:139], v[160:175]
v_cvt_pk_bf16_f32 v143, v46, v47
v_max_f32 v10, v10, v79
v_add_f32 v9, v9, v31
s_waitcnt lgkmcnt(4)
v_mfma_f32_32x32x16_bf16 v[176:191], v[216:219], v[136:139], v[176:191]
v_add_f32 v8, v8, v32
v_add_f32 v9, v9, v33
v_add_f32 v8, v8, v34
v_add_f32 v9, v9, v35
v_mfma_f32_32x32x16_bf16 v[192:207], v[220:223], v[136:139], v[192:207]
v_add_f32 v8, v8, v36
v_add_f32 v9, v9, v37
v_cmp_lt_f32 vcc, 0x41000000, v10
s_waitcnt lgkmcnt(2)
v_mfma_f32_32x32x16_bf16 v[144:159], v[224:227], v[140:143], v[144:159]
v_add_f32 v8, v8, v38
v_add_f32 v9, v9, v39
v_add_f32 v8, v8, v40
v_add_f32 v9, v9, v41
v_mfma_f32_32x32x16_bf16 v[160:175], v[228:231], v[140:143], v[160:175]
v_add_f32 v8, v8, v42
v_add_f32 v9, v9, v43
v_add_f32 v8, v8, v44
s_waitcnt lgkmcnt(0)
v_mfma_f32_32x32x16_bf16 v[176:191], v[232:235], v[140:143], v[176:191]
v_add_f32 v9, v9, v45
v_add_f32 v8, v8, v46
v_add_f32 v9, v9, v47
v_mfma_f32_32x32x16_bf16 v[192:207], v[236:239], v[140:143], v[192:207]
s_cbranch_vccnz LatB_rs_7
LatB_rs_7r:
ds_read_b128 v[208:211], v7 offset:0
ds_read_b128 v[212:215], v7 offset:4096
ds_read_b128 v[216:219], v7 offset:8192
ds_read_b128 v[220:223], v7 offset:12288
ds_read_b128 v[224:227], v7 offset:1024
ds_read_b128 v[228:231], v7 offset:5120
ds_read_b128 v[232:235], v7 offset:9216
v_exp_f32 v48, v48
v_exp_f32 v49, v49
v_exp_f32 v50, v50
v_exp_f32 v51, v51
v_exp_f32 v52, v52
v_exp_f32 v53, v53
v_exp_f32 v54, v54
v_exp_f32 v55, v55
v_cvt_pk_bf16_f32 v128, v48, v49
v_cvt_pk_bf16_f32 v129, v50, v51
v_cvt_pk_bf16_f32 v130, v52, v53
v_cvt_pk_bf16_f32 v131, v54, v55
ds_read_b128 v[236:239], v7 offset:13312
s_add_u32 m0, s30, 0
s_nop 0
buffer_load_dwordx4 v13, s[8:11], s29 offen offset:0 lds
s_waitcnt lgkmcnt(7)
v_mfma_f32_32x32x16_bf16 v[144:159], v[208:211], v[128:131], v[144:159]
v_exp_f32 v56, v56
v_exp_f32 v57, v57
v_exp_f32 v58, v58
v_exp_f32 v59, v59
v_exp_f32 v60, v60
ds_read_b128 v[208:211], v7 offset:2048
buffer_load_dwordx4 v13, s[8:11], s29 offen offset:1024 lds
s_waitcnt lgkmcnt(7)
v_mfma_f32_32x32x16_bf16 v[160:175], v[212:215], v[128:131], v[160:175]
v_exp_f32 v61, v61
v_exp_f32 v62, v62
v_exp_f32 v63, v63
v_cvt_pk_bf16_f32 v132, v56, v57
v_cvt_pk_bf16_f32 v133, v58, v59
ds_read_b128 v[212:215], v7 offset:6144
buffer_load_dwordx4 v13, s[8:11], s29 offen offset:2048 lds
s_waitcnt lgkmcnt(7)
v_mfma_f32_32x32x16_bf16 v[176:191], v[216:219], v[128:131], v[176:191]
v_cvt_pk_bf16_f32 v134, v60, v61
v_cvt_pk_bf16_f32 v135, v62, v63
v_add_f32 v8, v8, v48
v_add_f32 v9, v9, v49
v_add_f32 v8, v8, v50
ds_read_b128 v[216:219], v7 offset:10240
buffer_load_dwordx4 v13, s[8:11], s29 offen offset:3072 lds
s_waitcnt lgkmcnt(7)
v_mfma_f32_32x32x16_bf16 v[192:207], v[220:223], v[128:131], v[192:207]
v_add_f32 v9, v9, v51
v_add_f32 v8, v8, v52
v_add_f32 v9, v9, v53
v_add_f32 v8, v8, v54
v_add_f32 v9, v9, v55
ds_read_b128 v[220:223], v7 offset:14336
s_add_u32 m0, s30, 4096
s_add_u32 s29, s29, 4096
buffer_load_dwordx4 v13, s[8:11], s29 offen offset:0 lds
s_waitcnt lgkmcnt(7)
v_mfma_f32_32x32x16_bf16 v[144:159], v[224:227], v[132:135], v[144:159]
v_exp_f32 v64, v64
v_exp_f32 v65, v65
v_exp_f32 v66, v66
v_exp_f32 v67, v67
v_exp_f32 v68, v68
ds_read_b128 v[224:227], v7 offset:3072
buffer_load_dwordx4 v13, s[8:11], s29 offen offset:1024 lds
s_waitcnt lgkmcnt(7)
v_mfma_f32_32x32x16_bf16 v[160:175], v[228:231], v[132:135], v[160:175]
v_exp_f32 v69, v69
v_exp_f32 v70, v70
v_exp_f32 v71, v71
v_cvt_pk_bf16_f32 v136, v64, v65
v_cvt_pk_bf16_f32 v137, v66, v67
ds_read_b128 v[228:231], v7 offset:7168
buffer_load_dwordx4 v13, s[8:11], s29 offen offset:2048 lds
s_waitcnt lgkmcnt(7)
v_mfma_f32_32x32x16_bf16 v[176:191], v[232:235], v[132:135], v[176:191]
v_cvt_pk_bf16_f32 v138, v68, v69
v_cvt_pk_bf16_f32 v139, v70, v71
v_add_f32 v8, v8, v56
v_add_f32 v9, v9, v57
v_add_f32 v8, v8, v58
ds_read_b128 v[232:235], v7 offset:11264
buffer_load_dwordx4 v13, s[8:11], s29 offen offset:3072 lds
s_add_u32 s29, s29, 28672
s_waitcnt lgkmcnt(7)
v_mfma_f32_32x32x16_bf16 v[192:207], v[236:239], v[132:135], v[192:207]
v_add_f32 v9, v9, v59
v_add_f32 v8, v8, v60
v_add_f32 v9, v9, v61
v_add_f32 v8, v8, v62
v_add_f32 v9, v9, v63
ds_read_b128 v[236:239], v7 offset:15360
s_waitcnt lgkmcnt(7)
v_mfma_f32_32x32x16_bf16 v[144:159], v[208:211], v[136:139], v[144:159]
v_exp_f32 v72, v72
v_exp_f32 v73, v73
v_exp_f32 v74, v74
v_exp_f32 v75, v75
v_exp_f32 v76, v76
s_add_u32 s30, s38, s37
s_add_u32 s38, s38, 0x8000
s_cmp_eq_u32 s38, 0x18000
s_cselect_b32 s38, 0, s38
s_waitcnt vmcnt(8)
s_barrier
s_waitcnt lgkmcnt(6)
v_mfma_f32_32x32x16_bf16 v[160:175], v[212:215], v[136:139], v[160:175]
v_exp_f32 v77, v77
v_exp_f32 v78, v78
v_exp_f32 v79, v79
v_cvt_pk_bf16_f32 v140, v72, v73
v_cvt_pk_bf16_f32 v141, v74, v75
s_mov_b64 exec, s[20:21]
s_add_u32 m0, s53, 0
s_add_u32 s31, s54, 0
buffer_load_dwordx4 v13, s[8:11], s31 offen offset:0 lds
s_add_u32 m0, s53, 0
s_add_u32 s31, s54, 0
buffer_load_dwordx4 v13, s[8:11], s31 offen offset:1024 lds
s_add_u32 m0, s53, 0
s_add_u32 s31, s54, 0
buffer_load_dwordx4 v13, s[8:11], s31 offen offset:2048 lds
s_mov_b64 exec, -1
s_waitcnt lgkmcnt(5)
v_mfma_f32_32x32x16_bf16 v[176:191], v[216:219], v[136:139], v[176:191]
v_cvt_pk_bf16_f32 v142, v76, v77
v_cvt_pk_bf16_f32 v143, v78, v79
v_add_f32 v8, v8, v64
v_add_f32 v9, v9, v65
v_add_f32 v8, v8, v66
s_mov_b64 exec, s[20:21]
s_add_u32 m0, s53, 0
s_add_u32 s31, s54, 0
buffer_load_dwordx4 v13, s[8:11], s31 offen offset:3072 lds
s_add_u32 m0, s53, 4096
s_add_u32 s31, s54, 4096
buffer_load_dwordx4 v13, s[8:11], s31 offen offset:0 lds
s_add_u32 m0, s53, 20480
s_add_u32 s31, s54, 20480
buffer_load_dwordx4 v13, s[8:11], s31 offen offset:0 lds
s_mov_b64 exec, -1
s_waitcnt lgkmcnt(4)
v_mfma_f32_32x32x16_bf16 v[192:207], v[220:223], v[136:139], v[192:207]
v_add_f32 v9, v9, v67
v_add_f32 v8, v8, v68
v_add_f32 v9, v9, v69
v_add_f32 v8, v8, v70
v_add_f32 v9, v9, v71
s_mov_b64 exec, s[20:21]
s_add_u32 m0, s53, 20480
s_add_u32 s31, s54, 20480
buffer_load_dwordx4 v13, s[8:11], s31 offen offset:1024 lds
s_add_u32 m0, s53, 20480
s_add_u32 s31, s54, 20480
buffer_load_dwordx4 v13, s[8:11], s31 offen offset:2048 lds
s_add_u32 m0, s53, 20480
s_add_u32 s31, s54, 20480
buffer_load_dwordx4 v13, s[8:11], s31 offen offset:3072 lds
s_mov_b64 exec, -1
s_waitcnt lgkmcnt(3)
v_mfma_f32_32x32x16_bf16 v[144:159], v[224:227], v[140:143], v[144:159]
v_add_f32 v8, v8, v72
v_add_f32 v9, v9, v73
s_mov_b64 exec, s[20:21]
s_add_u32 m0, s53, 24576
s_add_u32 s31, s54, 24576
buffer_load_dwordx4 v13, s[8:11], s31 offen offset:0 lds
s_add_u32 m0, s53, 40960
s_add_u32 s31, s54, 40960
buffer_load_dwordx4 v13, s[8:11], s31 offen offset:0 lds
s_add_u32 m0, s53, 40960
s_add_u32 s31, s54, 40960
buffer_load_dwordx4 v13, s[8:11], s31 offen offset:1024 lds
s_mov_b64 exec, -1
s_waitcnt lgkmcnt(2)
v_mfma_f32_32x32x16_bf16 v[160:175], v[228:231], v[140:143], v[160:175]
v_add_f32 v8, v8, v74
v_add_f32 v9, v9, v75
s_mov_b64 exec, s[20:21]
s_add_u32 m0, s53, 40960
s_add_u32 s31, s54, 40960
buffer_load_dwordx4 v13, s[8:11], s31 offen offset:2048 lds
s_add_u32 m0, s53, 40960
s_add_u32 s31, s54, 40960
buffer_load_dwordx4 v13, s[8:11], s31 offen offset:3072 lds
s_add_u32 m0, s53, 45056
s_add_u32 s31, s54, 45056
buffer_load_dwordx4 v13, s[8:11], s31 offen offset:0 lds
s_mov_b64 exec, -1
s_waitcnt lgkmcnt(1)
v_mfma_f32_32x32x16_bf16 v[176:191], v[232:235], v[140:143], v[176:191]
v_add_f32 v8, v8, v76
v_add_f32 v9, v9, v77
s_waitcnt lgkmcnt(0)
v_mfma_f32_32x32x16_bf16 v[192:207], v[236:239], v[140:143], v[192:207]
v_add_f32 v8, v8, v78
v_add_f32 v9, v9, v79
s_branch LatB_epi
LatB_m1:
v_cmp_le_i32 s[44:45], 0, v11
v_cmp_le_i32 s[46:47], 1, v11
v_cmp_le_i32 s[48:49], 2, v11
v_cmp_le_i32 s[50:51], 3, v11
v_cndmask_b32 v16, v12, v112, s[44:45]
v_cmp_le_i32 s[44:45], 8, v11
v_cndmask_b32 v17, v12, v112, s[46:47]
v_cmp_le_i32 s[46:47], 9, v11
v_cndmask_b32 v18, v12, v112, s[48:49]
v_cmp_le_i32 s[48:49], 10, v11
v_cndmask_b32 v19, v12, v112, s[50:51]
v_cmp_le_i32 s[50:51], 11, v11
v_cndmask_b32 v20, v12, v112, s[44:45]
v_cmp_le_i32 s[44:45], 16, v11
v_cndmask_b32 v21, v12, v112, s[46:47]
v_cmp_le_i32 s[46:47], 17, v11
v_cndmask_b32 v22, v12, v112, s[48:49]
v_cmp_le_i32 s[48:49], 18, v11
v_cndmask_b32 v23, v12, v112, s[50:51]
v_cmp_le_i32 s[50:51], 19, v11
v_cndmask_b32 v24, v12, v112, s[44:45]
v_cmp_le_i32 s[44:45], 24, v11
v_cndmask_b32 v25, v12, v112, s[46:47]
v_cmp_le_i32 s[46:47], 25, v11
v_cndmask_b32 v26, v12, v112, s[48:49]
v_cmp_le_i32 s[48:49], 26, v11
v_cndmask_b32 v27, v12, v112, s[50:51]
v_cmp_le_i32 s[50:51], 27, v11
v_cndmask_b32 v28, v12, v112, s[44:45]
v_cmp_le_i32 s[44:45], 32, v11
v_cndmask_b32 v29, v12, v112, s[46:47]
v_cmp_le_i32 s[46:47], 33, v11
v_cndmask_b32 v30, v12, v112, s[48:49]
v_cmp_le_i32 s[48:49], 34, v11
v_cndmask_b32 v31, v12, v112, s[50:51]
v_cmp_le_i32 s[50:51], 35, v11
v_cndmask_b32 v32, v12, v112, s[44:45]
v_cmp_le_i32 s[44:45], 40, v11
v_cndmask_b32 v33, v12, v112, s[46:47]
v_cmp_le_i32 s[46:47], 41, v11
v_cndmask_b32 v34, v12, v112, s[48:49]
v_cmp_le_i32 s[48:49], 42, v11
v_cndmask_b32 v35, v12, v112, s[50:51]
v_cmp_le_i32 s[50:51], 43, v11
v_cndmask_b32 v36, v12, v112, s[44:45]
v_cmp_le_i32 s[44:45], 48, v11
v_cndmask_b32 v37, v12, v112, s[46:47]
v_cmp_le_i32 s[46:47], 49, v11
v_cndmask_b32 v38, v12, v112, s[48:49]
v_cmp_le_i32 s[48:49], 50, v11
v_cndmask_b32 v39, v12, v112, s[50:51]
v_cmp_le_i32 s[50:51], 51, v11
v_cndmask_b32 v40, v12, v112, s[44:45]
v_cmp_le_i32 s[44:45], 56, v11
v_cndmask_b32 v41, v12, v112, s[46:47]
v_cmp_le_i32 s[46:47], 57, v11
v_cndmask_b32 v42, v12, v112, s[48:49]
v_cmp_le_i32 s[48:49], 58, v11
v_cndmask_b32 v43, v12, v112, s[50:51]
v_cmp_le_i32 s[50:51], 59, v11
v_cndmask_b32 v44, v12, v112, s[44:45]
v_cndmask_b32 v45, v12, v112, s[46:47]
v_cndmask_b32 v46, v12, v112, s[48:49]
v_cndmask_b32 v47, v12, v112, s[50:51]
ds_read_b128 v[236:239], v7 offset:23552
v_exp_f32 v48, v48
v_exp_f32 v49, v49
s_waitcnt lgkmcnt(6)
v_mfma_f32_32x32x16_bf16 v[16:31], v[208:211], v[80:83], v[16:31]
ds_read_b128 v[208:211], v7 offset:24576
s_add_u32 m0, s30, 0
s_nop 0
buffer_load_dwordx4 v13, s[8:11], s29 offen offset:0 lds
v_exp_f32 v50, v50
v_cvt_pk_bf16_f32 v128, v48, v49
v_add_f32 v8, v8, v48
v_mfma_f32_32x32x16_bf16 v[16:31], v[212:215], v[84:87], v[16:31]
ds_read_b128 v[212:215], v7 offset:25600
v_exp_f32 v51, v51
v_add_f32 v9, v9, v49
v_add_f32 v8, v8, v50
s_waitcnt lgkmcnt(6)
v_mfma_f32_32x32x16_bf16 v[16:31], v[216:219], v[88:91], v[16:31]
ds_read_b128 v[216:219], v7 offset:26624
buffer_load_dwordx4 v13, s[8:11], s29 offen offset:1024 lds
v_exp_f32 v52, v52
v_cvt_pk_bf16_f32 v129, v50, v51
v_add_f32 v9, v9, v51
v_mfma_f32_32x32x16_bf16 v[16:31], v[220:223], v[92:95], v[16:31]
ds_read_b128 v[220:223], v7 offset:27648
v_exp_f32 v53, v53
v_exp_f32 v54, v54
s_waitcnt lgkmcnt(6)
v_mfma_f32_32x32x16_bf16 v[16:31], v[224:227], v[96:99], v[16:31]
ds_read_b128 v[224:227], v7 offset:28672
buffer_load_dwordx4 v13, s[8:11], s29 offen offset:2048 lds
v_exp_f32 v55, v55
v_cvt_pk_bf16_f32 v130, v52, v53
v_add_f32 v8, v8, v52
v_mfma_f32_32x32x16_bf16 v[16:31], v[228:231], v[100:103], v[16:31]
ds_read_b128 v[228:231], v7 offset:29696
v_exp_f32 v56, v56
v_cvt_pk_bf16_f32 v131, v54, v55
v_add_f32 v9, v9, v53
s_waitcnt lgkmcnt(6)
v_mfma_f32_32x32x16_bf16 v[16:31], v[232:235], v[104:107], v[16:31]
ds_read_b128 v[232:235], v7 offset:30720
buffer_load_dwordx4 v13, s[8:11], s29 offen offset:3072 lds
v_exp_f32 v57, v57
v_add_f32 v8, v8, v54
v_add_f32 v9, v9, v55
v_mfma_f32_32x32x16_bf16 v[16:31], v[236:239], v[108:111], v[16:31]
ds_read_b128 v[236:239], v7 offset:31744
v_exp_f32 v58, v58
v_exp_f32 v59, v59
v_cvt_pk_bf16_f32 v132, v56, v57
s_waitcnt lgkmcnt(6)
v_mfma_f32_32x32x16_bf16 v[32:47], v[208:211], v[80:83], v[32:47]
ds_read_b128 v[208:211], v7 offset:0
s_add_u32 m0, s30, 4096
s_add_u32 s29, s29, 4096
buffer_load_dwordx4 v13, s[8:11], s29 offen offset:0 lds
v_exp_f32 v60, v60
v_cvt_pk_bf16_f32 v133, v58, v59
v_mfma_f32_32x32x16_bf16 v[32:47], v[212:215], v[84:87], v[32:47]
ds_read_b128 v[212:215], v7 offset:4096
v_exp_f32 v61, v61
v_max3_f32 v10, v16, v17, v18
v_add_f32 v8, v8, v56
s_waitcnt lgkmcnt(6)
v_mfma_f32_32x32x16_bf16 v[32:47], v[216:219], v[88:91], v[32:47]
ds_read_b128 v[216:219], v7 offset:8192
buffer_load_dwordx4 v13, s[8:11], s29 offen offset:1024 lds
v_exp_f32 v62, v62
v_cvt_pk_bf16_f32 v134, v60, v61
v_max3_f32 v10, v10, v19, v20
v_mfma_f32_32x32x16_bf16 v[32:47], v[220:223], v[92:95], v[32:47]
ds_read_b128 v[220:223], v7 offset:12288
v_exp_f32 v63, v63
v_max3_f32 v10, v10, v21, v22
v_add_f32 v9, v9, v57
s_waitcnt lgkmcnt(6)
v_mfma_f32_32x32x16_bf16 v[32:47], v[224:227], v[96:99], v[32:47]
ds_read_b128 v[224:227], v7 offset:1024
buffer_load_dwordx4 v13, s[8:11], s29 offen offset:2048 lds
v_exp_f32 v64, v64
v_exp_f32 v65, v65
v_cvt_pk_bf16_f32 v135, v62, v63
v_max3_f32 v10, v10, v23, v24
v_mfma_f32_32x32x16_bf16 v[32:47], v[228:231], v[100:103], v[32:47]
ds_read_b128 v[228:231], v7 offset:5120
v_exp_f32 v66, v66
v_cvt_pk_bf16_f32 v136, v64, v65
v_max3_f32 v10, v10, v25, v26
s_waitcnt lgkmcnt(6)
v_mfma_f32_32x32x16_bf16 v[32:47], v[232:235], v[104:107], v[32:47]
ds_read_b128 v[232:235], v7 offset:9216
buffer_load_dwordx4 v13, s[8:11], s29 offen offset:3072 lds
s_add_u32 s29, s29, 28672
v_exp_f32 v67, v67
v_max3_f32 v10, v10, v27, v28
v_mfma_f32_32x32x16_bf16 v[32:47], v[236:239], v[108:111], v[32:47]
ds_read_b128 v[236:239], v7 offset:13312
v_exp_f32 v68, v68
v_cvt_pk_bf16_f32 v137, v66, v67
v_max3_f32 v10, v10, v29, v30
s_waitcnt lgkmcnt(6)
v_mfma_f32_32x32x16_bf16 v[144:159], v[208:211], v[128:131], v[144:159]
ds_read_b128 v[208:211], v7 offset:2048
v_exp_f32 v69, v69
v_exp_f32 v70, v70
v_add_f32 v8, v8, v58
v_mfma_f32_32x32x16_bf16 v[160:175], v[212:215], v[128:131], v[160:175]
ds_read_b128 v[212:215], v7 offset:6144
v_exp_f32 v71, v71
v_cvt_pk_bf16_f32 v138, v68, v69
v_max3_f32 v10, v10, v31, v32
s_waitcnt lgkmcnt(6)
v_mfma_f32_32x32x16_bf16 v[176:191], v[216:219], v[128:131], v[176:191]
ds_read_b128 v[216:219], v7 offset:10240
v_exp_f32 v72, v72
v_cvt_pk_bf16_f32 v139, v70, v71
v_max3_f32 v10, v10, v33, v34
v_add_f32 v9, v9, v59
v_mfma_f32_32x32x16_bf16 v[192:207], v[220:223], v[128:131], v[192:207]
ds_read_b128 v[220:223], v7 offset:14336
v_exp_f32 v73, v73
v_max3_f32 v10, v10, v35, v36
v_add_f32 v8, v8, v60
s_waitcnt lgkmcnt(6)
v_mfma_f32_32x32x16_bf16 v[144:159], v[224:227], v[132:135], v[144:159]
ds_read_b128 v[224:227], v7 offset:3072
v_exp_f32 v74, v74
v_exp_f32 v75, v75
v_cvt_pk_bf16_f32 v140, v72, v73
v_max3_f32 v10, v10, v37, v38
v_mfma_f32_32x32x16_bf16 v[160:175], v[228:231], v[132:135], v[160:175]
ds_read_b128 v[228:231], v7 offset:7168
v_exp_f32 v76, v76
v_cvt_pk_bf16_f32 v141, v74, v75
v_max3_f32 v10, v10, v39, v40
s_waitcnt lgkmcnt(6)
v_mfma_f32_32x32x16_bf16 v[176:191], v[232:235], v[132:135], v[176:191]
ds_read_b128 v[232:235], v7 offset:11264
v_exp_f32 v77, v77
v_max3_f32 v10, v10, v41, v42
v_add_f32 v9, v9, v61
v_add_f32 v8, v8, v62
v_mfma_f32_32x32x16_bf16 v[192:207], v[236:239], v[132:135], v[192:207]
s_add_u32 s30, s38, s37
s_add_u32 s38, s38, 0x8000
s_cmp_eq_u32 s38, 0x18000
s_cselect_b32 s38, 0, s38
ds_read_b128 v[236:239], v7 offset:15360
v_exp_f32 v78, v78
v_cvt_pk_bf16_f32 v142, v76, v77
v_max3_f32 v10, v10, v43, v44
s_waitcnt lgkmcnt(6)
v_mfma_f32_32x32x16_bf16 v[144:159], v[208:211], v[136:139], v[144:159]
s_waitcnt vmcnt(8)
s_barrier
v_add_u32 v7, s38, v13
v_exp_f32 v79, v79
v_max3_f32 v10, v10, v45, v46
v_mfma_f32_32x32x16_bf16 v[160:175], v[212:215], v[136:139], v[160:175]
v_cvt_pk_bf16_f32 v143, v78, v79
v_max_f32 v10, v10, v47
v_add_f32 v9, v9, v63
s_waitcnt lgkmcnt(4)
v_mfma_f32_32x32x16_bf16 v[176:191], v[216:219], v[136:139], v[176:191]
v_add_f32 v8, v8, v64
v_add_f32 v9, v9, v65
v_add_f32 v8, v8, v66
v_add_f32 v9, v9, v67
v_mfma_f32_32x32x16_bf16 v[192:207], v[220:223], v[136:139], v[192:207]
v_add_f32 v8, v8, v68
v_add_f32 v9, v9, v69
v_cmp_lt_f32 vcc, 0x41000000, v10
s_waitcnt lgkmcnt(2)
v_mfma_f32_32x32x16_bf16 v[144:159], v[224:227], v[140:143], v[144:159]
v_add_f32 v8, v8, v70
v_add_f32 v9, v9, v71
v_add_f32 v8, v8, v72
v_add_f32 v9, v9, v73
v_mfma_f32_32x32x16_bf16 v[160:175], v[228:231], v[140:143], v[160:175]
v_add_f32 v8, v8, v74
v_add_f32 v9, v9, v75
v_add_f32 v8, v8, v76
s_waitcnt lgkmcnt(0)
v_mfma_f32_32x32x16_bf16 v[176:191], v[232:235], v[140:143], v[176:191]
v_add_f32 v9, v9, v77
v_add_f32 v8, v8, v78
v_add_f32 v9, v9, v79
v_mfma_f32_32x32x16_bf16 v[192:207], v[236:239], v[140:143], v[192:207]
s_cbranch_vccnz LatB_rs_8
LatB_rs_8r:
LatB_f0:
ds_read_b128 v[208:211], v7 offset:0
ds_read_b128 v[212:215], v7 offset:4096
ds_read_b128 v[216:219], v7 offset:8192
ds_read_b128 v[220:223], v7 offset:12288
ds_read_b128 v[224:227], v7 offset:1024
ds_read_b128 v[228:231], v7 offset:5120
ds_read_b128 v[232:235], v7 offset:9216
v_exp_f32 v16, v16
v_exp_f32 v17, v17
v_exp_f32 v18, v18
v_exp_f32 v19, v19
v_exp_f32 v20, v20
v_exp_f32 v21, v21
v_exp_f32 v22, v22
v_exp_f32 v23, v23
v_cvt_pk_bf16_f32 v128, v16, v17
v_cvt_pk_bf16_f32 v129, v18, v19
v_cvt_pk_bf16_f32 v130, v20, v21
v_cvt_pk_bf16_f32 v131, v22, v23
ds_read_b128 v[236:239], v7 offset:13312
s_add_u32 m0, s30, 0
s_nop 0
buffer_load_dwordx4 v13, s[8:11], s29 offen offset:0 lds
s_waitcnt lgkmcnt(7)
v_mfma_f32_32x32x16_bf16 v[144:159], v[208:211], v[128:131], v[144:159]
v_exp_f32 v24, v24
v_exp_f32 v25, v25
v_exp_f32 v26, v26
v_exp_f32 v27, v27
v_exp_f32 v28, v28
ds_read_b128 v[208:211], v7 offset:2048
buffer_load_dwordx4 v13, s[8:11], s29 offen offset:1024 lds
s_waitcnt lgkmcnt(7)
v_mfma_f32_32x32x16_bf16 v[160:175], v[212:215], v[128:131], v[160:175]
v_exp_f32 v29, v29
v_exp_f32 v30, v30
v_exp_f32 v31, v31
v_cvt_pk_bf16_f32 v132, v24, v25
v_cvt_pk_bf16_f32 v133, v26, v27
ds_read_b128 v[212:215], v7 offset:6144
buffer_load_dwordx4 v13, s[8:11], s29 offen offset:2048 lds
s_waitcnt lgkmcnt(7)
v_mfma_f32_32x32x16_bf16 v[176:191], v[216:219], v[128:131], v[176:191]
v_cvt_pk_bf16_f32 v134, v28, v29
v_cvt_pk_bf16_f32 v135, v30, v31
v_add_f32 v8, v8, v16
v_add_f32 v9, v9, v17
v_add_f32 v8, v8, v18
ds_read_b128 v[216:219], v7 offset:10240
buffer_load_dwordx4 v13, s[8:11], s29 offen offset:3072 lds
s_waitcnt lgkmcnt(7)
v_mfma_f32_32x32x16_bf16 v[192:207], v[220:223], v[128:131], v[192:207]
v_add_f32 v9, v9, v19
v_add_f32 v8, v8, v20
v_add_f32 v9, v9, v21
v_add_f32 v8, v8, v22
v_add_f32 v9, v9, v23
ds_read_b128 v[220:223], v7 offset:14336
s_add_u32 m0, s30, 4096
s_add_u32 s29, s29, 4096
buffer_load_dwordx4 v13, s[8:11], s29 offen offset:0 lds
s_waitcnt lgkmcnt(7)
v_mfma_f32_32x32x16_bf16 v[144:159], v[224:227], v[132:135], v[144:159]
v_exp_f32 v32, v32
v_exp_f32 v33, v33
v_exp_f32 v34, v34
v_exp_f32 v35, v35
v_exp_f32 v36, v36
ds_read_b128 v[224:227], v7 offset:3072
buffer_load_dwordx4 v13, s[8:11], s29 offen offset:1024 lds
s_waitcnt lgkmcnt(7)
v_mfma_f32_32x32x16_bf16 v[160:175], v[228:231], v[132:135], v[160:175]
v_exp_f32 v37, v37
v_exp_f32 v38, v38
v_exp_f32 v39, v39
v_cvt_pk_bf16_f32 v136, v32, v33
v_cvt_pk_bf16_f32 v137, v34, v35
ds_read_b128 v[228:231], v7 offset:7168
buffer_load_dwordx4 v13, s[8:11], s29 offen offset:2048 lds
s_waitcnt lgkmcnt(7)
v_mfma_f32_32x32x16_bf16 v[176:191], v[232:235], v[132:135], v[176:191]
v_cvt_pk_bf16_f32 v138, v36, v37
v_cvt_pk_bf16_f32 v139, v38, v39
v_add_f32 v8, v8, v24
v_add_f32 v9, v9, v25
v_add_f32 v8, v8, v26
ds_read_b128 v[232:235], v7 offset:11264
buffer_load_dwordx4 v13, s[8:11], s29 offen offset:3072 lds
s_add_u32 s29, s29, 28672
s_waitcnt lgkmcnt(7)
v_mfma_f32_32x32x16_bf16 v[192:207], v[236:239], v[132:135], v[192:207]
v_add_f32 v9, v9, v27
v_add_f32 v8, v8, v28
v_add_f32 v9, v9, v29
v_add_f32 v8, v8, v30
v_add_f32 v9, v9, v31
ds_read_b128 v[236:239], v7 offset:15360
s_waitcnt lgkmcnt(7)
v_mfma_f32_32x32x16_bf16 v[144:159], v[208:211], v[136:139], v[144:159]
v_exp_f32 v40, v40
v_exp_f32 v41, v41
v_exp_f32 v42, v42
v_exp_f32 v43, v43
v_exp_f32 v44, v44
s_add_u32 s30, s38, s37
s_add_u32 s38, s38, 0x8000
s_cmp_eq_u32 s38, 0x18000
s_cselect_b32 s38, 0, s38
s_waitcnt vmcnt(8)
s_barrier
s_waitcnt lgkmcnt(6)
v_mfma_f32_32x32x16_bf16 v[160:175], v[212:215], v[136:139], v[160:175]
v_exp_f32 v45, v45
v_exp_f32 v46, v46
v_exp_f32 v47, v47
v_cvt_pk_bf16_f32 v140, v40, v41
v_cvt_pk_bf16_f32 v141, v42, v43
s_mov_b64 exec, s[20:21]
s_add_u32 m0, s53, 0
s_add_u32 s31, s54, 0
buffer_load_dwordx4 v13, s[8:11], s31 offen offset:0 lds
s_add_u32 m0, s53, 0
s_add_u32 s31, s54, 0
buffer_load_dwordx4 v13, s[8:11], s31 offen offset:1024 lds
s_add_u32 m0, s53, 0
s_add_u32 s31, s54, 0
buffer_load_dwordx4 v13, s[8:11], s31 offen offset:2048 lds
s_mov_b64 exec, -1
s_waitcnt lgkmcnt(5)
v_mfma_f32_32x32x16_bf16 v[176:191], v[216:219], v[136:139], v[176:191]
v_cvt_pk_bf16_f32 v142, v44, v45
v_cvt_pk_bf16_f32 v143, v46, v47
v_add_f32 v8, v8, v32
v_add_f32 v9, v9, v33
v_add_f32 v8, v8, v34
s_mov_b64 exec, s[20:21]
s_add_u32 m0, s53, 0
s_add_u32 s31, s54, 0
buffer_load_dwordx4 v13, s[8:11], s31 offen offset:3072 lds
s_add_u32 m0, s53, 4096
s_add_u32 s31, s54, 4096
buffer_load_dwordx4 v13, s[8:11], s31 offen offset:0 lds
s_add_u32 m0, s53, 20480
s_add_u32 s31, s54, 20480
buffer_load_dwordx4 v13, s[8:11], s31 offen offset:0 lds
s_mov_b64 exec, -1
s_waitcnt lgkmcnt(4)
v_mfma_f32_32x32x16_bf16 v[192:207], v[220:223], v[136:139], v[192:207]
v_add_f32 v9, v9, v35
v_add_f32 v8, v8, v36
v_add_f32 v9, v9, v37
v_add_f32 v8, v8, v38
v_add_f32 v9, v9, v39
s_mov_b64 exec, s[20:21]
s_add_u32 m0, s53, 20480
s_add_u32 s31, s54, 20480
buffer_load_dwordx4 v13, s[8:11], s31 offen offset:1024 lds
s_add_u32 m0, s53, 20480
s_add_u32 s31, s54, 20480
buffer_load_dwordx4 v13, s[8:11], s31 offen offset:2048 lds
s_add_u32 m0, s53, 20480
s_add_u32 s31, s54, 20480
buffer_load_dwordx4 v13, s[8:11], s31 offen offset:3072 lds
s_mov_b64 exec, -1
s_waitcnt lgkmcnt(3)
v_mfma_f32_32x32x16_bf16 v[144:159], v[224:227], v[140:143], v[144:159]
v_add_f32 v8, v8, v40
v_add_f32 v9, v9, v41
s_mov_b64 exec, s[20:21]
s_add_u32 m0, s53, 24576
s_add_u32 s31, s54, 24576
buffer_load_dwordx4 v13, s[8:11], s31 offen offset:0 lds
s_add_u32 m0, s53, 40960
s_add_u32 s31, s54, 40960
buffer_load_dwordx4 v13, s[8:11], s31 offen offset:0 lds
s_add_u32 m0, s53, 40960
s_add_u32 s31, s54, 40960
buffer_load_dwordx4 v13, s[8:11], s31 offen offset:1024 lds
s_mov_b64 exec, -1
s_waitcnt lgkmcnt(2)
v_mfma_f32_32x32x16_bf16 v[160:175], v[228:231], v[140:143], v[160:175]
v_add_f32 v8, v8, v42
v_add_f32 v9, v9, v43
s_mov_b64 exec, s[20:21]
s_add_u32 m0, s53, 40960
s_add_u32 s31, s54, 40960
buffer_load_dwordx4 v13, s[8:11], s31 offen offset:2048 lds
s_add_u32 m0, s53, 40960
s_add_u32 s31, s54, 40960
buffer_load_dwordx4 v13, s[8:11], s31 offen offset:3072 lds
s_add_u32 m0, s53, 45056
s_add_u32 s31, s54, 45056
buffer_load_dwordx4 v13, s[8:11], s31 offen offset:0 lds
s_mov_b64 exec, -1
s_waitcnt lgkmcnt(1)
v_mfma_f32_32x32x16_bf16 v[176:191], v[232:235], v[140:143], v[176:191]
v_add_f32 v8, v8, v44
v_add_f32 v9, v9, v45
s_waitcnt lgkmcnt(0)
v_mfma_f32_32x32x16_bf16 v[192:207], v[236:239], v[140:143], v[192:207]
v_add_f32 v8, v8, v46
v_add_f32 v9, v9, v47
s_branch LatB_epi
LatB_rs_5:
v_mov_b32 v14, v10
s_nop 1
v_permlane32_swap_b32 v14, v10
v_max3_f32 v10, v10, v14, 0
v_sub_f32 v14, 0, v10
v_exp_f32 v14, v14
v_sub_f32 v112, v112, v10
v_sub_f32 v113, v113, v10
v_sub_f32 v114, v114, v10
v_sub_f32 v115, v115, v10
v_sub_f32 v116, v116, v10
v_sub_f32 v117, v117, v10
v_sub_f32 v118, v118, v10
v_sub_f32 v119, v119, v10
v_sub_f32 v120, v120, v10
v_sub_f32 v121, v121, v10
v_sub_f32 v122, v122, v10
v_sub_f32 v123, v123, v10
v_sub_f32 v124, v124, v10
v_sub_f32 v125, v125, v10
v_sub_f32 v126, v126, v10
v_sub_f32 v127, v127, v10
v_sub_f32 v48, v48, v10
v_sub_f32 v49, v49, v10
v_sub_f32 v50, v50, v10
v_sub_f32 v51, v51, v10
v_sub_f32 v52, v52, v10
v_sub_f32 v53, v53, v10
v_sub_f32 v54, v54, v10
v_sub_f32 v55, v55, v10
v_sub_f32 v56, v56, v10
v_sub_f32 v57, v57, v10
v_sub_f32 v58, v58, v10
v_sub_f32 v59, v59, v10
v_sub_f32 v60, v60, v10
v_sub_f32 v61, v61, v10
v_sub_f32 v62, v62, v10
v_sub_f32 v63, v63, v10
v_sub_f32 v64, v64, v10
v_sub_f32 v65, v65, v10
v_sub_f32 v66, v66, v10
v_sub_f32 v67, v67, v10
v_sub_f32 v68, v68, v10
v_sub_f32 v69, v69, v10
v_sub_f32 v70, v70, v10
v_sub_f32 v71, v71, v10
v_sub_f32 v72, v72, v10
v_sub_f32 v73, v73, v10
v_sub_f32 v74, v74, v10
v_sub_f32 v75, v75, v10
v_sub_f32 v76, v76, v10
v_sub_f32 v77, v77, v10
v_sub_f32 v78, v78, v10
v_sub_f32 v79, v79, v10
v_mul_f32 v8, v8, v14
v_mul_f32 v9, v9, v14
v_mul_f32 v144, v144, v14
v_mul_f32 v145, v145, v14
v_mul_f32 v146, v146, v14
v_mul_f32 v147, v147, v14
v_mul_f32 v148, v148, v14
v_mul_f32 v149, v149, v14
v_mul_f32 v150, v150, v14
v_mul_f32 v151, v151, v14
v_mul_f32 v152, v152, v14
v_mul_f32 v153, v153, v14
v_mul_f32 v154, v154, v14
v_mul_f32 v155, v155, v14
v_mul_f32 v156, v156, v14
v_mul_f32 v157, v157, v14
v_mul_f32 v158, v158, v14
v_mul_f32 v159, v159, v14
v_mul_f32 v160, v160, v14
v_mul_f32 v161, v161, v14
v_mul_f32 v162, v162, v14
v_mul_f32 v163, v163, v14
v_mul_f32 v164, v164, v14
v_mul_f32 v165, v165, v14
v_mul_f32 v166, v166, v14
v_mul_f32 v167, v167, v14
v_mul_f32 v168, v168, v14
v_mul_f32 v169, v169, v14
v_mul_f32 v170, v170, v14
v_mul_f32 v171, v171, v14
v_mul_f32 v172, v172, v14
v_mul_f32 v173, v173, v14
v_mul_f32 v174, v174, v14
v_mul_f32 v175, v175, v14
v_mul_f32 v176, v176, v14
v_mul_f32 v177, v177, v14
v_mul_f32 v178, v178, v14
v_mul_f32 v179, v179, v14
v_mul_f32 v180, v180, v14
v_mul_f32 v181, v181, v14
v_mul_f32 v182, v182, v14
v_mul_f32 v183, v183, v14
v_mul_f32 v184, v184, v14
v_mul_f32 v185, v185, v14
v_mul_f32 v186, v186, v14
v_mul_f32 v187, v187, v14
v_mul_f32 v188, v188, v14
v_mul_f32 v189, v189, v14
v_mul_f32 v190, v190, v14
v_mul_f32 v191, v191, v14
v_mul_f32 v192, v192, v14
v_mul_f32 v193, v193, v14
v_mul_f32 v194, v194, v14
v_mul_f32 v195, v195, v14
v_mul_f32 v196, v196, v14
v_mul_f32 v197, v197, v14
v_mul_f32 v198, v198, v14
v_mul_f32 v199, v199, v14
v_mul_f32 v200, v200, v14
v_mul_f32 v201, v201, v14
v_mul_f32 v202, v202, v14
v_mul_f32 v203, v203, v14
v_mul_f32 v204, v204, v14
v_mul_f32 v205, v205, v14
v_mul_f32 v206, v206, v14
v_mul_f32 v207, v207, v14
s_nop 1
s_branch LatB_rs_5r
LatB_rs_6:
v_mov_b32 v14, v10
s_nop 1
v_permlane32_swap_b32 v14, v10
v_max3_f32 v10, v10, v14, 0
v_sub_f32 v14, 0, v10
v_exp_f32 v14, v14
v_sub_f32 v112, v112, v10
v_sub_f32 v113, v113, v10
v_sub_f32 v114, v114, v10
v_sub_f32 v115, v115, v10
v_sub_f32 v116, v116, v10
v_sub_f32 v117, v117, v10
v_sub_f32 v118, v118, v10
v_sub_f32 v119, v119, v10
v_sub_f32 v120, v120, v10
v_sub_f32 v121, v121, v10
v_sub_f32 v122, v122, v10
v_sub_f32 v123, v123, v10
v_sub_f32 v124, v124, v10
v_sub_f32 v125, v125, v10
v_sub_f32 v126, v126, v10
v_sub_f32 v127, v127, v10
v_sub_f32 v16, v16, v10
v_sub_f32 v17, v17, v10
v_sub_f32 v18, v18, v10
v_sub_f32 v19, v19, v10
v_sub_f32 v20, v20, v10
v_sub_f32 v21, v21, v10
v_sub_f32 v22, v22, v10
v_sub_f32 v23, v23, v10
v_sub_f32 v24, v24, v10
v_sub_f32 v25, v25, v10
v_sub_f32 v26, v26, v10
v_sub_f32 v27, v27, v10
v_sub_f32 v28, v28, v10
v_sub_f32 v29, v29, v10
v_sub_f32 v30, v30, v10
v_sub_f32 v31, v31, v10
v_sub_f32 v32, v32, v10
v_sub_f32 v33, v33, v10
v_sub_f32 v34, v34, v10
v_sub_f32 v35, v35, v10
v_sub_f32 v36, v36, v10
v_sub_f32 v37, v37, v10
v_sub_f32 v38, v38, v10
v_sub_f32 v39, v39, v10
v_sub_f32 v40, v40, v10
v_sub_f32 v41, v41, v10
v_sub_f32 v42, v42, v10
v_sub_f32 v43, v43, v10
v_sub_f32 v44, v44, v10
v_sub_f32 v45, v45, v10
v_sub_f32 v46, v46, v10
v_sub_f32 v47, v47, v10
v_mul_f32 v8, v8, v14
v_mul_f32 v9, v9, v14
v_mul_f32 v144, v144, v14
v_mul_f32 v145, v145, v14
v_mul_f32 v146, v146, v14
v_mul_f32 v147, v147, v14
v_mul_f32 v148, v148, v14
v_mul_f32 v149, v149, v14
v_mul_f32 v150, v150, v14
v_mul_f32 v151, v151, v14
v_mul_f32 v152, v152, v14
v_mul_f32 v153, v153, v14
v_mul_f32 v154, v154, v14
v_mul_f32 v155, v155, v14
v_mul_f32 v156, v156, v14
v_mul_f32 v157, v157, v14
v_mul_f32 v158, v158, v14
v_mul_f32 v159, v159, v14
v_mul_f32 v160, v160, v14
v_mul_f32 v161, v161, v14
v_mul_f32 v162, v162, v14
v_mul_f32 v163, v163, v14
v_mul_f32 v164, v164, v14
v_mul_f32 v165, v165, v14
v_mul_f32 v166, v166, v14
v_mul_f32 v167, v167, v14
v_mul_f32 v168, v168, v14
v_mul_f32 v169, v169, v14
v_mul_f32 v170, v170, v14
v_mul_f32 v171, v171, v14
v_mul_f32 v172, v172, v14
v_mul_f32 v173, v173, v14
v_mul_f32 v174, v174, v14
v_mul_f32 v175, v175, v14
v_mul_f32 v176, v176, v14
v_mul_f32 v177, v177, v14
v_mul_f32 v178, v178, v14
v_mul_f32 v179, v179, v14
v_mul_f32 v180, v180, v14
v_mul_f32 v181, v181, v14
v_mul_f32 v182, v182, v14
v_mul_f32 v183, v183, v14
v_mul_f32 v184, v184, v14
v_mul_f32 v185, v185, v14
v_mul_f32 v186, v186, v14
v_mul_f32 v187, v187, v14
v_mul_f32 v188, v188, v14
v_mul_f32 v189, v189, v14
v_mul_f32 v190, v190, v14
v_mul_f32 v191, v191, v14
v_mul_f32 v192, v192, v14
v_mul_f32 v193, v193, v14
v_mul_f32 v194, v194, v14
v_mul_f32 v195, v195, v14
v_mul_f32 v196, v196, v14
v_mul_f32 v197, v197, v14
v_mul_f32 v198, v198, v14
v_mul_f32 v199, v199, v14
v_mul_f32 v200, v200, v14
v_mul_f32 v201, v201, v14
v_mul_f32 v202, v202, v14
v_mul_f32 v203, v203, v14
v_mul_f32 v204, v204, v14
v_mul_f32 v205, v205, v14
v_mul_f32 v206, v206, v14
v_mul_f32 v207, v207, v14
s_nop 1
s_branch LatB_rs_6r
LatB_rs_7:
v_mov_b32 v14, v10
s_nop 1
v_permlane32_swap_b32 v14, v10
v_max3_f32 v10, v10, v14, 0
v_sub_f32 v14, 0, v10
v_exp_f32 v14, v14
v_sub_f32 v112, v112, v10
v_sub_f32 v113, v113, v10
v_sub_f32 v114, v114, v10
v_sub_f32 v115, v115, v10
v_sub_f32 v116, v116, v10
v_sub_f32 v117, v117, v10
v_sub_f32 v118, v118, v10
v_sub_f32 v119, v119, v10
v_sub_f32 v120, v120, v10
v_sub_f32 v121, v121, v10
v_sub_f32 v122, v122, v10
v_sub_f32 v123, v123, v10
v_sub_f32 v124, v124, v10
v_sub_f32 v125, v125, v10
v_sub_f32 v126, v126, v10
v_sub_f32 v127, v127, v10
v_sub_f32 v48, v48, v10
v_sub_f32 v49, v49, v10
v_sub_f32 v50, v50, v10
v_sub_f32 v51, v51, v10
v_sub_f32 v52, v52, v10
v_sub_f32 v53, v53, v10
v_sub_f32 v54, v54, v10
v_sub_f32 v55, v55, v10
v_sub_f32 v56, v56, v10
v_sub_f32 v57, v57, v10
v_sub_f32 v58, v58, v10
v_sub_f32 v59, v59, v10
v_sub_f32 v60, v60, v10
v_sub_f32 v61, v61, v10
v_sub_f32 v62, v62, v10
v_sub_f32 v63, v63, v10
v_sub_f32 v64, v64, v10
v_sub_f32 v65, v65, v10
v_sub_f32 v66, v66, v10
v_sub_f32 v67, v67, v10
v_sub_f32 v68, v68, v10
v_sub_f32 v69, v69, v10
v_sub_f32 v70, v70, v10
v_sub_f32 v71, v71, v10
v_sub_f32 v72, v72, v10
v_sub_f32 v73, v73, v10
v_sub_f32 v74, v74, v10
v_sub_f32 v75, v75, v10
v_sub_f32 v76, v76, v10
v_sub_f32 v77, v77, v10
v_sub_f32 v78, v78, v10
v_sub_f32 v79, v79, v10
v_mul_f32 v8, v8, v14
v_mul_f32 v9, v9, v14
v_mul_f32 v144, v144, v14
v_mul_f32 v145, v145, v14
v_mul_f32 v146, v146, v14
v_mul_f32 v147, v147, v14
v_mul_f32 v148, v148, v14
v_mul_f32 v149, v149, v14
v_mul_f32 v150, v150, v14
v_mul_f32 v151, v151, v14
v_mul_f32 v152, v152, v14
v_mul_f32 v153, v153, v14
v_mul_f32 v154, v154, v14
v_mul_f32 v155, v155, v14
v_mul_f32 v156, v156, v14
v_mul_f32 v157, v157, v14
v_mul_f32 v158, v158, v14
v_mul_f32 v159, v159, v14
v_mul_f32 v160, v160, v14
v_mul_f32 v161, v161, v14
v_mul_f32 v162, v162, v14
v_mul_f32 v163, v163, v14
v_mul_f32 v164, v164, v14
v_mul_f32 v165, v165, v14
v_mul_f32 v166, v166, v14
v_mul_f32 v167, v167, v14
v_mul_f32 v168, v168, v14
v_mul_f32 v169, v169, v14
v_mul_f32 v170, v170, v14
v_mul_f32 v171, v171, v14
v_mul_f32 v172, v172, v14
v_mul_f32 v173, v173, v14
v_mul_f32 v174, v174, v14
v_mul_f32 v175, v175, v14
v_mul_f32 v176, v176, v14
v_mul_f32 v177, v177, v14
v_mul_f32 v178, v178, v14
v_mul_f32 v179, v179, v14
v_mul_f32 v180, v180, v14
v_mul_f32 v181, v181, v14
v_mul_f32 v182, v182, v14
v_mul_f32 v183, v183, v14
v_mul_f32 v184, v184, v14
v_mul_f32 v185, v185, v14
v_mul_f32 v186, v186, v14
v_mul_f32 v187, v187, v14
v_mul_f32 v188, v188, v14
v_mul_f32 v189, v189, v14
v_mul_f32 v190, v190, v14
v_mul_f32 v191, v191, v14
v_mul_f32 v192, v192, v14
v_mul_f32 v193, v193, v14
v_mul_f32 v194, v194, v14
v_mul_f32 v195, v195, v14
v_mul_f32 v196, v196, v14
v_mul_f32 v197, v197, v14
v_mul_f32 v198, v198, v14
v_mul_f32 v199, v199, v14
v_mul_f32 v200, v200, v14
v_mul_f32 v201, v201, v14
v_mul_f32 v202, v202, v14
v_mul_f32 v203, v203, v14
v_mul_f32 v204, v204, v14
v_mul_f32 v205, v205, v14
v_mul_f32 v206, v206, v14
v_mul_f32 v207, v207, v14
s_nop 1
s_branch LatB_rs_7r
LatB_rs_8:
v_mov_b32 v14, v10
s_nop 1
v_permlane32_swap_b32 v14, v10
v_max3_f32 v10, v10, v14, 0
v_sub_f32 v14, 0, v10
v_exp_f32 v14, v14
v_sub_f32 v112, v112, v10
v_sub_f32 v113, v113, v10
v_sub_f32 v114, v114, v10
v_sub_f32 v115, v115, v10
v_sub_f32 v116, v116, v10
v_sub_f32 v117, v117, v10
v_sub_f32 v118, v118, v10
v_sub_f32 v119, v119, v10
v_sub_f32 v120, v120, v10
v_sub_f32 v121, v121, v10
v_sub_f32 v122, v122, v10
v_sub_f32 v123, v123, v10
v_sub_f32 v124, v124, v10
v_sub_f32 v125, v125, v10
v_sub_f32 v126, v126, v10
v_sub_f32 v127, v127, v10
v_sub_f32 v16, v16, v10
v_sub_f32 v17, v17, v10
v_sub_f32 v18, v18, v10
v_sub_f32 v19, v19, v10
v_sub_f32 v20, v20, v10
v_sub_f32 v21, v21, v10
v_sub_f32 v22, v22, v10
v_sub_f32 v23, v23, v10
v_sub_f32 v24, v24, v10
v_sub_f32 v25, v25, v10
v_sub_f32 v26, v26, v10
v_sub_f32 v27, v27, v10
v_sub_f32 v28, v28, v10
v_sub_f32 v29, v29, v10
v_sub_f32 v30, v30, v10
v_sub_f32 v31, v31, v10
v_sub_f32 v32, v32, v10
v_sub_f32 v33, v33, v10
v_sub_f32 v34, v34, v10
v_sub_f32 v35, v35, v10
v_sub_f32 v36, v36, v10
v_sub_f32 v37, v37, v10
v_sub_f32 v38, v38, v10
v_sub_f32 v39, v39, v10
v_sub_f32 v40, v40, v10
v_sub_f32 v41, v41, v10
v_sub_f32 v42, v42, v10
v_sub_f32 v43, v43, v10
v_sub_f32 v44, v44, v10
v_sub_f32 v45, v45, v10
v_sub_f32 v46, v46, v10
v_sub_f32 v47, v47, v10
v_mul_f32 v8, v8, v14
v_mul_f32 v9, v9, v14
v_mul_f32 v144, v144, v14
v_mul_f32 v145, v145, v14
v_mul_f32 v146, v146, v14
v_mul_f32 v147, v147, v14
v_mul_f32 v148, v148, v14
v_mul_f32 v149, v149, v14
v_mul_f32 v150, v150, v14
v_mul_f32 v151, v151, v14
v_mul_f32 v152, v152, v14
v_mul_f32 v153, v153, v14
v_mul_f32 v154, v154, v14
v_mul_f32 v155, v155, v14
v_mul_f32 v156, v156, v14
v_mul_f32 v157, v157, v14
v_mul_f32 v158, v158, v14
v_mul_f32 v159, v159, v14
v_mul_f32 v160, v160, v14
v_mul_f32 v161, v161, v14
v_mul_f32 v162, v162, v14
v_mul_f32 v163, v163, v14
v_mul_f32 v164, v164, v14
v_mul_f32 v165, v165, v14
v_mul_f32 v166, v166, v14
v_mul_f32 v167, v167, v14
v_mul_f32 v168, v168, v14
v_mul_f32 v169, v169, v14
v_mul_f32 v170, v170, v14
v_mul_f32 v171, v171, v14
v_mul_f32 v172, v172, v14
v_mul_f32 v173, v173, v14
v_mul_f32 v174, v174, v14
v_mul_f32 v175, v175, v14
v_mul_f32 v176, v176, v14
v_mul_f32 v177, v177, v14
v_mul_f32 v178, v178, v14
v_mul_f32 v179, v179, v14
v_mul_f32 v180, v180, v14
v_mul_f32 v181, v181, v14
v_mul_f32 v182, v182, v14
v_mul_f32 v183, v183, v14
v_mul_f32 v184, v184, v14
v_mul_f32 v185, v185, v14
v_mul_f32 v186, v186, v14
v_mul_f32 v187, v187, v14
v_mul_f32 v188, v188, v14
v_mul_f32 v189, v189, v14
v_mul_f32 v190, v190, v14
v_mul_f32 v191, v191, v14
v_mul_f32 v192, v192, v14
v_mul_f32 v193, v193, v14
v_mul_f32 v194, v194, v14
v_mul_f32 v195, v195, v14
v_mul_f32 v196, v196, v14
v_mul_f32 v197, v197, v14
v_mul_f32 v198, v198, v14
v_mul_f32 v199, v199, v14
v_mul_f32 v200, v200, v14
v_mul_f32 v201, v201, v14
v_mul_f32 v202, v202, v14
v_mul_f32 v203, v203, v14
v_mul_f32 v204, v204, v14
v_mul_f32 v205, v205, v14
v_mul_f32 v206, v206, v14
v_mul_f32 v207, v207, v14
s_nop 1
s_branch LatB_rs_8r
LatB_epi:
s_lshl_b32 s59, s61, 2
v_mov_b32 v6, 0
buffer_load_dword v5, v6, s[16:19], s59 offen sc1
s_cmp_gt_i32 s52, 0
s_cselect_b64 exec, -1, 0
s_sub_u32 s52, s52, 1
s_add_u32 m0, s30, 0
s_nop 0
buffer_load_dwordx4 v13, s[8:11], s29 offen offset:0 lds
buffer_load_dwordx4 v13, s[8:11], s29 offen offset:1024 lds
buffer_load_dwordx4 v13, s[8:11], s29 offen offset:2048 lds
buffer_load_dwordx4 v13, s[8:11], s29 offen offset:3072 lds
s_add_u32 m0, s30, 4096
s_add_u32 s29, s29, 4096
buffer_load_dwordx4 v13, s[8:11], s29 offen offset:0 lds
buffer_load_dwordx4 v13, s[8:11], s29 offen offset:1024 lds
buffer_load_dwordx4 v13, s[8:11], s29 offen offset:2048 lds
buffer_load_dwordx4 v13, s[8:11], s29 offen offset:3072 lds
s_add_u32 s29, s29, 28672
s_mov_b64 exec, -1
v_add_f32 v8, v8, v9
v_mov_b32 v14, v8
s_nop 1
v_permlane32_swap_b32 v14, v8
v_add_f32 v8, v8, v14
v_rcp_f32 v8, v8
s_nop 3
v_mul_f32 v144, v144, v8
v_mul_f32 v145, v145, v8
v_cvt_pk_bf16_f32 v16, v144, v145
v_mul_f32 v146, v146, v8
v_mul_f32 v147, v147, v8
v_cvt_pk_bf16_f32 v17, v146, v147
v_mul_f32 v148, v148, v8
v_mul_f32 v149, v149, v8
v_cvt_pk_bf16_f32 v18, v148, v149
v_mul_f32 v150, v150, v8
v_mul_f32 v151, v151, v8
v_cvt_pk_bf16_f32 v19, v150, v151
v_mul_f32 v152, v152, v8
v_mul_f32 v153, v153, v8
v_cvt_pk_bf16_f32 v20, v152, v153
v_mul_f32 v154, v154, v8
v_mul_f32 v155, v155, v8
v_cvt_pk_bf16_f32 v21, v154, v155
v_mul_f32 v156, v156, v8
v_mul_f32 v157, v157, v8
v_cvt_pk_bf16_f32 v22, v156, v157
v_mul_f32 v158, v158, v8
v_mul_f32 v159, v159, v8
v_cvt_pk_bf16_f32 v23, v158, v159
buffer_store_dwordx4 v[16:19], v1, s[8:11], s36 offen offset:0
buffer_store_dwordx4 v[20:23], v1, s[8:11], s36 offen offset:512
s_add_u32 s36, s36, 4096
v_mul_f32 v160, v160, v8
v_mul_f32 v161, v161, v8
v_cvt_pk_bf16_f32 v24, v160, v161
v_mul_f32 v162, v162, v8
v_mul_f32 v163, v163, v8
v_cvt_pk_bf16_f32 v25, v162, v163
v_mul_f32 v164, v164, v8
v_mul_f32 v165, v165, v8
v_cvt_pk_bf16_f32 v26, v164, v165
v_mul_f32 v166, v166, v8
v_mul_f32 v167, v167, v8
v_cvt_pk_bf16_f32 v27, v166, v167
v_mul_f32 v168, v168, v8
v_mul_f32 v169, v169, v8
v_cvt_pk_bf16_f32 v28, v168, v169
v_mul_f32 v170, v170, v8
v_mul_f32 v171, v171, v8
v_cvt_pk_bf16_f32 v29, v170, v171
v_mul_f32 v172, v172, v8
v_mul_f32 v173, v173, v8
v_cvt_pk_bf16_f32 v30, v172, v173
v_mul_f32 v174, v174, v8
v_mul_f32 v175, v175, v8
v_cvt_pk_bf16_f32 v31, v174, v175
buffer_store_dwordx4 v[24:27], v1, s[8:11], s36 offen offset:0
buffer_store_dwordx4 v[28:31], v1, s[8:11], s36 offen offset:512
s_add_u32 s36, s36, 4096
v_mul_f32 v176, v176, v8
v_mul_f32 v177, v177, v8
v_cvt_pk_bf16_f32 v32, v176, v177
v_mul_f32 v178, v178, v8
v_mul_f32 v179, v179, v8
v_cvt_pk_bf16_f32 v33, v178, v179
v_mul_f32 v180, v180, v8
v_mul_f32 v181, v181, v8
v_cvt_pk_bf16_f32 v34, v180, v181
v_mul_f32 v182, v182, v8
v_mul_f32 v183, v183, v8
v_cvt_pk_bf16_f32 v35, v182, v183
v_mul_f32 v184, v184, v8
v_mul_f32 v185, v185, v8
v_cvt_pk_bf16_f32 v36, v184, v185
v_mul_f32 v186, v186, v8
v_mul_f32 v187, v187, v8
v_cvt_pk_bf16_f32 v37, v186, v187
v_mul_f32 v188, v188, v8
v_mul_f32 v189, v189, v8
v_cvt_pk_bf16_f32 v38, v188, v189
v_mul_f32 v190, v190, v8
v_mul_f32 v191, v191, v8
v_cvt_pk_bf16_f32 v39, v190, v191
buffer_store_dwordx4 v[32:35], v1, s[8:11], s36 offen offset:0
buffer_store_dwordx4 v[36:39], v1, s[8:11], s36 offen offset:512
s_add_u32 s36, s36, 4096
v_mul_f32 v192, v192, v8
v_mul_f32 v193, v193, v8
v_cvt_pk_bf16_f32 v40, v192, v193
v_mul_f32 v194, v194, v8
v_mul_f32 v195, v195, v8
v_cvt_pk_bf16_f32 v41, v194, v195
v_mul_f32 v196, v196, v8
v_mul_f32 v197, v197, v8
v_cvt_pk_bf16_f32 v42, v196, v197
v_mul_f32 v198, v198, v8
v_mul_f32 v199, v199, v8
v_cvt_pk_bf16_f32 v43, v198, v199
v_mul_f32 v200, v200, v8
v_mul_f32 v201, v201, v8
v_cvt_pk_bf16_f32 v44, v200, v201
v_mul_f32 v202, v202, v8
v_mul_f32 v203, v203, v8
v_cvt_pk_bf16_f32 v45, v202, v203
v_mul_f32 v204, v204, v8
v_mul_f32 v205, v205, v8
v_cvt_pk_bf16_f32 v46, v204, v205
v_mul_f32 v206, v206, v8
v_mul_f32 v207, v207, v8
v_cvt_pk_bf16_f32 v47, v206, v207
buffer_store_dwordx4 v[40:43], v1, s[8:11], s36 offen offset:0
buffer_store_dwordx4 v[44:47], v1, s[8:11], s36 offen offset:512
s_cmp_ge_u32 s39, 22
s_cbranch_scc1 LatB_ldt
s_lshl_b32 s62, s61, 2
s_and_b32 s31, s24, 3
s_add_u32 s62, s62, s31
s_mul_i32 s55, s62, 40960
s_add_u32 s55, s55, 44040192
s_mul_i32 s56, s62, 2560
s_add_u32 s56, s56, 79757312
s_mul_i32 s57, s60, 640
s_add_u32 s57, s57, 79691776
s_lshr_b32 s58, s62, 1
s_mul_i32 s58, s58, 54
s_mul_i32 s31, s60, 5
s_add_u32 s58, s58, s31
s_lshl_b32 s58, s58, 12
s_and_b32 s31, s62, 1
s_lshl_b32 s31, s31, 11
s_add_u32 s58, s58, s31
s_add_u32 s58, s58, 47185920
v_and_b32 v3, 31, v2
v_mul_u32_u24 v3, 80, v3
v_lshrrev_b32 v4, 5, v2
v_lshlrev_b32 v4, 4, v4
v_add_u32 v7, 0x18000, v13
s_waitcnt vmcnt(16)
v_readfirstlane_b32 s63, v5
s_cmp_ge_u32 s63, 5
s_cbranch_scc1 LatB_w_ok
s_mov_b32 s62, 8000
LatB_w_sp:
s_sleep 16
buffer_load_dword v5, v6, s[16:19], s59 offen sc1
s_waitcnt vmcnt(0)
v_readfirstlane_b32 s63, v5
s_cmp_ge_u32 s63, 5
s_cbranch_scc1 LatB_w_ok
s_sub_u32 s62, s62, 1
s_cmp_lg_u32 s62, 0
s_cbranch_scc1 LatB_w_sp
LatB_w_ok:
buffer_load_dwordx4 v[96:99], v13, s[8:11], s55 offen offset:0 sc1
buffer_load_dwordx4 v[100:103], v13, s[8:11], s55 offen offset:1024 sc1
buffer_load_dwordx4 v[104:107], v13, s[8:11], s55 offen offset:2048 sc1
buffer_load_dwordx4 v[108:111], v13, s[8:11], s55 offen offset:3072 sc1
buffer_load_dwordx4 v[160:163], v3, s[8:11], s56 offen offset:0 sc1
buffer_load_dwordx4 v[164:167], v3, s[8:11], s56 offen offset:16 sc1
buffer_load_dwordx4 v[168:171], v3, s[8:11], s56 offen offset:32 sc1
buffer_load_dwordx4 v[172:175], v3, s[8:11], s56 offen offset:48 sc1
buffer_load_dwordx4 v[176:179], v3, s[8:11], s56 offen offset:64 sc1
buffer_load_dwordx4 v[112:115], v0, s[8:11], s55 offen offset:0 sc1
buffer_load_dwordx4 v[116:119], v0, s[8:11], s55 offen offset:1024 sc1
buffer_load_dwordx4 v[120:123], v0, s[8:11], s55 offen offset:2048 sc1
buffer_load_dwordx4 v[124:127], v0, s[8:11], s55 offen offset:3072 sc1
s_add_u32 s55, s55, 8192
buffer_load_dwordx4 v[128:131], v13, s[8:11], s55 offen offset:0 sc1
buffer_load_dwordx4 v[132:135], v13, s[8:11], s55 offen offset:1024 sc1
buffer_load_dwordx4 v[136:139], v13, s[8:11], s55 offen offset:2048 sc1
buffer_load_dwordx4 v[140:143], v13, s[8:11], s55 offen offset:3072 sc1
buffer_load_dwordx4 v[144:147], v0, s[8:11], s55 offen offset:0 sc1
buffer_load_dwordx4 v[148:151], v0, s[8:11], s55 offen offset:1024 sc1
buffer_load_dwordx4 v[152:155], v0, s[8:11], s55 offen offset:2048 sc1
buffer_load_dwordx4 v[156:159], v0, s[8:11], s55 offen offset:3072 sc1
s_add_u32 s30, s38, s37
s_add_u32 s38, s38, 0x8000
s_cmp_eq_u32 s38, 0x18000
s_cselect_b32 s38, 0, s38
s_barrier
s_bitcmp1_b32 s27, 1
s_cbranch_scc1 LatB_odd
s_cmp_gt_i32 s52, 0
s_cselect_b64 exec, -1, 0
s_sub_u32 s52, s52, 1
s_add_u32 m0, s30, 0
s_nop 0
buffer_load_dwordx4 v13, s[8:11], s29 offen offset:0 lds
buffer_load_dwordx4 v13, s[8:11], s29 offen offset:1024 lds
buffer_load_dwordx4 v13, s[8:11], s29 offen offset:2048 lds
buffer_load_dwordx4 v13, s[8:11], s29 offen offset:3072 lds
s_add_u32 m0, s30, 4096
s_add_u32 s29, s29, 4096
buffer_load_dwordx4 v13, s[8:11], s29 offen offset:0 lds
buffer_load_dwordx4 v13, s[8:11], s29 offen offset:1024 lds
buffer_load_dwordx4 v13, s[8:11], s29 offen offset:2048 lds
buffer_load_dwordx4 v13, s[8:11], s29 offen offset:3072 lds
s_add_u32 s29, s29, 28672
s_mov_b64 exec, -1
s_add_u32 s30, s38, s37
s_add_u32 s38, s38, 0x8000
s_cmp_eq_u32 s38, 0x18000
s_cselect_b32 s38, 0, s38
s_waitcnt vmcnt(37)
s_barrier
LatB_odd:
s_cmp_gt_i32 s52, 0
s_cselect_b64 exec, -1, 0
s_sub_u32 s52, s52, 1
s_add_u32 m0, s30, 0
s_nop 0
buffer_load_dwordx4 v13, s[8:11], s29 offen offset:0 lds
buffer_load_dwordx4 v13, s[8:11], s29 offen offset:1024 lds
buffer_load_dwordx4 v13, s[8:11], s29 offen offset:2048 lds
buffer_load_dwordx4 v13, s[8:11], s29 offen offset:3072 lds
s_add_u32 m0, s30, 4096
s_add_u32 s29, s29, 4096
buffer_load_dwordx4 v13, s[8:11], s29 offen offset:0 lds
buffer_load_dwordx4 v13, s[8:11], s29 offen offset:1024 lds
buffer_load_dwordx4 v13, s[8:11], s29 offen offset:2048 lds
buffer_load_dwordx4 v13, s[8:11], s29 offen offset:3072 lds
s_add_u32 s29, s29, 28672
s_mov_b64 exec, -1
ds_read_b128 v[208:211], v7 offset:0
ds_read_b128 v[212:215], v7 offset:1024
ds_read_b128 v[216:219], v7 offset:2048
ds_read_b128 v[220:223], v7 offset:3072
ds_read_b128 v[224:227], v7 offset:4096
ds_read_b128 v[228:231], v7 offset:5120
ds_read_b128 v[232:235], v7 offset:6144
s_waitcnt vmcnt(28)
s_waitcnt lgkmcnt(6)
v_mfma_f32_32x32x16_bf16 v[16:31], v[208:211], v[96:99], 0
ds_read_b128 v[236:239], v7 offset:7168
s_waitcnt lgkmcnt(6)
v_mfma_f32_32x32x16_bf16 v[32:47], v[212:215], v[96:99], 0
ds_read_b128 v[208:211], v7 offset:8192
s_waitcnt lgkmcnt(6)
v_mfma_f32_32x32x16_bf16 v[48:63], v[216:219], v[96:99], 0
ds_read_b128 v[212:215], v7 offset:9216
s_waitcnt lgkmcnt(6)
v_mfma_f32_32x32x16_bf16 v[64:79], v[220:223], v[96:99], 0
ds_read_b128 v[216:219], v7 offset:10240
s_waitcnt lgkmcnt(6)
v_mfma_f32_32x32x16_bf16 v[80:95], v[224:227], v[96:99], 0
s_add_u32 s55, s55, 8192
buffer_load_dwordx4 v[96:99], v13, s[8:11], s55 offen offset:0 sc1
ds_read_b128 v[220:223], v7 offset:11264
s_waitcnt vmcnt(28)
s_waitcnt lgkmcnt(6)
v_mfma_f32_32x32x16_bf16 v[16:31], v[228:231], v[100:103], v[16:31]
ds_read_b128 v[224:227], v7 offset:12288
s_waitcnt lgkmcnt(6)
v_mfma_f32_32x32x16_bf16 v[32:47], v[232:235], v[100:103], v[32:47]
ds_read_b128 v[228:231], v7 offset:13312
s_waitcnt lgkmcnt(6)
v_mfma_f32_32x32x16_bf16 v[48:63], v[236:239], v[100:103], v[48:63]
ds_read_b128 v[232:235], v7 offset:14336
s_waitcnt lgkmcnt(6)
v_mfma_f32_32x32x16_bf16 v[64:79], v[208:211], v[100:103], v[64:79]
ds_read_b128 v[236:239], v7 offset:15360
s_waitcnt lgkmcnt(6)
v_mfma_f32_32x32x16_bf16 v[80:95], v[212:215], v[100:103], v[80:95]
buffer_load_dwordx4 v[100:103], v13, s[8:11], s55 offen offset:1024 sc1
ds_read_b128 v[208:211], v7 offset:16384
s_waitcnt vmcnt(28)
s_waitcnt lgkmcnt(6)
v_mfma_f32_32x32x16_bf16 v[16:31], v[216:219], v[104:107], v[16:31]
ds_read_b128 v[212:215], v7 offset:17408
s_waitcnt lgkmcnt(6)
v_mfma_f32_32x32x16_bf16 v[32:47], v[220:223], v[104:107], v[32:47]
ds_read_b128 v[216:219], v7 offset:18432
s_waitcnt lgkmcnt(6)
v_mfma_f32_32x32x16_bf16 v[48:63], v[224:227], v[104:107], v[48:63]
ds_read_b128 v[220:223], v7 offset:19456
s_waitcnt lgkmcnt(6)
v_mfma_f32_32x32x16_bf16 v[64:79], v[228:231], v[104:107], v[64:79]
s_add_u32 s30, s38, s37
s_add_u32 s38, s38, 0x8000
s_cmp_eq_u32 s38, 0x18000
s_cselect_b32 s38, 0, s38
s_waitcnt vmcnt(10)
s_barrier
s_cmp_gt_i32 s52, 0
s_cselect_b64 exec, -1, 0
s_sub_u32 s52, s52, 1
s_add_u32 m0, s30, 0
s_nop 0
buffer_load_dwordx4 v13, s[8:11], s29 offen offset:0 lds
buffer_load_dwordx4 v13, s[8:11], s29 offen offset:1024 lds
buffer_load_dwordx4 v13, s[8:11], s29 offen offset:2048 lds
buffer_load_dwordx4 v13, s[8:11], s29 offen offset:3072 lds
s_add_u32 m0, s30, 4096
s_add_u32 s29, s29, 4096
buffer_load_dwordx4 v13, s[8:11], s29 offen offset:0 lds
buffer_load_dwordx4 v13, s[8:11], s29 offen offset:1024 lds
buffer_load_dwordx4 v13, s[8:11], s29 offen offset:2048 lds
buffer_load_dwordx4 v13, s[8:11], s29 offen offset:3072 lds
s_add_u32 s29, s29, 28672
s_mov_b64 exec, -1
ds_read_b128 v[224:227], v7 offset:20480
s_waitcnt lgkmcnt(6)
v_mfma_f32_32x32x16_bf16 v[80:95], v[232:235], v[104:107], v[80:95]
buffer_load_dwordx4 v[104:107], v13, s[8:11], s55 offen offset:2048 sc1
ds_read_b128 v[228:231], v7 offset:21504
s_waitcnt lgkmcnt(6)
v_mfma_f32_32x32x16_bf16 v[16:31], v[236:239], v[108:111], v[16:31]
ds_read_b128 v[232:235], v7 offset:22528
s_waitcnt lgkmcnt(6)
v_mfma_f32_32x32x16_bf16 v[32:47], v[208:211], v[108:111], v[32:47]
ds_read_b128 v[236:239], v7 offset:23552
s_waitcnt lgkmcnt(6)
v_mfma_f32_32x32x16_bf16 v[48:63], v[212:215], v[108:111], v[48:63]
ds_read_b128 v[208:211], v7 offset:24576
s_waitcnt lgkmcnt(6)
v_mfma_f32_32x32x16_bf16 v[64:79], v[216:219], v[108:111], v[64:79]
ds_read_b128 v[212:215], v7 offset:25600
s_waitcnt lgkmcnt(6)
v_mfma_f32_32x32x16_bf16 v[80:95], v[220:223], v[108:111], v[80:95]
buffer_load_dwordx4 v[108:111], v13, s[8:11], s55 offen offset:3072 sc1
ds_read_b128 v[216:219], v7 offset:26624
s_add_u32 m0, s53, 0
s_add_u32 s31, s54, 61440
buffer_load_dwordx4 v13, s[8:11], s31 offen offset:0 lds
s_waitcnt lgkmcnt(6)
v_mfma_f32_32x32x16_bf16 v[16:31], v[224:227], v[112:115], v[16:31]
ds_read_b128 v[220:223], v7 offset:27648
s_add_u32 m0, s53, 0
s_add_u32 s31, s54, 61440
buffer_load_dwordx4 v13, s[8:11], s31 offen offset:1024 lds
s_waitcnt lgkmcnt(6)
v_mfma_f32_32x32x16_bf16 v[32:47], v[228:231], v[112:115], v[32:47]
ds_read_b128 v[224:227], v7 offset:28672
s_add_u32 m0, s53, 0
s_add_u32 s31, s54, 61440
buffer_load_dwordx4 v13, s[8:11], s31 offen offset:2048 lds
s_waitcnt lgkmcnt(6)
v_mfma_f32_32x32x16_bf16 v[48:63], v[232:235], v[112:115], v[48:63]
ds_read_b128 v[228:231], v7 offset:29696
s_add_u32 m0, s53, 0
s_add_u32 s31, s54, 61440
buffer_load_dwordx4 v13, s[8:11], s31 offen offset:3072 lds
s_waitcnt lgkmcnt(6)
v_mfma_f32_32x32x16_bf16 v[64:79], v[236:239], v[112:115], v[64:79]
ds_read_b128 v[232:235], v7 offset:30720
s_add_u32 m0, s53, 4096
s_add_u32 s31, s54, 65536
buffer_load_dwordx4 v13, s[8:11], s31 offen offset:0 lds
v_add_f32 v160, v160, v162
v_add_f32 v161, v161, v163
s_waitcnt lgkmcnt(6)
v_mfma_f32_32x32x16_bf16 v[80:95], v[208:211], v[112:115], v[80:95]
buffer_load_dwordx4 v[112:115], v0, s[8:11], s55 offen offset:0 sc1
ds_read_b128 v[236:239], v7 offset:31744
v_add_f32 v160, v160, v164
v_add_f32 v161, v161, v165
s_waitcnt lgkmcnt(6)
v_mfma_f32_32x32x16_bf16 v[16:31], v[212:215], v[116:119], v[16:31]
ds_read_b128 v[208:211], v7 offset:32768
v_add_f32 v160, v160, v166
v_add_f32 v161, v161, v167
s_waitcnt lgkmcnt(6)
v_mfma_f32_32x32x16_bf16 v[32:47], v[216:219], v[116:119], v[32:47]
ds_read_b128 v[212:215], v7 offset:33792
v_add_f32 v160, v160, v168
v_add_f32 v161, v161, v169
s_waitcnt lgkmcnt(6)
v_mfma_f32_32x32x16_bf16 v[48:63], v[220:223], v[116:119], v[48:63]
ds_read_b128 v[216:219], v7 offset:34816
v_add_f32 v160, v160, v170
v_add_f32 v161, v161, v171
s_waitcnt lgkmcnt(6)
v_mfma_f32_32x32x16_bf16 v[64:79], v[224:227], v[116:119], v[64:79]
ds_read_b128 v[220:223], v7 offset:35840
v_add_f32 v160, v160, v172
v_add_f32 v161, v161, v173
s_waitcnt lgkmcnt(6)
v_mfma_f32_32x32x16_bf16 v[80:95], v[228:231], v[116:119], v[80:95]
buffer_load_dwordx4 v[116:119], v0, s[8:11], s55 offen offset:1024 sc1
ds_read_b128 v[224:227], v7 offset:36864
v_add_f32 v160, v160, v174
v_add_f32 v161, v161, v175
s_waitcnt lgkmcnt(6)
v_mfma_f32_32x32x16_bf16 v[16:31], v[232:235], v[120:123], v[16:31]
ds_read_b128 v[228:231], v7 offset:37888
v_add_f32 v160, v160, v176
v_add_f32 v161, v161, v177
s_waitcnt lgkmcnt(6)
v_mfma_f32_32x32x16_bf16 v[32:47], v[236:239], v[120:123], v[32:47]
ds_read_b128 v[232:235], v7 offset:38912
v_add_f32 v160, v160, v178
v_add_f32 v161, v161, v179
s_waitcnt lgkmcnt(6)
v_mfma_f32_32x32x16_bf16 v[48:63], v[208:211], v[120:123], v[48:63]
ds_read_b128 v[236:239], v7 offset:39936
v_mul_f32 v240, 0x3acccccd, v160
v_mul_f32 v241, 0x3acccccd, v161
s_waitcnt lgkmcnt(6)
v_mfma_f32_32x32x16_bf16 v[64:79], v[212:215], v[120:123], v[64:79]
s_add_u32 s30, s38, s37
s_add_u32 s38, s38, 0x8000
s_cmp_eq_u32 s38, 0x18000
s_cselect_b32 s38, 0, s38
s_waitcnt vmcnt(19)
s_barrier
s_cmp_gt_i32 s52, 0
s_cselect_b64 exec, -1, 0
s_sub_u32 s52, s52, 1
s_add_u32 m0, s30, 0
s_nop 0
buffer_load_dwordx4 v13, s[8:11], s29 offen offset:0 lds
buffer_load_dwordx4 v13, s[8:11], s29 offen offset:1024 lds
buffer_load_dwordx4 v13, s[8:11], s29 offen offset:2048 lds
buffer_load_dwordx4 v13, s[8:11], s29 offen offset:3072 lds
s_add_u32 m0, s30, 4096
s_add_u32 s29, s29, 4096
buffer_load_dwordx4 v13, s[8:11], s29 offen offset:0 lds
buffer_load_dwordx4 v13, s[8:11], s29 offen offset:1024 lds
buffer_load_dwordx4 v13, s[8:11], s29 offen offset:2048 lds
buffer_load_dwordx4 v13, s[8:11], s29 offen offset:3072 lds
s_add_u32 s29, s29, 28672
s_mov_b64 exec, -1
ds_read_b128 v[208:211], v7 offset:40960
v_fma_f32 v241, -v240, v240, v241
v_max_f32 v241, 0, v241
s_waitcnt lgkmcnt(6)
v_mfma_f32_32x32x16_bf16 v[80:95], v[216:219], v[120:123], v[80:95]
buffer_load_dwordx4 v[120:123], v0, s[8:11], s55 offen offset:2048 sc1
ds_read_b128 v[212:215], v7 offset:41984
v_add_f32 v241, 0x3727c5ac, v241
v_rsq_f32 v244, v241
s_waitcnt lgkmcnt(6)
v_mfma_f32_32x32x16_bf16 v[16:31], v[220:223], v[124:127], v[16:31]
ds_read_b128 v[216:219], v7 offset:43008
v_nop
v_mul_f32 v241, v241, v244
s_waitcnt lgkmcnt(6)
v_mfma_f32_32x32x16_bf16 v[32:47], v[224:227], v[124:127], v[32:47]
ds_read_b128 v[220:223], v7 offset:44032
v_mul_f32 v242, 0xc0135761, v244
v_mul_f32 v243, v244, v244
s_waitcnt lgkmcnt(6)
v_mfma_f32_32x32x16_bf16 v[48:63], v[228:231], v[124:127], v[48:63]
ds_read_b128 v[224:227], v7 offset:45056
v_mul_f32 v243, v243, v244
v_mul_f32 v243, 0xbdd2d3e8, v243
s_waitcnt lgkmcnt(6)
v_mfma_f32_32x32x16_bf16 v[64:79], v[232:235], v[124:127], v[64:79]
ds_read_b128 v[228:231], v7 offset:46080
s_waitcnt lgkmcnt(6)
v_mfma_f32_32x32x16_bf16 v[80:95], v[236:239], v[124:127], v[80:95]
buffer_load_dwordx4 v[124:127], v0, s[8:11], s55 offen offset:3072 sc1
ds_read_b128 v[232:235], v7 offset:47104
s_add_u32 m0, s53, 20480
s_add_u32 s31, s54, 81920
buffer_load_dwordx4 v13, s[8:11], s31 offen offset:0 lds
s_waitcnt lgkmcnt(6)
v_mfma_f32_32x32x16_bf16 v[16:31], v[208:211], v[128:131], v[16:31]
ds_read_b128 v[236:239], v7 offset:48128
s_add_u32 m0, s53, 20480
s_add_u32 s31, s54, 81920
buffer_load_dwordx4 v13, s[8:11], s31 offen offset:1024 lds
s_waitcnt lgkmcnt(6)
v_mfma_f32_32x32x16_bf16 v[32:47], v[212:215], v[128:131], v[32:47]
ds_read_b128 v[208:211], v7 offset:49152
s_add_u32 m0, s53, 20480
s_add_u32 s31, s54, 81920
buffer_load_dwordx4 v13, s[8:11], s31 offen offset:2048 lds
s_waitcnt lgkmcnt(6)
v_mfma_f32_32x32x16_bf16 v[48:63], v[216:219], v[128:131], v[48:63]
ds_read_b128 v[212:215], v7 offset:50176
s_add_u32 m0, s53, 20480
s_add_u32 s31, s54, 81920
buffer_load_dwordx4 v13, s[8:11], s31 offen offset:3072 lds
s_waitcnt lgkmcnt(6)
v_mfma_f32_32x32x16_bf16 v[64:79], v[220:223], v[128:131], v[64:79]
ds_read_b128 v[216:219], v7 offset:51200
s_add_u32 m0, s53, 24576
s_add_u32 s31, s54, 86016
buffer_load_dwordx4 v13, s[8:11], s31 offen offset:0 lds
s_waitcnt lgkmcnt(6)
v_mfma_f32_32x32x16_bf16 v[80:95], v[224:227], v[128:131], v[80:95]
s_add_u32 s55, s55, 8192
buffer_load_dwordx4 v[128:131], v13, s[8:11], s55 offen offset:0 sc1
ds_read_b128 v[220:223], v7 offset:52224
s_waitcnt lgkmcnt(6)
v_mfma_f32_32x32x16_bf16 v[16:31], v[228:231], v[132:135], v[16:31]
ds_read_b128 v[224:227], v7 offset:53248
s_waitcnt lgkmcnt(6)
v_mfma_f32_32x32x16_bf16 v[32:47], v[232:235], v[132:135], v[32:47]
ds_read_b128 v[228:231], v7 offset:54272
s_waitcnt lgkmcnt(6)
v_mfma_f32_32x32x16_bf16 v[48:63], v[236:239], v[132:135], v[48:63]
ds_read_b128 v[232:235], v7 offset:55296
buffer_load_dwordx4 v[160:163], v4, s[8:11], s57 offen offset:256
s_waitcnt lgkmcnt(6)
v_mfma_f32_32x32x16_bf16 v[64:79], v[208:211], v[132:135], v[64:79]
ds_read_b128 v[236:239], v7 offset:56320
buffer_load_dwordx4 v[164:167], v4, s[8:11], s57 offen offset:288
s_waitcnt lgkmcnt(6)
v_mfma_f32_32x32x16_bf16 v[80:95], v[212:215], v[132:135], v[80:95]
buffer_load_dwordx4 v[132:135], v13, s[8:11], s55 offen offset:1024 sc1
ds_read_b128 v[208:211], v7 offset:57344
buffer_load_dwordx4 v[168:171], v4, s[8:11], s57 offen offset:320
s_waitcnt lgkmcnt(6)
v_mfma_f32_32x32x16_bf16 v[16:31], v[216:219], v[136:139], v[16:31]
ds_read_b128 v[212:215], v7 offset:58368
buffer_load_dwordx4 v[172:175], v4, s[8:11], s57 offen offset:352
s_waitcnt lgkmcnt(6)
v_mfma_f32_32x32x16_bf16 v[32:47], v[220:223], v[136:139], v[32:47]
ds_read_b128 v[216:219], v7 offset:59392
buffer_load_dwordx4 v[176:179], v4, s[8:11], s57 offen offset:384
s_waitcnt lgkmcnt(6)
v_mfma_f32_32x32x16_bf16 v[48:63], v[224:227], v[136:139], v[48:63]
ds_read_b128 v[220:223], v7 offset:60416
buffer_load_dwordx4 v[180:183], v4, s[8:11], s57 offen offset:416
s_waitcnt lgkmcnt(6)
v_mfma_f32_32x32x16_bf16 v[64:79], v[228:231], v[136:139], v[64:79]
s_add_u32 s30, s38, s37
s_add_u32 s38, s38, 0x8000
s_cmp_eq_u32 s38, 0x18000
s_cselect_b32 s38, 0, s38
s_waitcnt vmcnt(25)
s_barrier
s_cmp_gt_i32 s52, 0
s_cselect_b64 exec, -1, 0
s_sub_u32 s52, s52, 1
s_add_u32 m0, s30, 0
s_nop 0
buffer_load_dwordx4 v13, s[8:11], s29 offen offset:0 lds
buffer_load_dwordx4 v13, s[8:11], s29 offen offset:1024 lds
buffer_load_dwordx4 v13, s[8:11], s29 offen offset:2048 lds
buffer_load_dwordx4 v13, s[8:11], s29 offen offset:3072 lds
s_add_u32 m0, s30, 4096
s_add_u32 s29, s29, 4096
buffer_load_dwordx4 v13, s[8:11], s29 offen offset:0 lds
buffer_load_dwordx4 v13, s[8:11], s29 offen offset:1024 lds
buffer_load_dwordx4 v13, s[8:11], s29 offen offset:2048 lds
buffer_load_dwordx4 v13, s[8:11], s29 offen offset:3072 lds
s_add_u32 s29, s29, 28672
s_mov_b64 exec, -1
ds_read_b128 v[224:227], v7 offset:0
buffer_load_dwordx4 v[184:187], v4, s[8:11], s57 offen offset:448
s_waitcnt lgkmcnt(6)
v_mfma_f32_32x32x16_bf16 v[80:95], v[232:235], v[136:139], v[80:95]
buffer_load_dwordx4 v[136:139], v13, s[8:11], s55 offen offset:2048 sc1
ds_read_b128 v[228:231], v7 offset:1024
buffer_load_dwordx4 v[188:191], v4, s[8:11], s57 offen offset:480
s_waitcnt lgkmcnt(6)
v_mfma_f32_32x32x16_bf16 v[16:31], v[236:239], v[140:143], v[16:31]
ds_read_b128 v[232:235], v7 offset:2048
buffer_load_dwordx4 v[192:195], v4, s[8:11], s57 offen offset:512
s_waitcnt lgkmcnt(6)
v_mfma_f32_32x32x16_bf16 v[32:47], v[208:211], v[140:143], v[32:47]
ds_read_b128 v[236:239], v7 offset:3072
buffer_load_dwordx4 v[196:199], v4, s[8:11], s57 offen offset:544
s_waitcnt lgkmcnt(6)
v_mfma_f32_32x32x16_bf16 v[48:63], v[212:215], v[140:143], v[48:63]
ds_read_b128 v[208:211], v7 offset:4096
buffer_load_dwordx4 v[200:203], v4, s[8:11], s57 offen offset:576
s_waitcnt lgkmcnt(6)
v_mfma_f32_32x32x16_bf16 v[64:79], v[216:219], v[140:143], v[64:79]
ds_read_b128 v[212:215], v7 offset:5120
buffer_load_dwordx4 v[204:207], v4, s[8:11], s57 offen offset:608
s_waitcnt lgkmcnt(6)
v_mfma_f32_32x32x16_bf16 v[80:95], v[220:223], v[140:143], v[80:95]
buffer_load_dwordx4 v[140:143], v13, s[8:11], s55 offen offset:3072 sc1
ds_read_b128 v[216:219], v7 offset:6144
s_add_u32 m0, s53, 40960
s_add_u32 s31, s54, 102400
buffer_load_dwordx4 v13, s[8:11], s31 offen offset:0 lds
s_waitcnt lgkmcnt(6)
v_mfma_f32_32x32x16_bf16 v[16:31], v[224:227], v[144:147], v[16:31]
ds_read_b128 v[220:223], v7 offset:7168
s_add_u32 m0, s53, 40960
s_add_u32 s31, s54, 102400
buffer_load_dwordx4 v13, s[8:11], s31 offen offset:1024 lds
s_waitcnt lgkmcnt(6)
v_mfma_f32_32x32x16_bf16 v[32:47], v[228:231], v[144:147], v[32:47]
ds_read_b128 v[224:227], v7 offset:8192
s_add_u32 m0, s53, 40960
s_add_u32 s31, s54, 102400
buffer_load_dwordx4 v13, s[8:11], s31 offen offset:2048 lds
s_waitcnt lgkmcnt(6)
v_mfma_f32_32x32x16_bf16 v[48:63], v[232:235], v[144:147], v[48:63]
ds_read_b128 v[228:231], v7 offset:9216
s_add_u32 m0, s53, 40960
s_add_u32 s31, s54, 102400
buffer_load_dwordx4 v13, s[8:11], s31 offen offset:3072 lds
s_waitcnt lgkmcnt(6)
v_mfma_f32_32x32x16_bf16 v[64:79], v[236:239], v[144:147], v[64:79]
ds_read_b128 v[232:235], v7 offset:10240
s_add_u32 m0, s53, 45056
s_add_u32 s31, s54, 106496
buffer_load_dwordx4 v13, s[8:11], s31 offen offset:0 lds
s_waitcnt lgkmcnt(6)
v_mfma_f32_32x32x16_bf16 v[80:95], v[208:211], v[144:147], v[80:95]
buffer_load_dwordx4 v[144:147], v0, s[8:11], s55 offen offset:0 sc1
ds_read_b128 v[236:239], v7 offset:11264
s_waitcnt lgkmcnt(6)
v_mfma_f32_32x32x16_bf16 v[16:31], v[212:215], v[148:151], v[16:31]
ds_read_b128 v[208:211], v7 offset:12288
s_waitcnt lgkmcnt(6)
v_mfma_f32_32x32x16_bf16 v[32:47], v[216:219], v[148:151], v[32:47]
ds_read_b128 v[212:215], v7 offset:13312
s_waitcnt lgkmcnt(6)
v_mfma_f32_32x32x16_bf16 v[48:63], v[220:223], v[148:151], v[48:63]
ds_read_b128 v[216:219], v7 offset:14336
s_waitcnt lgkmcnt(6)
v_mfma_f32_32x32x16_bf16 v[64:79], v[224:227], v[148:151], v[64:79]
ds_read_b128 v[220:223], v7 offset:15360
s_waitcnt lgkmcnt(6)
v_mfma_f32_32x32x16_bf16 v[80:95], v[228:231], v[148:151], v[80:95]
buffer_load_dwordx4 v[148:151], v0, s[8:11], s55 offen offset:1024 sc1
ds_read_b128 v[224:227], v7 offset:16384
s_waitcnt lgkmcnt(6)
v_mfma_f32_32x32x16_bf16 v[16:31], v[232:235], v[152:155], v[16:31]
ds_read_b128 v[228:231], v7 offset:17408
s_waitcnt lgkmcnt(6)
v_mfma_f32_32x32x16_bf16 v[32:47], v[236:239], v[152:155], v[32:47]
ds_read_b128 v[232:235], v7 offset:18432
s_waitcnt lgkmcnt(6)
v_mfma_f32_32x32x16_bf16 v[48:63], v[208:211], v[152:155], v[48:63]
ds_read_b128 v[236:239], v7 offset:19456
s_waitcnt lgkmcnt(6)
v_mfma_f32_32x32x16_bf16 v[64:79], v[212:215], v[152:155], v[64:79]
s_add_u32 s30, s38, s37
s_add_u32 s38, s38, 0x8000
s_cmp_eq_u32 s38, 0x18000
s_cselect_b32 s38, 0, s38
s_waitcnt vmcnt(31)
s_barrier
s_cmp_gt_i32 s52, 0
s_cselect_b64 exec, -1, 0
s_sub_u32 s52, s52, 1
s_add_u32 m0, s30, 0
s_nop 0
buffer_load_dwordx4 v13, s[8:11], s29 offen offset:0 lds
buffer_load_dwordx4 v13, s[8:11], s29 offen offset:1024 lds
buffer_load_dwordx4 v13, s[8:11], s29 offen offset:2048 lds
buffer_load_dwordx4 v13, s[8:11], s29 offen offset:3072 lds
s_add_u32 m0, s30, 4096
s_add_u32 s29, s29, 4096
buffer_load_dwordx4 v13, s[8:11], s29 offen offset:0 lds
buffer_load_dwordx4 v13, s[8:11], s29 offen offset:1024 lds
buffer_load_dwordx4 v13, s[8:11], s29 offen offset:2048 lds
buffer_load_dwordx4 v13, s[8:11], s29 offen offset:3072 lds
s_add_u32 s29, s29, 28672
s_mov_b64 exec, -1
ds_read_b128 v[208:211], v7 offset:20480
s_waitcnt lgkmcnt(6)
v_mfma_f32_32x32x16_bf16 v[80:95], v[216:219], v[152:155], v[80:95]
buffer_load_dwordx4 v[152:155], v0, s[8:11], s55 offen offset:2048 sc1
ds_read_b128 v[212:215], v7 offset:21504
s_waitcnt lgkmcnt(6)
v_mfma_f32_32x32x16_bf16 v[16:31], v[220:223], v[156:159], v[16:31]
ds_read_b128 v[216:219], v7 offset:22528
s_waitcnt lgkmcnt(6)
v_mfma_f32_32x32x16_bf16 v[32:47], v[224:227], v[156:159], v[32:47]
ds_read_b128 v[220:223], v7 offset:23552
s_waitcnt lgkmcnt(6)
v_mfma_f32_32x32x16_bf16 v[48:63], v[228:231], v[156:159], v[48:63]
ds_read_b128 v[224:227], v7 offset:24576
s_waitcnt lgkmcnt(6)
v_mfma_f32_32x32x16_bf16 v[64:79], v[232:235], v[156:159], v[64:79]
ds_read_b128 v[228:231], v7 offset:25600
s_waitcnt lgkmcnt(6)
v_mfma_f32_32x32x16_bf16 v[80:95], v[236:239], v[156:159], v[80:95]
buffer_load_dwordx4 v[156:159], v0, s[8:11], s55 offen offset:3072 sc1
ds_read_b128 v[232:235], v7 offset:26624
s_add_u32 m0, s53, 0
s_add_u32 s31, s54, 122880
buffer_load_dwordx4 v13, s[8:11], s31 offen offset:0 lds
s_waitcnt lgkmcnt(6)
v_mfma_f32_32x32x16_bf16 v[16:31], v[208:211], v[96:99], v[16:31]
ds_read_b128 v[236:239], v7 offset:27648
s_add_u32 m0, s53, 0
s_add_u32 s31, s54, 122880
buffer_load_dwordx4 v13, s[8:11], s31 offen offset:1024 lds
s_waitcnt lgkmcnt(6)
v_mfma_f32_32x32x16_bf16 v[32:47], v[212:215], v[96:99], v[32:47]
ds_read_b128 v[208:211], v7 offset:28672
s_add_u32 m0, s53, 0
s_add_u32 s31, s54, 122880
buffer_load_dwordx4 v13, s[8:11], s31 offen offset:2048 lds
s_waitcnt lgkmcnt(6)
v_mfma_f32_32x32x16_bf16 v[48:63], v[216:219], v[96:99], v[48:63]
ds_read_b128 v[212:215], v7 offset:29696
s_add_u32 m0, s53, 0
s_add_u32 s31, s54, 122880
buffer_load_dwordx4 v13, s[8:11], s31 offen offset:3072 lds
s_waitcnt lgkmcnt(6)
v_mfma_f32_32x32x16_bf16 v[64:79], v[220:223], v[96:99], v[64:79]
ds_read_b128 v[216:219], v7 offset:30720
s_add_u32 m0, s53, 4096
s_add_u32 s31, s54, 126976
buffer_load_dwordx4 v13, s[8:11], s31 offen offset:0 lds
s_waitcnt lgkmcnt(6)
v_mfma_f32_32x32x16_bf16 v[80:95], v[224:227], v[96:99], v[80:95]
s_add_u32 s55, s55, 8192
buffer_load_dwordx4 v[96:99], v13, s[8:11], s55 offen offset:0 sc1
ds_read_b128 v[220:223], v7 offset:31744
s_waitcnt lgkmcnt(6)
v_mfma_f32_32x32x16_bf16 v[16:31], v[228:231], v[100:103], v[16:31]
ds_read_b128 v[224:227], v7 offset:32768
s_waitcnt lgkmcnt(6)
v_mfma_f32_32x32x16_bf16 v[32:47], v[232:235], v[100:103], v[32:47]
ds_read_b128 v[228:231], v7 offset:33792
s_waitcnt lgkmcnt(6)
v_mfma_f32_32x32x16_bf16 v[48:63], v[236:239], v[100:103], v[48:63]
ds_read_b128 v[232:235], v7 offset:34816
s_waitcnt lgkmcnt(6)
v_mfma_f32_32x32x16_bf16 v[64:79], v[208:211], v[100:103], v[64:79]
ds_read_b128 v[236:239], v7 offset:35840
s_waitcnt lgkmcnt(6)
v_mfma_f32_32x32x16_bf16 v[80:95], v[212:215], v[100:103], v[80:95]
buffer_load_dwordx4 v[100:103], v13, s[8:11], s55 offen offset:1024 sc1
ds_read_b128 v[208:211], v7 offset:36864
s_waitcnt lgkmcnt(6)
v_mfma_f32_32x32x16_bf16 v[16:31], v[216:219], v[104:107], v[16:31]
ds_read_b128 v[212:215], v7 offset:37888
s_waitcnt lgkmcnt(6)
v_mfma_f32_32x32x16_bf16 v[32:47], v[220:223], v[104:107], v[32:47]
ds_read_b128 v[216:219], v7 offset:38912
s_waitcnt lgkmcnt(6)
v_mfma_f32_32x32x16_bf16 v[48:63], v[224:227], v[104:107], v[48:63]
ds_read_b128 v[220:223], v7 offset:39936
s_waitcnt lgkmcnt(6)
v_mfma_f32_32x32x16_bf16 v[64:79], v[228:231], v[104:107], v[64:79]
s_add_u32 s30, s38, s37
s_add_u32 s38, s38, 0x8000
s_cmp_eq_u32 s38, 0x18000
s_cselect_b32 s38, 0, s38
s_waitcnt vmcnt(19)
s_barrier
s_cmp_gt_i32 s52, 0
s_cselect_b64 exec, -1, 0
s_sub_u32 s52, s52, 1
s_add_u32 m0, s30, 0
s_nop 0
buffer_load_dwordx4 v13, s[8:11], s29 offen offset:0 lds
buffer_load_dwordx4 v13, s[8:11], s29 offen offset:1024 lds
buffer_load_dwordx4 v13, s[8:11], s29 offen offset:2048 lds
buffer_load_dwordx4 v13, s[8:11], s29 offen offset:3072 lds
s_add_u32 m0, s30, 4096
s_add_u32 s29, s29, 4096
buffer_load_dwordx4 v13, s[8:11], s29 offen offset:0 lds
buffer_load_dwordx4 v13, s[8:11], s29 offen offset:1024 lds
buffer_load_dwordx4 v13, s[8:11], s29 offen offset:2048 lds
buffer_load_dwordx4 v13, s[8:11], s29 offen offset:3072 lds
s_add_u32 s29, s29, 28672
s_mov_b64 exec, -1
ds_read_b128 v[224:227], v7 offset:40960
s_waitcnt lgkmcnt(6)
v_mfma_f32_32x32x16_bf16 v[80:95], v[232:235], v[104:107], v[80:95]
buffer_load_dwordx4 v[104:107], v13, s[8:11], s55 offen offset:2048 sc1
ds_read_b128 v[228:231], v7 offset:41984
s_waitcnt lgkmcnt(6)
v_mfma_f32_32x32x16_bf16 v[16:31], v[236:239], v[108:111], v[16:31]
ds_read_b128 v[232:235], v7 offset:43008
s_waitcnt lgkmcnt(6)
v_mfma_f32_32x32x16_bf16 v[32:47], v[208:211], v[108:111], v[32:47]
ds_read_b128 v[236:239], v7 offset:44032
s_waitcnt lgkmcnt(6)
v_mfma_f32_32x32x16_bf16 v[48:63], v[212:215], v[108:111], v[48:63]
ds_read_b128 v[208:211], v7 offset:45056
s_waitcnt lgkmcnt(6)
v_mfma_f32_32x32x16_bf16 v[64:79], v[216:219], v[108:111], v[64:79]
ds_read_b128 v[212:215], v7 offset:46080
s_waitcnt lgkmcnt(6)
v_mfma_f32_32x32x16_bf16 v[80:95], v[220:223], v[108:111], v[80:95]
buffer_load_dwordx4 v[108:111], v13, s[8:11], s55 offen offset:3072 sc1
ds_read_b128 v[216:219], v7 offset:47104
s_add_u32 m0, s53, 20480
s_add_u32 s31, s54, 143360
buffer_load_dwordx4 v13, s[8:11], s31 offen offset:0 lds
s_waitcnt lgkmcnt(6)
v_mfma_f32_32x32x16_bf16 v[16:31], v[224:227], v[112:115], v[16:31]
ds_read_b128 v[220:223], v7 offset:48128
s_add_u32 m0, s53, 20480
s_add_u32 s31, s54, 143360
buffer_load_dwordx4 v13, s[8:11], s31 offen offset:1024 lds
s_waitcnt lgkmcnt(6)
v_mfma_f32_32x32x16_bf16 v[32:47], v[228:231], v[112:115], v[32:47]
ds_read_b128 v[224:227], v7 offset:49152
s_add_u32 m0, s53, 20480
s_add_u32 s31, s54, 143360
buffer_load_dwordx4 v13, s[8:11], s31 offen offset:2048 lds
s_waitcnt lgkmcnt(6)
v_mfma_f32_32x32x16_bf16 v[48:63], v[232:235], v[112:115], v[48:63]
ds_read_b128 v[228:231], v7 offset:50176
s_add_u32 m0, s53, 20480
s_add_u32 s31, s54, 143360
buffer_load_dwordx4 v13, s[8:11], s31 offen offset:3072 lds
s_waitcnt lgkmcnt(6)
v_mfma_f32_32x32x16_bf16 v[64:79], v[236:239], v[112:115], v[64:79]
ds_read_b128 v[232:235], v7 offset:51200
s_add_u32 m0, s53, 24576
s_add_u32 s31, s54, 147456
buffer_load_dwordx4 v13, s[8:11], s31 offen offset:0 lds
s_waitcnt lgkmcnt(6)
v_mfma_f32_32x32x16_bf16 v[80:95], v[208:211], v[112:115], v[80:95]
buffer_load_dwordx4 v[112:115], v0, s[8:11], s55 offen offset:0 sc1
ds_read_b128 v[236:239], v7 offset:52224
s_waitcnt lgkmcnt(6)
v_mfma_f32_32x32x16_bf16 v[16:31], v[212:215], v[116:119], v[16:31]
ds_read_b128 v[208:211], v7 offset:53248
s_waitcnt lgkmcnt(6)
v_mfma_f32_32x32x16_bf16 v[32:47], v[216:219], v[116:119], v[32:47]
ds_read_b128 v[212:215], v7 offset:54272
s_waitcnt lgkmcnt(6)
v_mfma_f32_32x32x16_bf16 v[48:63], v[220:223], v[116:119], v[48:63]
ds_read_b128 v[216:219], v7 offset:55296
s_waitcnt lgkmcnt(6)
v_mfma_f32_32x32x16_bf16 v[64:79], v[224:227], v[116:119], v[64:79]
ds_read_b128 v[220:223], v7 offset:56320
s_waitcnt lgkmcnt(6)
v_mfma_f32_32x32x16_bf16 v[80:95], v[228:231], v[116:119], v[80:95]
buffer_load_dwordx4 v[116:119], v0, s[8:11], s55 offen offset:1024 sc1
ds_read_b128 v[224:227], v7 offset:57344
s_waitcnt lgkmcnt(6)
v_mfma_f32_32x32x16_bf16 v[16:31], v[232:235], v[120:123], v[16:31]
ds_read_b128 v[228:231], v7 offset:58368
s_waitcnt lgkmcnt(6)
v_mfma_f32_32x32x16_bf16 v[32:47], v[236:239], v[120:123], v[32:47]
ds_read_b128 v[232:235], v7 offset:59392
s_waitcnt lgkmcnt(6)
v_mfma_f32_32x32x16_bf16 v[48:63], v[208:211], v[120:123], v[48:63]
ds_read_b128 v[236:239], v7 offset:60416
s_waitcnt lgkmcnt(6)
v_mfma_f32_32x32x16_bf16 v[64:79], v[212:215], v[120:123], v[64:79]
s_add_u32 s30, s38, s37
s_add_u32 s38, s38, 0x8000
s_cmp_eq_u32 s38, 0x18000
s_cselect_b32 s38, 0, s38
s_waitcnt vmcnt(19)
s_barrier
s_cmp_gt_i32 s52, 0
s_cselect_b64 exec, -1, 0
s_sub_u32 s52, s52, 1
s_add_u32 m0, s30, 0
s_nop 0
buffer_load_dwordx4 v13, s[8:11], s29 offen offset:0 lds
buffer_load_dwordx4 v13, s[8:11], s29 offen offset:1024 lds
buffer_load_dwordx4 v13, s[8:11], s29 offen offset:2048 lds
buffer_load_dwordx4 v13, s[8:11], s29 offen offset:3072 lds
s_add_u32 m0, s30, 4096
s_add_u32 s29, s29, 4096
buffer_load_dwordx4 v13, s[8:11], s29 offen offset:0 lds
buffer_load_dwordx4 v13, s[8:11], s29 offen offset:1024 lds
buffer_load_dwordx4 v13, s[8:11], s29 offen offset:2048 lds
buffer_load_dwordx4 v13, s[8:11], s29 offen offset:3072 lds
s_add_u32 s29, s29, 28672
s_mov_b64 exec, -1
ds_read_b128 v[208:211], v7 offset:0
s_waitcnt lgkmcnt(6)
v_mfma_f32_32x32x16_bf16 v[80:95], v[216:219], v[120:123], v[80:95]
buffer_load_dwordx4 v[120:123], v0, s[8:11], s55 offen offset:2048 sc1
ds_read_b128 v[212:215], v7 offset:1024
s_waitcnt lgkmcnt(6)
v_mfma_f32_32x32x16_bf16 v[16:31], v[220:223], v[124:127], v[16:31]
ds_read_b128 v[216:219], v7 offset:2048
s_waitcnt lgkmcnt(6)
v_mfma_f32_32x32x16_bf16 v[32:47], v[224:227], v[124:127], v[32:47]
ds_read_b128 v[220:223], v7 offset:3072
s_waitcnt lgkmcnt(6)
v_mfma_f32_32x32x16_bf16 v[48:63], v[228:231], v[124:127], v[48:63]
ds_read_b128 v[224:227], v7 offset:4096
s_waitcnt lgkmcnt(6)
v_mfma_f32_32x32x16_bf16 v[64:79], v[232:235], v[124:127], v[64:79]
ds_read_b128 v[228:231], v7 offset:5120
s_waitcnt lgkmcnt(6)
v_mfma_f32_32x32x16_bf16 v[80:95], v[236:239], v[124:127], v[80:95]
buffer_load_dwordx4 v[124:127], v0, s[8:11], s55 offen offset:3072 sc1
ds_read_b128 v[232:235], v7 offset:6144
s_add_u32 m0, s53, 40960
s_add_u32 s31, s54, 163840
buffer_load_dwordx4 v13, s[8:11], s31 offen offset:0 lds
s_waitcnt lgkmcnt(6)
v_mfma_f32_32x32x16_bf16 v[16:31], v[208:211], v[128:131], v[16:31]
ds_read_b128 v[236:239], v7 offset:7168
s_add_u32 m0, s53, 40960
s_add_u32 s31, s54, 163840
buffer_load_dwordx4 v13, s[8:11], s31 offen offset:1024 lds
s_waitcnt lgkmcnt(6)
v_mfma_f32_32x32x16_bf16 v[32:47], v[212:215], v[128:131], v[32:47]
ds_read_b128 v[208:211], v7 offset:8192
s_add_u32 m0, s53, 40960
s_add_u32 s31, s54, 163840
buffer_load_dwordx4 v13, s[8:11], s31 offen offset:2048 lds
s_waitcnt lgkmcnt(6)
v_mfma_f32_32x32x16_bf16 v[48:63], v[216:219], v[128:131], v[48:63]
ds_read_b128 v[212:215], v7 offset:9216
s_add_u32 m0, s53, 40960
s_add_u32 s31, s54, 163840
buffer_load_dwordx4 v13, s[8:11], s31 offen offset:3072 lds
s_waitcnt lgkmcnt(6)
v_mfma_f32_32x32x16_bf16 v[64:79], v[220:223], v[128:131], v[64:79]
ds_read_b128 v[216:219], v7 offset:10240
s_add_u32 m0, s53, 45056
s_add_u32 s31, s54, 167936
buffer_load_dwordx4 v13, s[8:11], s31 offen offset:0 lds
s_waitcnt lgkmcnt(6)
v_mfma_f32_32x32x16_bf16 v[80:95], v[224:227], v[128:131], v[80:95]
buffer_load_dwordx4 v[128:131], v4, s[8:11], s57 offen offset:0
ds_read_b128 v[220:223], v7 offset:11264
s_waitcnt lgkmcnt(6)
v_mfma_f32_32x32x16_bf16 v[16:31], v[228:231], v[132:135], v[16:31]
ds_read_b128 v[224:227], v7 offset:12288
s_waitcnt lgkmcnt(6)
v_mfma_f32_32x32x16_bf16 v[32:47], v[232:235], v[132:135], v[32:47]
ds_read_b128 v[228:231], v7 offset:13312
s_waitcnt lgkmcnt(6)
v_mfma_f32_32x32x16_bf16 v[48:63], v[236:239], v[132:135], v[48:63]
ds_read_b128 v[232:235], v7 offset:14336
s_waitcnt lgkmcnt(6)
v_mfma_f32_32x32x16_bf16 v[64:79], v[208:211], v[132:135], v[64:79]
ds_read_b128 v[236:239], v7 offset:15360
s_waitcnt lgkmcnt(6)
v_mfma_f32_32x32x16_bf16 v[80:95], v[212:215], v[132:135], v[80:95]
buffer_load_dwordx4 v[132:135], v4, s[8:11], s57 offen offset:32
ds_read_b128 v[208:211], v7 offset:16384
s_waitcnt lgkmcnt(6)
v_mfma_f32_32x32x16_bf16 v[16:31], v[216:219], v[136:139], v[16:31]
ds_read_b128 v[212:215], v7 offset:17408
s_waitcnt lgkmcnt(6)
v_mfma_f32_32x32x16_bf16 v[32:47], v[220:223], v[136:139], v[32:47]
ds_read_b128 v[216:219], v7 offset:18432
s_waitcnt lgkmcnt(6)
v_mfma_f32_32x32x16_bf16 v[48:63], v[224:227], v[136:139], v[48:63]
ds_read_b128 v[220:223], v7 offset:19456
s_waitcnt lgkmcnt(6)
v_mfma_f32_32x32x16_bf16 v[64:79], v[228:231], v[136:139], v[64:79]
s_add_u32 s30, s38, s37
s_add_u32 s38, s38, 0x8000
s_cmp_eq_u32 s38, 0x18000
s_cselect_b32 s38, 0, s38
s_waitcnt vmcnt(19)
s_barrier
s_cmp_gt_i32 s52, 0
s_cselect_b64 exec, -1, 0
s_sub_u32 s52, s52, 1
s_add_u32 m0, s30, 0
s_nop 0
buffer_load_dwordx4 v13, s[8:11], s29 offen offset:0 lds
buffer_load_dwordx4 v13, s[8:11], s29 offen offset:1024 lds
buffer_load_dwordx4 v13, s[8:11], s29 offen offset:2048 lds
buffer_load_dwordx4 v13, s[8:11], s29 offen offset:3072 lds
s_add_u32 m0, s30, 4096
s_add_u32 s29, s29, 4096
buffer_load_dwordx4 v13, s[8:11], s29 offen offset:0 lds
buffer_load_dwordx4 v13, s[8:11], s29 offen offset:1024 lds
buffer_load_dwordx4 v13, s[8:11], s29 offen offset:2048 lds
buffer_load_dwordx4 v13, s[8:11], s29 offen offset:3072 lds
s_add_u32 s29, s29, 28672
s_mov_b64 exec, -1
ds_read_b128 v[224:227], v7 offset:20480
s_waitcnt lgkmcnt(6)
v_mfma_f32_32x32x16_bf16 v[80:95], v[232:235], v[136:139], v[80:95]
buffer_load_dwordx4 v[136:139], v4, s[8:11], s57 offen offset:64
ds_read_b128 v[228:231], v7 offset:21504
s_waitcnt lgkmcnt(6)
v_mfma_f32_32x32x16_bf16 v[16:31], v[236:239], v[140:143], v[16:31]
ds_read_b128 v[232:235], v7 offset:22528
s_waitcnt lgkmcnt(6)
v_mfma_f32_32x32x16_bf16 v[32:47], v[208:211], v[140:143], v[32:47]
ds_read_b128 v[236:239], v7 offset:23552
s_waitcnt lgkmcnt(6)
v_mfma_f32_32x32x16_bf16 v[48:63], v[212:215], v[140:143], v[48:63]
ds_read_b128 v[208:211], v7 offset:24576
s_waitcnt lgkmcnt(6)
v_mfma_f32_32x32x16_bf16 v[64:79], v[216:219], v[140:143], v[64:79]
ds_read_b128 v[212:215], v7 offset:25600
s_waitcnt lgkmcnt(6)
v_mfma_f32_32x32x16_bf16 v[80:95], v[220:223], v[140:143], v[80:95]
buffer_load_dwordx4 v[140:143], v4, s[8:11], s57 offen offset:96
ds_read_b128 v[216:219], v7 offset:26624
s_add_u32 m0, s53, 0
s_add_u32 s31, s54, 184320
buffer_load_dwordx4 v13, s[8:11], s31 offen offset:0 lds
s_waitcnt lgkmcnt(6)
v_mfma_f32_32x32x16_bf16 v[16:31], v[224:227], v[144:147], v[16:31]
ds_read_b128 v[220:223], v7 offset:27648
s_add_u32 m0, s53, 0
s_add_u32 s31, s54, 184320
buffer_load_dwordx4 v13, s[8:11], s31 offen offset:1024 lds
s_waitcnt lgkmcnt(6)
v_mfma_f32_32x32x16_bf16 v[32:47], v[228:231], v[144:147], v[32:47]
ds_read_b128 v[224:227], v7 offset:28672
s_add_u32 m0, s53, 0
s_add_u32 s31, s54, 184320
buffer_load_dwordx4 v13, s[8:11], s31 offen offset:2048 lds
s_waitcnt lgkmcnt(6)
v_mfma_f32_32x32x16_bf16 v[48:63], v[232:235], v[144:147], v[48:63]
ds_read_b128 v[228:231], v7 offset:29696
s_add_u32 m0, s53, 0
s_add_u32 s31, s54, 184320
buffer_load_dwordx4 v13, s[8:11], s31 offen offset:3072 lds
s_waitcnt lgkmcnt(6)
v_mfma_f32_32x32x16_bf16 v[64:79], v[236:239], v[144:147], v[64:79]
ds_read_b128 v[232:235], v7 offset:30720
s_add_u32 m0, s53, 4096
s_add_u32 s31, s54, 188416
buffer_load_dwordx4 v13, s[8:11], s31 offen offset:0 lds
s_waitcnt lgkmcnt(6)
v_mfma_f32_32x32x16_bf16 v[80:95], v[208:211], v[144:147], v[80:95]
buffer_load_dwordx4 v[144:147], v4, s[8:11], s57 offen offset:128
ds_read_b128 v[236:239], v7 offset:31744
s_waitcnt lgkmcnt(6)
v_mfma_f32_32x32x16_bf16 v[16:31], v[212:215], v[148:151], v[16:31]
ds_read_b128 v[208:211], v7 offset:32768
s_waitcnt lgkmcnt(6)
v_mfma_f32_32x32x16_bf16 v[32:47], v[216:219], v[148:151], v[32:47]
ds_read_b128 v[212:215], v7 offset:33792
s_waitcnt lgkmcnt(6)
v_mfma_f32_32x32x16_bf16 v[48:63], v[220:223], v[148:151], v[48:63]
ds_read_b128 v[216:219], v7 offset:34816
s_waitcnt lgkmcnt(6)
v_mfma_f32_32x32x16_bf16 v[64:79], v[224:227], v[148:151], v[64:79]
ds_read_b128 v[220:223], v7 offset:35840
s_waitcnt lgkmcnt(6)
v_mfma_f32_32x32x16_bf16 v[80:95], v[228:231], v[148:151], v[80:95]
buffer_load_dwordx4 v[148:151], v4, s[8:11], s57 offen offset:160
ds_read_b128 v[224:227], v7 offset:36864
s_waitcnt lgkmcnt(6)
v_mfma_f32_32x32x16_bf16 v[16:31], v[232:235], v[152:155], v[16:31]
ds_read_b128 v[228:231], v7 offset:37888
s_waitcnt lgkmcnt(6)
v_mfma_f32_32x32x16_bf16 v[32:47], v[236:239], v[152:155], v[32:47]
ds_read_b128 v[232:235], v7 offset:38912
s_waitcnt lgkmcnt(6)
v_mfma_f32_32x32x16_bf16 v[48:63], v[208:211], v[152:155], v[48:63]
ds_read_b128 v[236:239], v7 offset:39936
s_waitcnt lgkmcnt(6)
v_mfma_f32_32x32x16_bf16 v[64:79], v[212:215], v[152:155], v[64:79]
s_add_u32 s30, s38, s37
s_add_u32 s38, s38, 0x8000
s_cmp_eq_u32 s38, 0x18000
s_cselect_b32 s38, 0, s38
s_waitcnt vmcnt(19)
s_barrier
s_cmp_gt_i32 s52, 0
s_cselect_b64 exec, -1, 0
s_sub_u32 s52, s52, 1
s_add_u32 m0, s30, 0
s_nop 0
buffer_load_dwordx4 v13, s[8:11], s29 offen offset:0 lds
buffer_load_dwordx4 v13, s[8:11], s29 offen offset:1024 lds
buffer_load_dwordx4 v13, s[8:11], s29 offen offset:2048 lds
buffer_load_dwordx4 v13, s[8:11], s29 offen offset:3072 lds
s_add_u32 m0, s30, 4096
s_add_u32 s29, s29, 4096
buffer_load_dwordx4 v13, s[8:11], s29 offen offset:0 lds
buffer_load_dwordx4 v13, s[8:11], s29 offen offset:1024 lds
buffer_load_dwordx4 v13, s[8:11], s29 offen offset:2048 lds
buffer_load_dwordx4 v13, s[8:11], s29 offen offset:3072 lds
s_add_u32 s29, s29, 28672
s_mov_b64 exec, -1
ds_read_b128 v[208:211], v7 offset:40960
s_waitcnt lgkmcnt(6)
v_mfma_f32_32x32x16_bf16 v[80:95], v[216:219], v[152:155], v[80:95]
buffer_load_dwordx4 v[152:155], v4, s[8:11], s57 offen offset:192
ds_read_b128 v[212:215], v7 offset:41984
s_waitcnt lgkmcnt(6)
v_mfma_f32_32x32x16_bf16 v[16:31], v[220:223], v[156:159], v[16:31]
ds_read_b128 v[216:219], v7 offset:43008
s_waitcnt lgkmcnt(6)
v_mfma_f32_32x32x16_bf16 v[32:47], v[224:227], v[156:159], v[32:47]
ds_read_b128 v[220:223], v7 offset:44032
s_waitcnt lgkmcnt(6)
v_mfma_f32_32x32x16_bf16 v[48:63], v[228:231], v[156:159], v[48:63]
ds_read_b128 v[224:227], v7 offset:45056
s_waitcnt lgkmcnt(6)
v_mfma_f32_32x32x16_bf16 v[64:79], v[232:235], v[156:159], v[64:79]
ds_read_b128 v[228:231], v7 offset:46080
s_waitcnt lgkmcnt(6)
v_mfma_f32_32x32x16_bf16 v[80:95], v[236:239], v[156:159], v[80:95]
buffer_load_dwordx4 v[156:159], v4, s[8:11], s57 offen offset:224
ds_read_b128 v[232:235], v7 offset:47104
s_waitcnt lgkmcnt(6)
v_mfma_f32_32x32x16_bf16 v[16:31], v[208:211], v[96:99], v[16:31]
ds_read_b128 v[236:239], v7 offset:48128
s_waitcnt lgkmcnt(6)
v_mfma_f32_32x32x16_bf16 v[32:47], v[212:215], v[96:99], v[32:47]
ds_read_b128 v[208:211], v7 offset:49152
s_waitcnt lgkmcnt(6)
v_mfma_f32_32x32x16_bf16 v[48:63], v[216:219], v[96:99], v[48:63]
ds_read_b128 v[212:215], v7 offset:50176
s_waitcnt lgkmcnt(6)
v_mfma_f32_32x32x16_bf16 v[64:79], v[220:223], v[96:99], v[64:79]
ds_read_b128 v[216:219], v7 offset:51200
s_waitcnt lgkmcnt(6)
v_mfma_f32_32x32x16_bf16 v[80:95], v[224:227], v[96:99], v[80:95]
ds_read_b128 v[220:223], v7 offset:52224
s_waitcnt lgkmcnt(6)
v_mfma_f32_32x32x16_bf16 v[16:31], v[228:231], v[100:103], v[16:31]
ds_read_b128 v[224:227], v7 offset:53248
s_waitcnt lgkmcnt(6)
v_mfma_f32_32x32x16_bf16 v[32:47], v[232:235], v[100:103], v[32:47]
ds_read_b128 v[228:231], v7 offset:54272
s_waitcnt lgkmcnt(6)
v_mfma_f32_32x32x16_bf16 v[48:63], v[236:239], v[100:103], v[48:63]
ds_read_b128 v[232:235], v7 offset:55296
s_waitcnt lgkmcnt(6)
v_mfma_f32_32x32x16_bf16 v[64:79], v[208:211], v[100:103], v[64:79]
ds_read_b128 v[236:239], v7 offset:56320
s_waitcnt lgkmcnt(6)
v_mfma_f32_32x32x16_bf16 v[80:95], v[212:215], v[100:103], v[80:95]
ds_read_b128 v[208:211], v7 offset:57344
s_waitcnt lgkmcnt(6)
v_mfma_f32_32x32x16_bf16 v[16:31], v[216:219], v[104:107], v[16:31]
ds_read_b128 v[212:215], v7 offset:58368
s_waitcnt lgkmcnt(6)
v_mfma_f32_32x32x16_bf16 v[32:47], v[220:223], v[104:107], v[32:47]
ds_read_b128 v[216:219], v7 offset:59392
s_waitcnt lgkmcnt(6)
v_mfma_f32_32x32x16_bf16 v[48:63], v[224:227], v[104:107], v[48:63]
ds_read_b128 v[220:223], v7 offset:60416
s_waitcnt lgkmcnt(6)
v_mfma_f32_32x32x16_bf16 v[64:79], v[228:231], v[104:107], v[64:79]
s_add_u32 s30, s38, s37
s_add_u32 s38, s38, 0x8000
s_cmp_eq_u32 s38, 0x18000
s_cselect_b32 s38, 0, s38
s_waitcnt vmcnt(12)
s_barrier
s_cmp_gt_i32 s52, 0
s_cselect_b64 exec, -1, 0
s_sub_u32 s52, s52, 1
s_add_u32 m0, s30, 0
s_nop 0
buffer_load_dwordx4 v13, s[8:11], s29 offen offset:0 lds
buffer_load_dwordx4 v13, s[8:11], s29 offen offset:1024 lds
buffer_load_dwordx4 v13, s[8:11], s29 offen offset:2048 lds
buffer_load_dwordx4 v13, s[8:11], s29 offen offset:3072 lds
s_add_u32 m0, s30, 4096
s_add_u32 s29, s29, 4096
buffer_load_dwordx4 v13, s[8:11], s29 offen offset:0 lds
buffer_load_dwordx4 v13, s[8:11], s29 offen offset:1024 lds
buffer_load_dwordx4 v13, s[8:11], s29 offen offset:2048 lds
buffer_load_dwordx4 v13, s[8:11], s29 offen offset:3072 lds
s_add_u32 s29, s29, 28672
s_mov_b64 exec, -1
ds_read_b128 v[224:227], v7 offset:0
s_waitcnt lgkmcnt(6)
v_mfma_f32_32x32x16_bf16 v[80:95], v[232:235], v[104:107], v[80:95]
ds_read_b128 v[228:231], v7 offset:1024
s_waitcnt lgkmcnt(6)
v_mfma_f32_32x32x16_bf16 v[16:31], v[236:239], v[108:111], v[16:31]
ds_read_b128 v[232:235], v7 offset:2048
s_waitcnt lgkmcnt(6)
v_mfma_f32_32x32x16_bf16 v[32:47], v[208:211], v[108:111], v[32:47]
ds_read_b128 v[236:239], v7 offset:3072
s_waitcnt lgkmcnt(6)
v_mfma_f32_32x32x16_bf16 v[48:63], v[212:215], v[108:111], v[48:63]
ds_read_b128 v[208:211], v7 offset:4096
s_waitcnt lgkmcnt(6)
v_mfma_f32_32x32x16_bf16 v[64:79], v[216:219], v[108:111], v[64:79]
ds_read_b128 v[212:215], v7 offset:5120
s_waitcnt lgkmcnt(6)
v_mfma_f32_32x32x16_bf16 v[80:95], v[220:223], v[108:111], v[80:95]
ds_read_b128 v[216:219], v7 offset:6144
s_waitcnt lgkmcnt(6)
v_mfma_f32_32x32x16_bf16 v[16:31], v[224:227], v[112:115], v[16:31]
ds_read_b128 v[220:223], v7 offset:7168
s_waitcnt lgkmcnt(6)
v_mfma_f32_32x32x16_bf16 v[32:47], v[228:231], v[112:115], v[32:47]
ds_read_b128 v[224:227], v7 offset:8192
s_waitcnt lgkmcnt(6)
v_mfma_f32_32x32x16_bf16 v[48:63], v[232:235], v[112:115], v[48:63]
ds_read_b128 v[228:231], v7 offset:9216
s_waitcnt lgkmcnt(6)
v_mfma_f32_32x32x16_bf16 v[64:79], v[236:239], v[112:115], v[64:79]
ds_read_b128 v[232:235], v7 offset:10240
s_waitcnt lgkmcnt(6)
v_mfma_f32_32x32x16_bf16 v[80:95], v[208:211], v[112:115], v[80:95]
ds_read_b128 v[236:239], v7 offset:11264
s_waitcnt lgkmcnt(6)
v_mfma_f32_32x32x16_bf16 v[16:31], v[212:215], v[116:119], v[16:31]
ds_read_b128 v[208:211], v7 offset:12288
s_waitcnt lgkmcnt(6)
v_mfma_f32_32x32x16_bf16 v[32:47], v[216:219], v[116:119], v[32:47]
ds_read_b128 v[212:215], v7 offset:13312
s_waitcnt lgkmcnt(6)
v_mfma_f32_32x32x16_bf16 v[48:63], v[220:223], v[116:119], v[48:63]
ds_read_b128 v[216:219], v7 offset:14336
s_waitcnt lgkmcnt(6)
v_mfma_f32_32x32x16_bf16 v[64:79], v[224:227], v[116:119], v[64:79]
ds_read_b128 v[220:223], v7 offset:15360
s_waitcnt lgkmcnt(6)
v_mfma_f32_32x32x16_bf16 v[80:95], v[228:231], v[116:119], v[80:95]
ds_read_b128 v[224:227], v7 offset:16384
s_waitcnt lgkmcnt(6)
v_mfma_f32_32x32x16_bf16 v[16:31], v[232:235], v[120:123], v[16:31]
ds_read_b128 v[228:231], v7 offset:17408
s_waitcnt lgkmcnt(6)
v_mfma_f32_32x32x16_bf16 v[32:47], v[236:239], v[120:123], v[32:47]
ds_read_b128 v[232:235], v7 offset:18432
s_waitcnt lgkmcnt(6)
v_mfma_f32_32x32x16_bf16 v[48:63], v[208:211], v[120:123], v[48:63]
ds_read_b128 v[236:239], v7 offset:19456
s_waitcnt lgkmcnt(6)
v_mfma_f32_32x32x16_bf16 v[64:79], v[212:215], v[120:123], v[64:79]
s_waitcnt lgkmcnt(5)
v_mfma_f32_32x32x16_bf16 v[80:95], v[216:219], v[120:123], v[80:95]
s_waitcnt lgkmcnt(4)
v_mfma_f32_32x32x16_bf16 v[16:31], v[220:223], v[124:127], v[16:31]
s_waitcnt lgkmcnt(3)
v_mfma_f32_32x32x16_bf16 v[32:47], v[224:227], v[124:127], v[32:47]
s_waitcnt lgkmcnt(2)
v_mfma_f32_32x32x16_bf16 v[48:63], v[228:231], v[124:127], v[48:63]
s_waitcnt lgkmcnt(1)
v_mfma_f32_32x32x16_bf16 v[64:79], v[232:235], v[124:127], v[64:79]
s_waitcnt lgkmcnt(0)
v_mfma_f32_32x32x16_bf16 v[80:95], v[236:239], v[124:127], v[80:95]
s_add_u32 s30, s38, s37
s_add_u32 s38, s38, 0x8000
s_cmp_eq_u32 s38, 0x18000
s_cselect_b32 s38, 0, s38
s_waitcnt vmcnt(10)
s_barrier
s_cmp_gt_i32 s52, 0
s_cselect_b64 exec, -1, 0
s_sub_u32 s52, s52, 1
s_add_u32 m0, s30, 0
s_nop 0
buffer_load_dwordx4 v13, s[8:11], s29 offen offset:0 lds
buffer_load_dwordx4 v13, s[8:11], s29 offen offset:1024 lds
buffer_load_dwordx4 v13, s[8:11], s29 offen offset:2048 lds
buffer_load_dwordx4 v13, s[8:11], s29 offen offset:3072 lds
s_add_u32 m0, s30, 4096
s_add_u32 s29, s29, 4096
buffer_load_dwordx4 v13, s[8:11], s29 offen offset:0 lds
buffer_load_dwordx4 v13, s[8:11], s29 offen offset:1024 lds
buffer_load_dwordx4 v13, s[8:11], s29 offen offset:2048 lds
buffer_load_dwordx4 v13, s[8:11], s29 offen offset:3072 lds
s_add_u32 s29, s29, 28672
s_mov_b64 exec, -1
v_fma_f32 v48, -v240, v160, v48
v_fma_f32 v49, -v240, v161, v49
v_fma_f32 v50, -v240, v162, v50
v_fma_f32 v51, -v240, v163, v51
v_fma_f32 v52, -v240, v164, v52
v_fma_f32 v53, -v240, v165, v53
v_fma_f32 v54, -v240, v166, v54
v_fma_f32 v55, -v240, v167, v55
v_mul_f32 v208, v48, v48
v_mul_f32 v209, v49, v49
v_mul_f32 v210, v50, v50
v_mul_f32 v211, v51, v51
v_mul_f32 v212, v52, v52
v_mul_f32 v213, v53, v53
v_mul_f32 v214, v54, v54
v_mul_f32 v215, v55, v55
v_fma_f32 v208, v208, v243, v242
v_fma_f32 v209, v209, v243, v242
v_fma_f32 v210, v210, v243, v242
v_fma_f32 v211, v211, v243, v242
v_fma_f32 v212, v212, v243, v242
v_fma_f32 v213, v213, v243, v242
v_fma_f32 v214, v214, v243, v242
v_fma_f32 v215, v215, v243, v242
v_mul_f32 v208, v208, v48
v_mul_f32 v209, v209, v49
v_mul_f32 v210, v210, v50
v_mul_f32 v211, v211, v51
v_mul_f32 v212, v212, v52
v_mul_f32 v213, v213, v53
v_mul_f32 v214, v214, v54
v_mul_f32 v215, v215, v55
v_exp_f32 v208, v208
v_exp_f32 v209, v209
v_exp_f32 v210, v210
v_exp_f32 v211, v211
v_exp_f32 v212, v212
v_exp_f32 v213, v213
v_exp_f32 v214, v214
v_exp_f32 v215, v215
v_fma_f32 v208, v208, v241, v241
v_fma_f32 v209, v209, v241, v241
v_fma_f32 v210, v210, v241, v241
v_fma_f32 v211, v211, v241, v241
v_fma_f32 v212, v212, v241, v241
v_fma_f32 v213, v213, v241, v241
v_fma_f32 v214, v214, v241, v241
v_fma_f32 v215, v215, v241, v241
v_rcp_f32 v208, v208
v_rcp_f32 v209, v209
v_rcp_f32 v210, v210
v_rcp_f32 v211, v211
v_rcp_f32 v212, v212
v_rcp_f32 v213, v213
v_rcp_f32 v214, v214
v_rcp_f32 v215, v215
v_mul_f32 v48, v48, v208
v_mul_f32 v49, v49, v209
v_mul_f32 v50, v50, v210
v_mul_f32 v51, v51, v211
v_mul_f32 v52, v52, v212
v_mul_f32 v53, v53, v213
v_mul_f32 v54, v54, v214
v_mul_f32 v55, v55, v215
v_cvt_pk_bf16_f32 v48, v48, v49
v_cvt_pk_bf16_f32 v49, v50, v51
v_cvt_pk_bf16_f32 v50, v52, v53
v_cvt_pk_bf16_f32 v51, v54, v55
s_add_u32 s31, s58, 8192
buffer_store_dwordx4 v[48:51], v1, s[8:11], s31 offen offset:0
s_add_u32 s30, s38, s37
s_add_u32 s38, s38, 0x8000
s_cmp_eq_u32 s38, 0x18000
s_cselect_b32 s38, 0, s38
s_waitcnt vmcnt(9)
s_barrier
s_cmp_gt_i32 s52, 0
s_cselect_b64 exec, -1, 0
s_sub_u32 s52, s52, 1
s_add_u32 m0, s30, 0
s_nop 0
buffer_load_dwordx4 v13, s[8:11], s29 offen offset:0 lds
buffer_load_dwordx4 v13, s[8:11], s29 offen offset:1024 lds
buffer_load_dwordx4 v13, s[8:11], s29 offen offset:2048 lds
buffer_load_dwordx4 v13, s[8:11], s29 offen offset:3072 lds
s_add_u32 m0, s30, 4096
s_add_u32 s29, s29, 4096
buffer_load_dwordx4 v13, s[8:11], s29 offen offset:0 lds
buffer_load_dwordx4 v13, s[8:11], s29 offen offset:1024 lds
buffer_load_dwordx4 v13, s[8:11], s29 offen offset:2048 lds
buffer_load_dwordx4 v13, s[8:11], s29 offen offset:3072 lds
s_add_u32 s29, s29, 28672
s_mov_b64 exec, -1
v_fma_f32 v56, -v240, v168, v56
v_fma_f32 v57, -v240, v169, v57
v_fma_f32 v58, -v240, v170, v58
v_fma_f32 v59, -v240, v171, v59
v_fma_f32 v60, -v240, v172, v60
v_fma_f32 v61, -v240, v173, v61
v_fma_f32 v62, -v240, v174, v62
v_fma_f32 v63, -v240, v175, v63
v_mul_f32 v208, v56, v56
v_mul_f32 v209, v57, v57
v_mul_f32 v210, v58, v58
v_mul_f32 v211, v59, v59
v_mul_f32 v212, v60, v60
v_mul_f32 v213, v61, v61
v_mul_f32 v214, v62, v62
v_mul_f32 v215, v63, v63
v_fma_f32 v208, v208, v243, v242
v_fma_f32 v209, v209, v243, v242
v_fma_f32 v210, v210, v243, v242
v_fma_f32 v211, v211, v243, v242
v_fma_f32 v212, v212, v243, v242
v_fma_f32 v213, v213, v243, v242
v_fma_f32 v214, v214, v243, v242
v_fma_f32 v215, v215, v243, v242
v_mul_f32 v208, v208, v56
v_mul_f32 v209, v209, v57
v_mul_f32 v210, v210, v58
v_mul_f32 v211, v211, v59
v_mul_f32 v212, v212, v60
v_mul_f32 v213, v213, v61
v_mul_f32 v214, v214, v62
v_mul_f32 v215, v215, v63
v_exp_f32 v208, v208
v_exp_f32 v209, v209
v_exp_f32 v210, v210
v_exp_f32 v211, v211
v_exp_f32 v212, v212
v_exp_f32 v213, v213
v_exp_f32 v214, v214
v_exp_f32 v215, v215
v_fma_f32 v208, v208, v241, v241
v_fma_f32 v209, v209, v241, v241
v_fma_f32 v210, v210, v241, v241
v_fma_f32 v211, v211, v241, v241
v_fma_f32 v212, v212, v241, v241
v_fma_f32 v213, v213, v241, v241
v_fma_f32 v214, v214, v241, v241
v_fma_f32 v215, v215, v241, v241
v_rcp_f32 v208, v208
v_rcp_f32 v209, v209
v_rcp_f32 v210, v210
v_rcp_f32 v211, v211
v_rcp_f32 v212, v212
v_rcp_f32 v213, v213
v_rcp_f32 v214, v214
v_rcp_f32 v215, v215
v_mul_f32 v56, v56, v208
v_mul_f32 v57, v57, v209
v_mul_f32 v58, v58, v210
v_mul_f32 v59, v59, v211
v_mul_f32 v60, v60, v212
v_mul_f32 v61, v61, v213
v_mul_f32 v62, v62, v214
v_mul_f32 v63, v63, v215
v_cvt_pk_bf16_f32 v56, v56, v57
v_cvt_pk_bf16_f32 v57, v58, v59
v_cvt_pk_bf16_f32 v58, v60, v61
v_cvt_pk_bf16_f32 v59, v62, v63
s_add_u32 s31, s58, 8192
buffer_store_dwordx4 v[56:59], v1, s[8:11], s31 offen offset:512
s_add_u32 s30, s38, s37
s_add_u32 s38, s38, 0x8000
s_cmp_eq_u32 s38, 0x18000
s_cselect_b32 s38, 0, s38
s_waitcnt vmcnt(10)
s_barrier
s_cmp_gt_i32 s52, 0
s_cselect_b64 exec, -1, 0
s_sub_u32 s52, s52, 1
s_add_u32 m0, s30, 0
s_nop 0
buffer_load_dwordx4 v13, s[8:11], s29 offen offset:0 lds
buffer_load_dwordx4 v13, s[8:11], s29 offen offset:1024 lds
buffer_load_dwordx4 v13, s[8:11], s29 offen offset:2048 lds
buffer_load_dwordx4 v13, s[8:11], s29 offen offset:3072 lds
s_add_u32 m0, s30, 4096
s_add_u32 s29, s29, 4096
buffer_load_dwordx4 v13, s[8:11], s29 offen offset:0 lds
buffer_load_dwordx4 v13, s[8:11], s29 offen offset:1024 lds
buffer_load_dwordx4 v13, s[8:11], s29 offen offset:2048 lds
buffer_load_dwordx4 v13, s[8:11], s29 offen offset:3072 lds
s_add_u32 s29, s29, 28672
s_mov_b64 exec, -1
v_fma_f32 v64, -v240, v176, v64
v_fma_f32 v65, -v240, v177, v65
v_fma_f32 v66, -v240, v178, v66
v_fma_f32 v67, -v240, v179, v67
v_fma_f32 v68, -v240, v180, v68
v_fma_f32 v69, -v240, v181, v69
v_fma_f32 v70, -v240, v182, v70
v_fma_f32 v71, -v240, v183, v71
v_mul_f32 v208, v64, v64
v_mul_f32 v209, v65, v65
v_mul_f32 v210, v66, v66
v_mul_f32 v211, v67, v67
v_mul_f32 v212, v68, v68
v_mul_f32 v213, v69, v69
v_mul_f32 v214, v70, v70
v_mul_f32 v215, v71, v71
v_fma_f32 v208, v208, v243, v242
v_fma_f32 v209, v209, v243, v242
v_fma_f32 v210, v210, v243, v242
v_fma_f32 v211, v211, v243, v242
v_fma_f32 v212, v212, v243, v242
v_fma_f32 v213, v213, v243, v242
v_fma_f32 v214, v214, v243, v242
v_fma_f32 v215, v215, v243, v242
v_mul_f32 v208, v208, v64
v_mul_f32 v209, v209, v65
v_mul_f32 v210, v210, v66
v_mul_f32 v211, v211, v67
v_mul_f32 v212, v212, v68
v_mul_f32 v213, v213, v69
v_mul_f32 v214, v214, v70
v_mul_f32 v215, v215, v71
v_exp_f32 v208, v208
v_exp_f32 v209, v209
v_exp_f32 v210, v210
v_exp_f32 v211, v211
v_exp_f32 v212, v212
v_exp_f32 v213, v213
v_exp_f32 v214, v214
v_exp_f32 v215, v215
v_fma_f32 v208, v208, v241, v241
v_fma_f32 v209, v209, v241, v241
v_fma_f32 v210, v210, v241, v241
v_fma_f32 v211, v211, v241, v241
v_fma_f32 v212, v212, v241, v241
v_fma_f32 v213, v213, v241, v241
v_fma_f32 v214, v214, v241, v241
v_fma_f32 v215, v215, v241, v241
v_rcp_f32 v208, v208
v_rcp_f32 v209, v209
v_rcp_f32 v210, v210
v_rcp_f32 v211, v211
v_rcp_f32 v212, v212
v_rcp_f32 v213, v213
v_rcp_f32 v214, v214
v_rcp_f32 v215, v215
v_mul_f32 v64, v64, v208
v_mul_f32 v65, v65, v209
v_mul_f32 v66, v66, v210
v_mul_f32 v67, v67, v211
v_mul_f32 v68, v68, v212
v_mul_f32 v69, v69, v213
v_mul_f32 v70, v70, v214
v_mul_f32 v71, v71, v215
v_cvt_pk_bf16_f32 v64, v64, v65
v_cvt_pk_bf16_f32 v65, v66, v67
v_cvt_pk_bf16_f32 v66, v68, v69
v_cvt_pk_bf16_f32 v67, v70, v71
s_add_u32 s31, s58, 12288
buffer_store_dwordx4 v[64:67], v1, s[8:11], s31 offen offset:0
s_add_u32 s30, s38, s37
s_add_u32 s38, s38, 0x8000
s_cmp_eq_u32 s38, 0x18000
s_cselect_b32 s38, 0, s38
s_waitcnt vmcnt(10)
s_barrier
s_cmp_gt_i32 s52, 0
s_cselect_b64 exec, -1, 0
s_sub_u32 s52, s52, 1
s_add_u32 m0, s30, 0
s_nop 0
buffer_load_dwordx4 v13, s[8:11], s29 offen offset:0 lds
buffer_load_dwordx4 v13, s[8:11], s29 offen offset:1024 lds
buffer_load_dwordx4 v13, s[8:11], s29 offen offset:2048 lds
buffer_load_dwordx4 v13, s[8:11], s29 offen offset:3072 lds
s_add_u32 m0, s30, 4096
s_add_u32 s29, s29, 4096
buffer_load_dwordx4 v13, s[8:11], s29 offen offset:0 lds
buffer_load_dwordx4 v13, s[8:11], s29 offen offset:1024 lds
buffer_load_dwordx4 v13, s[8:11], s29 offen offset:2048 lds
buffer_load_dwordx4 v13, s[8:11], s29 offen offset:3072 lds
s_add_u32 s29, s29, 28672
s_mov_b64 exec, -1
v_fma_f32 v72, -v240, v184, v72
v_fma_f32 v73, -v240, v185, v73
v_fma_f32 v74, -v240, v186, v74
v_fma_f32 v75, -v240, v187, v75
v_fma_f32 v76, -v240, v188, v76
v_fma_f32 v77, -v240, v189, v77
v_fma_f32 v78, -v240, v190, v78
v_fma_f32 v79, -v240, v191, v79
v_mul_f32 v208, v72, v72
v_mul_f32 v209, v73, v73
v_mul_f32 v210, v74, v74
v_mul_f32 v211, v75, v75
v_mul_f32 v212, v76, v76
v_mul_f32 v213, v77, v77
v_mul_f32 v214, v78, v78
v_mul_f32 v215, v79, v79
v_fma_f32 v208, v208, v243, v242
v_fma_f32 v209, v209, v243, v242
v_fma_f32 v210, v210, v243, v242
v_fma_f32 v211, v211, v243, v242
v_fma_f32 v212, v212, v243, v242
v_fma_f32 v213, v213, v243, v242
v_fma_f32 v214, v214, v243, v242
v_fma_f32 v215, v215, v243, v242
v_mul_f32 v208, v208, v72
v_mul_f32 v209, v209, v73
v_mul_f32 v210, v210, v74
v_mul_f32 v211, v211, v75
v_mul_f32 v212, v212, v76
v_mul_f32 v213, v213, v77
v_mul_f32 v214, v214, v78
v_mul_f32 v215, v215, v79
v_exp_f32 v208, v208
v_exp_f32 v209, v209
v_exp_f32 v210, v210
v_exp_f32 v211, v211
v_exp_f32 v212, v212
v_exp_f32 v213, v213
v_exp_f32 v214, v214
v_exp_f32 v215, v215
v_fma_f32 v208, v208, v241, v241
v_fma_f32 v209, v209, v241, v241
v_fma_f32 v210, v210, v241, v241
v_fma_f32 v211, v211, v241, v241
v_fma_f32 v212, v212, v241, v241
v_fma_f32 v213, v213, v241, v241
v_fma_f32 v214, v214, v241, v241
v_fma_f32 v215, v215, v241, v241
v_rcp_f32 v208, v208
v_rcp_f32 v209, v209
v_rcp_f32 v210, v210
v_rcp_f32 v211, v211
v_rcp_f32 v212, v212
v_rcp_f32 v213, v213
v_rcp_f32 v214, v214
v_rcp_f32 v215, v215
v_mul_f32 v72, v72, v208
v_mul_f32 v73, v73, v209
v_mul_f32 v74, v74, v210
v_mul_f32 v75, v75, v211
v_mul_f32 v76, v76, v212
v_mul_f32 v77, v77, v213
v_mul_f32 v78, v78, v214
v_mul_f32 v79, v79, v215
v_cvt_pk_bf16_f32 v72, v72, v73
v_cvt_pk_bf16_f32 v73, v74, v75
v_cvt_pk_bf16_f32 v74, v76, v77
v_cvt_pk_bf16_f32 v75, v78, v79
s_add_u32 s31, s58, 12288
buffer_store_dwordx4 v[72:75], v1, s[8:11], s31 offen offset:512
s_add_u32 s30, s38, s37
s_add_u32 s38, s38, 0x8000
s_cmp_eq_u32 s38, 0x18000
s_cselect_b32 s38, 0, s38
s_waitcnt vmcnt(10)
s_barrier
s_cmp_gt_i32 s52, 0
s_cselect_b64 exec, -1, 0
s_sub_u32 s52, s52, 1
s_add_u32 m0, s30, 0
s_nop 0
buffer_load_dwordx4 v13, s[8:11], s29 offen offset:0 lds
buffer_load_dwordx4 v13, s[8:11], s29 offen offset:1024 lds
buffer_load_dwordx4 v13, s[8:11], s29 offen offset:2048 lds
buffer_load_dwordx4 v13, s[8:11], s29 offen offset:3072 lds
s_add_u32 m0, s30, 4096
s_add_u32 s29, s29, 4096
buffer_load_dwordx4 v13, s[8:11], s29 offen offset:0 lds
buffer_load_dwordx4 v13, s[8:11], s29 offen offset:1024 lds
buffer_load_dwordx4 v13, s[8:11], s29 offen offset:2048 lds
buffer_load_dwordx4 v13, s[8:11], s29 offen offset:3072 lds
s_add_u32 s29, s29, 28672
s_mov_b64 exec, -1
v_fma_f32 v16, -v240, v128, v16
v_fma_f32 v17, -v240, v129, v17
v_fma_f32 v18, -v240, v130, v18
v_fma_f32 v19, -v240, v131, v19
v_fma_f32 v20, -v240, v132, v20
v_fma_f32 v21, -v240, v133, v21
v_fma_f32 v22, -v240, v134, v22
v_fma_f32 v23, -v240, v135, v23
v_mul_f32 v208, v16, v16
v_mul_f32 v209, v17, v17
v_mul_f32 v210, v18, v18
v_mul_f32 v211, v19, v19
v_mul_f32 v212, v20, v20
v_mul_f32 v213, v21, v21
v_mul_f32 v214, v22, v22
v_mul_f32 v215, v23, v23
v_fma_f32 v208, v208, v243, v242
v_fma_f32 v209, v209, v243, v242
v_fma_f32 v210, v210, v243, v242
v_fma_f32 v211, v211, v243, v242
v_fma_f32 v212, v212, v243, v242
v_fma_f32 v213, v213, v243, v242
v_fma_f32 v214, v214, v243, v242
v_fma_f32 v215, v215, v243, v242
v_mul_f32 v208, v208, v16
v_mul_f32 v209, v209, v17
v_mul_f32 v210, v210, v18
v_mul_f32 v211, v211, v19
v_mul_f32 v212, v212, v20
v_mul_f32 v213, v213, v21
v_mul_f32 v214, v214, v22
v_mul_f32 v215, v215, v23
v_exp_f32 v208, v208
v_exp_f32 v209, v209
v_exp_f32 v210, v210
v_exp_f32 v211, v211
v_exp_f32 v212, v212
v_exp_f32 v213, v213
v_exp_f32 v214, v214
v_exp_f32 v215, v215
v_fma_f32 v208, v208, v241, v241
v_fma_f32 v209, v209, v241, v241
v_fma_f32 v210, v210, v241, v241
v_fma_f32 v211, v211, v241, v241
v_fma_f32 v212, v212, v241, v241
v_fma_f32 v213, v213, v241, v241
v_fma_f32 v214, v214, v241, v241
v_fma_f32 v215, v215, v241, v241
v_rcp_f32 v208, v208
v_rcp_f32 v209, v209
v_rcp_f32 v210, v210
v_rcp_f32 v211, v211
v_rcp_f32 v212, v212
v_rcp_f32 v213, v213
v_rcp_f32 v214, v214
v_rcp_f32 v215, v215
v_mul_f32 v16, v16, v208
v_mul_f32 v17, v17, v209
v_mul_f32 v18, v18, v210
v_mul_f32 v19, v19, v211
v_mul_f32 v20, v20, v212
v_mul_f32 v21, v21, v213
v_mul_f32 v22, v22, v214
v_mul_f32 v23, v23, v215
v_cvt_pk_bf16_f32 v16, v16, v17
v_cvt_pk_bf16_f32 v17, v18, v19
v_cvt_pk_bf16_f32 v18, v20, v21
v_cvt_pk_bf16_f32 v19, v22, v23
s_add_u32 s31, s58, 0
buffer_store_dwordx4 v[16:19], v1, s[8:11], s31 offen offset:0
s_add_u32 s30, s38, s37
s_add_u32 s38, s38, 0x8000
s_cmp_eq_u32 s38, 0x18000
s_cselect_b32 s38, 0, s38
s_waitcnt vmcnt(10)
s_barrier
s_cmp_gt_i32 s52, 0
s_cselect_b64 exec, -1, 0
s_sub_u32 s52, s52, 1
s_add_u32 m0, s30, 0
s_nop 0
buffer_load_dwordx4 v13, s[8:11], s29 offen offset:0 lds
buffer_load_dwordx4 v13, s[8:11], s29 offen offset:1024 lds
buffer_load_dwordx4 v13, s[8:11], s29 offen offset:2048 lds
buffer_load_dwordx4 v13, s[8:11], s29 offen offset:3072 lds
s_add_u32 m0, s30, 4096
s_add_u32 s29, s29, 4096
buffer_load_dwordx4 v13, s[8:11], s29 offen offset:0 lds
buffer_load_dwordx4 v13, s[8:11], s29 offen offset:1024 lds
buffer_load_dwordx4 v13, s[8:11], s29 offen offset:2048 lds
buffer_load_dwordx4 v13, s[8:11], s29 offen offset:3072 lds
s_add_u32 s29, s29, 28672
s_mov_b64 exec, -1
v_fma_f32 v24, -v240, v136, v24
v_fma_f32 v25, -v240, v137, v25
v_fma_f32 v26, -v240, v138, v26
v_fma_f32 v27, -v240, v139, v27
v_fma_f32 v28, -v240, v140, v28
v_fma_f32 v29, -v240, v141, v29
v_fma_f32 v30, -v240, v142, v30
v_fma_f32 v31, -v240, v143, v31
v_mul_f32 v208, v24, v24
v_mul_f32 v209, v25, v25
v_mul_f32 v210, v26, v26
v_mul_f32 v211, v27, v27
v_mul_f32 v212, v28, v28
v_mul_f32 v213, v29, v29
v_mul_f32 v214, v30, v30
v_mul_f32 v215, v31, v31
v_fma_f32 v208, v208, v243, v242
v_fma_f32 v209, v209, v243, v242
v_fma_f32 v210, v210, v243, v242
v_fma_f32 v211, v211, v243, v242
v_fma_f32 v212, v212, v243, v242
v_fma_f32 v213, v213, v243, v242
v_fma_f32 v214, v214, v243, v242
v_fma_f32 v215, v215, v243, v242
v_mul_f32 v208, v208, v24
v_mul_f32 v209, v209, v25
v_mul_f32 v210, v210, v26
v_mul_f32 v211, v211, v27
v_mul_f32 v212, v212, v28
v_mul_f32 v213, v213, v29
v_mul_f32 v214, v214, v30
v_mul_f32 v215, v215, v31
v_exp_f32 v208, v208
v_exp_f32 v209, v209
v_exp_f32 v210, v210
v_exp_f32 v211, v211
v_exp_f32 v212, v212
v_exp_f32 v213, v213
v_exp_f32 v214, v214
v_exp_f32 v215, v215
v_fma_f32 v208, v208, v241, v241
v_fma_f32 v209, v209, v241, v241
v_fma_f32 v210, v210, v241, v241
v_fma_f32 v211, v211, v241, v241
v_fma_f32 v212, v212, v241, v241
v_fma_f32 v213, v213, v241, v241
v_fma_f32 v214, v214, v241, v241
v_fma_f32 v215, v215, v241, v241
v_rcp_f32 v208, v208
v_rcp_f32 v209, v209
v_rcp_f32 v210, v210
v_rcp_f32 v211, v211
v_rcp_f32 v212, v212
v_rcp_f32 v213, v213
v_rcp_f32 v214, v214
v_rcp_f32 v215, v215
v_mul_f32 v24, v24, v208
v_mul_f32 v25, v25, v209
v_mul_f32 v26, v26, v210
v_mul_f32 v27, v27, v211
v_mul_f32 v28, v28, v212
v_mul_f32 v29, v29, v213
v_mul_f32 v30, v30, v214
v_mul_f32 v31, v31, v215
v_cvt_pk_bf16_f32 v24, v24, v25
v_cvt_pk_bf16_f32 v25, v26, v27
v_cvt_pk_bf16_f32 v26, v28, v29
v_cvt_pk_bf16_f32 v27, v30, v31
s_add_u32 s31, s58, 0
buffer_store_dwordx4 v[24:27], v1, s[8:11], s31 offen offset:512
s_add_u32 s30, s38, s37
s_add_u32 s38, s38, 0x8000
s_cmp_eq_u32 s38, 0x18000
s_cselect_b32 s38, 0, s38
s_waitcnt vmcnt(10)
s_barrier
s_cmp_gt_i32 s52, 0
s_cselect_b64 exec, -1, 0
s_sub_u32 s52, s52, 1
s_add_u32 m0, s30, 0
s_nop 0
buffer_load_dwordx4 v13, s[8:11], s29 offen offset:0 lds
buffer_load_dwordx4 v13, s[8:11], s29 offen offset:1024 lds
buffer_load_dwordx4 v13, s[8:11], s29 offen offset:2048 lds
buffer_load_dwordx4 v13, s[8:11], s29 offen offset:3072 lds
s_add_u32 m0, s30, 4096
s_add_u32 s29, s29, 4096
buffer_load_dwordx4 v13, s[8:11], s29 offen offset:0 lds
buffer_load_dwordx4 v13, s[8:11], s29 offen offset:1024 lds
buffer_load_dwordx4 v13, s[8:11], s29 offen offset:2048 lds
buffer_load_dwordx4 v13, s[8:11], s29 offen offset:3072 lds
s_add_u32 s29, s29, 28672
s_mov_b64 exec, -1
v_fma_f32 v32, -v240, v144, v32
v_fma_f32 v33, -v240, v145, v33
v_fma_f32 v34, -v240, v146, v34
v_fma_f32 v35, -v240, v147, v35
v_fma_f32 v36, -v240, v148, v36
v_fma_f32 v37, -v240, v149, v37
v_fma_f32 v38, -v240, v150, v38
v_fma_f32 v39, -v240, v151, v39
v_mul_f32 v208, v32, v32
v_mul_f32 v209, v33, v33
v_mul_f32 v210, v34, v34
v_mul_f32 v211, v35, v35
v_mul_f32 v212, v36, v36
v_mul_f32 v213, v37, v37
v_mul_f32 v214, v38, v38
v_mul_f32 v215, v39, v39
v_fma_f32 v208, v208, v243, v242
v_fma_f32 v209, v209, v243, v242
v_fma_f32 v210, v210, v243, v242
v_fma_f32 v211, v211, v243, v242
v_fma_f32 v212, v212, v243, v242
v_fma_f32 v213, v213, v243, v242
v_fma_f32 v214, v214, v243, v242
v_fma_f32 v215, v215, v243, v242
v_mul_f32 v208, v208, v32
v_mul_f32 v209, v209, v33
v_mul_f32 v210, v210, v34
v_mul_f32 v211, v211, v35
v_mul_f32 v212, v212, v36
v_mul_f32 v213, v213, v37
v_mul_f32 v214, v214, v38
v_mul_f32 v215, v215, v39
v_exp_f32 v208, v208
v_exp_f32 v209, v209
v_exp_f32 v210, v210
v_exp_f32 v211, v211
v_exp_f32 v212, v212
v_exp_f32 v213, v213
v_exp_f32 v214, v214
v_exp_f32 v215, v215
v_fma_f32 v208, v208, v241, v241
v_fma_f32 v209, v209, v241, v241
v_fma_f32 v210, v210, v241, v241
v_fma_f32 v211, v211, v241, v241
v_fma_f32 v212, v212, v241, v241
v_fma_f32 v213, v213, v241, v241
v_fma_f32 v214, v214, v241, v241
v_fma_f32 v215, v215, v241, v241
v_rcp_f32 v208, v208
v_rcp_f32 v209, v209
v_rcp_f32 v210, v210
v_rcp_f32 v211, v211
v_rcp_f32 v212, v212
v_rcp_f32 v213, v213
v_rcp_f32 v214, v214
v_rcp_f32 v215, v215
v_mul_f32 v32, v32, v208
v_mul_f32 v33, v33, v209
v_mul_f32 v34, v34, v210
v_mul_f32 v35, v35, v211
v_mul_f32 v36, v36, v212
v_mul_f32 v37, v37, v213
v_mul_f32 v38, v38, v214
v_mul_f32 v39, v39, v215
v_cvt_pk_bf16_f32 v32, v32, v33
v_cvt_pk_bf16_f32 v33, v34, v35
v_cvt_pk_bf16_f32 v34, v36, v37
v_cvt_pk_bf16_f32 v35, v38, v39
s_add_u32 s31, s58, 4096
buffer_store_dwordx4 v[32:35], v1, s[8:11], s31 offen offset:0
s_add_u32 s30, s38, s37
s_add_u32 s38, s38, 0x8000
s_cmp_eq_u32 s38, 0x18000
s_cselect_b32 s38, 0, s38
s_waitcnt vmcnt(10)
s_barrier
s_cmp_gt_i32 s52, 0
s_cselect_b64 exec, -1, 0
s_sub_u32 s52, s52, 1
s_add_u32 m0, s30, 0
s_nop 0
buffer_load_dwordx4 v13, s[8:11], s29 offen offset:0 lds
buffer_load_dwordx4 v13, s[8:11], s29 offen offset:1024 lds
buffer_load_dwordx4 v13, s[8:11], s29 offen offset:2048 lds
buffer_load_dwordx4 v13, s[8:11], s29 offen offset:3072 lds
s_add_u32 m0, s30, 4096
s_add_u32 s29, s29, 4096
buffer_load_dwordx4 v13, s[8:11], s29 offen offset:0 lds
buffer_load_dwordx4 v13, s[8:11], s29 offen offset:1024 lds
buffer_load_dwordx4 v13, s[8:11], s29 offen offset:2048 lds
buffer_load_dwordx4 v13, s[8:11], s29 offen offset:3072 lds
s_add_u32 s29, s29, 28672
s_mov_b64 exec, -1
v_fma_f32 v40, -v240, v152, v40
v_fma_f32 v41, -v240, v153, v41
v_fma_f32 v42, -v240, v154, v42
v_fma_f32 v43, -v240, v155, v43
v_fma_f32 v44, -v240, v156, v44
v_fma_f32 v45, -v240, v157, v45
v_fma_f32 v46, -v240, v158, v46
v_fma_f32 v47, -v240, v159, v47
v_mul_f32 v208, v40, v40
v_mul_f32 v209, v41, v41
v_mul_f32 v210, v42, v42
v_mul_f32 v211, v43, v43
v_mul_f32 v212, v44, v44
v_mul_f32 v213, v45, v45
v_mul_f32 v214, v46, v46
v_mul_f32 v215, v47, v47
v_fma_f32 v208, v208, v243, v242
v_fma_f32 v209, v209, v243, v242
v_fma_f32 v210, v210, v243, v242
v_fma_f32 v211, v211, v243, v242
v_fma_f32 v212, v212, v243, v242
v_fma_f32 v213, v213, v243, v242
v_fma_f32 v214, v214, v243, v242
v_fma_f32 v215, v215, v243, v242
v_mul_f32 v208, v208, v40
v_mul_f32 v209, v209, v41
v_mul_f32 v210, v210, v42
v_mul_f32 v211, v211, v43
v_mul_f32 v212, v212, v44
v_mul_f32 v213, v213, v45
v_mul_f32 v214, v214, v46
v_mul_f32 v215, v215, v47
v_exp_f32 v208, v208
v_exp_f32 v209, v209
v_exp_f32 v210, v210
v_exp_f32 v211, v211
v_exp_f32 v212, v212
v_exp_f32 v213, v213
v_exp_f32 v214, v214
v_exp_f32 v215, v215
v_fma_f32 v208, v208, v241, v241
v_fma_f32 v209, v209, v241, v241
v_fma_f32 v210, v210, v241, v241
v_fma_f32 v211, v211, v241, v241
v_fma_f32 v212, v212, v241, v241
v_fma_f32 v213, v213, v241, v241
v_fma_f32 v214, v214, v241, v241
v_fma_f32 v215, v215, v241, v241
v_rcp_f32 v208, v208
v_rcp_f32 v209, v209
v_rcp_f32 v210, v210
v_rcp_f32 v211, v211
v_rcp_f32 v212, v212
v_rcp_f32 v213, v213
v_rcp_f32 v214, v214
v_rcp_f32 v215, v215
v_mul_f32 v40, v40, v208
v_mul_f32 v41, v41, v209
v_mul_f32 v42, v42, v210
v_mul_f32 v43, v43, v211
v_mul_f32 v44, v44, v212
v_mul_f32 v45, v45, v213
v_mul_f32 v46, v46, v214
v_mul_f32 v47, v47, v215
v_cvt_pk_bf16_f32 v40, v40, v41
v_cvt_pk_bf16_f32 v41, v42, v43
v_cvt_pk_bf16_f32 v42, v44, v45
v_cvt_pk_bf16_f32 v43, v46, v47
s_add_u32 s31, s58, 4096
buffer_store_dwordx4 v[40:43], v1, s[8:11], s31 offen offset:512
s_add_u32 s30, s38, s37
s_add_u32 s38, s38, 0x8000
s_cmp_eq_u32 s38, 0x18000
s_cselect_b32 s38, 0, s38
s_waitcnt vmcnt(10)
s_barrier
s_cmp_gt_i32 s52, 0
s_cselect_b64 exec, -1, 0
s_sub_u32 s52, s52, 1
s_add_u32 m0, s30, 0
s_nop 0
buffer_load_dwordx4 v13, s[8:11], s29 offen offset:0 lds
buffer_load_dwordx4 v13, s[8:11], s29 offen offset:1024 lds
buffer_load_dwordx4 v13, s[8:11], s29 offen offset:2048 lds
buffer_load_dwordx4 v13, s[8:11], s29 offen offset:3072 lds
s_add_u32 m0, s30, 4096
s_add_u32 s29, s29, 4096
buffer_load_dwordx4 v13, s[8:11], s29 offen offset:0 lds
buffer_load_dwordx4 v13, s[8:11], s29 offen offset:1024 lds
buffer_load_dwordx4 v13, s[8:11], s29 offen offset:2048 lds
buffer_load_dwordx4 v13, s[8:11], s29 offen offset:3072 lds
s_add_u32 s29, s29, 28672
s_mov_b64 exec, -1
s_cmp_eq_u32 s60, 10
s_cbranch_scc1 LatB_ldt8
v_fma_f32 v80, -v240, v192, v80
v_fma_f32 v81, -v240, v193, v81
v_fma_f32 v82, -v240, v194, v82
v_fma_f32 v83, -v240, v195, v83
v_fma_f32 v84, -v240, v196, v84
v_fma_f32 v85, -v240, v197, v85
v_fma_f32 v86, -v240, v198, v86
v_fma_f32 v87, -v240, v199, v87
v_mul_f32 v208, v80, v80
v_mul_f32 v209, v81, v81
v_mul_f32 v210, v82, v82
v_mul_f32 v211, v83, v83
v_mul_f32 v212, v84, v84
v_mul_f32 v213, v85, v85
v_mul_f32 v214, v86, v86
v_mul_f32 v215, v87, v87
v_fma_f32 v208, v208, v243, v242
v_fma_f32 v209, v209, v243, v242
v_fma_f32 v210, v210, v243, v242
v_fma_f32 v211, v211, v243, v242
v_fma_f32 v212, v212, v243, v242
v_fma_f32 v213, v213, v243, v242
v_fma_f32 v214, v214, v243, v242
v_fma_f32 v215, v215, v243, v242
v_mul_f32 v208, v208, v80
v_mul_f32 v209, v209, v81
v_mul_f32 v210, v210, v82
v_mul_f32 v211, v211, v83
v_mul_f32 v212, v212, v84
v_mul_f32 v213, v213, v85
v_mul_f32 v214, v214, v86
v_mul_f32 v215, v215, v87
v_exp_f32 v208, v208
v_exp_f32 v209, v209
v_exp_f32 v210, v210
v_exp_f32 v211, v211
v_exp_f32 v212, v212
v_exp_f32 v213, v213
v_exp_f32 v214, v214
v_exp_f32 v215, v215
v_fma_f32 v208, v208, v241, v241
v_fma_f32 v209, v209, v241, v241
v_fma_f32 v210, v210, v241, v241
v_fma_f32 v211, v211, v241, v241
v_fma_f32 v212, v212, v241, v241
v_fma_f32 v213, v213, v241, v241
v_fma_f32 v214, v214, v241, v241
v_fma_f32 v215, v215, v241, v241
v_rcp_f32 v208, v208
v_rcp_f32 v209, v209
v_rcp_f32 v210, v210
v_rcp_f32 v211, v211
v_rcp_f32 v212, v212
v_rcp_f32 v213, v213
v_rcp_f32 v214, v214
v_rcp_f32 v215, v215
v_mul_f32 v80, v80, v208
v_mul_f32 v81, v81, v209
v_mul_f32 v82, v82, v210
v_mul_f32 v83, v83, v211
v_mul_f32 v84, v84, v212
v_mul_f32 v85, v85, v213
v_mul_f32 v86, v86, v214
v_mul_f32 v87, v87, v215
v_cvt_pk_bf16_f32 v80, v80, v81
v_cvt_pk_bf16_f32 v81, v82, v83
v_cvt_pk_bf16_f32 v82, v84, v85
v_cvt_pk_bf16_f32 v83, v86, v87
s_add_u32 s31, s58, 16384
buffer_store_dwordx4 v[80:83], v1, s[8:11], s31 offen offset:0
s_add_u32 s30, s38, s37
s_add_u32 s38, s38, 0x8000
s_cmp_eq_u32 s38, 0x18000
s_cselect_b32 s38, 0, s38
s_waitcnt vmcnt(10)
s_barrier
s_cmp_gt_i32 s52, 0
s_cselect_b64 exec, -1, 0
s_sub_u32 s52, s52, 1
s_add_u32 m0, s30, 0
s_nop 0
buffer_load_dwordx4 v13, s[8:11], s29 offen offset:0 lds
buffer_load_dwordx4 v13, s[8:11], s29 offen offset:1024 lds
buffer_load_dwordx4 v13, s[8:11], s29 offen offset:2048 lds
buffer_load_dwordx4 v13, s[8:11], s29 offen offset:3072 lds
s_add_u32 m0, s30, 4096
s_add_u32 s29, s29, 4096
buffer_load_dwordx4 v13, s[8:11], s29 offen offset:0 lds
buffer_load_dwordx4 v13, s[8:11], s29 offen offset:1024 lds
buffer_load_dwordx4 v13, s[8:11], s29 offen offset:2048 lds
buffer_load_dwordx4 v13, s[8:11], s29 offen offset:3072 lds
s_add_u32 s29, s29, 28672
s_mov_b64 exec, -1
v_fma_f32 v88, -v240, v200, v88
v_fma_f32 v89, -v240, v201, v89
v_fma_f32 v90, -v240, v202, v90
v_fma_f32 v91, -v240, v203, v91
v_fma_f32 v92, -v240, v204, v92
v_fma_f32 v93, -v240, v205, v93
v_fma_f32 v94, -v240, v206, v94
v_fma_f32 v95, -v240, v207, v95
v_mul_f32 v208, v88, v88
v_mul_f32 v209, v89, v89
v_mul_f32 v210, v90, v90
v_mul_f32 v211, v91, v91
v_mul_f32 v212, v92, v92
v_mul_f32 v213, v93, v93
v_mul_f32 v214, v94, v94
v_mul_f32 v215, v95, v95
v_fma_f32 v208, v208, v243, v242
v_fma_f32 v209, v209, v243, v242
v_fma_f32 v210, v210, v243, v242
v_fma_f32 v211, v211, v243, v242
v_fma_f32 v212, v212, v243, v242
v_fma_f32 v213, v213, v243, v242
v_fma_f32 v214, v214, v243, v242
v_fma_f32 v215, v215, v243, v242
v_mul_f32 v208, v208, v88
v_mul_f32 v209, v209, v89
v_mul_f32 v210, v210, v90
v_mul_f32 v211, v211, v91
v_mul_f32 v212, v212, v92
v_mul_f32 v213, v213, v93
v_mul_f32 v214, v214, v94
v_mul_f32 v215, v215, v95
v_exp_f32 v208, v208
v_exp_f32 v209, v209
v_exp_f32 v210, v210
v_exp_f32 v211, v211
v_exp_f32 v212, v212
v_exp_f32 v213, v213
v_exp_f32 v214, v214
v_exp_f32 v215, v215
v_fma_f32 v208, v208, v241, v241
v_fma_f32 v209, v209, v241, v241
v_fma_f32 v210, v210, v241, v241
v_fma_f32 v211, v211, v241, v241
v_fma_f32 v212, v212, v241, v241
v_fma_f32 v213, v213, v241, v241
v_fma_f32 v214, v214, v241, v241
v_fma_f32 v215, v215, v241, v241
v_rcp_f32 v208, v208
v_rcp_f32 v209, v209
v_rcp_f32 v210, v210
v_rcp_f32 v211, v211
v_rcp_f32 v212, v212
v_rcp_f32 v213, v213
v_rcp_f32 v214, v214
v_rcp_f32 v215, v215
v_mul_f32 v88, v88, v208
v_mul_f32 v89, v89, v209
v_mul_f32 v90, v90, v210
v_mul_f32 v91, v91, v211
v_mul_f32 v92, v92, v212
v_mul_f32 v93, v93, v213
v_mul_f32 v94, v94, v214
v_mul_f32 v95, v95, v215
v_cvt_pk_bf16_f32 v88, v88, v89
v_cvt_pk_bf16_f32 v89, v90, v91
v_cvt_pk_bf16_f32 v90, v92, v93
v_cvt_pk_bf16_f32 v91, v94, v95
s_add_u32 s31, s58, 16384
buffer_store_dwordx4 v[88:91], v1, s[8:11], s31 offen offset:512
LatB_ldt8:
s_waitcnt vmcnt(8)
LatB_ldt:
s_add_u32 s30, s38, s37
s_add_u32 s38, s38, 0x8000
s_cmp_eq_u32 s38, 0x18000
s_cselect_b32 s38, 0, s38
s_waitcnt vmcnt(16)
s_barrier
LatB_ld:
s_cmp_le_i32 s52, 0
s_cbranch_scc1 LatB_fin
s_sub_u32 s52, s52, 1
s_add_u32 m0, s30, 0
s_nop 0
buffer_load_dwordx4 v13, s[8:11], s29 offen offset:0 lds
buffer_load_dwordx4 v13, s[8:11], s29 offen offset:1024 lds
buffer_load_dwordx4 v13, s[8:11], s29 offen offset:2048 lds
buffer_load_dwordx4 v13, s[8:11], s29 offen offset:3072 lds
s_add_u32 m0, s30, 4096
s_add_u32 s29, s29, 4096
buffer_load_dwordx4 v13, s[8:11], s29 offen offset:0 lds
buffer_load_dwordx4 v13, s[8:11], s29 offen offset:1024 lds
buffer_load_dwordx4 v13, s[8:11], s29 offen offset:2048 lds
buffer_load_dwordx4 v13, s[8:11], s29 offen offset:3072 lds
s_add_u32 s29, s29, 28672
s_add_u32 s30, s38, s37
s_add_u32 s38, s38, 0x8000
s_cmp_eq_u32 s38, 0x18000
s_cselect_b32 s38, 0, s38
s_waitcnt vmcnt(8)
s_barrier
s_branch LatB_ld
LatB_fin:
s_waitcnt vmcnt(0)
s_endpgm
Lat_s5:
s_sub_u32 s60, s39, 22
s_and_b32 s61, s2, 7
s_lshl_b32 s61, s61, 1
s_sub_u32 s31, s60, 5
s_add_u32 s62, s61, 1
s_cmp_ge_u32 s60, 5
s_cselect_b32 s60, s31, s60
s_cselect_b32 s61, s62, s61
s_lshl_b32 s62, s61, 2
s_and_b32 s31, s24, 3
s_add_u32 s62, s62, s31
s_mul_i32 s63, s62, 40960
s_add_u32 s30, s63, 40894464
s_mul_i32 s29, s24, 5120
s_lshl_b32 s31, s60, 8
s_add_u32 s29, s29, s31
v_mul_u32_u24 v8, 1280, v14
v_add_u32 v8, v8, v4
s_mov_b32 s36, 0
s_mul_i32 s50, s36, 163840
s_add_u32 s50, s50, s29
s_lshl_b32 s55, s36, 13
s_add_u32 s55, s55, s30
s_add_u32 s36, s36, 1
s_cmp_eq_u32 s36, 5
s_cselect_b32 s36, 0, s36
s_add_u32 m0, s35, 65536
s_add_u32 s31, s50, 0
buffer_load_dwordx4 v8, s[12:15], s31 offen lds
s_add_u32 m0, s35, 73728
s_add_u32 s31, s50, 40960
buffer_load_dwordx4 v8, s[12:15], s31 offen lds
buffer_load_dwordx4 v[48:51], v13, s[8:11], s55 offen offset:0
buffer_load_dwordx4 v[52:55], v13, s[8:11], s55 offen offset:1024
buffer_load_dwordx4 v[56:59], v13, s[8:11], s55 offen offset:2048
buffer_load_dwordx4 v[60:63], v13, s[8:11], s55 offen offset:3072
s_mul_i32 s51, s36, 163840
s_add_u32 s51, s51, s29
s_lshl_b32 s56, s36, 13
s_add_u32 s56, s56, s30
s_add_u32 s36, s36, 1
s_cmp_eq_u32 s36, 5
s_cselect_b32 s36, 0, s36
s_barrier
s_add_u32 m0, s35, 81920
s_add_u32 s31, s50, 81920
buffer_load_dwordx4 v8, s[12:15], s31 offen lds
s_add_u32 m0, s35, 90112
s_add_u32 s31, s50, 122880
buffer_load_dwordx4 v8, s[12:15], s31 offen lds
buffer_load_dwordx4 v[64:67], v0, s[8:11], s55 offen offset:0
buffer_load_dwordx4 v[68:71], v0, s[8:11], s55 offen offset:1024
buffer_load_dwordx4 v[72:75], v0, s[8:11], s55 offen offset:2048
buffer_load_dwordx4 v[76:79], v0, s[8:11], s55 offen offset:3072
v_mul_u32_u24 v10, 52, v2
v_lshrrev_b32 v10, 8, v10
v_mul_u32_u24 v10, 163200, v10
v_lshl_add_u32 v12, v2, 7, v10
v_and_b32 v11, 1, v2
v_lshlrev_b32 v11, 7, v11
v_bfe_u32 v10, v2, 1, 3
v_lshl_add_u32 v10, v10, 13, v11
v_cmp_le_u32 vcc, 32, v2
s_nop 1
v_cndmask_b32 v12, v12, v10, vcc
v_bfe_u32 v10, v2, 1, 1
v_lshl_add_u32 v11, v10, 13, v11
v_bfe_u32 v10, v2, 2, 2
v_lshl_add_u32 v11, v10, 20, v11
v_cmp_le_u32 vcc, 48, v2
s_nop 1
v_cndmask_b32 v12, v12, v11, vcc
s_lshl_b32 s31, s39, 3
s_add_u32 s31, s31, s24
s_mul_i32 s20, s31, 640
s_lshr_b32 s21, s31, 5
s_and_b32 s22, s2, 7
s_lshl_b32 s22, s22, 3
s_add_u32 s21, s21, s22
s_mul_i32 s21, s21, 40960
s_and_b32 s31, s31, 31
s_lshl_b32 s31, s31, 8
s_add_u32 s21, s21, s31
s_add_u32 s21, s21, 40894464
s_lshl_b32 s22, s26, 3
s_add_u32 s22, s22, s24
s_lshl_b32 s22, s22, 14
s_lshl_b32 s31, s25, 8
s_add_u32 s22, s22, s31
s_add_u32 s22, s22, 1048576
s_mov_b32 exec_lo, 0
s_mov_b32 exec_hi, 0xf0000
buffer_load_dword v10, v12, s[4:7], s22 offen
s_mov_b64 exec, -1
s_mov_b64 exec, 0x7fe0
buffer_load_dword v10, v12, s[12:15], s20 offen
s_mov_b32 exec_lo, 0
s_mov_b32 exec_hi, 0x3c
buffer_load_dword v10, v12, s[8:11], s21 offen
s_mov_b64 exec, -1
s_barrier
s_add_u32 m0, s35, 0
s_add_u32 s31, s51, 0
buffer_load_dwordx4 v8, s[12:15], s31 offen lds
s_add_u32 m0, s35, 8192
s_add_u32 s31, s51, 40960
buffer_load_dwordx4 v8, s[12:15], s31 offen lds
s_add_u32 m0, s35, 16384
s_add_u32 s31, s51, 81920
buffer_load_dwordx4 v8, s[12:15], s31 offen lds
s_add_u32 m0, s35, 24576
s_add_u32 s31, s51, 122880
buffer_load_dwordx4 v8, s[12:15], s31 offen lds
buffer_load_dwordx4 v[112:115], v13, s[8:11], s56 offen offset:0
buffer_load_dwordx4 v[116:119], v13, s[8:11], s56 offen offset:1024
buffer_load_dwordx4 v[120:123], v13, s[8:11], s56 offen offset:2048
buffer_load_dwordx4 v[124:127], v13, s[8:11], s56 offen offset:3072
buffer_load_dwordx4 v[128:131], v0, s[8:11], s56 offen offset:0
buffer_load_dwordx4 v[132:135], v0, s[8:11], s56 offen offset:1024
buffer_load_dwordx4 v[136:139], v0, s[8:11], s56 offen offset:2048
buffer_load_dwordx4 v[140:143], v0, s[8:11], s56 offen offset:3072
s_mul_i32 s52, s36, 163840
s_add_u32 s52, s52, s29
s_lshl_b32 s57, s36, 13
s_add_u32 s57, s57, s30
s_add_u32 s36, s36, 1
s_cmp_eq_u32 s36, 5
s_cselect_b32 s36, 0, s36
s_mul_i32 s53, s36, 163840
s_add_u32 s53, s53, s29
s_lshl_b32 s58, s36, 13
s_add_u32 s58, s58, s30
s_add_u32 s36, s36, 1
s_cmp_eq_u32 s36, 5
s_cselect_b32 s36, 0, s36
s_mul_i32 s54, s36, 163840
s_add_u32 s54, s54, s29
s_lshl_b32 s59, s36, 13
s_add_u32 s59, s59, s30
s_add_u32 s36, s36, 1
s_cmp_eq_u32 s36, 5
s_cselect_b32 s36, 0, s36
s_mul_i32 s41, s38, 1048576
s_add_u32 s41, s41, s34
s_lshl_b32 s46, s38, 13
s_add_u32 s46, s46, s33
s_add_u32 s38, s38, 1
s_cmp_eq_u32 s38, 5
s_cselect_b32 s38, 0, s38
s_mul_i32 s42, s38, 1048576
s_add_u32 s42, s42, s34
s_lshl_b32 s47, s38, 13
s_add_u32 s47, s47, s33
s_add_u32 s38, s38, 1
s_cmp_eq_u32 s38, 5
s_cselect_b32 s38, 0, s38
s_mul_i32 s43, s38, 1048576
s_add_u32 s43, s43, s34
s_lshl_b32 s48, s38, 13
s_add_u32 s48, s48, s33
s_add_u32 s38, s38, 1
s_cmp_eq_u32 s38, 5
s_cselect_b32 s38, 0, s38
s_mul_i32 s44, s38, 1048576
s_add_u32 s44, s44, s34
s_lshl_b32 s49, s38, 13
s_add_u32 s49, s49, s33
s_add_u32 s38, s38, 1
s_cmp_eq_u32 s38, 5
s_cselect_b32 s38, 0, s38
v_lshrrev_b32 v1, 5, v2
v_lshlrev_b32 v4, 10, v1
v_lshl_add_u32 v4, v14, 6, v4
v_bfe_u32 v14, v2, 4, 1
v_lshl_add_u32 v4, v14, 5, v4
v_lshl_add_u32 v4, v15, 3, v4
v_add_u32 v5, 0x10000, v4
v_add_u32 v6, 0x20000, v4
v_add_u32 v7, 0x10000, v13
s_and_b32 s31, s32, 1
s_lshl_b32 s31, s31, 5
v_and_b32 v11, 31, v2
v_add_u32 v11, s31, v11
v_lshlrev_b32 v15, 2, v1
v_sub_u32 v11, v11, v15
v_and_b32 v15, 15, v2
v_lshlrev_b32 v15, 4, v15
v_lshl_add_u32 v15, v14, 10, v15
v_lshl_add_u32 v1, v1, 8, v15
s_lshl_b32 s29, s25, 20
s_lshr_b32 s36, s27, 1
s_lshl_b32 s36, s36, 7
s_lshl_b32 s31, s25, 2
s_add_u32 s36, s36, s31
s_lshl_b32 s36, s36, 12
s_and_b32 s31, s27, 1
s_lshl_b32 s31, s31, 11
s_add_u32 s36, s36, s31
s_add_u32 s36, s36, 54525952
s_and_b32 s37, s24, 3
s_lshl_b32 s37, s37, 13
s_lshr_b32 s34, s37, 1
s_lshr_b32 s31, s24, 2
s_lshl_b32 s30, s31, 9
v_add_u32 v4, s30, v4
v_add_u32 v5, s30, v5
v_add_u32 v6, s30, v6
s_lshl_b32 s60, s60, 1
s_add_u32 s60, s60, s31
s_lshl_b32 s31, s60, 12
s_add_u32 s63, s63, s31
s_add_u32 s33, s63, 34603008
s_add_u32 s63, s63, 44040192
s_mul_i32 s62, s62, 2560
s_lshl_b32 s60, s60, 3
s_add_u32 s62, s62, s60
s_add_u32 s62, s62, 79757312
s_waitcnt vmcnt(25)
s_barrier
ds_read_b64_tr_b16 v[208:209], v5 offset:0
ds_read_b64_tr_b16 v[210:211], v5 offset:2048
ds_read_b64_tr_b16 v[212:213], v5 offset:256
ds_read_b64_tr_b16 v[214:215], v5 offset:2304
ds_read_b64_tr_b16 v[216:217], v5 offset:4096
ds_read_b64_tr_b16 v[218:219], v5 offset:6144
ds_read_b64_tr_b16 v[220:221], v5 offset:4352
ds_read_b64_tr_b16 v[222:223], v5 offset:6400
ds_read_b64_tr_b16 v[224:225], v5 offset:8192
ds_read_b64_tr_b16 v[226:227], v5 offset:10240
ds_read_b64_tr_b16 v[228:229], v5 offset:8448
ds_read_b64_tr_b16 v[230:231], v5 offset:10496
s_mov_b64 exec, 0x1ff8000
buffer_load_dword v10, v12, s[12:15], s20 offen
s_mov_b32 exec_lo, 0
s_mov_b32 exec_hi, 0x3c0
buffer_load_dword v10, v12, s[8:11], s21 offen
s_mov_b64 exec, -1
s_mov_b32 exec_lo, 0
s_mov_b32 exec_hi, 0xf00000
buffer_load_dword v10, v12, s[4:7], s22 offen
s_mov_b64 exec, -1
ds_read_b64_tr_b16 v[232:233], v5 offset:12288
ds_read_b64_tr_b16 v[234:235], v5 offset:14336
s_waitcnt vmcnt(24)
s_waitcnt lgkmcnt(12)
v_mfma_f32_32x32x16_bf16 v[16:31], v[208:211], v[48:51], 0
s_add_u32 m0, s35, 32768
s_add_u32 s31, s52, 0
buffer_load_dwordx4 v8, s[12:15], s31 offen lds
ds_read_b64_tr_b16 v[236:237], v5 offset:12544
ds_read_b64_tr_b16 v[238:239], v5 offset:14592
s_waitcnt lgkmcnt(12)
v_mfma_f32_32x32x16_bf16 v[32:47], v[212:215], v[48:51], 0
s_add_u32 m0, s35, 40960
s_add_u32 s31, s52, 40960
buffer_load_dwordx4 v8, s[12:15], s31 offen lds
s_waitcnt vmcnt(24)
s_barrier
ds_read_b64_tr_b16 v[208:209], v5 offset:16384
ds_read_b64_tr_b16 v[210:211], v5 offset:18432
s_waitcnt lgkmcnt(12)
v_mfma_f32_32x32x16_bf16 v[16:31], v[216:219], v[52:55], v[16:31]
s_add_u32 m0, s35, 49152
s_add_u32 s31, s52, 81920
buffer_load_dwordx4 v8, s[12:15], s31 offen lds
ds_read_b64_tr_b16 v[212:213], v5 offset:16640
ds_read_b64_tr_b16 v[214:215], v5 offset:18688
s_waitcnt lgkmcnt(12)
v_mfma_f32_32x32x16_bf16 v[32:47], v[220:223], v[52:55], v[32:47]
s_add_u32 m0, s35, 57344
s_add_u32 s31, s52, 122880
buffer_load_dwordx4 v8, s[12:15], s31 offen lds
ds_read_b64_tr_b16 v[216:217], v5 offset:20480
ds_read_b64_tr_b16 v[218:219], v5 offset:22528
s_waitcnt lgkmcnt(12)
v_mfma_f32_32x32x16_bf16 v[16:31], v[224:227], v[56:59], v[16:31]
buffer_load_dwordx4 v[80:83], v13, s[8:11], s57 offen offset:0
ds_read_b64_tr_b16 v[220:221], v5 offset:20736
ds_read_b64_tr_b16 v[222:223], v5 offset:22784
s_waitcnt lgkmcnt(12)
v_mfma_f32_32x32x16_bf16 v[32:47], v[228:231], v[56:59], v[32:47]
buffer_load_dwordx4 v[84:87], v13, s[8:11], s57 offen offset:1024
ds_read_b64_tr_b16 v[224:225], v5 offset:24576
ds_read_b64_tr_b16 v[226:227], v5 offset:26624
s_waitcnt lgkmcnt(12)
v_mfma_f32_32x32x16_bf16 v[16:31], v[232:235], v[60:63], v[16:31]
buffer_load_dwordx4 v[88:91], v13, s[8:11], s57 offen offset:2048
ds_read_b64_tr_b16 v[228:229], v5 offset:24832
ds_read_b64_tr_b16 v[230:231], v5 offset:26880
s_waitcnt lgkmcnt(12)
v_mfma_f32_32x32x16_bf16 v[32:47], v[236:239], v[60:63], v[32:47]
buffer_load_dwordx4 v[92:95], v13, s[8:11], s57 offen offset:3072
ds_read_b64_tr_b16 v[232:233], v5 offset:28672
ds_read_b64_tr_b16 v[234:235], v5 offset:30720
s_waitcnt vmcnt(26)
s_waitcnt lgkmcnt(12)
v_mfma_f32_32x32x16_bf16 v[16:31], v[208:211], v[64:67], v[16:31]
buffer_load_dwordx4 v[96:99], v0, s[8:11], s57 offen offset:0
ds_read_b64_tr_b16 v[236:237], v5 offset:28928
ds_read_b64_tr_b16 v[238:239], v5 offset:30976
s_waitcnt lgkmcnt(12)
v_mfma_f32_32x32x16_bf16 v[32:47], v[212:215], v[64:67], v[32:47]
buffer_load_dwordx4 v[100:103], v0, s[8:11], s57 offen offset:1024
s_waitcnt vmcnt(21)
s_barrier
ds_read_b64_tr_b16 v[208:209], v4 offset:0
ds_read_b64_tr_b16 v[210:211], v4 offset:2048
s_waitcnt lgkmcnt(12)
v_mfma_f32_32x32x16_bf16 v[16:31], v[216:219], v[68:71], v[16:31]
buffer_load_dwordx4 v[104:107], v0, s[8:11], s57 offen offset:2048
ds_read_b64_tr_b16 v[212:213], v4 offset:256
ds_read_b64_tr_b16 v[214:215], v4 offset:2304
s_waitcnt lgkmcnt(12)
v_mfma_f32_32x32x16_bf16 v[32:47], v[220:223], v[68:71], v[32:47]
buffer_load_dwordx4 v[108:111], v0, s[8:11], s57 offen offset:3072
ds_read_b64_tr_b16 v[216:217], v4 offset:4096
ds_read_b64_tr_b16 v[218:219], v4 offset:6144
s_waitcnt lgkmcnt(12)
v_mfma_f32_32x32x16_bf16 v[16:31], v[224:227], v[72:75], v[16:31]
ds_read_b64_tr_b16 v[220:221], v4 offset:4352
ds_read_b64_tr_b16 v[222:223], v4 offset:6400
s_waitcnt lgkmcnt(12)
v_mfma_f32_32x32x16_bf16 v[32:47], v[228:231], v[72:75], v[32:47]
s_mov_b32 exec_lo, 0
s_mov_b32 exec_hi, 0xf000000
buffer_load_dword v10, v12, s[4:7], s22 offen
s_mov_b64 exec, -1
ds_read_b64_tr_b16 v[224:225], v4 offset:8192
ds_read_b64_tr_b16 v[226:227], v4 offset:10240
s_waitcnt lgkmcnt(12)
v_mfma_f32_32x32x16_bf16 v[16:31], v[232:235], v[76:79], v[16:31]
ds_read_b64_tr_b16 v[228:229], v4 offset:8448
ds_read_b64_tr_b16 v[230:231], v4 offset:10496
s_waitcnt lgkmcnt(12)
v_mfma_f32_32x32x16_bf16 v[32:47], v[236:239], v[76:79], v[32:47]
ds_read_b64_tr_b16 v[232:233], v4 offset:12288
ds_read_b64_tr_b16 v[234:235], v4 offset:14336
s_waitcnt vmcnt(20)
s_waitcnt lgkmcnt(12)
v_mfma_f32_32x32x16_bf16 v[16:31], v[208:211], v[112:115], v[16:31]
s_add_u32 m0, s35, 98304
s_add_u32 s31, s53, 0
buffer_load_dwordx4 v8, s[12:15], s31 offen lds
ds_read_b64_tr_b16 v[236:237], v4 offset:12544
ds_read_b64_tr_b16 v[238:239], v4 offset:14592
s_waitcnt lgkmcnt(12)
v_mfma_f32_32x32x16_bf16 v[32:47], v[212:215], v[112:115], v[32:47]
s_add_u32 m0, s35, 106496
s_add_u32 s31, s53, 40960
buffer_load_dwordx4 v8, s[12:15], s31 offen lds
ds_read_b64_tr_b16 v[208:209], v4 offset:16384
ds_read_b64_tr_b16 v[210:211], v4 offset:18432
s_waitcnt lgkmcnt(12)
v_mfma_f32_32x32x16_bf16 v[16:31], v[216:219], v[116:119], v[16:31]
s_add_u32 m0, s35, 114688
s_add_u32 s31, s53, 81920
buffer_load_dwordx4 v8, s[12:15], s31 offen lds
ds_read_b64_tr_b16 v[212:213], v4 offset:16640
ds_read_b64_tr_b16 v[214:215], v4 offset:18688
s_waitcnt lgkmcnt(12)
v_mfma_f32_32x32x16_bf16 v[32:47], v[220:223], v[116:119], v[32:47]
s_add_u32 m0, s35, 122880
s_add_u32 s31, s53, 122880
buffer_load_dwordx4 v8, s[12:15], s31 offen lds
ds_read_b64_tr_b16 v[216:217], v4 offset:20480
ds_read_b64_tr_b16 v[218:219], v4 offset:22528
s_waitcnt lgkmcnt(12)
v_mfma_f32_32x32x16_bf16 v[16:31], v[224:227], v[120:123], v[16:31]
buffer_load_dwordx4 v[48:51], v13, s[8:11], s58 offen offset:0
ds_read_b64_tr_b16 v[220:221], v4 offset:20736
ds_read_b64_tr_b16 v[222:223], v4 offset:22784
s_waitcnt lgkmcnt(12)
v_mfma_f32_32x32x16_bf16 v[32:47], v[228:231], v[120:123], v[32:47]
buffer_load_dwordx4 v[52:55], v13, s[8:11], s58 offen offset:1024
ds_read_b64_tr_b16 v[224:225], v4 offset:24576
ds_read_b64_tr_b16 v[226:227], v4 offset:26624
s_waitcnt lgkmcnt(12)
v_mfma_f32_32x32x16_bf16 v[16:31], v[232:235], v[124:127], v[16:31]
buffer_load_dwordx4 v[56:59], v13, s[8:11], s58 offen offset:2048
ds_read_b64_tr_b16 v[228:229], v4 offset:24832
ds_read_b64_tr_b16 v[230:231], v4 offset:26880
s_waitcnt lgkmcnt(12)
v_mfma_f32_32x32x16_bf16 v[32:47], v[236:239], v[124:127], v[32:47]
buffer_load_dwordx4 v[60:63], v13, s[8:11], s58 offen offset:3072
ds_read_b64_tr_b16 v[232:233], v4 offset:28672
ds_read_b64_tr_b16 v[234:235], v4 offset:30720
s_waitcnt vmcnt(24)
s_waitcnt lgkmcnt(12)
v_mfma_f32_32x32x16_bf16 v[16:31], v[208:211], v[128:131], v[16:31]
buffer_load_dwordx4 v[64:67], v0, s[8:11], s58 offen offset:0
ds_read_b64_tr_b16 v[236:237], v4 offset:28928
ds_read_b64_tr_b16 v[238:239], v4 offset:30976
s_waitcnt lgkmcnt(12)
v_mfma_f32_32x32x16_bf16 v[32:47], v[212:215], v[128:131], v[32:47]
buffer_load_dwordx4 v[68:71], v0, s[8:11], s58 offen offset:1024
s_waitcnt vmcnt(19)
s_barrier
ds_read_b64_tr_b16 v[208:209], v4 offset:32768
ds_read_b64_tr_b16 v[210:211], v4 offset:34816
s_waitcnt lgkmcnt(12)
v_mfma_f32_32x32x16_bf16 v[16:31], v[216:219], v[132:135], v[16:31]
buffer_load_dwordx4 v[72:75], v0, s[8:11], s58 offen offset:2048
ds_read_b64_tr_b16 v[212:213], v4 offset:33024
ds_read_b64_tr_b16 v[214:215], v4 offset:35072
s_waitcnt lgkmcnt(12)
v_mfma_f32_32x32x16_bf16 v[32:47], v[220:223], v[132:135], v[32:47]
buffer_load_dwordx4 v[76:79], v0, s[8:11], s58 offen offset:3072
ds_read_b64_tr_b16 v[216:217], v4 offset:36864
ds_read_b64_tr_b16 v[218:219], v4 offset:38912
s_waitcnt lgkmcnt(12)
v_mfma_f32_32x32x16_bf16 v[16:31], v[224:227], v[136:139], v[16:31]
ds_read_b64_tr_b16 v[220:221], v4 offset:37120
ds_read_b64_tr_b16 v[222:223], v4 offset:39168
s_waitcnt lgkmcnt(12)
v_mfma_f32_32x32x16_bf16 v[32:47], v[228:231], v[136:139], v[32:47]
s_mov_b32 exec_lo, 0
s_mov_b32 exec_hi, 0xf0000000
buffer_load_dword v10, v12, s[4:7], s22 offen
s_mov_b64 exec, -1
ds_read_b64_tr_b16 v[224:225], v4 offset:40960
ds_read_b64_tr_b16 v[226:227], v4 offset:43008
s_waitcnt lgkmcnt(12)
v_mfma_f32_32x32x16_bf16 v[16:31], v[232:235], v[140:143], v[16:31]
s_mov_b64 exec, 0xffff
buffer_load_dword v10, v9, s[8:11], s45 offen
s_mov_b64 exec, -1
ds_read_b64_tr_b16 v[228:229], v4 offset:41216
ds_read_b64_tr_b16 v[230:231], v4 offset:43264
s_waitcnt lgkmcnt(12)
v_mfma_f32_32x32x16_bf16 v[32:47], v[236:239], v[140:143], v[32:47]
ds_read_b64_tr_b16 v[232:233], v4 offset:45056
ds_read_b64_tr_b16 v[234:235], v4 offset:47104
s_waitcnt vmcnt(19)
s_waitcnt lgkmcnt(12)
v_mfma_f32_32x32x16_bf16 v[16:31], v[208:211], v[80:83], v[16:31]
s_add_u32 m0, s35, 131072
s_add_u32 s31, s54, 0
buffer_load_dwordx4 v8, s[12:15], s31 offen lds
ds_read_b64_tr_b16 v[236:237], v4 offset:45312
ds_read_b64_tr_b16 v[238:239], v4 offset:47360
s_waitcnt lgkmcnt(12)
v_mfma_f32_32x32x16_bf16 v[32:47], v[212:215], v[80:83], v[32:47]
s_add_u32 m0, s35, 139264
s_add_u32 s31, s54, 40960
buffer_load_dwordx4 v8, s[12:15], s31 offen lds
ds_read_b64_tr_b16 v[208:209], v4 offset:49152
ds_read_b64_tr_b16 v[210:211], v4 offset:51200
s_waitcnt lgkmcnt(12)
v_mfma_f32_32x32x16_bf16 v[16:31], v[216:219], v[84:87], v[16:31]
s_add_u32 m0, s35, 147456
s_add_u32 s31, s54, 81920
buffer_load_dwordx4 v8, s[12:15], s31 offen lds
ds_read_b64_tr_b16 v[212:213], v4 offset:49408
ds_read_b64_tr_b16 v[214:215], v4 offset:51456
s_waitcnt lgkmcnt(12)
v_mfma_f32_32x32x16_bf16 v[32:47], v[220:223], v[84:87], v[32:47]
s_add_u32 m0, s35, 155648
s_add_u32 s31, s54, 122880
buffer_load_dwordx4 v8, s[12:15], s31 offen lds
ds_read_b64_tr_b16 v[216:217], v4 offset:53248
ds_read_b64_tr_b16 v[218:219], v4 offset:55296
s_waitcnt lgkmcnt(12)
v_mfma_f32_32x32x16_bf16 v[16:31], v[224:227], v[88:91], v[16:31]
buffer_load_dwordx4 v[112:115], v13, s[8:11], s59 offen offset:0
ds_read_b64_tr_b16 v[220:221], v4 offset:53504
ds_read_b64_tr_b16 v[222:223], v4 offset:55552
s_waitcnt lgkmcnt(12)
v_mfma_f32_32x32x16_bf16 v[32:47], v[228:231], v[88:91], v[32:47]
buffer_load_dwordx4 v[116:119], v13, s[8:11], s59 offen offset:1024
ds_read_b64_tr_b16 v[224:225], v4 offset:57344
ds_read_b64_tr_b16 v[226:227], v4 offset:59392
s_waitcnt lgkmcnt(12)
v_mfma_f32_32x32x16_bf16 v[16:31], v[232:235], v[92:95], v[16:31]
buffer_load_dwordx4 v[120:123], v13, s[8:11], s59 offen offset:2048
ds_read_b64_tr_b16 v[228:229], v4 offset:57600
ds_read_b64_tr_b16 v[230:231], v4 offset:59648
s_waitcnt lgkmcnt(12)
v_mfma_f32_32x32x16_bf16 v[32:47], v[236:239], v[92:95], v[32:47]
buffer_load_dwordx4 v[124:127], v13, s[8:11], s59 offen offset:3072
ds_read_b64_tr_b16 v[232:233], v4 offset:61440
ds_read_b64_tr_b16 v[234:235], v4 offset:63488
s_waitcnt vmcnt(23)
s_waitcnt lgkmcnt(12)
v_mfma_f32_32x32x16_bf16 v[16:31], v[208:211], v[96:99], v[16:31]
buffer_load_dwordx4 v[128:131], v0, s[8:11], s59 offen offset:0
ds_read_b64_tr_b16 v[236:237], v4 offset:61696
ds_read_b64_tr_b16 v[238:239], v4 offset:63744
s_waitcnt lgkmcnt(12)
v_mfma_f32_32x32x16_bf16 v[32:47], v[212:215], v[96:99], v[32:47]
buffer_load_dwordx4 v[132:135], v0, s[8:11], s59 offen offset:1024
s_waitcnt vmcnt(20)
s_barrier
ds_read_b64_tr_b16 v[208:209], v5 offset:32768
ds_read_b64_tr_b16 v[210:211], v5 offset:34816
s_waitcnt lgkmcnt(12)
v_mfma_f32_32x32x16_bf16 v[16:31], v[216:219], v[100:103], v[16:31]
buffer_load_dwordx4 v[136:139], v0, s[8:11], s59 offen offset:2048
ds_read_b64_tr_b16 v[212:213], v5 offset:33024
ds_read_b64_tr_b16 v[214:215], v5 offset:35072
s_waitcnt lgkmcnt(12)
v_mfma_f32_32x32x16_bf16 v[32:47], v[220:223], v[100:103], v[32:47]
buffer_load_dwordx4 v[140:143], v0, s[8:11], s59 offen offset:3072
ds_read_b64_tr_b16 v[216:217], v5 offset:36864
ds_read_b64_tr_b16 v[218:219], v5 offset:38912
s_waitcnt lgkmcnt(12)
v_mfma_f32_32x32x16_bf16 v[16:31], v[224:227], v[104:107], v[16:31]
buffer_load_dwordx4 v[240:243], v13, s[8:11], s33 offen offset:0
ds_read_b64_tr_b16 v[220:221], v5 offset:37120
ds_read_b64_tr_b16 v[222:223], v5 offset:39168
s_waitcnt lgkmcnt(12)
v_mfma_f32_32x32x16_bf16 v[32:47], v[228:231], v[104:107], v[32:47]
buffer_load_dwordx4 v[244:247], v13, s[8:11], s33 offen offset:1024
ds_read_b64_tr_b16 v[224:225], v5 offset:40960
ds_read_b64_tr_b16 v[226:227], v5 offset:43008
s_waitcnt lgkmcnt(12)
v_mfma_f32_32x32x16_bf16 v[16:31], v[232:235], v[108:111], v[16:31]
buffer_load_dwordx4 v[248:251], v13, s[8:11], s33 offen offset:2048
ds_read_b64_tr_b16 v[228:229], v5 offset:41216
ds_read_b64_tr_b16 v[230:231], v5 offset:43264
s_waitcnt lgkmcnt(12)
v_mfma_f32_32x32x16_bf16 v[32:47], v[236:239], v[108:111], v[32:47]
buffer_load_dwordx4 v[252:255], v13, s[8:11], s33 offen offset:3072
ds_read_b64_tr_b16 v[232:233], v5 offset:45056
ds_read_b64_tr_b16 v[234:235], v5 offset:47104
s_waitcnt vmcnt(22)
s_waitcnt lgkmcnt(12)
v_mfma_f32_32x32x16_bf16 v[16:31], v[208:211], v[48:51], v[16:31]
s_mov_b64 exec, 0xffff
buffer_load_dword v10, v9, s[8:11], s46 offen
s_mov_b64 exec, -1
ds_read_b64_tr_b16 v[236:237], v5 offset:45312
ds_read_b64_tr_b16 v[238:239], v5 offset:47360
s_waitcnt lgkmcnt(12)
v_mfma_f32_32x32x16_bf16 v[32:47], v[212:215], v[48:51], v[32:47]
ds_read_b64_tr_b16 v[208:209], v5 offset:49152
ds_read_b64_tr_b16 v[210:211], v5 offset:51200
s_waitcnt lgkmcnt(12)
v_mfma_f32_32x32x16_bf16 v[16:31], v[216:219], v[52:55], v[16:31]
ds_read_b64_tr_b16 v[212:213], v5 offset:49408
ds_read_b64_tr_b16 v[214:215], v5 offset:51456
s_waitcnt lgkmcnt(12)
v_mfma_f32_32x32x16_bf16 v[32:47], v[220:223], v[52:55], v[32:47]
s_add_u32 m0, s35, 65536
s_add_u32 s31, s40, 0
buffer_load_dwordx4 v3, s[4:7], s31 offen lds
ds_read_b64_tr_b16 v[216:217], v5 offset:53248
ds_read_b64_tr_b16 v[218:219], v5 offset:55296
s_waitcnt lgkmcnt(12)
v_mfma_f32_32x32x16_bf16 v[16:31], v[224:227], v[56:59], v[16:31]
ds_read_b64_tr_b16 v[220:221], v5 offset:53504
ds_read_b64_tr_b16 v[222:223], v5 offset:55552
s_waitcnt lgkmcnt(12)
v_mfma_f32_32x32x16_bf16 v[32:47], v[228:231], v[56:59], v[32:47]
s_add_u32 m0, s35, 73728
s_add_u32 s31, s40, 262144
buffer_load_dwordx4 v3, s[4:7], s31 offen lds
ds_read_b64_tr_b16 v[224:225], v5 offset:57344
ds_read_b64_tr_b16 v[226:227], v5 offset:59392
s_waitcnt lgkmcnt(12)
v_mfma_f32_32x32x16_bf16 v[16:31], v[232:235], v[60:63], v[16:31]
ds_read_b64_tr_b16 v[228:229], v5 offset:57600
ds_read_b64_tr_b16 v[230:231], v5 offset:59648
s_waitcnt lgkmcnt(12)
v_mfma_f32_32x32x16_bf16 v[32:47], v[236:239], v[60:63], v[32:47]
buffer_load_dwordx4 v[144:147], v13, s[8:11], s45 offen offset:0
ds_read_b64_tr_b16 v[232:233], v5 offset:61440
ds_read_b64_tr_b16 v[234:235], v5 offset:63488
s_waitcnt vmcnt(22)
s_waitcnt lgkmcnt(12)
v_mfma_f32_32x32x16_bf16 v[16:31], v[208:211], v[64:67], v[16:31]
ds_read_b64_tr_b16 v[236:237], v5 offset:61696
ds_read_b64_tr_b16 v[238:239], v5 offset:63744
s_waitcnt lgkmcnt(12)
v_mfma_f32_32x32x16_bf16 v[32:47], v[212:215], v[64:67], v[32:47]
buffer_load_dwordx4 v[148:151], v13, s[8:11], s45 offen offset:1024
s_waitcnt vmcnt(17)
s_barrier
ds_read_b64_tr_b16 v[208:209], v6 offset:0
ds_read_b64_tr_b16 v[210:211], v6 offset:2048
s_waitcnt lgkmcnt(12)
v_mfma_f32_32x32x16_bf16 v[16:31], v[216:219], v[68:71], v[16:31]
ds_read_b64_tr_b16 v[212:213], v6 offset:256
ds_read_b64_tr_b16 v[214:215], v6 offset:2304
s_waitcnt lgkmcnt(12)
v_mfma_f32_32x32x16_bf16 v[32:47], v[220:223], v[68:71], v[32:47]
buffer_load_dwordx4 v[152:155], v13, s[8:11], s45 offen offset:2048
ds_read_b64_tr_b16 v[216:217], v6 offset:4096
ds_read_b64_tr_b16 v[218:219], v6 offset:6144
s_waitcnt lgkmcnt(12)
v_mfma_f32_32x32x16_bf16 v[16:31], v[224:227], v[72:75], v[16:31]
ds_read_b64_tr_b16 v[220:221], v6 offset:4352
ds_read_b64_tr_b16 v[222:223], v6 offset:6400
s_waitcnt lgkmcnt(12)
v_mfma_f32_32x32x16_bf16 v[32:47], v[228:231], v[72:75], v[32:47]
buffer_load_dwordx4 v[156:159], v13, s[8:11], s45 offen offset:3072
ds_read_b64_tr_b16 v[224:225], v6 offset:8192
ds_read_b64_tr_b16 v[226:227], v6 offset:10240
s_waitcnt lgkmcnt(12)
v_mfma_f32_32x32x16_bf16 v[16:31], v[232:235], v[76:79], v[16:31]
ds_read_b64_tr_b16 v[228:229], v6 offset:8448
ds_read_b64_tr_b16 v[230:231], v6 offset:10496
s_waitcnt lgkmcnt(12)
v_mfma_f32_32x32x16_bf16 v[32:47], v[236:239], v[76:79], v[32:47]
s_add_u32 m0, s35, 81920
s_add_u32 s31, s40, 524288
buffer_load_dwordx4 v3, s[4:7], s31 offen lds
ds_read_b64_tr_b16 v[232:233], v6 offset:12288
ds_read_b64_tr_b16 v[234:235], v6 offset:14336
s_waitcnt vmcnt(16)
s_waitcnt lgkmcnt(12)
v_mfma_f32_32x32x16_bf16 v[16:31], v[208:211], v[112:115], v[16:31]
ds_read_b64_tr_b16 v[236:237], v6 offset:12544
ds_read_b64_tr_b16 v[238:239], v6 offset:14592
s_waitcnt lgkmcnt(12)
v_mfma_f32_32x32x16_bf16 v[32:47], v[212:215], v[112:115], v[32:47]
s_add_u32 m0, s35, 90112
s_add_u32 s31, s40, 786432
buffer_load_dwordx4 v3, s[4:7], s31 offen lds
ds_read_b64_tr_b16 v[208:209], v6 offset:16384
ds_read_b64_tr_b16 v[210:211], v6 offset:18432
s_waitcnt lgkmcnt(12)
v_mfma_f32_32x32x16_bf16 v[16:31], v[216:219], v[116:119], v[16:31]
ds_read_b64_tr_b16 v[212:213], v6 offset:16640
ds_read_b64_tr_b16 v[214:215], v6 offset:18688
s_waitcnt lgkmcnt(12)
v_mfma_f32_32x32x16_bf16 v[32:47], v[220:223], v[116:119], v[32:47]
buffer_load_dwordx4 v[160:163], v0, s[8:11], s45 offen offset:0
ds_read_b64_tr_b16 v[216:217], v6 offset:20480
ds_read_b64_tr_b16 v[218:219], v6 offset:22528
s_waitcnt lgkmcnt(12)
v_mfma_f32_32x32x16_bf16 v[16:31], v[224:227], v[120:123], v[16:31]
ds_read_b64_tr_b16 v[220:221], v6 offset:20736
ds_read_b64_tr_b16 v[222:223], v6 offset:22784
s_waitcnt lgkmcnt(12)
v_mfma_f32_32x32x16_bf16 v[32:47], v[228:231], v[120:123], v[32:47]
buffer_load_dwordx4 v[164:167], v0, s[8:11], s45 offen offset:1024
ds_read_b64_tr_b16 v[224:225], v6 offset:24576
ds_read_b64_tr_b16 v[226:227], v6 offset:26624
s_waitcnt lgkmcnt(12)
v_mfma_f32_32x32x16_bf16 v[16:31], v[232:235], v[124:127], v[16:31]
ds_read_b64_tr_b16 v[228:229], v6 offset:24832
ds_read_b64_tr_b16 v[230:231], v6 offset:26880
s_waitcnt lgkmcnt(12)
v_mfma_f32_32x32x16_bf16 v[32:47], v[236:239], v[124:127], v[32:47]
buffer_load_dwordx4 v[168:171], v0, s[8:11], s45 offen offset:2048
ds_read_b64_tr_b16 v[232:233], v6 offset:28672
ds_read_b64_tr_b16 v[234:235], v6 offset:30720
s_waitcnt vmcnt(16)
s_waitcnt lgkmcnt(12)
v_mfma_f32_32x32x16_bf16 v[16:31], v[208:211], v[128:131], v[16:31]
ds_read_b64_tr_b16 v[236:237], v6 offset:28928
ds_read_b64_tr_b16 v[238:239], v6 offset:30976
s_waitcnt lgkmcnt(12)
v_mfma_f32_32x32x16_bf16 v[32:47], v[212:215], v[128:131], v[32:47]
buffer_load_dwordx4 v[172:175], v0, s[8:11], s45 offen offset:3072
s_waitcnt lgkmcnt(10)
v_mfma_f32_32x32x16_bf16 v[16:31], v[216:219], v[132:135], v[16:31]
s_waitcnt lgkmcnt(8)
v_mfma_f32_32x32x16_bf16 v[32:47], v[220:223], v[132:135], v[32:47]
s_waitcnt lgkmcnt(6)
v_mfma_f32_32x32x16_bf16 v[16:31], v[224:227], v[136:139], v[16:31]
s_waitcnt lgkmcnt(4)
v_mfma_f32_32x32x16_bf16 v[32:47], v[228:231], v[136:139], v[32:47]
s_waitcnt lgkmcnt(2)
v_mfma_f32_32x32x16_bf16 v[16:31], v[232:235], v[140:143], v[16:31]
s_waitcnt lgkmcnt(0)
v_mfma_f32_32x32x16_bf16 v[32:47], v[236:239], v[140:143], v[32:47]
v_subrev_u32 v4, s30, v4
v_subrev_u32 v5, s30, v5
v_subrev_u32 v6, s30, v6
v_mov_b32 v8, 0xffff0000
v_and_b32 v14, 31, v2
v_mul_u32_u24 v14, 80, v14
s_waitcnt vmcnt(13)
v_lshlrev_b32 v208, 16, v240
v_and_b32 v209, v8, v240
v_lshlrev_b32 v210, 16, v241
v_and_b32 v211, v8, v241
v_lshlrev_b32 v212, 16, v242
v_and_b32 v213, v8, v242
v_lshlrev_b32 v214, 16, v243
v_and_b32 v215, v8, v243
v_lshlrev_b32 v216, 16, v244
v_and_b32 v217, v8, v244
v_lshlrev_b32 v218, 16, v245
v_and_b32 v219, v8, v245
v_lshlrev_b32 v220, 16, v246
v_and_b32 v221, v8, v246
v_lshlrev_b32 v222, 16, v247
v_and_b32 v223, v8, v247
v_lshlrev_b32 v224, 16, v248
v_and_b32 v225, v8, v248
v_lshlrev_b32 v226, 16, v249
v_and_b32 v227, v8, v249
v_lshlrev_b32 v228, 16, v250
v_and_b32 v229, v8, v250
v_lshlrev_b32 v230, 16, v251
v_and_b32 v231, v8, v251
v_lshlrev_b32 v232, 16, v252
v_and_b32 v233, v8, v252
v_lshlrev_b32 v234, 16, v253
v_and_b32 v235, v8, v253
v_lshlrev_b32 v236, 16, v254
v_and_b32 v237, v8, v254
v_lshlrev_b32 v238, 16, v255
v_and_b32 v239, v8, v255
v_add_f32 v16, v16, v208
v_add_f32 v17, v17, v209
v_add_f32 v18, v18, v210
v_add_f32 v19, v19, v211
v_add_f32 v20, v20, v212
v_add_f32 v21, v21, v213
v_add_f32 v22, v22, v214
v_add_f32 v23, v23, v215
v_add_f32 v24, v24, v216
v_add_f32 v25, v25, v217
v_add_f32 v26, v26, v218
v_add_f32 v27, v27, v219
v_add_f32 v28, v28, v220
v_add_f32 v29, v29, v221
v_add_f32 v30, v30, v222
v_add_f32 v31, v31, v223
v_add_f32 v32, v32, v224
v_add_f32 v33, v33, v225
v_add_f32 v34, v34, v226
v_add_f32 v35, v35, v227
v_add_f32 v36, v36, v228
v_add_f32 v37, v37, v229
v_add_f32 v38, v38, v230
v_add_f32 v39, v39, v231
v_add_f32 v40, v40, v232
v_add_f32 v41, v41, v233
v_add_f32 v42, v42, v234
v_add_f32 v43, v43, v235
v_add_f32 v44, v44, v236
v_add_f32 v45, v45, v237
v_add_f32 v46, v46, v238
v_add_f32 v47, v47, v239
v_cvt_pk_bf16_f32 v240, v16, v17
v_cvt_pk_bf16_f32 v241, v18, v19
v_cvt_pk_bf16_f32 v242, v20, v21
v_cvt_pk_bf16_f32 v243, v22, v23
v_cvt_pk_bf16_f32 v244, v24, v25
v_cvt_pk_bf16_f32 v245, v26, v27
v_cvt_pk_bf16_f32 v246, v28, v29
v_cvt_pk_bf16_f32 v247, v30, v31
v_cvt_pk_bf16_f32 v248, v32, v33
v_cvt_pk_bf16_f32 v249, v34, v35
v_cvt_pk_bf16_f32 v250, v36, v37
v_cvt_pk_bf16_f32 v251, v38, v39
v_cvt_pk_bf16_f32 v252, v40, v41
v_cvt_pk_bf16_f32 v253, v42, v43
v_cvt_pk_bf16_f32 v254, v44, v45
v_cvt_pk_bf16_f32 v255, v46, v47
buffer_store_dwordx4 v[240:243], v13, s[8:11], s63 offen offset:0 sc1
buffer_store_dwordx4 v[244:247], v13, s[8:11], s63 offen offset:1024 sc1
buffer_store_dwordx4 v[248:251], v13, s[8:11], s63 offen offset:2048 sc1
buffer_store_dwordx4 v[252:255], v13, s[8:11], s63 offen offset:3072 sc1
v_add_f32 v48, v16, v17
v_mul_f32 v49, v16, v16
v_fmac_f32 v49, v17, v17
v_add_f32 v50, v18, v19
v_mul_f32 v51, v18, v18
v_fmac_f32 v51, v19, v19
v_add_f32 v48, v48, v20
v_fmac_f32 v49, v20, v20
v_add_f32 v50, v50, v21
v_fmac_f32 v51, v21, v21
v_add_f32 v48, v48, v22
v_fmac_f32 v49, v22, v22
v_add_f32 v50, v50, v23
v_fmac_f32 v51, v23, v23
v_add_f32 v48, v48, v24
v_fmac_f32 v49, v24, v24
v_add_f32 v50, v50, v25
v_fmac_f32 v51, v25, v25
v_add_f32 v48, v48, v26
v_fmac_f32 v49, v26, v26
v_add_f32 v50, v50, v27
v_fmac_f32 v51, v27, v27
v_add_f32 v48, v48, v28
v_fmac_f32 v49, v28, v28
v_add_f32 v50, v50, v29
v_fmac_f32 v51, v29, v29
v_add_f32 v48, v48, v30
v_fmac_f32 v49, v30, v30
v_add_f32 v50, v50, v31
v_fmac_f32 v51, v31, v31
v_add_f32 v48, v48, v32
v_fmac_f32 v49, v32, v32
v_add_f32 v50, v50, v33
v_fmac_f32 v51, v33, v33
v_add_f32 v48, v48, v34
v_fmac_f32 v49, v34, v34
v_add_f32 v50, v50, v35
v_fmac_f32 v51, v35, v35
v_add_f32 v48, v48, v36
v_fmac_f32 v49, v36, v36
v_add_f32 v50, v50, v37
v_fmac_f32 v51, v37, v37
v_add_f32 v48, v48, v38
v_fmac_f32 v49, v38, v38
v_add_f32 v50, v50, v39
v_fmac_f32 v51, v39, v39
v_add_f32 v48, v48, v40
v_fmac_f32 v49, v40, v40
v_add_f32 v50, v50, v41
v_fmac_f32 v51, v41, v41
v_add_f32 v48, v48, v42
v_fmac_f32 v49, v42, v42
v_add_f32 v50, v50, v43
v_fmac_f32 v51, v43, v43
v_add_f32 v48, v48, v44
v_fmac_f32 v49, v44, v44
v_add_f32 v50, v50, v45
v_fmac_f32 v51, v45, v45
v_add_f32 v48, v48, v46
v_fmac_f32 v49, v46, v46
v_add_f32 v50, v50, v47
v_fmac_f32 v51, v47, v47
v_add_f32 v48, v48, v50
v_add_f32 v49, v49, v51
v_mov_b32 v50, v48
v_mov_b32 v51, v49
s_nop 0
v_permlane32_swap_b32 v50, v48
v_permlane32_swap_b32 v51, v49
v_add_f32 v48, v48, v50
v_add_f32 v49, v49, v51
s_mov_b32 exec_hi, 0
buffer_store_dwordx2 v[48:49], v14, s[8:11], s62 offen sc1
s_mov_b64 exec, -1
s_nop 1
s_branch Lat_join
Lat_end:
s_endpgm
.globl l3_kernel
.p2align 8
.type l3_kernel,@function
l3_kernel:
s_load_dwordx2 s[4:5], s[0:1], 0
s_load_dwordx2 s[8:9], s[0:1], 104
s_load_dwordx2 s[12:13], s[0:1], 88
s_mov_b32 s6, 0x280000
s_mov_b32 s7, 0x00020000
s_mov_b32 s10, 0x10000000
s_mov_b32 s11, 0x00020000
s_mov_b32 s14, 0x280000
s_mov_b32 s15, 0x00020000
v_lshrrev_b32 v1, 6, v0
v_and_b32 v2, 63, v0
v_readfirstlane_b32 s24, v1
s_cmp_ge_u32 s2, 256
s_cbranch_scc1 Ll3_end
s_bfe_u32 s25, s2, 0x20001
s_lshl_b32 s25, s25, 3
s_lshr_b32 s27, s2, 5
s_add_u32 s25, s25, s27
s_and_b32 s26, s2, 1
s_lshl_b32 s26, s26, 2
s_bfe_u32 s27, s2, 0x20003
s_add_u32 s26, s26, s27
v_lshlrev_b32 v3, 4, v2
v_add_u32 v4, 0x1000, v3
s_mul_i32 s28, s24, 21
s_cmp_eq_u32 s24, 5
s_cselect_b32 s28, 106, s28
s_sub_u32 s27, s24, 6
s_mul_i32 s27, s27, 27
s_cmp_ge_u32 s24, 6
s_cselect_b32 s28, s27, s28
s_cselect_b32 s29, 54, 128
s_mov_b32 s30, 54525952
s_cselect_b32 s30, 47185920, s30
s_mov_b32 s31, 71303168
s_cselect_b32 s31, 76546048, s31
s_mul_i32 s32, s25, s29
s_add_u32 s32, s32, s28
s_lshl_b32 s32, s32, 12
s_add_u32 s30, s30, s32
s_mul_i32 s32, s26, s29
s_add_u32 s32, s32, s28
s_mul_i32 s32, s32, 5120
s_add_u32 s31, s31, s32
v_and_b32 v5, 15, v2
v_lshrrev_b32 v6, 4, v2
v_mul_u32_u24 v7, 1280, v5
v_lshl_add_u32 v7, v6, 3, v7
v_lshlrev_b32 v8, 4, v5
v_and_b32 v9, 1, v6
v_lshl_add_u32 v8, v9, 9, v8
v_lshrrev_b32 v9, 1, v6
v_lshl_add_u32 v8, v9, 3, v8
s_and_b32 s33, s24, 3
s_lshr_b32 s34, s24, 2
s_lshl_b32 s35, s25, 2
s_add_u32 s35, s35, s33
s_mul_i32 s35, s35, 20480
s_mul_i32 s36, s26, 160
s_add_u32 s35, s35, s36
s_lshl_b32 s36, s34, 5
s_add_u32 s35, s35, s36
s_lshl_b32 s36, s25, 1
s_lshr_b32 s37, s33, 1
s_add_u32 s36, s36, s37
s_mul_i32 s36, s36, 40
s_mul_i32 s37, s26, 5
s_add_u32 s36, s36, s37
s_add_u32 s36, s36, s34
s_lshl_b32 s36, s36, 10
s_and_b32 s37, s33, 1
s_lshl_b32 s37, s37, 8
s_add_u32 s36, s36, s37
s_add_u32 s36, s36, 44040192
s_add_u32 s37, s36, 4096
s_waitcnt lgkmcnt(0)
buffer_load_dwordx2 v[10:11], v7, s[4:7], s35 offen offset:0
buffer_load_dwordx2 v[16:17], v8, s[8:11], s36 offen offset:0
buffer_load_dwordx2 v[12:13], v7, s[4:7], s35 offen offset:64
buffer_load_dwordx2 v[18:19], v8, s[8:11], s36 offen offset:2048
buffer_load_dwordx2 v[14:15], v7, s[4:7], s35 offen offset:128
buffer_load_dwordx2 v[20:21], v8, s[8:11], s37 offen offset:0
s_cmp_ge_u32 s24, 6
s_cselect_b32 s38, 6, 5
s_cbranch_scc1 Ll3_p1
s_cmp_ge_u32 s24, 4
s_cbranch_scc1 Ll3_p2
Ll3_p3:
buffer_load_dwordx4 v[152:155], v3, s[8:11], s31 offen offset:0
buffer_load_dwordx4 v[156:159], v3, s[8:11], s31 offen offset:1024
buffer_load_dwordx4 v[160:163], v3, s[8:11], s31 offen offset:2048
buffer_load_dwordx4 v[164:167], v3, s[8:11], s31 offen offset:3072
buffer_load_dwordx4 v[168:171], v4, s[8:11], s31 offen offset:0
buffer_load_dwordx4 v[136:139], v3, s[8:11], s30 offen offset:0
buffer_load_dwordx4 v[140:143], v3, s[8:11], s30 offen offset:1024
buffer_load_dwordx4 v[144:147], v3, s[8:11], s30 offen offset:2048
buffer_load_dwordx4 v[148:151], v3, s[8:11], s30 offen offset:3072
s_add_u32 s30, s30, 4096
s_add_u32 s31, s31, 5120
buffer_load_dwordx4 v[44:47], v3, s[8:11], s31 offen offset:0
buffer_load_dwordx4 v[48:51], v3, s[8:11], s31 offen offset:1024
buffer_load_dwordx4 v[52:55], v3, s[8:11], s31 offen offset:2048
buffer_load_dwordx4 v[56:59], v3, s[8:11], s31 offen offset:3072
buffer_load_dwordx4 v[60:63], v4, s[8:11], s31 offen offset:0
buffer_load_dwordx4 v[28:31], v3, s[8:11], s30 offen offset:0
buffer_load_dwordx4 v[32:35], v3, s[8:11], s30 offen offset:1024
buffer_load_dwordx4 v[36:39], v3, s[8:11], s30 offen offset:2048
buffer_load_dwordx4 v[40:43], v3, s[8:11], s30 offen offset:3072
s_add_u32 s30, s30, 4096
s_add_u32 s31, s31, 5120
buffer_load_dwordx4 v[80:83], v3, s[8:11], s31 offen offset:0
buffer_load_dwordx4 v[84:87], v3, s[8:11], s31 offen offset:1024
buffer_load_dwordx4 v[88:91], v3, s[8:11], s31 offen offset:2048
buffer_load_dwordx4 v[92:95], v3, s[8:11], s31 offen offset:3072
buffer_load_dwordx4 v[96:99], v4, s[8:11], s31 offen offset:0
buffer_load_dwordx4 v[64:67], v3, s[8:11], s30 offen offset:0
buffer_load_dwordx4 v[68:71], v3, s[8:11], s30 offen offset:1024
buffer_load_dwordx4 v[72:75], v3, s[8:11], s30 offen offset:2048
buffer_load_dwordx4 v[76:79], v3, s[8:11], s30 offen offset:3072
s_add_u32 s30, s30, 4096
s_add_u32 s31, s31, 5120
buffer_load_dwordx4 v[116:119], v3, s[8:11], s31 offen offset:0
buffer_load_dwordx4 v[120:123], v3, s[8:11], s31 offen offset:1024
buffer_load_dwordx4 v[124:127], v3, s[8:11], s31 offen offset:2048
buffer_load_dwordx4 v[128:131], v3, s[8:11], s31 offen offset:3072
buffer_load_dwordx4 v[132:135], v4, s[8:11], s31 offen offset:0
buffer_load_dwordx4 v[100:103], v3, s[8:11], s30 offen offset:0
buffer_load_dwordx4 v[104:107], v3, s[8:11], s30 offen offset:1024
buffer_load_dwordx4 v[108:111], v3, s[8:11], s30 offen offset:2048
buffer_load_dwordx4 v[112:115], v3, s[8:11], s30 offen offset:3072
s_add_u32 s30, s30, 4096
s_add_u32 s31, s31, 5120
v_accvgpr_write_b32 a0, 0
v_accvgpr_write_b32 a1, 0
v_accvgpr_write_b32 a2, 0
v_accvgpr_write_b32 a3, 0
v_accvgpr_write_b32 a4, 0
v_accvgpr_write_b32 a5, 0
v_accvgpr_write_b32 a6, 0
v_accvgpr_write_b32 a7, 0
v_accvgpr_write_b32 a8, 0
v_accvgpr_write_b32 a9, 0
v_accvgpr_write_b32 a10, 0
v_accvgpr_write_b32 a11, 0
v_accvgpr_write_b32 a12, 0
v_accvgpr_write_b32 a13, 0
v_accvgpr_write_b32 a14, 0
v_accvgpr_write_b32 a15, 0
v_accvgpr_write_b32 a16, 0
v_accvgpr_write_b32 a17, 0
v_accvgpr_write_b32 a18, 0
v_accvgpr_write_b32 a19, 0
v_accvgpr_write_b32 a20, 0
v_accvgpr_write_b32 a21, 0
v_accvgpr_write_b32 a22, 0
v_accvgpr_write_b32 a23, 0
v_accvgpr_write_b32 a24, 0
v_accvgpr_write_b32 a25, 0
v_accvgpr_write_b32 a26, 0
v_accvgpr_write_b32 a27, 0
v_accvgpr_write_b32 a28, 0
v_accvgpr_write_b32 a29, 0
v_accvgpr_write_b32 a30, 0
v_accvgpr_write_b32 a31, 0
v_accvgpr_write_b32 a32, 0
v_accvgpr_write_b32 a33, 0
v_accvgpr_write_b32 a34, 0
v_accvgpr_write_b32 a35, 0
v_accvgpr_write_b32 a36, 0
v_accvgpr_write_b32 a37, 0
v_accvgpr_write_b32 a38, 0
v_accvgpr_write_b32 a39, 0
v_accvgpr_write_b32 a40, 0
v_accvgpr_write_b32 a41, 0
v_accvgpr_write_b32 a42, 0
v_accvgpr_write_b32 a43, 0
v_accvgpr_write_b32 a44, 0
v_accvgpr_write_b32 a45, 0
v_accvgpr_write_b32 a46, 0
v_accvgpr_write_b32 a47, 0
v_accvgpr_write_b32 a48, 0
v_accvgpr_write_b32 a49, 0
v_accvgpr_write_b32 a50, 0
v_accvgpr_write_b32 a51, 0
v_accvgpr_write_b32 a52, 0
v_accvgpr_write_b32 a53, 0
v_accvgpr_write_b32 a54, 0
v_accvgpr_write_b32 a55, 0
v_accvgpr_write_b32 a56, 0
v_accvgpr_write_b32 a57, 0
v_accvgpr_write_b32 a58, 0
v_accvgpr_write_b32 a59, 0
v_accvgpr_write_b32 a60, 0
v_accvgpr_write_b32 a61, 0
v_accvgpr_write_b32 a62, 0
v_accvgpr_write_b32 a63, 0
v_accvgpr_write_b32 a64, 0
v_accvgpr_write_b32 a65, 0
v_accvgpr_write_b32 a66, 0
v_accvgpr_write_b32 a67, 0
v_accvgpr_write_b32 a68, 0
v_accvgpr_write_b32 a69, 0
v_accvgpr_write_b32 a70, 0
v_accvgpr_write_b32 a71, 0
v_accvgpr_write_b32 a72, 0
v_accvgpr_write_b32 a73, 0
v_accvgpr_write_b32 a74, 0
v_accvgpr_write_b32 a75, 0
v_accvgpr_write_b32 a76, 0
v_accvgpr_write_b32 a77, 0
v_accvgpr_write_b32 a78, 0
v_accvgpr_write_b32 a79, 0
s_branch Ll3_pos3b
Ll3_p2:
buffer_load_dwordx4 v[116:119], v3, s[8:11], s31 offen offset:0
buffer_load_dwordx4 v[120:123], v3, s[8:11], s31 offen offset:1024
buffer_load_dwordx4 v[124:127], v3, s[8:11], s31 offen offset:2048
buffer_load_dwordx4 v[128:131], v3, s[8:11], s31 offen offset:3072
buffer_load_dwordx4 v[132:135], v4, s[8:11], s31 offen offset:0
buffer_load_dwordx4 v[100:103], v3, s[8:11], s30 offen offset:0
buffer_load_dwordx4 v[104:107], v3, s[8:11], s30 offen offset:1024
buffer_load_dwordx4 v[108:111], v3, s[8:11], s30 offen offset:2048
buffer_load_dwordx4 v[112:115], v3, s[8:11], s30 offen offset:3072
s_add_u32 s30, s30, 4096
s_add_u32 s31, s31, 5120
buffer_load_dwordx4 v[152:155], v3, s[8:11], s31 offen offset:0
buffer_load_dwordx4 v[156:159], v3, s[8:11], s31 offen offset:1024
buffer_load_dwordx4 v[160:163], v3, s[8:11], s31 offen offset:2048
buffer_load_dwordx4 v[164:167], v3, s[8:11], s31 offen offset:3072
buffer_load_dwordx4 v[168:171], v4, s[8:11], s31 offen offset:0
buffer_load_dwordx4 v[136:139], v3, s[8:11], s30 offen offset:0
buffer_load_dwordx4 v[140:143], v3, s[8:11], s30 offen offset:1024
buffer_load_dwordx4 v[144:147], v3, s[8:11], s30 offen offset:2048
buffer_load_dwordx4 v[148:151], v3, s[8:11], s30 offen offset:3072
s_add_u32 s30, s30, 4096
s_add_u32 s31, s31, 5120
buffer_load_dwordx4 v[44:47], v3, s[8:11], s31 offen offset:0
buffer_load_dwordx4 v[48:51], v3, s[8:11], s31 offen offset:1024
buffer_load_dwordx4 v[52:55], v3, s[8:11], s31 offen offset:2048
buffer_load_dwordx4 v[56:59], v3, s[8:11], s31 offen offset:3072
buffer_load_dwordx4 v[60:63], v4, s[8:11], s31 offen offset:0
buffer_load_dwordx4 v[28:31], v3, s[8:11], s30 offen offset:0
buffer_load_dwordx4 v[32:35], v3, s[8:11], s30 offen offset:1024
buffer_load_dwordx4 v[36:39], v3, s[8:11], s30 offen offset:2048
buffer_load_dwordx4 v[40:43], v3, s[8:11], s30 offen offset:3072
s_add_u32 s30, s30, 4096
s_add_u32 s31, s31, 5120
buffer_load_dwordx4 v[80:83], v3, s[8:11], s31 offen offset:0
buffer_load_dwordx4 v[84:87], v3, s[8:11], s31 offen offset:1024
buffer_load_dwordx4 v[88:91], v3, s[8:11], s31 offen offset:2048
buffer_load_dwordx4 v[92:95], v3, s[8:11], s31 offen offset:3072
buffer_load_dwordx4 v[96:99], v4, s[8:11], s31 offen offset:0
buffer_load_dwordx4 v[64:67], v3, s[8:11], s30 offen offset:0
buffer_load_dwordx4 v[68:71], v3, s[8:11], s30 offen offset:1024
buffer_load_dwordx4 v[72:75], v3, s[8:11], s30 offen offset:2048
buffer_load_dwordx4 v[76:79], v3, s[8:11], s30 offen offset:3072
s_add_u32 s30, s30, 4096
s_add_u32 s31, s31, 5120
v_accvgpr_write_b32 a0, 0
v_accvgpr_write_b32 a1, 0
v_accvgpr_write_b32 a2, 0
v_accvgpr_write_b32 a3, 0
v_accvgpr_write_b32 a4, 0
v_accvgpr_write_b32 a5, 0
v_accvgpr_write_b32 a6, 0
v_accvgpr_write_b32 a7, 0
v_accvgpr_write_b32 a8, 0
v_accvgpr_write_b32 a9, 0
v_accvgpr_write_b32 a10, 0
v_accvgpr_write_b32 a11, 0
v_accvgpr_write_b32 a12, 0
v_accvgpr_write_b32 a13, 0
v_accvgpr_write_b32 a14, 0
v_accvgpr_write_b32 a15, 0
v_accvgpr_write_b32 a16, 0
v_accvgpr_write_b32 a17, 0
v_accvgpr_write_b32 a18, 0
v_accvgpr_write_b32 a19, 0
v_accvgpr_write_b32 a20, 0
v_accvgpr_write_b32 a21, 0
v_accvgpr_write_b32 a22, 0
v_accvgpr_write_b32 a23, 0
v_accvgpr_write_b32 a24, 0
v_accvgpr_write_b32 a25, 0
v_accvgpr_write_b32 a26, 0
v_accvgpr_write_b32 a27, 0
v_accvgpr_write_b32 a28, 0
v_accvgpr_write_b32 a29, 0
v_accvgpr_write_b32 a30, 0
v_accvgpr_write_b32 a31, 0
v_accvgpr_write_b32 a32, 0
v_accvgpr_write_b32 a33, 0
v_accvgpr_write_b32 a34, 0
v_accvgpr_write_b32 a35, 0
v_accvgpr_write_b32 a36, 0
v_accvgpr_write_b32 a37, 0
v_accvgpr_write_b32 a38, 0
v_accvgpr_write_b32 a39, 0
v_accvgpr_write_b32 a40, 0
v_accvgpr_write_b32 a41, 0
v_accvgpr_write_b32 a42, 0
v_accvgpr_write_b32 a43, 0
v_accvgpr_write_b32 a44, 0
v_accvgpr_write_b32 a45, 0
v_accvgpr_write_b32 a46, 0
v_accvgpr_write_b32 a47, 0
v_accvgpr_write_b32 a48, 0
v_accvgpr_write_b32 a49, 0
v_accvgpr_write_b32 a50, 0
v_accvgpr_write_b32 a51, 0
v_accvgpr_write_b32 a52, 0
v_accvgpr_write_b32 a53, 0
v_accvgpr_write_b32 a54, 0
v_accvgpr_write_b32 a55, 0
v_accvgpr_write_b32 a56, 0
v_accvgpr_write_b32 a57, 0
v_accvgpr_write_b32 a58, 0
v_accvgpr_write_b32 a59, 0
v_accvgpr_write_b32 a60, 0
v_accvgpr_write_b32 a61, 0
v_accvgpr_write_b32 a62, 0
v_accvgpr_write_b32 a63, 0
v_accvgpr_write_b32 a64, 0
v_accvgpr_write_b32 a65, 0
v_accvgpr_write_b32 a66, 0
v_accvgpr_write_b32 a67, 0
v_accvgpr_write_b32 a68, 0
v_accvgpr_write_b32 a69, 0
v_accvgpr_write_b32 a70, 0
v_accvgpr_write_b32 a71, 0
v_accvgpr_write_b32 a72, 0
v_accvgpr_write_b32 a73, 0
v_accvgpr_write_b32 a74, 0
v_accvgpr_write_b32 a75, 0
v_accvgpr_write_b32 a76, 0
v_accvgpr_write_b32 a77, 0
v_accvgpr_write_b32 a78, 0
v_accvgpr_write_b32 a79, 0
s_branch Ll3_pos2b
Ll3_p1:
buffer_load_dwordx4 v[80:83], v3, s[8:11], s31 offen offset:0
buffer_load_dwordx4 v[84:87], v3, s[8:11], s31 offen offset:1024
buffer_load_dwordx4 v[88:91], v3, s[8:11], s31 offen offset:2048
buffer_load_dwordx4 v[92:95], v3, s[8:11], s31 offen offset:3072
buffer_load_dwordx4 v[96:99], v4, s[8:11], s31 offen offset:0
buffer_load_dwordx4 v[64:67], v3, s[8:11], s30 offen offset:0
buffer_load_dwordx4 v[68:71], v3, s[8:11], s30 offen offset:1024
buffer_load_dwordx4 v[72:75], v3, s[8:11], s30 offen offset:2048
buffer_load_dwordx4 v[76:79], v3, s[8:11], s30 offen offset:3072
s_add_u32 s30, s30, 4096
s_add_u32 s31, s31, 5120
buffer_load_dwordx4 v[116:119], v3, s[8:11], s31 offen offset:0
buffer_load_dwordx4 v[120:123], v3, s[8:11], s31 offen offset:1024
buffer_load_dwordx4 v[124:127], v3, s[8:11], s31 offen offset:2048
buffer_load_dwordx4 v[128:131], v3, s[8:11], s31 offen offset:3072
buffer_load_dwordx4 v[132:135], v4, s[8:11], s31 offen offset:0
buffer_load_dwordx4 v[100:103], v3, s[8:11], s30 offen offset:0
buffer_load_dwordx4 v[104:107], v3, s[8:11], s30 offen offset:1024
buffer_load_dwordx4 v[108:111], v3, s[8:11], s30 offen offset:2048
buffer_load_dwordx4 v[112:115], v3, s[8:11], s30 offen offset:3072
s_add_u32 s30, s30, 4096
s_add_u32 s31, s31, 5120
buffer_load_dwordx4 v[152:155], v3, s[8:11], s31 offen offset:0
buffer_load_dwordx4 v[156:159], v3, s[8:11], s31 offen offset:1024
buffer_load_dwordx4 v[160:163], v3, s[8:11], s31 offen offset:2048
buffer_load_dwordx4 v[164:167], v3, s[8:11], s31 offen offset:3072
buffer_load_dwordx4 v[168:171], v4, s[8:11], s31 offen offset:0
buffer_load_dwordx4 v[136:139], v3, s[8:11], s30 offen offset:0
buffer_load_dwordx4 v[140:143], v3, s[8:11], s30 offen offset:1024
buffer_load_dwordx4 v[144:147], v3, s[8:11], s30 offen offset:2048
buffer_load_dwordx4 v[148:151], v3, s[8:11], s30 offen offset:3072
s_add_u32 s30, s30, 4096
s_add_u32 s31, s31, 5120
buffer_load_dwordx4 v[44:47], v3, s[8:11], s31 offen offset:0
buffer_load_dwordx4 v[48:51], v3, s[8:11], s31 offen offset:1024
buffer_load_dwordx4 v[52:55], v3, s[8:11], s31 offen offset:2048
buffer_load_dwordx4 v[56:59], v3, s[8:11], s31 offen offset:3072
buffer_load_dwordx4 v[60:63], v4, s[8:11], s31 offen offset:0
buffer_load_dwordx4 v[28:31], v3, s[8:11], s30 offen offset:0
buffer_load_dwordx4 v[32:35], v3, s[8:11], s30 offen offset:1024
buffer_load_dwordx4 v[36:39], v3, s[8:11], s30 offen offset:2048
buffer_load_dwordx4 v[40:43], v3, s[8:11], s30 offen offset:3072
s_add_u32 s30, s30, 4096
s_add_u32 s31, s31, 5120
v_accvgpr_write_b32 a0, 0
v_accvgpr_write_b32 a1, 0
v_accvgpr_write_b32 a2, 0
v_accvgpr_write_b32 a3, 0
v_accvgpr_write_b32 a4, 0
v_accvgpr_write_b32 a5, 0
v_accvgpr_write_b32 a6, 0
v_accvgpr_write_b32 a7, 0
v_accvgpr_write_b32 a8, 0
v_accvgpr_write_b32 a9, 0
v_accvgpr_write_b32 a10, 0
v_accvgpr_write_b32 a11, 0
v_accvgpr_write_b32 a12, 0
v_accvgpr_write_b32 a13, 0
v_accvgpr_write_b32 a14, 0
v_accvgpr_write_b32 a15, 0
v_accvgpr_write_b32 a16, 0
v_accvgpr_write_b32 a17, 0
v_accvgpr_write_b32 a18, 0
v_accvgpr_write_b32 a19, 0
v_accvgpr_write_b32 a20, 0
v_accvgpr_write_b32 a21, 0
v_accvgpr_write_b32 a22, 0
v_accvgpr_write_b32 a23, 0
v_accvgpr_write_b32 a24, 0
v_accvgpr_write_b32 a25, 0
v_accvgpr_write_b32 a26, 0
v_accvgpr_write_b32 a27, 0
v_accvgpr_write_b32 a28, 0
v_accvgpr_write_b32 a29, 0
v_accvgpr_write_b32 a30, 0
v_accvgpr_write_b32 a31, 0
v_accvgpr_write_b32 a32, 0
v_accvgpr_write_b32 a33, 0
v_accvgpr_write_b32 a34, 0
v_accvgpr_write_b32 a35, 0
v_accvgpr_write_b32 a36, 0
v_accvgpr_write_b32 a37, 0
v_accvgpr_write_b32 a38, 0
v_accvgpr_write_b32 a39, 0
v_accvgpr_write_b32 a40, 0
v_accvgpr_write_b32 a41, 0
v_accvgpr_write_b32 a42, 0
v_accvgpr_write_b32 a43, 0
v_accvgpr_write_b32 a44, 0
v_accvgpr_write_b32 a45, 0
v_accvgpr_write_b32 a46, 0
v_accvgpr_write_b32 a47, 0
v_accvgpr_write_b32 a48, 0
v_accvgpr_write_b32 a49, 0
v_accvgpr_write_b32 a50, 0
v_accvgpr_write_b32 a51, 0
v_accvgpr_write_b32 a52, 0
v_accvgpr_write_b32 a53, 0
v_accvgpr_write_b32 a54, 0
v_accvgpr_write_b32 a55, 0
v_accvgpr_write_b32 a56, 0
v_accvgpr_write_b32 a57, 0
v_accvgpr_write_b32 a58, 0
v_accvgpr_write_b32 a59, 0
v_accvgpr_write_b32 a60, 0
v_accvgpr_write_b32 a61, 0
v_accvgpr_write_b32 a62, 0
v_accvgpr_write_b32 a63, 0
v_accvgpr_write_b32 a64, 0
v_accvgpr_write_b32 a65, 0
v_accvgpr_write_b32 a66, 0
v_accvgpr_write_b32 a67, 0
v_accvgpr_write_b32 a68, 0
v_accvgpr_write_b32 a69, 0
v_accvgpr_write_b32 a70, 0
v_accvgpr_write_b32 a71, 0
v_accvgpr_write_b32 a72, 0
v_accvgpr_write_b32 a73, 0
v_accvgpr_write_b32 a74, 0
v_accvgpr_write_b32 a75, 0
v_accvgpr_write_b32 a76, 0
v_accvgpr_write_b32 a77, 0
v_accvgpr_write_b32 a78, 0
v_accvgpr_write_b32 a79, 0
s_branch Ll3_pos1b
Ll3_loop:
Ll3_pos0b:
s_waitcnt vmcnt(27)
v_mfma_f32_16x16x32_bf16 a[0:3], v[44:47], v[28:31], a[0:3]
v_mfma_f32_16x16x32_bf16 a[4:7], v[44:47], v[32:35], a[4:7]
v_mfma_f32_16x16x32_bf16 a[8:11], v[44:47], v[36:39], a[8:11]
v_mfma_f32_16x16x32_bf16 a[12:15], v[44:47], v[40:43], a[12:15]
buffer_load_dwordx4 v[44:47], v3, s[8:11], s31 offen offset:0
v_mfma_f32_16x16x32_bf16 a[16:19], v[48:51], v[28:31], a[16:19]
v_mfma_f32_16x16x32_bf16 a[20:23], v[48:51], v[32:35], a[20:23]
v_mfma_f32_16x16x32_bf16 a[24:27], v[48:51], v[36:39], a[24:27]
v_mfma_f32_16x16x32_bf16 a[28:31], v[48:51], v[40:43], a[28:31]
buffer_load_dwordx4 v[48:51], v3, s[8:11], s31 offen offset:1024
v_mfma_f32_16x16x32_bf16 a[32:35], v[52:55], v[28:31], a[32:35]
v_mfma_f32_16x16x32_bf16 a[36:39], v[52:55], v[32:35], a[36:39]
v_mfma_f32_16x16x32_bf16 a[40:43], v[52:55], v[36:39], a[40:43]
v_mfma_f32_16x16x32_bf16 a[44:47], v[52:55], v[40:43], a[44:47]
buffer_load_dwordx4 v[52:55], v3, s[8:11], s31 offen offset:2048
v_mfma_f32_16x16x32_bf16 a[48:51], v[56:59], v[28:31], a[48:51]
v_mfma_f32_16x16x32_bf16 a[52:55], v[56:59], v[32:35], a[52:55]
v_mfma_f32_16x16x32_bf16 a[56:59], v[56:59], v[36:39], a[56:59]
v_mfma_f32_16x16x32_bf16 a[60:63], v[56:59], v[40:43], a[60:63]
buffer_load_dwordx4 v[56:59], v3, s[8:11], s31 offen offset:3072
v_mfma_f32_16x16x32_bf16 a[64:67], v[60:63], v[28:31], a[64:67]
buffer_load_dwordx4 v[28:31], v3, s[8:11], s30 offen offset:0
v_mfma_f32_16x16x32_bf16 a[68:71], v[60:63], v[32:35], a[68:71]
buffer_load_dwordx4 v[32:35], v3, s[8:11], s30 offen offset:1024
v_mfma_f32_16x16x32_bf16 a[72:75], v[60:63], v[36:39], a[72:75]
buffer_load_dwordx4 v[36:39], v3, s[8:11], s30 offen offset:2048
v_mfma_f32_16x16x32_bf16 a[76:79], v[60:63], v[40:43], a[76:79]
buffer_load_dwordx4 v[40:43], v3, s[8:11], s30 offen offset:3072
buffer_load_dwordx4 v[60:63], v4, s[8:11], s31 offen offset:0
s_add_u32 s30, s30, 4096
s_add_u32 s31, s31, 5120
Ll3_pos1b:
s_waitcnt vmcnt(27)
v_mfma_f32_16x16x32_bf16 a[0:3], v[80:83], v[64:67], a[0:3]
v_mfma_f32_16x16x32_bf16 a[4:7], v[80:83], v[68:71], a[4:7]
v_mfma_f32_16x16x32_bf16 a[8:11], v[80:83], v[72:75], a[8:11]
v_mfma_f32_16x16x32_bf16 a[12:15], v[80:83], v[76:79], a[12:15]
buffer_load_dwordx4 v[80:83], v3, s[8:11], s31 offen offset:0
v_mfma_f32_16x16x32_bf16 a[16:19], v[84:87], v[64:67], a[16:19]
v_mfma_f32_16x16x32_bf16 a[20:23], v[84:87], v[68:71], a[20:23]
v_mfma_f32_16x16x32_bf16 a[24:27], v[84:87], v[72:75], a[24:27]
v_mfma_f32_16x16x32_bf16 a[28:31], v[84:87], v[76:79], a[28:31]
buffer_load_dwordx4 v[84:87], v3, s[8:11], s31 offen offset:1024
v_mfma_f32_16x16x32_bf16 a[32:35], v[88:91], v[64:67], a[32:35]
v_mfma_f32_16x16x32_bf16 a[36:39], v[88:91], v[68:71], a[36:39]
v_mfma_f32_16x16x32_bf16 a[40:43], v[88:91], v[72:75], a[40:43]
v_mfma_f32_16x16x32_bf16 a[44:47], v[88:91], v[76:79], a[44:47]
buffer_load_dwordx4 v[88:91], v3, s[8:11], s31 offen offset:2048
v_mfma_f32_16x16x32_bf16 a[48:51], v[92:95], v[64:67], a[48:51]
v_mfma_f32_16x16x32_bf16 a[52:55], v[92:95], v[68:71], a[52:55]
v_mfma_f32_16x16x32_bf16 a[56:59], v[92:95], v[72:75], a[56:59]
v_mfma_f32_16x16x32_bf16 a[60:63], v[92:95], v[76:79], a[60:63]
buffer_load_dwordx4 v[92:95], v3, s[8:11], s31 offen offset:3072
v_mfma_f32_16x16x32_bf16 a[64:67], v[96:99], v[64:67], a[64:67]
buffer_load_dwordx4 v[64:67], v3, s[8:11], s30 offen offset:0
v_mfma_f32_16x16x32_bf16 a[68:71], v[96:99], v[68:71], a[68:71]
buffer_load_dwordx4 v[68:71], v3, s[8:11], s30 offen offset:1024
v_mfma_f32_16x16x32_bf16 a[72:75], v[96:99], v[72:75], a[72:75]
buffer_load_dwordx4 v[72:75], v3, s[8:11], s30 offen offset:2048
v_mfma_f32_16x16x32_bf16 a[76:79], v[96:99], v[76:79], a[76:79]
buffer_load_dwordx4 v[76:79], v3, s[8:11], s30 offen offset:3072
buffer_load_dwordx4 v[96:99], v4, s[8:11], s31 offen offset:0
s_add_u32 s30, s30, 4096
s_add_u32 s31, s31, 5120
Ll3_pos2b:
s_waitcnt vmcnt(27)
v_mfma_f32_16x16x32_bf16 a[0:3], v[116:119], v[100:103], a[0:3]
v_mfma_f32_16x16x32_bf16 a[4:7], v[116:119], v[104:107], a[4:7]
v_mfma_f32_16x16x32_bf16 a[8:11], v[116:119], v[108:111], a[8:11]
v_mfma_f32_16x16x32_bf16 a[12:15], v[116:119], v[112:115], a[12:15]
buffer_load_dwordx4 v[116:119], v3, s[8:11], s31 offen offset:0
v_mfma_f32_16x16x32_bf16 a[16:19], v[120:123], v[100:103], a[16:19]
v_mfma_f32_16x16x32_bf16 a[20:23], v[120:123], v[104:107], a[20:23]
v_mfma_f32_16x16x32_bf16 a[24:27], v[120:123], v[108:111], a[24:27]
v_mfma_f32_16x16x32_bf16 a[28:31], v[120:123], v[112:115], a[28:31]
buffer_load_dwordx4 v[120:123], v3, s[8:11], s31 offen offset:1024
v_mfma_f32_16x16x32_bf16 a[32:35], v[124:127], v[100:103], a[32:35]
v_mfma_f32_16x16x32_bf16 a[36:39], v[124:127], v[104:107], a[36:39]
v_mfma_f32_16x16x32_bf16 a[40:43], v[124:127], v[108:111], a[40:43]
v_mfma_f32_16x16x32_bf16 a[44:47], v[124:127], v[112:115], a[44:47]
buffer_load_dwordx4 v[124:127], v3, s[8:11], s31 offen offset:2048
v_mfma_f32_16x16x32_bf16 a[48:51], v[128:131], v[100:103], a[48:51]
v_mfma_f32_16x16x32_bf16 a[52:55], v[128:131], v[104:107], a[52:55]
v_mfma_f32_16x16x32_bf16 a[56:59], v[128:131], v[108:111], a[56:59]
v_mfma_f32_16x16x32_bf16 a[60:63], v[128:131], v[112:115], a[60:63]
buffer_load_dwordx4 v[128:131], v3, s[8:11], s31 offen offset:3072
v_mfma_f32_16x16x32_bf16 a[64:67], v[132:135], v[100:103], a[64:67]
buffer_load_dwordx4 v[100:103], v3, s[8:11], s30 offen offset:0
v_mfma_f32_16x16x32_bf16 a[68:71], v[132:135], v[104:107], a[68:71]
buffer_load_dwordx4 v[104:107], v3, s[8:11], s30 offen offset:1024
v_mfma_f32_16x16x32_bf16 a[72:75], v[132:135], v[108:111], a[72:75]
buffer_load_dwordx4 v[108:111], v3, s[8:11], s30 offen offset:2048
v_mfma_f32_16x16x32_bf16 a[76:79], v[132:135], v[112:115], a[76:79]
buffer_load_dwordx4 v[112:115], v3, s[8:11], s30 offen offset:3072
buffer_load_dwordx4 v[132:135], v4, s[8:11], s31 offen offset:0
s_add_u32 s30, s30, 4096
s_add_u32 s31, s31, 5120
Ll3_pos3b:
s_waitcnt vmcnt(27)
v_mfma_f32_16x16x32_bf16 a[0:3], v[152:155], v[136:139], a[0:3]
v_mfma_f32_16x16x32_bf16 a[4:7], v[152:155], v[140:143], a[4:7]
v_mfma_f32_16x16x32_bf16 a[8:11], v[152:155], v[144:147], a[8:11]
v_mfma_f32_16x16x32_bf16 a[12:15], v[152:155], v[148:151], a[12:15]
buffer_load_dwordx4 v[152:155], v3, s[8:11], s31 offen offset:0
v_mfma_f32_16x16x32_bf16 a[16:19], v[156:159], v[136:139], a[16:19]
v_mfma_f32_16x16x32_bf16 a[20:23], v[156:159], v[140:143], a[20:23]
v_mfma_f32_16x16x32_bf16 a[24:27], v[156:159], v[144:147], a[24:27]
v_mfma_f32_16x16x32_bf16 a[28:31], v[156:159], v[148:151], a[28:31]
buffer_load_dwordx4 v[156:159], v3, s[8:11], s31 offen offset:1024
v_mfma_f32_16x16x32_bf16 a[32:35], v[160:163], v[136:139], a[32:35]
v_mfma_f32_16x16x32_bf16 a[36:39], v[160:163], v[140:143], a[36:39]
v_mfma_f32_16x16x32_bf16 a[40:43], v[160:163], v[144:147], a[40:43]
v_mfma_f32_16x16x32_bf16 a[44:47], v[160:163], v[148:151], a[44:47]
buffer_load_dwordx4 v[160:163], v3, s[8:11], s31 offen offset:2048
v_mfma_f32_16x16x32_bf16 a[48:51], v[164:167], v[136:139], a[48:51]
v_mfma_f32_16x16x32_bf16 a[52:55], v[164:167], v[140:143], a[52:55]
v_mfma_f32_16x16x32_bf16 a[56:59], v[164:167], v[144:147], a[56:59]
v_mfma_f32_16x16x32_bf16 a[60:63], v[164:167], v[148:151], a[60:63]
buffer_load_dwordx4 v[164:167], v3, s[8:11], s31 offen offset:3072
v_mfma_f32_16x16x32_bf16 a[64:67], v[168:171], v[136:139], a[64:67]
buffer_load_dwordx4 v[136:139], v3, s[8:11], s30 offen offset:0
v_mfma_f32_16x16x32_bf16 a[68:71], v[168:171], v[140:143], a[68:71]
buffer_load_dwordx4 v[140:143], v3, s[8:11], s30 offen offset:1024
v_mfma_f32_16x16x32_bf16 a[72:75], v[168:171], v[144:147], a[72:75]
buffer_load_dwordx4 v[144:147], v3, s[8:11], s30 offen offset:2048
v_mfma_f32_16x16x32_bf16 a[76:79], v[168:171], v[148:151], a[76:79]
buffer_load_dwordx4 v[148:151], v3, s[8:11], s30 offen offset:3072
buffer_load_dwordx4 v[168:171], v4, s[8:11], s31 offen offset:0
s_add_u32 s30, s30, 4096
s_add_u32 s31, s31, 5120
s_sub_u32 s38, s38, 1
s_cmp_lg_u32 s38, 0
s_cbranch_scc1 Ll3_loop
s_waitcnt vmcnt(27)
v_mfma_f32_16x16x32_bf16 a[0:3], v[44:47], v[28:31], a[0:3]
v_mfma_f32_16x16x32_bf16 a[4:7], v[44:47], v[32:35], a[4:7]
v_mfma_f32_16x16x32_bf16 a[8:11], v[44:47], v[36:39], a[8:11]
v_mfma_f32_16x16x32_bf16 a[12:15], v[44:47], v[40:43], a[12:15]
v_mfma_f32_16x16x32_bf16 a[16:19], v[48:51], v[28:31], a[16:19]
v_mfma_f32_16x16x32_bf16 a[20:23], v[48:51], v[32:35], a[20:23]
v_mfma_f32_16x16x32_bf16 a[24:27], v[48:51], v[36:39], a[24:27]
v_mfma_f32_16x16x32_bf16 a[28:31], v[48:51], v[40:43], a[28:31]
v_mfma_f32_16x16x32_bf16 a[32:35], v[52:55], v[28:31], a[32:35]
v_mfma_f32_16x16x32_bf16 a[36:39], v[52:55], v[32:35], a[36:39]
v_mfma_f32_16x16x32_bf16 a[40:43], v[52:55], v[36:39], a[40:43]
v_mfma_f32_16x16x32_bf16 a[44:47], v[52:55], v[40:43], a[44:47]
v_mfma_f32_16x16x32_bf16 a[48:51], v[56:59], v[28:31], a[48:51]
v_mfma_f32_16x16x32_bf16 a[52:55], v[56:59], v[32:35], a[52:55]
v_mfma_f32_16x16x32_bf16 a[56:59], v[56:59], v[36:39], a[56:59]
v_mfma_f32_16x16x32_bf16 a[60:63], v[56:59], v[40:43], a[60:63]
v_mfma_f32_16x16x32_bf16 a[64:67], v[60:63], v[28:31], a[64:67]
v_mfma_f32_16x16x32_bf16 a[68:71], v[60:63], v[32:35], a[68:71]
v_mfma_f32_16x16x32_bf16 a[72:75], v[60:63], v[36:39], a[72:75]
v_mfma_f32_16x16x32_bf16 a[76:79], v[60:63], v[40:43], a[76:79]
s_waitcnt vmcnt(18)
v_mfma_f32_16x16x32_bf16 a[0:3], v[80:83], v[64:67], a[0:3]
v_mfma_f32_16x16x32_bf16 a[4:7], v[80:83], v[68:71], a[4:7]
v_mfma_f32_16x16x32_bf16 a[8:11], v[80:83], v[72:75], a[8:11]
v_mfma_f32_16x16x32_bf16 a[12:15], v[80:83], v[76:79], a[12:15]
v_mfma_f32_16x16x32_bf16 a[16:19], v[84:87], v[64:67], a[16:19]
v_mfma_f32_16x16x32_bf16 a[20:23], v[84:87], v[68:71], a[20:23]
v_mfma_f32_16x16x32_bf16 a[24:27], v[84:87], v[72:75], a[24:27]
v_mfma_f32_16x16x32_bf16 a[28:31], v[84:87], v[76:79], a[28:31]
v_mfma_f32_16x16x32_bf16 a[32:35], v[88:91], v[64:67], a[32:35]
v_mfma_f32_16x16x32_bf16 a[36:39], v[88:91], v[68:71], a[36:39]
v_mfma_f32_16x16x32_bf16 a[40:43], v[88:91], v[72:75], a[40:43]
v_mfma_f32_16x16x32_bf16 a[44:47], v[88:91], v[76:79], a[44:47]
v_mfma_f32_16x16x32_bf16 a[48:51], v[92:95], v[64:67], a[48:51]
v_mfma_f32_16x16x32_bf16 a[52:55], v[92:95], v[68:71], a[52:55]
v_mfma_f32_16x16x32_bf16 a[56:59], v[92:95], v[72:75], a[56:59]
v_mfma_f32_16x16x32_bf16 a[60:63], v[92:95], v[76:79], a[60:63]
v_mfma_f32_16x16x32_bf16 a[64:67], v[96:99], v[64:67], a[64:67]
v_mfma_f32_16x16x32_bf16 a[68:71], v[96:99], v[68:71], a[68:71]
v_mfma_f32_16x16x32_bf16 a[72:75], v[96:99], v[72:75], a[72:75]
v_mfma_f32_16x16x32_bf16 a[76:79], v[96:99], v[76:79], a[76:79]
s_waitcnt vmcnt(9)
v_mfma_f32_16x16x32_bf16 a[0:3], v[116:119], v[100:103], a[0:3]
v_mfma_f32_16x16x32_bf16 a[4:7], v[116:119], v[104:107], a[4:7]
v_mfma_f32_16x16x32_bf16 a[8:11], v[116:119], v[108:111], a[8:11]
v_mfma_f32_16x16x32_bf16 a[12:15], v[116:119], v[112:115], a[12:15]
v_mfma_f32_16x16x32_bf16 a[16:19], v[120:123], v[100:103], a[16:19]
v_mfma_f32_16x16x32_bf16 a[20:23], v[120:123], v[104:107], a[20:23]
v_mfma_f32_16x16x32_bf16 a[24:27], v[120:123], v[108:111], a[24:27]
v_mfma_f32_16x16x32_bf16 a[28:31], v[120:123], v[112:115], a[28:31]
v_mfma_f32_16x16x32_bf16 a[32:35], v[124:127], v[100:103], a[32:35]
v_mfma_f32_16x16x32_bf16 a[36:39], v[124:127], v[104:107], a[36:39]
v_mfma_f32_16x16x32_bf16 a[40:43], v[124:127], v[108:111], a[40:43]
v_mfma_f32_16x16x32_bf16 a[44:47], v[124:127], v[112:115], a[44:47]
v_mfma_f32_16x16x32_bf16 a[48:51], v[128:131], v[100:103], a[48:51]
v_mfma_f32_16x16x32_bf16 a[52:55], v[128:131], v[104:107], a[52:55]
v_mfma_f32_16x16x32_bf16 a[56:59], v[128:131], v[108:111], a[56:59]
v_mfma_f32_16x16x32_bf16 a[60:63], v[128:131], v[112:115], a[60:63]
v_mfma_f32_16x16x32_bf16 a[64:67], v[132:135], v[100:103], a[64:67]
v_mfma_f32_16x16x32_bf16 a[68:71], v[132:135], v[104:107], a[68:71]
v_mfma_f32_16x16x32_bf16 a[72:75], v[132:135], v[108:111], a[72:75]
v_mfma_f32_16x16x32_bf16 a[76:79], v[132:135], v[112:115], a[76:79]
s_waitcnt vmcnt(0)
v_mfma_f32_16x16x32_bf16 a[0:3], v[152:155], v[136:139], a[0:3]
v_mfma_f32_16x16x32_bf16 a[4:7], v[152:155], v[140:143], a[4:7]
v_mfma_f32_16x16x32_bf16 a[8:11], v[152:155], v[144:147], a[8:11]
v_mfma_f32_16x16x32_bf16 a[12:15], v[152:155], v[148:151], a[12:15]
v_mfma_f32_16x16x32_bf16 a[16:19], v[156:159], v[136:139], a[16:19]
v_mfma_f32_16x16x32_bf16 a[20:23], v[156:159], v[140:143], a[20:23]
v_mfma_f32_16x16x32_bf16 a[24:27], v[156:159], v[144:147], a[24:27]
v_mfma_f32_16x16x32_bf16 a[28:31], v[156:159], v[148:151], a[28:31]
v_mfma_f32_16x16x32_bf16 a[32:35], v[160:163], v[136:139], a[32:35]
v_mfma_f32_16x16x32_bf16 a[36:39], v[160:163], v[140:143], a[36:39]
v_mfma_f32_16x16x32_bf16 a[40:43], v[160:163], v[144:147], a[40:43]
v_mfma_f32_16x16x32_bf16 a[44:47], v[160:163], v[148:151], a[44:47]
v_mfma_f32_16x16x32_bf16 a[48:51], v[164:167], v[136:139], a[48:51]
v_mfma_f32_16x16x32_bf16 a[52:55], v[164:167], v[140:143], a[52:55]
v_mfma_f32_16x16x32_bf16 a[56:59], v[164:167], v[144:147], a[56:59]
v_mfma_f32_16x16x32_bf16 a[60:63], v[164:167], v[148:151], a[60:63]
v_mfma_f32_16x16x32_bf16 a[64:67], v[168:171], v[136:139], a[64:67]
v_mfma_f32_16x16x32_bf16 a[68:71], v[168:171], v[140:143], a[68:71]
v_mfma_f32_16x16x32_bf16 a[72:75], v[168:171], v[144:147], a[72:75]
v_mfma_f32_16x16x32_bf16 a[76:79], v[168:171], v[148:151], a[76:79]
s_mul_i32 s39, s24, 20480
v_add_u32 v4, s39, v3
s_nop 7
ds_write_b128 v4, a[0:3] offset:0
ds_write_b128 v4, a[4:7] offset:1024
ds_write_b128 v4, a[8:11] offset:2048
ds_write_b128 v4, a[12:15] offset:3072
ds_write_b128 v4, a[16:19] offset:4096
ds_write_b128 v4, a[20:23] offset:5120
ds_write_b128 v4, a[24:27] offset:6144
ds_write_b128 v4, a[28:31] offset:7168
ds_write_b128 v4, a[32:35] offset:8192
ds_write_b128 v4, a[36:39] offset:9216
ds_write_b128 v4, a[40:43] offset:10240
ds_write_b128 v4, a[44:47] offset:11264
ds_write_b128 v4, a[48:51] offset:12288
ds_write_b128 v4, a[52:55] offset:13312
ds_write_b128 v4, a[56:59] offset:14336
ds_write_b128 v4, a[60:63] offset:15360
ds_write_b128 v4, a[64:67] offset:16384
ds_write_b128 v4, a[68:71] offset:17408
ds_write_b128 v4, a[72:75] offset:18432
ds_write_b128 v4, a[76:79] offset:19456
s_lshl_b32 s39, s24, 10
v_add_u32 v4, s39, v3
v_add_u32 v5, 0x14000, v4
v_mov_b32 v9, 0xffff0000
s_waitcnt lgkmcnt(0)
s_barrier
v_add_u32 v6, 0x8000, v4
v_add_u32 v1, 0x8000, v5
ds_read_b128 v[28:31], v4 offset:0
ds_read_b128 v[32:35], v4 offset:20480
ds_read_b128 v[36:39], v4 offset:40960
ds_read_b128 v[40:43], v4 offset:61440
ds_read_b128 v[44:47], v5 offset:0
ds_read_b128 v[48:51], v5 offset:20480
ds_read_b128 v[52:55], v5 offset:40960
ds_read_b128 v[56:59], v5 offset:61440
ds_read_b128 v[60:63], v4 offset:8192
ds_read_b128 v[64:67], v4 offset:28672
ds_read_b128 v[68:71], v4 offset:49152
ds_read_b128 v[72:75], v6 offset:36864
ds_read_b128 v[76:79], v5 offset:8192
ds_read_b128 v[80:83], v5 offset:28672
ds_read_b128 v[84:87], v5 offset:49152
ds_read_b128 v[88:91], v1 offset:36864
s_cmp_ge_u32 s24, 4
s_cbranch_scc1 Ll3_two
s_waitcnt lgkmcnt(8)
ds_read_b128 v[92:95], v4 offset:16384
ds_read_b128 v[96:99], v4 offset:36864
ds_read_b128 v[100:103], v4 offset:57344
ds_read_b128 v[104:107], v6 offset:45056
ds_read_b128 v[108:111], v5 offset:16384
ds_read_b128 v[112:115], v5 offset:36864
ds_read_b128 v[116:119], v5 offset:57344
ds_read_b128 v[120:123], v1 offset:45056
v_add_f32 v28, v28, v32
v_add_f32 v36, v36, v40
v_add_f32 v44, v44, v48
v_add_f32 v52, v52, v56
v_add_f32 v29, v29, v33
v_add_f32 v37, v37, v41
v_add_f32 v45, v45, v49
v_add_f32 v53, v53, v57
v_add_f32 v30, v30, v34
v_add_f32 v38, v38, v42
v_add_f32 v46, v46, v50
v_add_f32 v54, v54, v58
v_add_f32 v31, v31, v35
v_add_f32 v39, v39, v43
v_add_f32 v47, v47, v51
v_add_f32 v55, v55, v59
v_add_f32 v28, v28, v36
v_add_f32 v28, v28, v44
v_add_f32 v29, v29, v37
v_add_f32 v29, v29, v45
v_add_f32 v30, v30, v38
v_add_f32 v30, v30, v46
v_add_f32 v31, v31, v39
v_add_f32 v31, v31, v47
v_lshlrev_b32 v130, 16, v16
v_and_b32 v131, v9, v16
v_lshlrev_b32 v134, 16, v10
v_and_b32 v135, v9, v10
v_lshlrev_b32 v132, 16, v17
v_and_b32 v133, v9, v17
v_lshlrev_b32 v136, 16, v11
v_and_b32 v137, v9, v11
v_add_f32 v130, v130, v52
v_add_f32 v131, v131, v53
v_add_f32 v132, v132, v54
v_add_f32 v133, v133, v55
v_mul_f32 v138, 0xbfb8aa3b, v130
v_mul_f32 v139, 0xbfb8aa3b, v131
v_mul_f32 v140, 0xbfb8aa3b, v132
v_mul_f32 v141, 0xbfb8aa3b, v133
v_exp_f32 v138, v138
v_exp_f32 v139, v139
v_exp_f32 v140, v140
v_exp_f32 v141, v141
v_add_f32 v138, 1.0, v138
v_add_f32 v139, 1.0, v139
v_add_f32 v140, 1.0, v140
v_add_f32 v141, 1.0, v141
v_rcp_f32 v138, v138
v_rcp_f32 v139, v139
v_rcp_f32 v140, v140
v_rcp_f32 v141, v141
v_mul_f32 v130, v130, v138
v_mul_f32 v131, v131, v139
v_mul_f32 v132, v132, v140
v_mul_f32 v133, v133, v141
v_fma_f32 v130, v130, v28, v134
v_fma_f32 v131, v131, v29, v135
v_fma_f32 v132, v132, v30, v136
v_fma_f32 v133, v133, v31, v137
v_cvt_pk_bf16_f32 v28, v130, v131
v_cvt_pk_bf16_f32 v29, v132, v133
buffer_store_dwordx2 v[28:29], v7, s[12:15], s35 offen offset:0
s_waitcnt lgkmcnt(8)
v_add_f32 v60, v60, v64
v_add_f32 v68, v68, v72
v_add_f32 v76, v76, v80
v_add_f32 v84, v84, v88
v_add_f32 v61, v61, v65
v_add_f32 v69, v69, v73
v_add_f32 v77, v77, v81
v_add_f32 v85, v85, v89
v_add_f32 v62, v62, v66
v_add_f32 v70, v70, v74
v_add_f32 v78, v78, v82
v_add_f32 v86, v86, v90
v_add_f32 v63, v63, v67
v_add_f32 v71, v71, v75
v_add_f32 v79, v79, v83
v_add_f32 v87, v87, v91
v_add_f32 v60, v60, v68
v_add_f32 v60, v60, v76
v_add_f32 v61, v61, v69
v_add_f32 v61, v61, v77
v_add_f32 v62, v62, v70
v_add_f32 v62, v62, v78
v_add_f32 v63, v63, v71
v_add_f32 v63, v63, v79
v_lshlrev_b32 v130, 16, v18
v_and_b32 v131, v9, v18
v_lshlrev_b32 v134, 16, v12
v_and_b32 v135, v9, v12
v_lshlrev_b32 v132, 16, v19
v_and_b32 v133, v9, v19
v_lshlrev_b32 v136, 16, v13
v_and_b32 v137, v9, v13
v_add_f32 v130, v130, v84
v_add_f32 v131, v131, v85
v_add_f32 v132, v132, v86
v_add_f32 v133, v133, v87
v_mul_f32 v138, 0xbfb8aa3b, v130
v_mul_f32 v139, 0xbfb8aa3b, v131
v_mul_f32 v140, 0xbfb8aa3b, v132
v_mul_f32 v141, 0xbfb8aa3b, v133
v_exp_f32 v138, v138
v_exp_f32 v139, v139
v_exp_f32 v140, v140
v_exp_f32 v141, v141
v_add_f32 v138, 1.0, v138
v_add_f32 v139, 1.0, v139
v_add_f32 v140, 1.0, v140
v_add_f32 v141, 1.0, v141
v_rcp_f32 v138, v138
v_rcp_f32 v139, v139
v_rcp_f32 v140, v140
v_rcp_f32 v141, v141
v_mul_f32 v130, v130, v138
v_mul_f32 v131, v131, v139
v_mul_f32 v132, v132, v140
v_mul_f32 v133, v133, v141
v_fma_f32 v130, v130, v60, v134
v_fma_f32 v131, v131, v61, v135
v_fma_f32 v132, v132, v62, v136
v_fma_f32 v133, v133, v63, v137
v_cvt_pk_bf16_f32 v60, v130, v131
v_cvt_pk_bf16_f32 v61, v132, v133
buffer_store_dwordx2 v[60:61], v7, s[12:15], s35 offen offset:64
s_waitcnt lgkmcnt(0)
v_add_f32 v92, v92, v96
v_add_f32 v100, v100, v104
v_add_f32 v108, v108, v112
v_add_f32 v116, v116, v120
v_add_f32 v93, v93, v97
v_add_f32 v101, v101, v105
v_add_f32 v109, v109, v113
v_add_f32 v117, v117, v121
v_add_f32 v94, v94, v98
v_add_f32 v102, v102, v106
v_add_f32 v110, v110, v114
v_add_f32 v118, v118, v122
v_add_f32 v95, v95, v99
v_add_f32 v103, v103, v107
v_add_f32 v111, v111, v115
v_add_f32 v119, v119, v123
v_add_f32 v92, v92, v100
v_add_f32 v92, v92, v108
v_add_f32 v93, v93, v101
v_add_f32 v93, v93, v109
v_add_f32 v94, v94, v102
v_add_f32 v94, v94, v110
v_add_f32 v95, v95, v103
v_add_f32 v95, v95, v111
v_lshlrev_b32 v130, 16, v20
v_and_b32 v131, v9, v20
v_lshlrev_b32 v134, 16, v14
v_and_b32 v135, v9, v14
v_lshlrev_b32 v132, 16, v21
v_and_b32 v133, v9, v21
v_lshlrev_b32 v136, 16, v15
v_and_b32 v137, v9, v15
v_add_f32 v130, v130, v116
v_add_f32 v131, v131, v117
v_add_f32 v132, v132, v118
v_add_f32 v133, v133, v119
v_mul_f32 v138, 0xbfb8aa3b, v130
v_mul_f32 v139, 0xbfb8aa3b, v131
v_mul_f32 v140, 0xbfb8aa3b, v132
v_mul_f32 v141, 0xbfb8aa3b, v133
v_exp_f32 v138, v138
v_exp_f32 v139, v139
v_exp_f32 v140, v140
v_exp_f32 v141, v141
v_add_f32 v138, 1.0, v138
v_add_f32 v139, 1.0, v139
v_add_f32 v140, 1.0, v140
v_add_f32 v141, 1.0, v141
v_rcp_f32 v138, v138
v_rcp_f32 v139, v139
v_rcp_f32 v140, v140
v_rcp_f32 v141, v141
v_mul_f32 v130, v130, v138
v_mul_f32 v131, v131, v139
v_mul_f32 v132, v132, v140
v_mul_f32 v133, v133, v141
v_fma_f32 v130, v130, v92, v134
v_fma_f32 v131, v131, v93, v135
v_fma_f32 v132, v132, v94, v136
v_fma_f32 v133, v133, v95, v137
v_cvt_pk_bf16_f32 v92, v130, v131
v_cvt_pk_bf16_f32 v93, v132, v133
buffer_store_dwordx2 v[92:93], v7, s[12:15], s35 offen offset:128
s_endpgm
Ll3_two:
s_waitcnt lgkmcnt(8)
v_add_f32 v28, v28, v32
v_add_f32 v36, v36, v40
v_add_f32 v44, v44, v48
v_add_f32 v52, v52, v56
v_add_f32 v29, v29, v33
v_add_f32 v37, v37, v41
v_add_f32 v45, v45, v49
v_add_f32 v53, v53, v57
v_add_f32 v30, v30, v34
v_add_f32 v38, v38, v42
v_add_f32 v46, v46, v50
v_add_f32 v54, v54, v58
v_add_f32 v31, v31, v35
v_add_f32 v39, v39, v43
v_add_f32 v47, v47, v51
v_add_f32 v55, v55, v59
v_add_f32 v28, v28, v36
v_add_f32 v28, v28, v44
v_add_f32 v29, v29, v37
v_add_f32 v29, v29, v45
v_add_f32 v30, v30, v38
v_add_f32 v30, v30, v46
v_add_f32 v31, v31, v39
v_add_f32 v31, v31, v47
v_lshlrev_b32 v130, 16, v16
v_and_b32 v131, v9, v16
v_lshlrev_b32 v134, 16, v10
v_and_b32 v135, v9, v10
v_lshlrev_b32 v132, 16, v17
v_and_b32 v133, v9, v17
v_lshlrev_b32 v136, 16, v11
v_and_b32 v137, v9, v11
v_add_f32 v130, v130, v52
v_add_f32 v131, v131, v53
v_add_f32 v132, v132, v54
v_add_f32 v133, v133, v55
v_mul_f32 v138, 0xbfb8aa3b, v130
v_mul_f32 v139, 0xbfb8aa3b, v131
v_mul_f32 v140, 0xbfb8aa3b, v132
v_mul_f32 v141, 0xbfb8aa3b, v133
v_exp_f32 v138, v138
v_exp_f32 v139, v139
v_exp_f32 v140, v140
v_exp_f32 v141, v141
v_add_f32 v138, 1.0, v138
v_add_f32 v139, 1.0, v139
v_add_f32 v140, 1.0, v140
v_add_f32 v141, 1.0, v141
v_rcp_f32 v138, v138
v_rcp_f32 v139, v139
v_rcp_f32 v140, v140
v_rcp_f32 v141, v141
v_mul_f32 v130, v130, v138
v_mul_f32 v131, v131, v139
v_mul_f32 v132, v132, v140
v_mul_f32 v133, v133, v141
v_fma_f32 v130, v130, v28, v134
v_fma_f32 v131, v131, v29, v135
v_fma_f32 v132, v132, v30, v136
v_fma_f32 v133, v133, v31, v137
v_cvt_pk_bf16_f32 v28, v130, v131
v_cvt_pk_bf16_f32 v29, v132, v133
buffer_store_dwordx2 v[28:29], v7, s[12:15], s35 offen offset:0
s_waitcnt lgkmcnt(0)
v_add_f32 v60, v60, v64
v_add_f32 v68, v68, v72
v_add_f32 v76, v76, v80
v_add_f32 v84, v84, v88
v_add_f32 v61, v61, v65
v_add_f32 v69, v69, v73
v_add_f32 v77, v77, v81
v_add_f32 v85, v85, v89
v_add_f32 v62, v62, v66
v_add_f32 v70, v70, v74
v_add_f32 v78, v78, v82
v_add_f32 v86, v86, v90
v_add_f32 v63, v63, v67
v_add_f32 v71, v71, v75
v_add_f32 v79, v79, v83
v_add_f32 v87, v87, v91
v_add_f32 v60, v60, v68
v_add_f32 v60, v60, v76
v_add_f32 v61, v61, v69
v_add_f32 v61, v61, v77
v_add_f32 v62, v62, v70
v_add_f32 v62, v62, v78
v_add_f32 v63, v63, v71
v_add_f32 v63, v63, v79
v_lshlrev_b32 v130, 16, v18
v_and_b32 v131, v9, v18
v_lshlrev_b32 v134, 16, v12
v_and_b32 v135, v9, v12
v_lshlrev_b32 v132, 16, v19
v_and_b32 v133, v9, v19
v_lshlrev_b32 v136, 16, v13
v_and_b32 v137, v9, v13
v_add_f32 v130, v130, v84
v_add_f32 v131, v131, v85
v_add_f32 v132, v132, v86
v_add_f32 v133, v133, v87
v_mul_f32 v138, 0xbfb8aa3b, v130
v_mul_f32 v139, 0xbfb8aa3b, v131
v_mul_f32 v140, 0xbfb8aa3b, v132
v_mul_f32 v141, 0xbfb8aa3b, v133
v_exp_f32 v138, v138
v_exp_f32 v139, v139
v_exp_f32 v140, v140
v_exp_f32 v141, v141
v_add_f32 v138, 1.0, v138
v_add_f32 v139, 1.0, v139
v_add_f32 v140, 1.0, v140
v_add_f32 v141, 1.0, v141
v_rcp_f32 v138, v138
v_rcp_f32 v139, v139
v_rcp_f32 v140, v140
v_rcp_f32 v141, v141
v_mul_f32 v130, v130, v138
v_mul_f32 v131, v131, v139
v_mul_f32 v132, v132, v140
v_mul_f32 v133, v133, v141
v_fma_f32 v130, v130, v60, v134
v_fma_f32 v131, v131, v61, v135
v_fma_f32 v132, v132, v62, v136
v_fma_f32 v133, v133, v63, v137
v_cvt_pk_bf16_f32 v60, v130, v131
v_cvt_pk_bf16_f32 v61, v132, v133
buffer_store_dwordx2 v[60:61], v7, s[12:15], s35 offen offset:64
Ll3_end:
s_endpgm
.section .rodata,"a"
.p2align 6
.amdhsa_kernel l1_kernel
  .amdhsa_next_free_vgpr 256
  .amdhsa_next_free_sgpr 100
  .amdhsa_accum_offset 128
  .amdhsa_group_segment_fixed_size 0
  .amdhsa_kernarg_size 112
  .amdhsa_user_sgpr_count 2
  .amdhsa_user_sgpr_kernarg_segment_ptr 1
  .amdhsa_system_sgpr_workgroup_id_x 1
.end_amdhsa_kernel
.p2align 6
.amdhsa_kernel l2_kernel
  .amdhsa_next_free_vgpr 256
  .amdhsa_next_free_sgpr 100
  .amdhsa_accum_offset 256
  .amdhsa_group_segment_fixed_size 0
  .amdhsa_kernarg_size 112
  .amdhsa_user_sgpr_count 2
  .amdhsa_user_sgpr_kernarg_segment_ptr 1
  .amdhsa_system_sgpr_workgroup_id_x 1
.end_amdhsa_kernel
.p2align 6
.amdhsa_kernel l3_kernel
  .amdhsa_next_free_vgpr 252
  .amdhsa_next_free_sgpr 100
  .amdhsa_accum_offset 172
  .amdhsa_group_segment_fixed_size 0
  .amdhsa_kernarg_size 112
  .amdhsa_user_sgpr_count 2
  .amdhsa_user_sgpr_kernarg_segment_ptr 1
  .amdhsa_system_sgpr_workgroup_id_x 1
.end_amdhsa_kernel
```
